```python
import torch

def _softmax(x, axis=-1):
    return torch.softmax(x, dim=axis)
def _gelu(x):
    return torch.nn.functional.gelu(x, approximate="tanh")
def _silu(x):
    return torch.nn.functional.silu(x)
def _sigmoid(x):
    return torch.sigmoid(x)
def _layernorm(x, axis=-1, eps=1e-5):
    m = x.mean(dim=axis, keepdim=True)
    v = x.var(dim=axis, keepdim=True, unbiased=False)
    return (x - m) / torch.sqrt(v + eps)
def _scatter_add(tgt, idx, src, axis=0):
    return tgt.clone().index_add_(axis, idx, src)
def _segment_sum(src, seg, n):
    out = torch.zeros((n,) + src.shape[1:], dtype=src.dtype)
    return out.index_add_(0, seg, src)
def _pad(x, pw):
    flat = tuple(v for pair in reversed(pw) for v in pair)
    return torch.nn.functional.pad(x, flat)

kernel_name = 'gated_mix__compressed_kv_cla__dense_activation_relu__prompt'

def setup_inputs():

    _w = (lambda a: (lambda t: t.to(torch.bfloat16) if t.is_floating_point() else t)(torch.as_tensor(a)))
    def _A_setup():
        B, H, Sq, Sk, D, M = 1, 16, 2048, 2048, 256, 448
        Dc = 4 * D
        return {
            "x": _w((lambda *s: torch.randn(*s, dtype=torch.bfloat16) * 0.05)(B, Sq, M)),
            "c_kv": _w((lambda *s: torch.randn(*s, dtype=torch.bfloat16) * 0.8)(B, Sk, Dc)),
            "w_q": _w((lambda *s: torch.randn(*s, dtype=torch.bfloat16) * 6.4)(M, H, D) * (M ** -0.5)),
            "w_uk": _w((lambda *s: torch.randn(*s, dtype=torch.bfloat16) * 6.4)(Dc, H, D) * (Dc ** -0.5)),
            "w_uv": _w((lambda *s: torch.randn(*s, dtype=torch.bfloat16) * 0.8)(Dc, H, D) * (Dc ** -0.5)),
            "w_o": _w((lambda *s: torch.randn(*s, dtype=torch.bfloat16) * 0.8)(H, D, M) * ((H * D) ** -0.5)),
        }
    _A_in = _A_setup()

    def _B_setup():
        B, S, D, Dff = 1, 2048, 448, 1792
        return {
            "x": _w((lambda *s: torch.randn(*s, dtype=torch.bfloat16) * 0.05)(B, S, D)),
            "w1": _w((lambda *s: torch.randn(*s, dtype=torch.bfloat16) * 0.05)(D, Dff)),
            "w2": _w((lambda *s: torch.randn(*s, dtype=torch.bfloat16) * 0.05)(Dff, D)),
        }
    _B_in = _B_setup()

    return {
        "A_x": _A_in["x"],
        "A_c_kv": _A_in["c_kv"],
        "A_w_q": _A_in["w_q"],
        "A_w_uk": _A_in["w_uk"],
        "A_w_uv": _A_in["w_uv"],
        "A_w_o": _A_in["w_o"],
        "B_x": _B_in["x"],
        "B_w1": _B_in["w1"],
        "B_w2": _B_in["w2"],
        "gate_w": _w((lambda *s: torch.randn(*s, dtype=torch.bfloat16) * 0.05)(448) * 16.0),
    }

def reference(A_x, A_c_kv, A_w_q, A_w_uk, A_w_uv, A_w_o, B_x, B_w1, B_w2, gate_w):
    def _A_ref(x, c_kv, w_q, w_uk, w_uv, w_o):
        B, Sq, M = x.shape[0], x.shape[1], x.shape[2]
        Sk = c_kv.shape[1]
        H, D = w_q.shape[1], w_q.shape[2]
        q = torch.einsum("bqm,mhd->bhqd", x, w_q)
        k = torch.einsum("bkc,chd->bhkd", c_kv, w_uk)
        v = torch.einsum("bkc,chd->bhkd", c_kv, w_uv)
        scores = torch.einsum("bhqd,bhkd->bhqk", q, k) * (D ** -0.5)
        off = Sk - Sq
        qi = torch.arange(Sq)[:, None]
        kj = torch.arange(Sk)[None, :]
        cmask = kj <= (qi + off)
        scores = torch.where(cmask[None, None], scores, -1e9)
        p = _softmax(scores, axis=-1)
        ctx = torch.einsum("bhqk,bhkd->bhqd", p, v)
        return torch.einsum("bhqd,hdm->bqm", ctx, w_o)

    def _B_ref(x, w1, w2):
        h = torch.einsum("bsd,df->bsf", x, w1)
        zero = torch.zeros_like(h)
        h = torch.maximum(h, zero)
        return torch.einsum("bsf,fd->bsd", h, w2)

    x = A_x
    g = _sigmoid((x * gate_w).sum(-1, keepdims=True))
    a = _A_ref(x, A_c_kv, A_w_q, A_w_uk, A_w_uv, A_w_o)
    b = _B_ref(x, B_w1, B_w2)
    return g * a + (1 - g) * b
```

```asm
; @launch grid=(256,1,1) block=(256,1,1) lds=148480
.amdgcn_target "amdgcn-amd-amdhsa--gfx950"
.text
.globl gated_mix__compressed_kv_cla__dense_activation_relu__prompt_kernel
.p2align 8
.type gated_mix__compressed_kv_cla__dense_activation_relu__prompt_kernel,@function
gated_mix__compressed_kv_cla__dense_activation_relu__prompt_kernel:
s_cmp_ge_u32 s2, 256
s_cbranch_scc1 mix_done
s_getpc_b64 s[82:83]
k1_pc0:
s_lshr_b32 s84, s2, 3
s_and_b32 s84, s84, 3
s_lshl_b32 s84, s84, 15
v_lshlrev_b32 v30, 7, v0
v_add_u32 v30, s84, v30
v_min_u32 v30, mix_end-k1_pc0, v30
v_mov_b32 v33, s83
v_add_co_u32 v32, vcc, s82, v30
v_addc_co_u32 v33, vcc, 0, v33, vcc
global_load_dword v34, v[32:33], off
s_load_dwordx4 s[36:39], s[0:1], 0
s_load_dwordx4 s[44:47], s[0:1], 24
s_load_dwordx2 s[42:43], s[0:1], 96
s_load_dwordx2 s[48:49], s[0:1], 16
s_load_dwordx2 s[74:75], s[0:1], 56
s_load_dwordx2 s[76:77], s[0:1], 72
s_and_b32 s50, s2, 7
s_lshr_b32 s51, s2, 3
s_lshr_b32 s52, s51, 3
s_lshl_b32 s53, s50, 2
s_add_u32 s52, s52, s53
s_lshr_b32 s53, s52, 1
s_and_b32 s54, s52, 1
s_and_b32 s55, s51, 7
s_lshr_b32 s78, s51, 4
s_lshl_b32 s79, s50, 1
s_add_u32 s78, s78, s79
s_and_b32 s79, s51, 15
v_lshrrev_b32 v5, 6, v0
v_and_b32 v6, 63, v0
s_nop 0
v_readfirstlane_b32 s56, v5
s_nop 3
s_lshr_b32 s57, s56, 1
s_and_b32 s58, s56, 1
s_lshl_b32 s80, s79, 2
s_add_u32 s80, s80, s56
v_lshrrev_b32 v7, 3, v6
v_lshlrev_b32 v24, 11, v7
v_and_b32 v25, 7, v6
v_lshrrev_b32 v26, 4, v6
v_xor_b32 v27, v25, v26
v_lshl_add_u32 v1, v27, 4, v24
v_xor_b32 v27, 4, v27
v_lshl_add_u32 v2, v27, 4, v24
v_lshrrev_b32 v7, 5, v6
v_lshlrev_b32 v24, 13, v7
v_and_b32 v25, 31, v6
v_lshlrev_b32 v26, 2, v7
v_xor_b32 v27, v25, v26
v_lshl_add_u32 v3, v27, 4, v24
v_xor_b32 v27, 8, v27
v_lshl_add_u32 v4, v27, 4, v24
v_lshrrev_b32 v28, 3, v6
v_mul_u32_u24 v28, 896, v28
v_and_b32 v29, 7, v6
v_lshrrev_b32 v30, 4, v6
v_xor_b32 v29, v29, v30
v_lshl_add_u32 v240, v29, 4, v28
v_xor_b32 v29, 4, v29
v_lshl_add_u32 v241, v29, 4, v28
s_lshl_b32 s100, s56, 12
v_and_b32 v24, 31, v6
s_lshl_b32 s59, s57, 14
v_lshlrev_b32 v25, 7, v24
v_add_u32 v25, s59, v25
v_lshrrev_b32 v26, 1, v24
v_and_b32 v26, 7, v26
v_lshrrev_b32 v27, 5, v6
v_add_u32 v28, 0, v27
v_xor_b32 v28, v28, v26
v_lshl_add_u32 v8, v28, 4, v25
v_add_u32 v12, 0x10000, v8
v_subrev_u32 v242, s59, v8
v_add_u32 v242, s100, v242
v_add_u32 v28, 2, v27
v_xor_b32 v28, v28, v26
v_lshl_add_u32 v9, v28, 4, v25
v_add_u32 v13, 0x10000, v9
v_subrev_u32 v243, s59, v9
v_add_u32 v243, s100, v243
v_add_u32 v28, 4, v27
v_xor_b32 v28, v28, v26
v_lshl_add_u32 v10, v28, 4, v25
v_add_u32 v14, 0x10000, v10
v_subrev_u32 v244, s59, v10
v_add_u32 v244, s100, v244
v_add_u32 v28, 6, v27
v_xor_b32 v28, v28, v26
v_lshl_add_u32 v11, v28, 4, v25
v_add_u32 v15, 0x10000, v11
v_subrev_u32 v245, s59, v11
v_add_u32 v245, s100, v245
v_lshrrev_b32 v24, 4, v6
v_and_b32 v25, 15, v6
v_lshrrev_b32 v26, 2, v25
v_and_b32 v27, 3, v25
v_lshrrev_b32 v28, 1, v24
v_lshl_add_u32 v28, v28, 3, v26
v_lshlrev_b32 v254, 8, v28
v_lshlrev_b32 v28, 9, v28
v_add_u32 v28, 0x8000, v28
v_and_b32 v29, 1, v24
v_lshlrev_b32 v29, 1, v29
v_lshrrev_b32 v30, 1, v27
v_add_u32 v29, v29, v30
v_lshl_add_u32 v254, v29, 4, v254
s_lshl_b32 s59, s58, 4
v_add_u32 v29, s59, v29
v_lshl_add_u32 v28, v29, 4, v28
v_and_b32 v30, 1, v27
v_lshl_add_u32 v28, v30, 3, v28
v_lshl_add_u32 v254, v30, 3, v254
v_xor_b32 v29, 0, v26
v_lshl_add_u32 v16, v29, 6, v28
v_add_u32 v20, 0x10000, v16
v_lshl_add_u32 v250, v29, 6, v254
v_xor_b32 v29, 1, v26
v_lshl_add_u32 v17, v29, 6, v28
v_add_u32 v21, 0x10000, v17
v_lshl_add_u32 v251, v29, 6, v254
v_xor_b32 v29, 2, v26
v_lshl_add_u32 v18, v29, 6, v28
v_add_u32 v22, 0x10000, v18
v_lshl_add_u32 v252, v29, 6, v254
v_xor_b32 v29, 3, v26
v_lshl_add_u32 v19, v29, 6, v28
v_add_u32 v23, 0x10000, v19
v_lshl_add_u32 v253, v29, 6, v254
v_lshlrev_b32 v31, 4, v6
v_lshrrev_b32 v24, 4, v6
v_and_b32 v25, 15, v6
v_lshlrev_b32 v26, 2, v24
v_xor_b32 v25, v25, v26
v_lshlrev_b32 v25, 4, v25
v_lshl_add_u32 v246, v24, 13, v25
v_add_u32 v247, 256, v246
v_mul_u32_u24 v248, 3584, v24
v_add_u32 v248, v248, v25
v_lshrrev_b32 v249, 5, v6
v_lshlrev_b32 v249, 4, v249
v_add_u32 v249, 147456, v249
s_waitcnt lgkmcnt(0)
s_mov_b32 s4, s38
s_mov_b32 s5, s39
s_mov_b32 s6, 0x400000
s_mov_b32 s7, 0x20000
s_cmp_eq_u32 s54, 0
s_cselect_b32 s8, s44, s46
s_cselect_b32 s9, s45, s47
s_lshl_b32 s59, s53, 9
s_add_u32 s8, s8, s59
s_addc_u32 s9, s9, 0
s_sub_u32 s10, 0x800000, s59
s_mov_b32 s11, 0x20000
s_lshl_b32 s59, s54, 24
s_lshl_b32 s33, s53, 20
s_add_u32 s59, s59, s33
s_add_u32 s12, s42, s59
s_addc_u32 s13, s43, 0
s_mov_b32 s14, 0x100000
s_mov_b32 s15, 0x20000
s_mov_b32 s84, s36
s_mov_b32 s85, s37
s_mov_b32 s86, 1835008
s_mov_b32 s87, 0x20000
s_lshl_b32 s59, s78, 9
s_add_u32 s88, s48, s59
s_addc_u32 s89, s49, 0
s_sub_u32 s90, 3670016, s59
s_mov_b32 s91, 0x20000
s_mul_i32 s59, s78, 224
s_and_b32 s33, s78, 1
s_lshl_b32 s33, s33, 5
s_sub_u32 s59, s59, s33
s_add_u32 s92, s74, s59
s_addc_u32 s93, s75, 0
s_sub_u32 s94, 1605632, s59
s_mov_b32 s95, 0x20000
s_mov_b32 s96, s76
s_mov_b32 s97, s77
s_mov_b32 s98, 896
s_mov_b32 s99, 0x20000
s_lshl_b32 s59, s55, 19
s_lshl_b32 s33, s56, 17
s_add_u32 s59, s59, s33
s_add_u32 s16, s59, 0
s_add_u32 s24, s33, 0
s_add_u32 s17, s59, 15360
s_add_u32 s25, s33, 15360
s_add_u32 s18, s59, 30720
s_add_u32 s26, s33, 30720
s_add_u32 s19, s59, 46080
s_add_u32 s27, s33, 46080
s_add_u32 s20, s59, 65536
s_add_u32 s28, s33, 65536
s_add_u32 s21, s59, 80896
s_add_u32 s29, s33, 80896
s_add_u32 s22, s59, 96256
s_add_u32 s30, s33, 96256
s_add_u32 s23, s59, 111616
s_add_u32 s31, s33, 111616
s_lshl_b32 s32, s56, 13
s_add_u32 s40, s42, 59834368
s_addc_u32 s41, s43, 0
v_mov_b32 v7, 0
global_load_dword v7, v7, s[40:41]
s_add_u32 m0, s32, 0
s_nop 0
buffer_load_dwordx4 v1, s[4:7], s16 offen offset:0 lds
buffer_load_dwordx4 v2, s[4:7], s17 offen offset:1024 lds
buffer_load_dwordx4 v1, s[4:7], s18 offen offset:2048 lds
buffer_load_dwordx4 v2, s[4:7], s19 offen offset:3072 lds
s_add_u32 m0, s32, 4096
s_nop 0
buffer_load_dwordx4 v1, s[4:7], s20 offen offset:0 lds
buffer_load_dwordx4 v2, s[4:7], s21 offen offset:1024 lds
buffer_load_dwordx4 v1, s[4:7], s22 offen offset:2048 lds
buffer_load_dwordx4 v2, s[4:7], s23 offen offset:3072 lds
s_add_u32 m0, s32, 32768
s_nop 0
buffer_load_dwordx4 v3, s[8:11], s24 offen offset:0 lds
buffer_load_dwordx4 v4, s[8:11], s25 offen offset:1024 lds
buffer_load_dwordx4 v3, s[8:11], s26 offen offset:2048 lds
buffer_load_dwordx4 v4, s[8:11], s27 offen offset:3072 lds
s_add_u32 m0, s32, 36864
s_nop 0
buffer_load_dwordx4 v3, s[8:11], s28 offen offset:0 lds
buffer_load_dwordx4 v4, s[8:11], s29 offen offset:1024 lds
buffer_load_dwordx4 v3, s[8:11], s30 offen offset:2048 lds
buffer_load_dwordx4 v4, s[8:11], s31 offen offset:3072 lds
v_add_u32 v1, 0x80, v1
v_add_u32 v2, 0x80, v2
v_add_u32 v3, 0x80000, v3
v_add_u32 v4, 0x80000, v4
s_add_u32 m0, s32, 65536
s_nop 0
buffer_load_dwordx4 v1, s[4:7], s16 offen offset:0 lds
buffer_load_dwordx4 v2, s[4:7], s17 offen offset:1024 lds
buffer_load_dwordx4 v1, s[4:7], s18 offen offset:2048 lds
buffer_load_dwordx4 v2, s[4:7], s19 offen offset:3072 lds
s_add_u32 m0, s32, 69632
s_nop 0
buffer_load_dwordx4 v1, s[4:7], s20 offen offset:0 lds
buffer_load_dwordx4 v2, s[4:7], s21 offen offset:1024 lds
buffer_load_dwordx4 v1, s[4:7], s22 offen offset:2048 lds
buffer_load_dwordx4 v2, s[4:7], s23 offen offset:3072 lds
s_add_u32 m0, s32, 98304
s_nop 0
buffer_load_dwordx4 v3, s[8:11], s24 offen offset:0 lds
buffer_load_dwordx4 v4, s[8:11], s25 offen offset:1024 lds
buffer_load_dwordx4 v3, s[8:11], s26 offen offset:2048 lds
buffer_load_dwordx4 v4, s[8:11], s27 offen offset:3072 lds
s_add_u32 m0, s32, 102400
s_nop 0
buffer_load_dwordx4 v3, s[8:11], s28 offen offset:0 lds
buffer_load_dwordx4 v4, s[8:11], s29 offen offset:1024 lds
buffer_load_dwordx4 v3, s[8:11], s30 offen offset:2048 lds
buffer_load_dwordx4 v4, s[8:11], s31 offen offset:3072 lds
v_add_u32 v1, 0x80, v1
v_add_u32 v2, 0x80, v2
v_add_u32 v3, 0x80000, v3
v_add_u32 v4, 0x80000, v4
s_mul_i32 s81, s80, 28672
s_lshl_b32 s40, s55, 2
s_add_u32 s40, s40, s56
s_lshl_b32 s40, s40, 14
v_lshrrev_b32 v96, 5, v6
v_lshlrev_b32 v96, 13, v96
v_and_b32 v97, 31, v6
v_lshl_add_u32 v96, v97, 4, v96
v_add_u32 v255, s40, v96
v_add_u32 v255, 1048576, v255
s_lshl_b32 s40, s2, 2
s_add_u32 s40, s40, s56
s_lshl_b32 s40, s40, 10
v_add_u32 v96, s40, v31
v_mov_b32 v97, v96
buffer_load_dwordx4 v[24:27], v97, s[4:7], 0 offen
v_add_u32 v97, 0x100000, v97
buffer_load_dwordx4 v[24:27], v97, s[4:7], 0 offen
v_add_u32 v97, 0x100000, v97
buffer_load_dwordx4 v[24:27], v97, s[4:7], 0 offen
v_add_u32 v97, 0x100000, v97
buffer_load_dwordx4 v[24:27], v97, s[4:7], 0 offen
v_add_u32 v97, 0x100000, v97
buffer_load_dwordx4 v[24:27], v255, s[8:11], 0 offen
v_add_u32 v255, 0x80000, v255
buffer_load_dwordx4 v[24:27], v255, s[8:11], 0 offen
v_add_u32 v255, 0x80000, v255
buffer_load_dwordx4 v[24:27], v255, s[8:11], 0 offen
v_add_u32 v255, 0x80000, v255
buffer_load_dwordx4 v[24:27], v255, s[8:11], 0 offen
v_add_u32 v255, 0x80000, v255
buffer_load_dwordx4 v[24:27], v255, s[8:11], 0 offen
v_add_u32 v255, 0x80000, v255
v_mov_b32 v97, v96
buffer_load_dwordx4 v[24:27], v97, s[84:87], 0 offen
v_add_u32 v97, 0x100000, v97
buffer_load_dwordx4 v[24:27], v97, s[84:87], 0 offen
v_add_u32 v97, 0x100000, v97
s_lshl_b32 s40, s78, 9
v_subrev_u32 v97, s40, v96
buffer_load_dwordx4 v[24:27], v97, s[88:91], 0 offen
v_add_u32 v97, 0x100000, v97
buffer_load_dwordx4 v[24:27], v97, s[88:91], 0 offen
v_add_u32 v97, 0x100000, v97
buffer_load_dwordx4 v[24:27], v97, s[88:91], 0 offen
v_add_u32 v97, 0x100000, v97
buffer_load_dwordx4 v[24:27], v97, s[88:91], 0 offen
v_add_u32 v97, 0x100000, v97
s_mul_i32 s40, s78, 224
s_and_b32 s41, s78, 1
s_lshl_b32 s41, s41, 5
s_sub_u32 s40, s40, s41
v_subrev_u32 v97, s40, v96
buffer_load_dwordx4 v[24:27], v97, s[92:95], 0 offen
v_add_u32 v97, 0x100000, v97
buffer_load_dwordx4 v[24:27], v97, s[92:95], 0 offen
v_add_u32 v97, 0x100000, v97
buffer_load_dwordx4 v[24:27], v31, s[96:99], 0 offen
s_waitcnt vmcnt(34)
v_readfirstlane_b32 s101, v7
s_nop 3
s_mul_i32 s101, s101, 0x9E3779B1
s_add_u32 s101, s101, 0x7F4A7C15
s_cmp_eq_u32 s56, 0
s_cbranch_scc0 k1_noid
s_getreg_b32 s40, hwreg(HW_REG_XCC_ID, 0, 4)
s_add_u32 s40, s40, s101
s_add_u32 s40, s40, 1
s_lshl_b32 s41, s78, 7
s_lshl_b32 s59, s79, 2
s_add_u32 s41, s41, s59
s_add_u32 s41, s41, 59793408
v_mov_b32 v28, s40
v_mov_b32 v29, s41
s_mov_b64 exec, 1
global_store_dword v29, v28, s[42:43] sc1
s_mov_b64 exec, -1
k1_noid:
s_barrier
ds_read_b128 v[32:35], v8 offset:0
ds_read_b64_tr_b16 v[48:49], v16 offset:0
ds_read_b64_tr_b16 v[50:51], v16 offset:2048
ds_read_b128 v[36:39], v8 offset:4096
ds_read_b128 v[40:43], v8 offset:8192
ds_read_b128 v[44:47], v8 offset:12288
ds_read_b64_tr_b16 v[52:53], v17 offset:0
ds_read_b64_tr_b16 v[54:55], v17 offset:2048
ds_read_b64_tr_b16 v[56:57], v18 offset:0
ds_read_b64_tr_b16 v[58:59], v18 offset:2048
ds_read_b64_tr_b16 v[60:61], v19 offset:0
ds_read_b64_tr_b16 v[62:63], v19 offset:2048
s_cmp_eq_u32 s54, 0
s_cbranch_scc0 k1_vpath
s_waitcnt lgkmcnt(0)
v_mfma_f32_32x32x16_bf16 a[0:15], v[48:51], v[32:35], 0
ds_read_b128 v[64:67], v9 offset:0
v_mfma_f32_32x32x16_bf16 a[16:31], v[48:51], v[36:39], 0
ds_read_b64_tr_b16 v[80:81], v16 offset:8192
v_mfma_f32_32x32x16_bf16 a[32:47], v[48:51], v[40:43], 0
ds_read_b64_tr_b16 v[82:83], v16 offset:10240
v_mfma_f32_32x32x16_bf16 a[48:63], v[48:51], v[44:47], 0
ds_read_b128 v[68:71], v9 offset:4096
v_mfma_f32_32x32x16_bf16 a[64:79], v[52:55], v[32:35], 0
ds_read_b128 v[72:75], v9 offset:8192
v_mfma_f32_32x32x16_bf16 a[80:95], v[52:55], v[36:39], 0
ds_read_b128 v[76:79], v9 offset:12288
v_mfma_f32_32x32x16_bf16 a[96:111], v[52:55], v[40:43], 0
ds_read_b64_tr_b16 v[84:85], v17 offset:8192
v_mfma_f32_32x32x16_bf16 a[112:127], v[52:55], v[44:47], 0
ds_read_b64_tr_b16 v[86:87], v17 offset:10240
v_mfma_f32_32x32x16_bf16 a[128:143], v[56:59], v[32:35], 0
ds_read_b64_tr_b16 v[88:89], v18 offset:8192
v_mfma_f32_32x32x16_bf16 a[144:159], v[56:59], v[36:39], 0
ds_read_b64_tr_b16 v[90:91], v18 offset:10240
v_mfma_f32_32x32x16_bf16 a[160:175], v[56:59], v[40:43], 0
ds_read_b64_tr_b16 v[92:93], v19 offset:8192
v_mfma_f32_32x32x16_bf16 a[176:191], v[56:59], v[44:47], 0
ds_read_b64_tr_b16 v[94:95], v19 offset:10240
v_mfma_f32_32x32x16_bf16 a[192:207], v[60:63], v[32:35], 0
v_mfma_f32_32x32x16_bf16 a[208:223], v[60:63], v[36:39], 0
v_mfma_f32_32x32x16_bf16 a[224:239], v[60:63], v[40:43], 0
v_mfma_f32_32x32x16_bf16 a[240:255], v[60:63], v[44:47], 0
s_waitcnt lgkmcnt(0)
v_mfma_f32_32x32x16_bf16 a[0:15], v[80:83], v[64:67], a[0:15]
ds_read_b128 v[32:35], v10 offset:0
v_mfma_f32_32x32x16_bf16 a[16:31], v[80:83], v[68:71], a[16:31]
ds_read_b64_tr_b16 v[48:49], v16 offset:16384
v_mfma_f32_32x32x16_bf16 a[32:47], v[80:83], v[72:75], a[32:47]
ds_read_b64_tr_b16 v[50:51], v16 offset:18432
v_mfma_f32_32x32x16_bf16 a[48:63], v[80:83], v[76:79], a[48:63]
ds_read_b128 v[36:39], v10 offset:4096
v_mfma_f32_32x32x16_bf16 a[64:79], v[84:87], v[64:67], a[64:79]
ds_read_b128 v[40:43], v10 offset:8192
v_mfma_f32_32x32x16_bf16 a[80:95], v[84:87], v[68:71], a[80:95]
ds_read_b128 v[44:47], v10 offset:12288
v_mfma_f32_32x32x16_bf16 a[96:111], v[84:87], v[72:75], a[96:111]
ds_read_b64_tr_b16 v[52:53], v17 offset:16384
v_mfma_f32_32x32x16_bf16 a[112:127], v[84:87], v[76:79], a[112:127]
ds_read_b64_tr_b16 v[54:55], v17 offset:18432
v_mfma_f32_32x32x16_bf16 a[128:143], v[88:91], v[64:67], a[128:143]
ds_read_b64_tr_b16 v[56:57], v18 offset:16384
v_mfma_f32_32x32x16_bf16 a[144:159], v[88:91], v[68:71], a[144:159]
ds_read_b64_tr_b16 v[58:59], v18 offset:18432
v_mfma_f32_32x32x16_bf16 a[160:175], v[88:91], v[72:75], a[160:175]
ds_read_b64_tr_b16 v[60:61], v19 offset:16384
v_mfma_f32_32x32x16_bf16 a[176:191], v[88:91], v[76:79], a[176:191]
ds_read_b64_tr_b16 v[62:63], v19 offset:18432
v_mfma_f32_32x32x16_bf16 a[192:207], v[92:95], v[64:67], a[192:207]
v_mfma_f32_32x32x16_bf16 a[208:223], v[92:95], v[68:71], a[208:223]
v_mfma_f32_32x32x16_bf16 a[224:239], v[92:95], v[72:75], a[224:239]
v_mfma_f32_32x32x16_bf16 a[240:255], v[92:95], v[76:79], a[240:255]
s_waitcnt lgkmcnt(0)
v_mfma_f32_32x32x16_bf16 a[0:15], v[48:51], v[32:35], a[0:15]
ds_read_b128 v[64:67], v11 offset:0
v_mfma_f32_32x32x16_bf16 a[16:31], v[48:51], v[36:39], a[16:31]
ds_read_b64_tr_b16 v[80:81], v16 offset:24576
v_mfma_f32_32x32x16_bf16 a[32:47], v[48:51], v[40:43], a[32:47]
ds_read_b64_tr_b16 v[82:83], v16 offset:26624
v_mfma_f32_32x32x16_bf16 a[48:63], v[48:51], v[44:47], a[48:63]
ds_read_b128 v[68:71], v11 offset:4096
v_mfma_f32_32x32x16_bf16 a[64:79], v[52:55], v[32:35], a[64:79]
ds_read_b128 v[72:75], v11 offset:8192
v_mfma_f32_32x32x16_bf16 a[80:95], v[52:55], v[36:39], a[80:95]
ds_read_b128 v[76:79], v11 offset:12288
v_mfma_f32_32x32x16_bf16 a[96:111], v[52:55], v[40:43], a[96:111]
ds_read_b64_tr_b16 v[84:85], v17 offset:24576
v_mfma_f32_32x32x16_bf16 a[112:127], v[52:55], v[44:47], a[112:127]
ds_read_b64_tr_b16 v[86:87], v17 offset:26624
v_mfma_f32_32x32x16_bf16 a[128:143], v[56:59], v[32:35], a[128:143]
ds_read_b64_tr_b16 v[88:89], v18 offset:24576
v_mfma_f32_32x32x16_bf16 a[144:159], v[56:59], v[36:39], a[144:159]
ds_read_b64_tr_b16 v[90:91], v18 offset:26624
v_mfma_f32_32x32x16_bf16 a[160:175], v[56:59], v[40:43], a[160:175]
ds_read_b64_tr_b16 v[92:93], v19 offset:24576
v_mfma_f32_32x32x16_bf16 a[176:191], v[56:59], v[44:47], a[176:191]
ds_read_b64_tr_b16 v[94:95], v19 offset:26624
v_mfma_f32_32x32x16_bf16 a[192:207], v[60:63], v[32:35], a[192:207]
v_mfma_f32_32x32x16_bf16 a[208:223], v[60:63], v[36:39], a[208:223]
v_mfma_f32_32x32x16_bf16 a[224:239], v[60:63], v[40:43], a[224:239]
v_mfma_f32_32x32x16_bf16 a[240:255], v[60:63], v[44:47], a[240:255]
s_mov_b32 s33, 7
.p2align 6
k1_k_loop:
s_waitcnt lgkmcnt(0)
v_mfma_f32_32x32x16_bf16 a[0:15], v[80:83], v[64:67], a[0:15]
s_waitcnt vmcnt(1)
s_barrier
s_add_u32 m0, s32, 0
v_mfma_f32_32x32x16_bf16 a[16:31], v[80:83], v[68:71], a[16:31]
ds_read_b128 v[32:35], v12 offset:0
buffer_load_dwordx4 v1, s[4:7], s16 offen offset:0 lds
v_mfma_f32_32x32x16_bf16 a[32:47], v[80:83], v[72:75], a[32:47]
ds_read_b64_tr_b16 v[48:49], v20 offset:0
v_mfma_f32_32x32x16_bf16 a[48:63], v[80:83], v[76:79], a[48:63]
ds_read_b64_tr_b16 v[50:51], v20 offset:2048
v_mfma_f32_32x32x16_bf16 a[64:79], v[84:87], v[64:67], a[64:79]
ds_read_b128 v[36:39], v12 offset:4096
buffer_load_dwordx4 v2, s[4:7], s17 offen offset:1024 lds
v_mfma_f32_32x32x16_bf16 a[80:95], v[84:87], v[68:71], a[80:95]
ds_read_b128 v[40:43], v12 offset:8192
v_mfma_f32_32x32x16_bf16 a[96:111], v[84:87], v[72:75], a[96:111]
ds_read_b128 v[44:47], v12 offset:12288
v_mfma_f32_32x32x16_bf16 a[112:127], v[84:87], v[76:79], a[112:127]
ds_read_b64_tr_b16 v[52:53], v21 offset:0
buffer_load_dwordx4 v1, s[4:7], s18 offen offset:2048 lds
v_mfma_f32_32x32x16_bf16 a[128:143], v[88:91], v[64:67], a[128:143]
ds_read_b64_tr_b16 v[54:55], v21 offset:2048
v_mfma_f32_32x32x16_bf16 a[144:159], v[88:91], v[68:71], a[144:159]
ds_read_b64_tr_b16 v[56:57], v22 offset:0
v_mfma_f32_32x32x16_bf16 a[160:175], v[88:91], v[72:75], a[160:175]
ds_read_b64_tr_b16 v[58:59], v22 offset:2048
buffer_load_dwordx4 v2, s[4:7], s19 offen offset:3072 lds
v_mfma_f32_32x32x16_bf16 a[176:191], v[88:91], v[76:79], a[176:191]
ds_read_b64_tr_b16 v[60:61], v23 offset:0
v_mfma_f32_32x32x16_bf16 a[192:207], v[92:95], v[64:67], a[192:207]
ds_read_b64_tr_b16 v[62:63], v23 offset:2048
s_add_u32 m0, s32, 4096
v_mfma_f32_32x32x16_bf16 a[208:223], v[92:95], v[68:71], a[208:223]
buffer_load_dwordx4 v1, s[4:7], s20 offen offset:0 lds
v_mfma_f32_32x32x16_bf16 a[224:239], v[92:95], v[72:75], a[224:239]
v_mfma_f32_32x32x16_bf16 a[240:255], v[92:95], v[76:79], a[240:255]
s_waitcnt lgkmcnt(0)
v_mfma_f32_32x32x16_bf16 a[0:15], v[48:51], v[32:35], a[0:15]
ds_read_b128 v[64:67], v13 offset:0
buffer_load_dwordx4 v2, s[4:7], s21 offen offset:1024 lds
v_mfma_f32_32x32x16_bf16 a[16:31], v[48:51], v[36:39], a[16:31]
ds_read_b64_tr_b16 v[80:81], v20 offset:8192
v_mfma_f32_32x32x16_bf16 a[32:47], v[48:51], v[40:43], a[32:47]
ds_read_b64_tr_b16 v[82:83], v20 offset:10240
v_mfma_f32_32x32x16_bf16 a[48:63], v[48:51], v[44:47], a[48:63]
ds_read_b128 v[68:71], v13 offset:4096
buffer_load_dwordx4 v1, s[4:7], s22 offen offset:2048 lds
v_mfma_f32_32x32x16_bf16 a[64:79], v[52:55], v[32:35], a[64:79]
ds_read_b128 v[72:75], v13 offset:8192
v_mfma_f32_32x32x16_bf16 a[80:95], v[52:55], v[36:39], a[80:95]
ds_read_b128 v[76:79], v13 offset:12288
v_mfma_f32_32x32x16_bf16 a[96:111], v[52:55], v[40:43], a[96:111]
ds_read_b64_tr_b16 v[84:85], v21 offset:8192
buffer_load_dwordx4 v2, s[4:7], s23 offen offset:3072 lds
v_mfma_f32_32x32x16_bf16 a[112:127], v[52:55], v[44:47], a[112:127]
ds_read_b64_tr_b16 v[86:87], v21 offset:10240
v_mfma_f32_32x32x16_bf16 a[128:143], v[56:59], v[32:35], a[128:143]
ds_read_b64_tr_b16 v[88:89], v22 offset:8192
s_add_u32 m0, s32, 32768
v_mfma_f32_32x32x16_bf16 a[144:159], v[56:59], v[36:39], a[144:159]
ds_read_b64_tr_b16 v[90:91], v22 offset:10240
buffer_load_dwordx4 v3, s[8:11], s24 offen offset:0 lds
v_mfma_f32_32x32x16_bf16 a[160:175], v[56:59], v[40:43], a[160:175]
ds_read_b64_tr_b16 v[92:93], v23 offset:8192
v_mfma_f32_32x32x16_bf16 a[176:191], v[56:59], v[44:47], a[176:191]
ds_read_b64_tr_b16 v[94:95], v23 offset:10240
v_mfma_f32_32x32x16_bf16 a[192:207], v[60:63], v[32:35], a[192:207]
buffer_load_dwordx4 v4, s[8:11], s25 offen offset:1024 lds
v_mfma_f32_32x32x16_bf16 a[208:223], v[60:63], v[36:39], a[208:223]
v_mfma_f32_32x32x16_bf16 a[224:239], v[60:63], v[40:43], a[224:239]
v_mfma_f32_32x32x16_bf16 a[240:255], v[60:63], v[44:47], a[240:255]
buffer_load_dwordx4 v3, s[8:11], s26 offen offset:2048 lds
s_waitcnt lgkmcnt(0)
v_mfma_f32_32x32x16_bf16 a[0:15], v[80:83], v[64:67], a[0:15]
ds_read_b128 v[32:35], v14 offset:0
v_mfma_f32_32x32x16_bf16 a[16:31], v[80:83], v[68:71], a[16:31]
ds_read_b64_tr_b16 v[48:49], v20 offset:16384
v_mfma_f32_32x32x16_bf16 a[32:47], v[80:83], v[72:75], a[32:47]
ds_read_b64_tr_b16 v[50:51], v20 offset:18432
buffer_load_dwordx4 v4, s[8:11], s27 offen offset:3072 lds
v_mfma_f32_32x32x16_bf16 a[48:63], v[80:83], v[76:79], a[48:63]
ds_read_b128 v[36:39], v14 offset:4096
v_mfma_f32_32x32x16_bf16 a[64:79], v[84:87], v[64:67], a[64:79]
ds_read_b128 v[40:43], v14 offset:8192
s_add_u32 m0, s32, 36864
v_mfma_f32_32x32x16_bf16 a[80:95], v[84:87], v[68:71], a[80:95]
ds_read_b128 v[44:47], v14 offset:12288
buffer_load_dwordx4 v3, s[8:11], s28 offen offset:0 lds
v_mfma_f32_32x32x16_bf16 a[96:111], v[84:87], v[72:75], a[96:111]
ds_read_b64_tr_b16 v[52:53], v21 offset:16384
v_mfma_f32_32x32x16_bf16 a[112:127], v[84:87], v[76:79], a[112:127]
ds_read_b64_tr_b16 v[54:55], v21 offset:18432
v_mfma_f32_32x32x16_bf16 a[128:143], v[88:91], v[64:67], a[128:143]
ds_read_b64_tr_b16 v[56:57], v22 offset:16384
buffer_load_dwordx4 v4, s[8:11], s29 offen offset:1024 lds
v_mfma_f32_32x32x16_bf16 a[144:159], v[88:91], v[68:71], a[144:159]
ds_read_b64_tr_b16 v[58:59], v22 offset:18432
v_mfma_f32_32x32x16_bf16 a[160:175], v[88:91], v[72:75], a[160:175]
ds_read_b64_tr_b16 v[60:61], v23 offset:16384
v_mfma_f32_32x32x16_bf16 a[176:191], v[88:91], v[76:79], a[176:191]
ds_read_b64_tr_b16 v[62:63], v23 offset:18432
buffer_load_dwordx4 v3, s[8:11], s30 offen offset:2048 lds
v_mfma_f32_32x32x16_bf16 a[192:207], v[92:95], v[64:67], a[192:207]
v_mfma_f32_32x32x16_bf16 a[208:223], v[92:95], v[68:71], a[208:223]
v_mfma_f32_32x32x16_bf16 a[224:239], v[92:95], v[72:75], a[224:239]
buffer_load_dwordx4 v4, s[8:11], s31 offen offset:3072 lds
v_mfma_f32_32x32x16_bf16 a[240:255], v[92:95], v[76:79], a[240:255]
s_waitcnt lgkmcnt(0)
v_mfma_f32_32x32x16_bf16 a[0:15], v[48:51], v[32:35], a[0:15]
ds_read_b128 v[64:67], v15 offset:0
v_mfma_f32_32x32x16_bf16 a[16:31], v[48:51], v[36:39], a[16:31]
ds_read_b64_tr_b16 v[80:81], v20 offset:24576
v_add_u32 v1, 0x80, v1
v_add_u32 v2, 0x80, v2
v_add_u32 v3, 0x80000, v3
v_add_u32 v4, 0x80000, v4
v_mfma_f32_32x32x16_bf16 a[32:47], v[48:51], v[40:43], a[32:47]
ds_read_b64_tr_b16 v[82:83], v20 offset:26624
v_mfma_f32_32x32x16_bf16 a[48:63], v[48:51], v[44:47], a[48:63]
ds_read_b128 v[68:71], v15 offset:4096
buffer_load_dwordx4 v[24:27], v255, s[8:11], 0 offen
v_mfma_f32_32x32x16_bf16 a[64:79], v[52:55], v[32:35], a[64:79]
ds_read_b128 v[72:75], v15 offset:8192
v_add_u32 v255, 0x80000, v255
v_mfma_f32_32x32x16_bf16 a[80:95], v[52:55], v[36:39], a[80:95]
ds_read_b128 v[76:79], v15 offset:12288
v_mfma_f32_32x32x16_bf16 a[96:111], v[52:55], v[40:43], a[96:111]
ds_read_b64_tr_b16 v[84:85], v21 offset:24576
v_mfma_f32_32x32x16_bf16 a[112:127], v[52:55], v[44:47], a[112:127]
ds_read_b64_tr_b16 v[86:87], v21 offset:26624
v_mfma_f32_32x32x16_bf16 a[128:143], v[56:59], v[32:35], a[128:143]
ds_read_b64_tr_b16 v[88:89], v22 offset:24576
v_mfma_f32_32x32x16_bf16 a[144:159], v[56:59], v[36:39], a[144:159]
ds_read_b64_tr_b16 v[90:91], v22 offset:26624
v_mfma_f32_32x32x16_bf16 a[160:175], v[56:59], v[40:43], a[160:175]
ds_read_b64_tr_b16 v[92:93], v23 offset:24576
v_mfma_f32_32x32x16_bf16 a[176:191], v[56:59], v[44:47], a[176:191]
ds_read_b64_tr_b16 v[94:95], v23 offset:26624
v_mfma_f32_32x32x16_bf16 a[192:207], v[60:63], v[32:35], a[192:207]
v_mfma_f32_32x32x16_bf16 a[208:223], v[60:63], v[36:39], a[208:223]
v_mfma_f32_32x32x16_bf16 a[224:239], v[60:63], v[40:43], a[224:239]
v_mfma_f32_32x32x16_bf16 a[240:255], v[60:63], v[44:47], a[240:255]
s_waitcnt lgkmcnt(0)
v_mfma_f32_32x32x16_bf16 a[0:15], v[80:83], v[64:67], a[0:15]
s_waitcnt vmcnt(1)
s_barrier
s_add_u32 m0, s32, 65536
v_mfma_f32_32x32x16_bf16 a[16:31], v[80:83], v[68:71], a[16:31]
ds_read_b128 v[32:35], v8 offset:0
buffer_load_dwordx4 v1, s[4:7], s16 offen offset:0 lds
v_mfma_f32_32x32x16_bf16 a[32:47], v[80:83], v[72:75], a[32:47]
ds_read_b64_tr_b16 v[48:49], v16 offset:0
v_mfma_f32_32x32x16_bf16 a[48:63], v[80:83], v[76:79], a[48:63]
ds_read_b64_tr_b16 v[50:51], v16 offset:2048
v_mfma_f32_32x32x16_bf16 a[64:79], v[84:87], v[64:67], a[64:79]
ds_read_b128 v[36:39], v8 offset:4096
buffer_load_dwordx4 v2, s[4:7], s17 offen offset:1024 lds
v_mfma_f32_32x32x16_bf16 a[80:95], v[84:87], v[68:71], a[80:95]
ds_read_b128 v[40:43], v8 offset:8192
v_mfma_f32_32x32x16_bf16 a[96:111], v[84:87], v[72:75], a[96:111]
ds_read_b128 v[44:47], v8 offset:12288
v_mfma_f32_32x32x16_bf16 a[112:127], v[84:87], v[76:79], a[112:127]
ds_read_b64_tr_b16 v[52:53], v17 offset:0
buffer_load_dwordx4 v1, s[4:7], s18 offen offset:2048 lds
v_mfma_f32_32x32x16_bf16 a[128:143], v[88:91], v[64:67], a[128:143]
ds_read_b64_tr_b16 v[54:55], v17 offset:2048
v_mfma_f32_32x32x16_bf16 a[144:159], v[88:91], v[68:71], a[144:159]
ds_read_b64_tr_b16 v[56:57], v18 offset:0
v_mfma_f32_32x32x16_bf16 a[160:175], v[88:91], v[72:75], a[160:175]
ds_read_b64_tr_b16 v[58:59], v18 offset:2048
buffer_load_dwordx4 v2, s[4:7], s19 offen offset:3072 lds
v_mfma_f32_32x32x16_bf16 a[176:191], v[88:91], v[76:79], a[176:191]
ds_read_b64_tr_b16 v[60:61], v19 offset:0
v_mfma_f32_32x32x16_bf16 a[192:207], v[92:95], v[64:67], a[192:207]
ds_read_b64_tr_b16 v[62:63], v19 offset:2048
s_add_u32 m0, s32, 69632
v_mfma_f32_32x32x16_bf16 a[208:223], v[92:95], v[68:71], a[208:223]
buffer_load_dwordx4 v1, s[4:7], s20 offen offset:0 lds
v_mfma_f32_32x32x16_bf16 a[224:239], v[92:95], v[72:75], a[224:239]
v_mfma_f32_32x32x16_bf16 a[240:255], v[92:95], v[76:79], a[240:255]
s_waitcnt lgkmcnt(0)
v_mfma_f32_32x32x16_bf16 a[0:15], v[48:51], v[32:35], a[0:15]
ds_read_b128 v[64:67], v9 offset:0
buffer_load_dwordx4 v2, s[4:7], s21 offen offset:1024 lds
v_mfma_f32_32x32x16_bf16 a[16:31], v[48:51], v[36:39], a[16:31]
ds_read_b64_tr_b16 v[80:81], v16 offset:8192
v_mfma_f32_32x32x16_bf16 a[32:47], v[48:51], v[40:43], a[32:47]
ds_read_b64_tr_b16 v[82:83], v16 offset:10240
v_mfma_f32_32x32x16_bf16 a[48:63], v[48:51], v[44:47], a[48:63]
ds_read_b128 v[68:71], v9 offset:4096
buffer_load_dwordx4 v1, s[4:7], s22 offen offset:2048 lds
v_mfma_f32_32x32x16_bf16 a[64:79], v[52:55], v[32:35], a[64:79]
ds_read_b128 v[72:75], v9 offset:8192
v_mfma_f32_32x32x16_bf16 a[80:95], v[52:55], v[36:39], a[80:95]
ds_read_b128 v[76:79], v9 offset:12288
v_mfma_f32_32x32x16_bf16 a[96:111], v[52:55], v[40:43], a[96:111]
ds_read_b64_tr_b16 v[84:85], v17 offset:8192
buffer_load_dwordx4 v2, s[4:7], s23 offen offset:3072 lds
v_mfma_f32_32x32x16_bf16 a[112:127], v[52:55], v[44:47], a[112:127]
ds_read_b64_tr_b16 v[86:87], v17 offset:10240
v_mfma_f32_32x32x16_bf16 a[128:143], v[56:59], v[32:35], a[128:143]
ds_read_b64_tr_b16 v[88:89], v18 offset:8192
s_add_u32 m0, s32, 98304
v_mfma_f32_32x32x16_bf16 a[144:159], v[56:59], v[36:39], a[144:159]
ds_read_b64_tr_b16 v[90:91], v18 offset:10240
buffer_load_dwordx4 v3, s[8:11], s24 offen offset:0 lds
v_mfma_f32_32x32x16_bf16 a[160:175], v[56:59], v[40:43], a[160:175]
ds_read_b64_tr_b16 v[92:93], v19 offset:8192
v_mfma_f32_32x32x16_bf16 a[176:191], v[56:59], v[44:47], a[176:191]
ds_read_b64_tr_b16 v[94:95], v19 offset:10240
v_mfma_f32_32x32x16_bf16 a[192:207], v[60:63], v[32:35], a[192:207]
buffer_load_dwordx4 v4, s[8:11], s25 offen offset:1024 lds
v_mfma_f32_32x32x16_bf16 a[208:223], v[60:63], v[36:39], a[208:223]
v_mfma_f32_32x32x16_bf16 a[224:239], v[60:63], v[40:43], a[224:239]
v_mfma_f32_32x32x16_bf16 a[240:255], v[60:63], v[44:47], a[240:255]
buffer_load_dwordx4 v3, s[8:11], s26 offen offset:2048 lds
s_waitcnt lgkmcnt(0)
v_mfma_f32_32x32x16_bf16 a[0:15], v[80:83], v[64:67], a[0:15]
ds_read_b128 v[32:35], v10 offset:0
v_mfma_f32_32x32x16_bf16 a[16:31], v[80:83], v[68:71], a[16:31]
ds_read_b64_tr_b16 v[48:49], v16 offset:16384
v_mfma_f32_32x32x16_bf16 a[32:47], v[80:83], v[72:75], a[32:47]
ds_read_b64_tr_b16 v[50:51], v16 offset:18432
buffer_load_dwordx4 v4, s[8:11], s27 offen offset:3072 lds
v_mfma_f32_32x32x16_bf16 a[48:63], v[80:83], v[76:79], a[48:63]
ds_read_b128 v[36:39], v10 offset:4096
v_mfma_f32_32x32x16_bf16 a[64:79], v[84:87], v[64:67], a[64:79]
ds_read_b128 v[40:43], v10 offset:8192
s_add_u32 m0, s32, 102400
v_mfma_f32_32x32x16_bf16 a[80:95], v[84:87], v[68:71], a[80:95]
ds_read_b128 v[44:47], v10 offset:12288
buffer_load_dwordx4 v3, s[8:11], s28 offen offset:0 lds
v_mfma_f32_32x32x16_bf16 a[96:111], v[84:87], v[72:75], a[96:111]
ds_read_b64_tr_b16 v[52:53], v17 offset:16384
v_mfma_f32_32x32x16_bf16 a[112:127], v[84:87], v[76:79], a[112:127]
ds_read_b64_tr_b16 v[54:55], v17 offset:18432
v_mfma_f32_32x32x16_bf16 a[128:143], v[88:91], v[64:67], a[128:143]
ds_read_b64_tr_b16 v[56:57], v18 offset:16384
buffer_load_dwordx4 v4, s[8:11], s29 offen offset:1024 lds
v_mfma_f32_32x32x16_bf16 a[144:159], v[88:91], v[68:71], a[144:159]
ds_read_b64_tr_b16 v[58:59], v18 offset:18432
v_mfma_f32_32x32x16_bf16 a[160:175], v[88:91], v[72:75], a[160:175]
ds_read_b64_tr_b16 v[60:61], v19 offset:16384
v_mfma_f32_32x32x16_bf16 a[176:191], v[88:91], v[76:79], a[176:191]
ds_read_b64_tr_b16 v[62:63], v19 offset:18432
buffer_load_dwordx4 v3, s[8:11], s30 offen offset:2048 lds
v_mfma_f32_32x32x16_bf16 a[192:207], v[92:95], v[64:67], a[192:207]
v_mfma_f32_32x32x16_bf16 a[208:223], v[92:95], v[68:71], a[208:223]
v_mfma_f32_32x32x16_bf16 a[224:239], v[92:95], v[72:75], a[224:239]
buffer_load_dwordx4 v4, s[8:11], s31 offen offset:3072 lds
v_mfma_f32_32x32x16_bf16 a[240:255], v[92:95], v[76:79], a[240:255]
s_waitcnt lgkmcnt(0)
v_mfma_f32_32x32x16_bf16 a[0:15], v[48:51], v[32:35], a[0:15]
ds_read_b128 v[64:67], v11 offset:0
v_mfma_f32_32x32x16_bf16 a[16:31], v[48:51], v[36:39], a[16:31]
ds_read_b64_tr_b16 v[80:81], v16 offset:24576
v_add_u32 v1, 0x80, v1
v_add_u32 v2, 0x80, v2
v_add_u32 v3, 0x80000, v3
v_add_u32 v4, 0x80000, v4
v_mfma_f32_32x32x16_bf16 a[32:47], v[48:51], v[40:43], a[32:47]
ds_read_b64_tr_b16 v[82:83], v16 offset:26624
v_mfma_f32_32x32x16_bf16 a[48:63], v[48:51], v[44:47], a[48:63]
ds_read_b128 v[68:71], v11 offset:4096
buffer_load_dwordx4 v[24:27], v255, s[8:11], 0 offen
v_mfma_f32_32x32x16_bf16 a[64:79], v[52:55], v[32:35], a[64:79]
ds_read_b128 v[72:75], v11 offset:8192
v_add_u32 v255, 0x80000, v255
v_mfma_f32_32x32x16_bf16 a[80:95], v[52:55], v[36:39], a[80:95]
ds_read_b128 v[76:79], v11 offset:12288
v_mfma_f32_32x32x16_bf16 a[96:111], v[52:55], v[40:43], a[96:111]
ds_read_b64_tr_b16 v[84:85], v17 offset:24576
v_mfma_f32_32x32x16_bf16 a[112:127], v[52:55], v[44:47], a[112:127]
ds_read_b64_tr_b16 v[86:87], v17 offset:26624
v_mfma_f32_32x32x16_bf16 a[128:143], v[56:59], v[32:35], a[128:143]
ds_read_b64_tr_b16 v[88:89], v18 offset:24576
v_mfma_f32_32x32x16_bf16 a[144:159], v[56:59], v[36:39], a[144:159]
ds_read_b64_tr_b16 v[90:91], v18 offset:26624
v_mfma_f32_32x32x16_bf16 a[160:175], v[56:59], v[40:43], a[160:175]
ds_read_b64_tr_b16 v[92:93], v19 offset:24576
v_mfma_f32_32x32x16_bf16 a[176:191], v[56:59], v[44:47], a[176:191]
ds_read_b64_tr_b16 v[94:95], v19 offset:26624
v_mfma_f32_32x32x16_bf16 a[192:207], v[60:63], v[32:35], a[192:207]
v_mfma_f32_32x32x16_bf16 a[208:223], v[60:63], v[36:39], a[208:223]
v_mfma_f32_32x32x16_bf16 a[224:239], v[60:63], v[40:43], a[224:239]
v_mfma_f32_32x32x16_bf16 a[240:255], v[60:63], v[44:47], a[240:255]
s_sub_u32 s33, s33, 1
s_cmp_lg_u32 s33, 0
s_cbranch_scc1 k1_k_loop
s_load_dwordx2 s[36:37], s[0:1], 40
s_load_dwordx2 s[38:39], s[0:1], 64
s_lshl_b32 s33, s56, 17
s_mul_i32 s59, s56, 57344
s_add_u32 s16, s33, 0
s_add_u32 s20, s59, 0
s_add_u32 s24, s81, 0
s_add_u32 s17, s33, 31744
s_add_u32 s21, s59, 13312
s_add_u32 s25, s81, 6144
s_add_u32 s18, s33, 63488
s_add_u32 s22, s59, 26624
s_add_u32 s26, s81, 12288
s_add_u32 s19, s33, 95232
s_add_u32 s23, s59, 39936
s_add_u32 s27, s81, 18432
s_waitcnt lgkmcnt(0)
v_mfma_f32_32x32x16_bf16 a[0:15], v[80:83], v[64:67], a[0:15]
s_waitcnt vmcnt(1)
s_barrier
v_mfma_f32_32x32x16_bf16 a[16:31], v[80:83], v[68:71], a[16:31]
ds_read_b128 v[32:35], v12 offset:0
v_mfma_f32_32x32x16_bf16 a[32:47], v[80:83], v[72:75], a[32:47]
ds_read_b64_tr_b16 v[48:49], v20 offset:0
s_add_u32 m0, s100, 0
v_mfma_f32_32x32x16_bf16 a[48:63], v[80:83], v[76:79], a[48:63]
ds_read_b64_tr_b16 v[50:51], v20 offset:2048
buffer_load_dwordx4 v240, s[84:87], s24 offen offset:0 lds
v_mfma_f32_32x32x16_bf16 a[64:79], v[84:87], v[64:67], a[64:79]
ds_read_b128 v[36:39], v12 offset:4096
v_mfma_f32_32x32x16_bf16 a[80:95], v[84:87], v[68:71], a[80:95]
ds_read_b128 v[40:43], v12 offset:8192
buffer_load_dwordx4 v241, s[84:87], s25 offen offset:1024 lds
v_mfma_f32_32x32x16_bf16 a[96:111], v[84:87], v[72:75], a[96:111]
ds_read_b128 v[44:47], v12 offset:12288
v_mfma_f32_32x32x16_bf16 a[112:127], v[84:87], v[76:79], a[112:127]
ds_read_b64_tr_b16 v[52:53], v21 offset:0
buffer_load_dwordx4 v240, s[84:87], s26 offen offset:2048 lds
v_mfma_f32_32x32x16_bf16 a[128:143], v[88:91], v[64:67], a[128:143]
ds_read_b64_tr_b16 v[54:55], v21 offset:2048
v_mfma_f32_32x32x16_bf16 a[144:159], v[88:91], v[68:71], a[144:159]
ds_read_b64_tr_b16 v[56:57], v22 offset:0
buffer_load_dwordx4 v241, s[84:87], s27 offen offset:3072 lds
v_mfma_f32_32x32x16_bf16 a[160:175], v[88:91], v[72:75], a[160:175]
ds_read_b64_tr_b16 v[58:59], v22 offset:2048
v_add_u32 v240, 0x80, v240
v_add_u32 v241, 0x80, v241
s_add_u32 m0, s100, 16384
v_mfma_f32_32x32x16_bf16 a[176:191], v[88:91], v[76:79], a[176:191]
ds_read_b64_tr_b16 v[60:61], v23 offset:0
buffer_load_dwordx4 v240, s[84:87], s24 offen offset:0 lds
v_mfma_f32_32x32x16_bf16 a[192:207], v[92:95], v[64:67], a[192:207]
ds_read_b64_tr_b16 v[62:63], v23 offset:2048
v_mfma_f32_32x32x16_bf16 a[208:223], v[92:95], v[68:71], a[208:223]
buffer_load_dwordx4 v241, s[84:87], s25 offen offset:1024 lds
v_mfma_f32_32x32x16_bf16 a[224:239], v[92:95], v[72:75], a[224:239]
v_mfma_f32_32x32x16_bf16 a[240:255], v[92:95], v[76:79], a[240:255]
buffer_load_dwordx4 v240, s[84:87], s26 offen offset:2048 lds
s_waitcnt lgkmcnt(0)
v_mfma_f32_32x32x16_bf16 a[0:15], v[48:51], v[32:35], a[0:15]
ds_read_b128 v[64:67], v13 offset:0
v_mfma_f32_32x32x16_bf16 a[16:31], v[48:51], v[36:39], a[16:31]
ds_read_b64_tr_b16 v[80:81], v20 offset:8192
buffer_load_dwordx4 v241, s[84:87], s27 offen offset:3072 lds
v_mfma_f32_32x32x16_bf16 a[32:47], v[48:51], v[40:43], a[32:47]
ds_read_b64_tr_b16 v[82:83], v20 offset:10240
v_add_u32 v240, 0x80, v240
v_add_u32 v241, 0x80, v241
s_add_u32 m0, s100, 32768
v_mfma_f32_32x32x16_bf16 a[48:63], v[48:51], v[44:47], a[48:63]
ds_read_b128 v[68:71], v13 offset:4096
buffer_load_dwordx4 v240, s[84:87], s24 offen offset:0 lds
v_mfma_f32_32x32x16_bf16 a[64:79], v[52:55], v[32:35], a[64:79]
ds_read_b128 v[72:75], v13 offset:8192
v_mfma_f32_32x32x16_bf16 a[80:95], v[52:55], v[36:39], a[80:95]
ds_read_b128 v[76:79], v13 offset:12288
buffer_load_dwordx4 v241, s[84:87], s25 offen offset:1024 lds
v_mfma_f32_32x32x16_bf16 a[96:111], v[52:55], v[40:43], a[96:111]
ds_read_b64_tr_b16 v[84:85], v21 offset:8192
v_mfma_f32_32x32x16_bf16 a[112:127], v[52:55], v[44:47], a[112:127]
ds_read_b64_tr_b16 v[86:87], v21 offset:10240
buffer_load_dwordx4 v240, s[84:87], s26 offen offset:2048 lds
v_mfma_f32_32x32x16_bf16 a[128:143], v[56:59], v[32:35], a[128:143]
ds_read_b64_tr_b16 v[88:89], v22 offset:8192
v_mfma_f32_32x32x16_bf16 a[144:159], v[56:59], v[36:39], a[144:159]
ds_read_b64_tr_b16 v[90:91], v22 offset:10240
buffer_load_dwordx4 v241, s[84:87], s27 offen offset:3072 lds
v_mfma_f32_32x32x16_bf16 a[160:175], v[56:59], v[40:43], a[160:175]
ds_read_b64_tr_b16 v[92:93], v23 offset:8192
v_add_u32 v240, 0x80, v240
v_add_u32 v241, 0x80, v241
s_add_u32 m0, s100, 49152
v_mfma_f32_32x32x16_bf16 a[176:191], v[56:59], v[44:47], a[176:191]
ds_read_b64_tr_b16 v[94:95], v23 offset:10240
buffer_load_dwordx4 v240, s[84:87], s24 offen offset:0 lds
v_mfma_f32_32x32x16_bf16 a[192:207], v[60:63], v[32:35], a[192:207]
v_mfma_f32_32x32x16_bf16 a[208:223], v[60:63], v[36:39], a[208:223]
buffer_load_dwordx4 v241, s[84:87], s25 offen offset:1024 lds
v_mfma_f32_32x32x16_bf16 a[224:239], v[60:63], v[40:43], a[224:239]
v_mfma_f32_32x32x16_bf16 a[240:255], v[60:63], v[44:47], a[240:255]
buffer_load_dwordx4 v240, s[84:87], s26 offen offset:2048 lds
s_waitcnt lgkmcnt(0)
v_mfma_f32_32x32x16_bf16 a[0:15], v[80:83], v[64:67], a[0:15]
ds_read_b128 v[32:35], v14 offset:0
v_mfma_f32_32x32x16_bf16 a[16:31], v[80:83], v[68:71], a[16:31]
ds_read_b64_tr_b16 v[48:49], v20 offset:16384
buffer_load_dwordx4 v241, s[84:87], s27 offen offset:3072 lds
v_mfma_f32_32x32x16_bf16 a[32:47], v[80:83], v[72:75], a[32:47]
ds_read_b64_tr_b16 v[50:51], v20 offset:18432
v_add_u32 v240, 0x80, v240
v_add_u32 v241, 0x80, v241
s_add_u32 m0, s100, 131072
v_mfma_f32_32x32x16_bf16 a[48:63], v[80:83], v[76:79], a[48:63]
ds_read_b128 v[36:39], v14 offset:4096
buffer_load_dwordx4 v246, s[88:91], s16 offen offset:0 lds
v_mfma_f32_32x32x16_bf16 a[64:79], v[84:87], v[64:67], a[64:79]
ds_read_b128 v[40:43], v14 offset:8192
v_mfma_f32_32x32x16_bf16 a[80:95], v[84:87], v[68:71], a[80:95]
ds_read_b128 v[44:47], v14 offset:12288
buffer_load_dwordx4 v246, s[88:91], s17 offen offset:1024 lds
v_mfma_f32_32x32x16_bf16 a[96:111], v[84:87], v[72:75], a[96:111]
ds_read_b64_tr_b16 v[52:53], v21 offset:16384
v_mfma_f32_32x32x16_bf16 a[112:127], v[84:87], v[76:79], a[112:127]
ds_read_b64_tr_b16 v[54:55], v21 offset:18432
buffer_load_dwordx4 v246, s[88:91], s18 offen offset:2048 lds
v_mfma_f32_32x32x16_bf16 a[128:143], v[88:91], v[64:67], a[128:143]
ds_read_b64_tr_b16 v[56:57], v22 offset:16384
v_mfma_f32_32x32x16_bf16 a[144:159], v[88:91], v[68:71], a[144:159]
ds_read_b64_tr_b16 v[58:59], v22 offset:18432
buffer_load_dwordx4 v246, s[88:91], s19 offen offset:3072 lds
v_mfma_f32_32x32x16_bf16 a[160:175], v[88:91], v[72:75], a[160:175]
ds_read_b64_tr_b16 v[60:61], v23 offset:16384
v_add_u32 v246, 524288, v246
v_mfma_f32_32x32x16_bf16 a[176:191], v[88:91], v[76:79], a[176:191]
ds_read_b64_tr_b16 v[62:63], v23 offset:18432
s_mov_b32 m0, 147456
s_nop 0
buffer_load_dwordx4 v31, s[96:99], 0 offen lds
v_mfma_f32_32x32x16_bf16 a[192:207], v[92:95], v[64:67], a[192:207]
v_mfma_f32_32x32x16_bf16 a[208:223], v[92:95], v[68:71], a[208:223]
v_mfma_f32_32x32x16_bf16 a[224:239], v[92:95], v[72:75], a[224:239]
v_mfma_f32_32x32x16_bf16 a[240:255], v[92:95], v[76:79], a[240:255]
s_waitcnt lgkmcnt(0)
v_mfma_f32_32x32x16_bf16 a[0:15], v[48:51], v[32:35], a[0:15]
ds_read_b128 v[64:67], v15 offset:0
v_mfma_f32_32x32x16_bf16 a[16:31], v[48:51], v[36:39], a[16:31]
ds_read_b64_tr_b16 v[80:81], v20 offset:24576
v_mfma_f32_32x32x16_bf16 a[32:47], v[48:51], v[40:43], a[32:47]
ds_read_b64_tr_b16 v[82:83], v20 offset:26624
v_mfma_f32_32x32x16_bf16 a[48:63], v[48:51], v[44:47], a[48:63]
ds_read_b128 v[68:71], v15 offset:4096
v_mfma_f32_32x32x16_bf16 a[64:79], v[52:55], v[32:35], a[64:79]
ds_read_b128 v[72:75], v15 offset:8192
v_mfma_f32_32x32x16_bf16 a[80:95], v[52:55], v[36:39], a[80:95]
ds_read_b128 v[76:79], v15 offset:12288
v_mfma_f32_32x32x16_bf16 a[96:111], v[52:55], v[40:43], a[96:111]
ds_read_b64_tr_b16 v[84:85], v21 offset:24576
v_mfma_f32_32x32x16_bf16 a[112:127], v[52:55], v[44:47], a[112:127]
ds_read_b64_tr_b16 v[86:87], v21 offset:26624
v_mfma_f32_32x32x16_bf16 a[128:143], v[56:59], v[32:35], a[128:143]
ds_read_b64_tr_b16 v[88:89], v22 offset:24576
v_mfma_f32_32x32x16_bf16 a[144:159], v[56:59], v[36:39], a[144:159]
ds_read_b64_tr_b16 v[90:91], v22 offset:26624
v_mfma_f32_32x32x16_bf16 a[160:175], v[56:59], v[40:43], a[160:175]
ds_read_b64_tr_b16 v[92:93], v23 offset:24576
v_mfma_f32_32x32x16_bf16 a[176:191], v[56:59], v[44:47], a[176:191]
ds_read_b64_tr_b16 v[94:95], v23 offset:26624
v_mfma_f32_32x32x16_bf16 a[192:207], v[60:63], v[32:35], a[192:207]
v_mfma_f32_32x32x16_bf16 a[208:223], v[60:63], v[36:39], a[208:223]
v_mfma_f32_32x32x16_bf16 a[224:239], v[60:63], v[40:43], a[224:239]
v_mfma_f32_32x32x16_bf16 a[240:255], v[60:63], v[44:47], a[240:255]
s_waitcnt lgkmcnt(0)
v_mfma_f32_32x32x16_bf16 a[0:15], v[80:83], v[64:67], a[0:15]
s_barrier
s_waitcnt vmcnt(5)
v_add_u32 v12, 0x10000, v250
v_add_u32 v13, 0x10000, v251
v_add_u32 v14, 0x10000, v252
v_add_u32 v15, 0x10000, v253
v_mfma_f32_32x32x16_bf16 a[16:31], v[80:83], v[68:71], a[16:31]
v_add_u32 v16, 0x20000, v250
v_add_u32 v17, 0x20000, v251
v_add_u32 v18, 0x20000, v252
v_add_u32 v19, 0x20000, v253
ds_read_b128 v[128:131], v242 offset:0
ds_read_b128 v[132:135], v243 offset:0
v_mfma_f32_32x32x16_bf16 a[32:47], v[80:83], v[72:75], a[32:47]
ds_read_b128 v[136:139], v244 offset:0
ds_read_b128 v[140:143], v245 offset:0
s_add_u32 m0, s100, 65536
v_mfma_f32_32x32x16_bf16 a[48:63], v[80:83], v[76:79], a[48:63]
ds_read_b128 v[144:147], v242 offset:16384
ds_read_b128 v[148:151], v243 offset:16384
s_nop 0
v_mfma_f32_32x32x16_bf16 a[64:79], v[84:87], v[64:67], a[64:79]
ds_read_b128 v[152:155], v244 offset:16384
ds_read_b128 v[156:159], v245 offset:16384
buffer_load_dwordx4 v240, s[84:87], s24 offen offset:0 lds
buffer_load_dwordx4 v241, s[84:87], s25 offen offset:1024 lds
v_mfma_f32_32x32x16_bf16 a[80:95], v[84:87], v[68:71], a[80:95]
ds_read_b128 v[160:163], v242 offset:32768
ds_read_b128 v[164:167], v243 offset:32768
buffer_load_dwordx4 v240, s[84:87], s26 offen offset:2048 lds
v_mfma_f32_32x32x16_bf16 a[96:111], v[84:87], v[72:75], a[96:111]
ds_read_b128 v[168:171], v244 offset:32768
ds_read_b128 v[172:175], v245 offset:32768
buffer_load_dwordx4 v241, s[84:87], s27 offen offset:3072 lds
v_mfma_f32_32x32x16_bf16 a[112:127], v[84:87], v[76:79], a[112:127]
ds_read_b128 v[176:179], v242 offset:49152
ds_read_b128 v[180:183], v243 offset:49152
v_add_u32 v240, 0x80, v240
v_mfma_f32_32x32x16_bf16 a[128:143], v[88:91], v[64:67], a[128:143]
ds_read_b128 v[184:187], v244 offset:49152
ds_read_b128 v[188:191], v245 offset:49152
v_add_u32 v241, 0x80, v241
s_add_u32 m0, s100, 81920
v_mfma_f32_32x32x16_bf16 a[144:159], v[88:91], v[68:71], a[144:159]
s_nop 0
buffer_load_dwordx4 v240, s[84:87], s24 offen offset:0 lds
buffer_load_dwordx4 v241, s[84:87], s25 offen offset:1024 lds
v_mfma_f32_32x32x16_bf16 a[160:175], v[88:91], v[72:75], a[160:175]
buffer_load_dwordx4 v240, s[84:87], s26 offen offset:2048 lds
buffer_load_dwordx4 v241, s[84:87], s27 offen offset:3072 lds
v_add_u32 v240, 0x80, v240
v_mfma_f32_32x32x16_bf16 a[176:191], v[88:91], v[76:79], a[176:191]
v_add_u32 v241, 0x80, v241
s_add_u32 m0, s100, 98304
s_nop 0
v_mfma_f32_32x32x16_bf16 a[192:207], v[92:95], v[64:67], a[192:207]
buffer_load_dwordx4 v240, s[84:87], s24 offen offset:0 lds
buffer_load_dwordx4 v241, s[84:87], s25 offen offset:1024 lds
buffer_load_dwordx4 v240, s[84:87], s26 offen offset:2048 lds
v_mfma_f32_32x32x16_bf16 a[208:223], v[92:95], v[68:71], a[208:223]
buffer_load_dwordx4 v241, s[84:87], s27 offen offset:3072 lds
v_add_u32 v240, 0x80, v240
v_add_u32 v241, 0x80, v241
s_add_u32 m0, s100, 114688
v_mfma_f32_32x32x16_bf16 a[224:239], v[92:95], v[72:75], a[224:239]
s_nop 0
buffer_load_dwordx4 v246, s[88:91], s16 offen offset:0 lds
buffer_load_dwordx4 v246, s[88:91], s17 offen offset:1024 lds
v_mfma_f32_32x32x16_bf16 a[240:255], v[92:95], v[76:79], a[240:255]
buffer_load_dwordx4 v246, s[88:91], s18 offen offset:2048 lds
buffer_load_dwordx4 v246, s[88:91], s19 offen offset:3072 lds
v_add_u32 v246, 524288, v246
s_branch k1_epi
k1_vpath:
s_waitcnt lgkmcnt(0)
v_mfma_f32_32x32x16_bf16 a[0:15], v[32:35], v[48:51], 0
ds_read_b128 v[64:67], v9 offset:0
v_mfma_f32_32x32x16_bf16 a[16:31], v[36:39], v[48:51], 0
ds_read_b64_tr_b16 v[80:81], v16 offset:8192
v_mfma_f32_32x32x16_bf16 a[32:47], v[40:43], v[48:51], 0
ds_read_b64_tr_b16 v[82:83], v16 offset:10240
v_mfma_f32_32x32x16_bf16 a[48:63], v[44:47], v[48:51], 0
ds_read_b128 v[68:71], v9 offset:4096
v_mfma_f32_32x32x16_bf16 a[64:79], v[32:35], v[52:55], 0
ds_read_b128 v[72:75], v9 offset:8192
v_mfma_f32_32x32x16_bf16 a[80:95], v[36:39], v[52:55], 0
ds_read_b128 v[76:79], v9 offset:12288
v_mfma_f32_32x32x16_bf16 a[96:111], v[40:43], v[52:55], 0
ds_read_b64_tr_b16 v[84:85], v17 offset:8192
v_mfma_f32_32x32x16_bf16 a[112:127], v[44:47], v[52:55], 0
ds_read_b64_tr_b16 v[86:87], v17 offset:10240
v_mfma_f32_32x32x16_bf16 a[128:143], v[32:35], v[56:59], 0
ds_read_b64_tr_b16 v[88:89], v18 offset:8192
v_mfma_f32_32x32x16_bf16 a[144:159], v[36:39], v[56:59], 0
ds_read_b64_tr_b16 v[90:91], v18 offset:10240
v_mfma_f32_32x32x16_bf16 a[160:175], v[40:43], v[56:59], 0
ds_read_b64_tr_b16 v[92:93], v19 offset:8192
v_mfma_f32_32x32x16_bf16 a[176:191], v[44:47], v[56:59], 0
ds_read_b64_tr_b16 v[94:95], v19 offset:10240
v_mfma_f32_32x32x16_bf16 a[192:207], v[32:35], v[60:63], 0
v_mfma_f32_32x32x16_bf16 a[208:223], v[36:39], v[60:63], 0
v_mfma_f32_32x32x16_bf16 a[224:239], v[40:43], v[60:63], 0
v_mfma_f32_32x32x16_bf16 a[240:255], v[44:47], v[60:63], 0
s_waitcnt lgkmcnt(0)
v_mfma_f32_32x32x16_bf16 a[0:15], v[64:67], v[80:83], a[0:15]
ds_read_b128 v[32:35], v10 offset:0
v_mfma_f32_32x32x16_bf16 a[16:31], v[68:71], v[80:83], a[16:31]
ds_read_b64_tr_b16 v[48:49], v16 offset:16384
v_mfma_f32_32x32x16_bf16 a[32:47], v[72:75], v[80:83], a[32:47]
ds_read_b64_tr_b16 v[50:51], v16 offset:18432
v_mfma_f32_32x32x16_bf16 a[48:63], v[76:79], v[80:83], a[48:63]
ds_read_b128 v[36:39], v10 offset:4096
v_mfma_f32_32x32x16_bf16 a[64:79], v[64:67], v[84:87], a[64:79]
ds_read_b128 v[40:43], v10 offset:8192
v_mfma_f32_32x32x16_bf16 a[80:95], v[68:71], v[84:87], a[80:95]
ds_read_b128 v[44:47], v10 offset:12288
v_mfma_f32_32x32x16_bf16 a[96:111], v[72:75], v[84:87], a[96:111]
ds_read_b64_tr_b16 v[52:53], v17 offset:16384
v_mfma_f32_32x32x16_bf16 a[112:127], v[76:79], v[84:87], a[112:127]
ds_read_b64_tr_b16 v[54:55], v17 offset:18432
v_mfma_f32_32x32x16_bf16 a[128:143], v[64:67], v[88:91], a[128:143]
ds_read_b64_tr_b16 v[56:57], v18 offset:16384
v_mfma_f32_32x32x16_bf16 a[144:159], v[68:71], v[88:91], a[144:159]
ds_read_b64_tr_b16 v[58:59], v18 offset:18432
v_mfma_f32_32x32x16_bf16 a[160:175], v[72:75], v[88:91], a[160:175]
ds_read_b64_tr_b16 v[60:61], v19 offset:16384
v_mfma_f32_32x32x16_bf16 a[176:191], v[76:79], v[88:91], a[176:191]
ds_read_b64_tr_b16 v[62:63], v19 offset:18432
v_mfma_f32_32x32x16_bf16 a[192:207], v[64:67], v[92:95], a[192:207]
v_mfma_f32_32x32x16_bf16 a[208:223], v[68:71], v[92:95], a[208:223]
v_mfma_f32_32x32x16_bf16 a[224:239], v[72:75], v[92:95], a[224:239]
v_mfma_f32_32x32x16_bf16 a[240:255], v[76:79], v[92:95], a[240:255]
s_waitcnt lgkmcnt(0)
v_mfma_f32_32x32x16_bf16 a[0:15], v[32:35], v[48:51], a[0:15]
ds_read_b128 v[64:67], v11 offset:0
v_mfma_f32_32x32x16_bf16 a[16:31], v[36:39], v[48:51], a[16:31]
ds_read_b64_tr_b16 v[80:81], v16 offset:24576
v_mfma_f32_32x32x16_bf16 a[32:47], v[40:43], v[48:51], a[32:47]
ds_read_b64_tr_b16 v[82:83], v16 offset:26624
v_mfma_f32_32x32x16_bf16 a[48:63], v[44:47], v[48:51], a[48:63]
ds_read_b128 v[68:71], v11 offset:4096
v_mfma_f32_32x32x16_bf16 a[64:79], v[32:35], v[52:55], a[64:79]
ds_read_b128 v[72:75], v11 offset:8192
v_mfma_f32_32x32x16_bf16 a[80:95], v[36:39], v[52:55], a[80:95]
ds_read_b128 v[76:79], v11 offset:12288
v_mfma_f32_32x32x16_bf16 a[96:111], v[40:43], v[52:55], a[96:111]
ds_read_b64_tr_b16 v[84:85], v17 offset:24576
v_mfma_f32_32x32x16_bf16 a[112:127], v[44:47], v[52:55], a[112:127]
ds_read_b64_tr_b16 v[86:87], v17 offset:26624
v_mfma_f32_32x32x16_bf16 a[128:143], v[32:35], v[56:59], a[128:143]
ds_read_b64_tr_b16 v[88:89], v18 offset:24576
v_mfma_f32_32x32x16_bf16 a[144:159], v[36:39], v[56:59], a[144:159]
ds_read_b64_tr_b16 v[90:91], v18 offset:26624
v_mfma_f32_32x32x16_bf16 a[160:175], v[40:43], v[56:59], a[160:175]
ds_read_b64_tr_b16 v[92:93], v19 offset:24576
v_mfma_f32_32x32x16_bf16 a[176:191], v[44:47], v[56:59], a[176:191]
ds_read_b64_tr_b16 v[94:95], v19 offset:26624
v_mfma_f32_32x32x16_bf16 a[192:207], v[32:35], v[60:63], a[192:207]
v_mfma_f32_32x32x16_bf16 a[208:223], v[36:39], v[60:63], a[208:223]
v_mfma_f32_32x32x16_bf16 a[224:239], v[40:43], v[60:63], a[224:239]
v_mfma_f32_32x32x16_bf16 a[240:255], v[44:47], v[60:63], a[240:255]
s_mov_b32 s33, 7
.p2align 6
k1_v_loop:
s_waitcnt lgkmcnt(0)
v_mfma_f32_32x32x16_bf16 a[0:15], v[64:67], v[80:83], a[0:15]
s_waitcnt vmcnt(1)
s_barrier
s_add_u32 m0, s32, 0
v_mfma_f32_32x32x16_bf16 a[16:31], v[68:71], v[80:83], a[16:31]
ds_read_b128 v[32:35], v12 offset:0
buffer_load_dwordx4 v1, s[4:7], s16 offen offset:0 lds
v_mfma_f32_32x32x16_bf16 a[32:47], v[72:75], v[80:83], a[32:47]
ds_read_b64_tr_b16 v[48:49], v20 offset:0
v_mfma_f32_32x32x16_bf16 a[48:63], v[76:79], v[80:83], a[48:63]
ds_read_b64_tr_b16 v[50:51], v20 offset:2048
v_mfma_f32_32x32x16_bf16 a[64:79], v[64:67], v[84:87], a[64:79]
ds_read_b128 v[36:39], v12 offset:4096
buffer_load_dwordx4 v2, s[4:7], s17 offen offset:1024 lds
v_mfma_f32_32x32x16_bf16 a[80:95], v[68:71], v[84:87], a[80:95]
ds_read_b128 v[40:43], v12 offset:8192
v_mfma_f32_32x32x16_bf16 a[96:111], v[72:75], v[84:87], a[96:111]
ds_read_b128 v[44:47], v12 offset:12288
v_mfma_f32_32x32x16_bf16 a[112:127], v[76:79], v[84:87], a[112:127]
ds_read_b64_tr_b16 v[52:53], v21 offset:0
buffer_load_dwordx4 v1, s[4:7], s18 offen offset:2048 lds
v_mfma_f32_32x32x16_bf16 a[128:143], v[64:67], v[88:91], a[128:143]
ds_read_b64_tr_b16 v[54:55], v21 offset:2048
v_mfma_f32_32x32x16_bf16 a[144:159], v[68:71], v[88:91], a[144:159]
ds_read_b64_tr_b16 v[56:57], v22 offset:0
v_mfma_f32_32x32x16_bf16 a[160:175], v[72:75], v[88:91], a[160:175]
ds_read_b64_tr_b16 v[58:59], v22 offset:2048
buffer_load_dwordx4 v2, s[4:7], s19 offen offset:3072 lds
v_mfma_f32_32x32x16_bf16 a[176:191], v[76:79], v[88:91], a[176:191]
ds_read_b64_tr_b16 v[60:61], v23 offset:0
v_mfma_f32_32x32x16_bf16 a[192:207], v[64:67], v[92:95], a[192:207]
ds_read_b64_tr_b16 v[62:63], v23 offset:2048
s_add_u32 m0, s32, 4096
v_mfma_f32_32x32x16_bf16 a[208:223], v[68:71], v[92:95], a[208:223]
buffer_load_dwordx4 v1, s[4:7], s20 offen offset:0 lds
v_mfma_f32_32x32x16_bf16 a[224:239], v[72:75], v[92:95], a[224:239]
v_mfma_f32_32x32x16_bf16 a[240:255], v[76:79], v[92:95], a[240:255]
s_waitcnt lgkmcnt(0)
v_mfma_f32_32x32x16_bf16 a[0:15], v[32:35], v[48:51], a[0:15]
ds_read_b128 v[64:67], v13 offset:0
buffer_load_dwordx4 v2, s[4:7], s21 offen offset:1024 lds
v_mfma_f32_32x32x16_bf16 a[16:31], v[36:39], v[48:51], a[16:31]
ds_read_b64_tr_b16 v[80:81], v20 offset:8192
v_mfma_f32_32x32x16_bf16 a[32:47], v[40:43], v[48:51], a[32:47]
ds_read_b64_tr_b16 v[82:83], v20 offset:10240
v_mfma_f32_32x32x16_bf16 a[48:63], v[44:47], v[48:51], a[48:63]
ds_read_b128 v[68:71], v13 offset:4096
buffer_load_dwordx4 v1, s[4:7], s22 offen offset:2048 lds
v_mfma_f32_32x32x16_bf16 a[64:79], v[32:35], v[52:55], a[64:79]
ds_read_b128 v[72:75], v13 offset:8192
v_mfma_f32_32x32x16_bf16 a[80:95], v[36:39], v[52:55], a[80:95]
ds_read_b128 v[76:79], v13 offset:12288
v_mfma_f32_32x32x16_bf16 a[96:111], v[40:43], v[52:55], a[96:111]
ds_read_b64_tr_b16 v[84:85], v21 offset:8192
buffer_load_dwordx4 v2, s[4:7], s23 offen offset:3072 lds
v_mfma_f32_32x32x16_bf16 a[112:127], v[44:47], v[52:55], a[112:127]
ds_read_b64_tr_b16 v[86:87], v21 offset:10240
v_mfma_f32_32x32x16_bf16 a[128:143], v[32:35], v[56:59], a[128:143]
ds_read_b64_tr_b16 v[88:89], v22 offset:8192
s_add_u32 m0, s32, 32768
v_mfma_f32_32x32x16_bf16 a[144:159], v[36:39], v[56:59], a[144:159]
ds_read_b64_tr_b16 v[90:91], v22 offset:10240
buffer_load_dwordx4 v3, s[8:11], s24 offen offset:0 lds
v_mfma_f32_32x32x16_bf16 a[160:175], v[40:43], v[56:59], a[160:175]
ds_read_b64_tr_b16 v[92:93], v23 offset:8192
v_mfma_f32_32x32x16_bf16 a[176:191], v[44:47], v[56:59], a[176:191]
ds_read_b64_tr_b16 v[94:95], v23 offset:10240
v_mfma_f32_32x32x16_bf16 a[192:207], v[32:35], v[60:63], a[192:207]
buffer_load_dwordx4 v4, s[8:11], s25 offen offset:1024 lds
v_mfma_f32_32x32x16_bf16 a[208:223], v[36:39], v[60:63], a[208:223]
v_mfma_f32_32x32x16_bf16 a[224:239], v[40:43], v[60:63], a[224:239]
v_mfma_f32_32x32x16_bf16 a[240:255], v[44:47], v[60:63], a[240:255]
buffer_load_dwordx4 v3, s[8:11], s26 offen offset:2048 lds
s_waitcnt lgkmcnt(0)
v_mfma_f32_32x32x16_bf16 a[0:15], v[64:67], v[80:83], a[0:15]
ds_read_b128 v[32:35], v14 offset:0
v_mfma_f32_32x32x16_bf16 a[16:31], v[68:71], v[80:83], a[16:31]
ds_read_b64_tr_b16 v[48:49], v20 offset:16384
v_mfma_f32_32x32x16_bf16 a[32:47], v[72:75], v[80:83], a[32:47]
ds_read_b64_tr_b16 v[50:51], v20 offset:18432
buffer_load_dwordx4 v4, s[8:11], s27 offen offset:3072 lds
v_mfma_f32_32x32x16_bf16 a[48:63], v[76:79], v[80:83], a[48:63]
ds_read_b128 v[36:39], v14 offset:4096
v_mfma_f32_32x32x16_bf16 a[64:79], v[64:67], v[84:87], a[64:79]
ds_read_b128 v[40:43], v14 offset:8192
s_add_u32 m0, s32, 36864
v_mfma_f32_32x32x16_bf16 a[80:95], v[68:71], v[84:87], a[80:95]
ds_read_b128 v[44:47], v14 offset:12288
buffer_load_dwordx4 v3, s[8:11], s28 offen offset:0 lds
v_mfma_f32_32x32x16_bf16 a[96:111], v[72:75], v[84:87], a[96:111]
ds_read_b64_tr_b16 v[52:53], v21 offset:16384
v_mfma_f32_32x32x16_bf16 a[112:127], v[76:79], v[84:87], a[112:127]
ds_read_b64_tr_b16 v[54:55], v21 offset:18432
v_mfma_f32_32x32x16_bf16 a[128:143], v[64:67], v[88:91], a[128:143]
ds_read_b64_tr_b16 v[56:57], v22 offset:16384
buffer_load_dwordx4 v4, s[8:11], s29 offen offset:1024 lds
v_mfma_f32_32x32x16_bf16 a[144:159], v[68:71], v[88:91], a[144:159]
ds_read_b64_tr_b16 v[58:59], v22 offset:18432
v_mfma_f32_32x32x16_bf16 a[160:175], v[72:75], v[88:91], a[160:175]
ds_read_b64_tr_b16 v[60:61], v23 offset:16384
v_mfma_f32_32x32x16_bf16 a[176:191], v[76:79], v[88:91], a[176:191]
ds_read_b64_tr_b16 v[62:63], v23 offset:18432
buffer_load_dwordx4 v3, s[8:11], s30 offen offset:2048 lds
v_mfma_f32_32x32x16_bf16 a[192:207], v[64:67], v[92:95], a[192:207]
v_mfma_f32_32x32x16_bf16 a[208:223], v[68:71], v[92:95], a[208:223]
v_mfma_f32_32x32x16_bf16 a[224:239], v[72:75], v[92:95], a[224:239]
buffer_load_dwordx4 v4, s[8:11], s31 offen offset:3072 lds
v_mfma_f32_32x32x16_bf16 a[240:255], v[76:79], v[92:95], a[240:255]
s_waitcnt lgkmcnt(0)
v_mfma_f32_32x32x16_bf16 a[0:15], v[32:35], v[48:51], a[0:15]
ds_read_b128 v[64:67], v15 offset:0
v_mfma_f32_32x32x16_bf16 a[16:31], v[36:39], v[48:51], a[16:31]
ds_read_b64_tr_b16 v[80:81], v20 offset:24576
v_add_u32 v1, 0x80, v1
v_add_u32 v2, 0x80, v2
v_add_u32 v3, 0x80000, v3
v_add_u32 v4, 0x80000, v4
v_mfma_f32_32x32x16_bf16 a[32:47], v[40:43], v[48:51], a[32:47]
ds_read_b64_tr_b16 v[82:83], v20 offset:26624
v_mfma_f32_32x32x16_bf16 a[48:63], v[44:47], v[48:51], a[48:63]
ds_read_b128 v[68:71], v15 offset:4096
buffer_load_dwordx4 v[24:27], v255, s[8:11], 0 offen
v_mfma_f32_32x32x16_bf16 a[64:79], v[32:35], v[52:55], a[64:79]
ds_read_b128 v[72:75], v15 offset:8192
v_add_u32 v255, 0x80000, v255
v_mfma_f32_32x32x16_bf16 a[80:95], v[36:39], v[52:55], a[80:95]
ds_read_b128 v[76:79], v15 offset:12288
v_mfma_f32_32x32x16_bf16 a[96:111], v[40:43], v[52:55], a[96:111]
ds_read_b64_tr_b16 v[84:85], v21 offset:24576
v_mfma_f32_32x32x16_bf16 a[112:127], v[44:47], v[52:55], a[112:127]
ds_read_b64_tr_b16 v[86:87], v21 offset:26624
v_mfma_f32_32x32x16_bf16 a[128:143], v[32:35], v[56:59], a[128:143]
ds_read_b64_tr_b16 v[88:89], v22 offset:24576
v_mfma_f32_32x32x16_bf16 a[144:159], v[36:39], v[56:59], a[144:159]
ds_read_b64_tr_b16 v[90:91], v22 offset:26624
v_mfma_f32_32x32x16_bf16 a[160:175], v[40:43], v[56:59], a[160:175]
ds_read_b64_tr_b16 v[92:93], v23 offset:24576
v_mfma_f32_32x32x16_bf16 a[176:191], v[44:47], v[56:59], a[176:191]
ds_read_b64_tr_b16 v[94:95], v23 offset:26624
v_mfma_f32_32x32x16_bf16 a[192:207], v[32:35], v[60:63], a[192:207]
v_mfma_f32_32x32x16_bf16 a[208:223], v[36:39], v[60:63], a[208:223]
v_mfma_f32_32x32x16_bf16 a[224:239], v[40:43], v[60:63], a[224:239]
v_mfma_f32_32x32x16_bf16 a[240:255], v[44:47], v[60:63], a[240:255]
s_waitcnt lgkmcnt(0)
v_mfma_f32_32x32x16_bf16 a[0:15], v[64:67], v[80:83], a[0:15]
s_waitcnt vmcnt(1)
s_barrier
s_add_u32 m0, s32, 65536
v_mfma_f32_32x32x16_bf16 a[16:31], v[68:71], v[80:83], a[16:31]
ds_read_b128 v[32:35], v8 offset:0
buffer_load_dwordx4 v1, s[4:7], s16 offen offset:0 lds
v_mfma_f32_32x32x16_bf16 a[32:47], v[72:75], v[80:83], a[32:47]
ds_read_b64_tr_b16 v[48:49], v16 offset:0
v_mfma_f32_32x32x16_bf16 a[48:63], v[76:79], v[80:83], a[48:63]
ds_read_b64_tr_b16 v[50:51], v16 offset:2048
v_mfma_f32_32x32x16_bf16 a[64:79], v[64:67], v[84:87], a[64:79]
ds_read_b128 v[36:39], v8 offset:4096
buffer_load_dwordx4 v2, s[4:7], s17 offen offset:1024 lds
v_mfma_f32_32x32x16_bf16 a[80:95], v[68:71], v[84:87], a[80:95]
ds_read_b128 v[40:43], v8 offset:8192
v_mfma_f32_32x32x16_bf16 a[96:111], v[72:75], v[84:87], a[96:111]
ds_read_b128 v[44:47], v8 offset:12288
v_mfma_f32_32x32x16_bf16 a[112:127], v[76:79], v[84:87], a[112:127]
ds_read_b64_tr_b16 v[52:53], v17 offset:0
buffer_load_dwordx4 v1, s[4:7], s18 offen offset:2048 lds
v_mfma_f32_32x32x16_bf16 a[128:143], v[64:67], v[88:91], a[128:143]
ds_read_b64_tr_b16 v[54:55], v17 offset:2048
v_mfma_f32_32x32x16_bf16 a[144:159], v[68:71], v[88:91], a[144:159]
ds_read_b64_tr_b16 v[56:57], v18 offset:0
v_mfma_f32_32x32x16_bf16 a[160:175], v[72:75], v[88:91], a[160:175]
ds_read_b64_tr_b16 v[58:59], v18 offset:2048
buffer_load_dwordx4 v2, s[4:7], s19 offen offset:3072 lds
v_mfma_f32_32x32x16_bf16 a[176:191], v[76:79], v[88:91], a[176:191]
ds_read_b64_tr_b16 v[60:61], v19 offset:0
v_mfma_f32_32x32x16_bf16 a[192:207], v[64:67], v[92:95], a[192:207]
ds_read_b64_tr_b16 v[62:63], v19 offset:2048
s_add_u32 m0, s32, 69632
v_mfma_f32_32x32x16_bf16 a[208:223], v[68:71], v[92:95], a[208:223]
buffer_load_dwordx4 v1, s[4:7], s20 offen offset:0 lds
v_mfma_f32_32x32x16_bf16 a[224:239], v[72:75], v[92:95], a[224:239]
v_mfma_f32_32x32x16_bf16 a[240:255], v[76:79], v[92:95], a[240:255]
s_waitcnt lgkmcnt(0)
v_mfma_f32_32x32x16_bf16 a[0:15], v[32:35], v[48:51], a[0:15]
ds_read_b128 v[64:67], v9 offset:0
buffer_load_dwordx4 v2, s[4:7], s21 offen offset:1024 lds
v_mfma_f32_32x32x16_bf16 a[16:31], v[36:39], v[48:51], a[16:31]
ds_read_b64_tr_b16 v[80:81], v16 offset:8192
v_mfma_f32_32x32x16_bf16 a[32:47], v[40:43], v[48:51], a[32:47]
ds_read_b64_tr_b16 v[82:83], v16 offset:10240
v_mfma_f32_32x32x16_bf16 a[48:63], v[44:47], v[48:51], a[48:63]
ds_read_b128 v[68:71], v9 offset:4096
buffer_load_dwordx4 v1, s[4:7], s22 offen offset:2048 lds
v_mfma_f32_32x32x16_bf16 a[64:79], v[32:35], v[52:55], a[64:79]
ds_read_b128 v[72:75], v9 offset:8192
v_mfma_f32_32x32x16_bf16 a[80:95], v[36:39], v[52:55], a[80:95]
ds_read_b128 v[76:79], v9 offset:12288
v_mfma_f32_32x32x16_bf16 a[96:111], v[40:43], v[52:55], a[96:111]
ds_read_b64_tr_b16 v[84:85], v17 offset:8192
buffer_load_dwordx4 v2, s[4:7], s23 offen offset:3072 lds
v_mfma_f32_32x32x16_bf16 a[112:127], v[44:47], v[52:55], a[112:127]
ds_read_b64_tr_b16 v[86:87], v17 offset:10240
v_mfma_f32_32x32x16_bf16 a[128:143], v[32:35], v[56:59], a[128:143]
ds_read_b64_tr_b16 v[88:89], v18 offset:8192
s_add_u32 m0, s32, 98304
v_mfma_f32_32x32x16_bf16 a[144:159], v[36:39], v[56:59], a[144:159]
ds_read_b64_tr_b16 v[90:91], v18 offset:10240
buffer_load_dwordx4 v3, s[8:11], s24 offen offset:0 lds
v_mfma_f32_32x32x16_bf16 a[160:175], v[40:43], v[56:59], a[160:175]
ds_read_b64_tr_b16 v[92:93], v19 offset:8192
v_mfma_f32_32x32x16_bf16 a[176:191], v[44:47], v[56:59], a[176:191]
ds_read_b64_tr_b16 v[94:95], v19 offset:10240
v_mfma_f32_32x32x16_bf16 a[192:207], v[32:35], v[60:63], a[192:207]
buffer_load_dwordx4 v4, s[8:11], s25 offen offset:1024 lds
v_mfma_f32_32x32x16_bf16 a[208:223], v[36:39], v[60:63], a[208:223]
v_mfma_f32_32x32x16_bf16 a[224:239], v[40:43], v[60:63], a[224:239]
v_mfma_f32_32x32x16_bf16 a[240:255], v[44:47], v[60:63], a[240:255]
buffer_load_dwordx4 v3, s[8:11], s26 offen offset:2048 lds
s_waitcnt lgkmcnt(0)
v_mfma_f32_32x32x16_bf16 a[0:15], v[64:67], v[80:83], a[0:15]
ds_read_b128 v[32:35], v10 offset:0
v_mfma_f32_32x32x16_bf16 a[16:31], v[68:71], v[80:83], a[16:31]
ds_read_b64_tr_b16 v[48:49], v16 offset:16384
v_mfma_f32_32x32x16_bf16 a[32:47], v[72:75], v[80:83], a[32:47]
ds_read_b64_tr_b16 v[50:51], v16 offset:18432
buffer_load_dwordx4 v4, s[8:11], s27 offen offset:3072 lds
v_mfma_f32_32x32x16_bf16 a[48:63], v[76:79], v[80:83], a[48:63]
ds_read_b128 v[36:39], v10 offset:4096
v_mfma_f32_32x32x16_bf16 a[64:79], v[64:67], v[84:87], a[64:79]
ds_read_b128 v[40:43], v10 offset:8192
s_add_u32 m0, s32, 102400
v_mfma_f32_32x32x16_bf16 a[80:95], v[68:71], v[84:87], a[80:95]
ds_read_b128 v[44:47], v10 offset:12288
buffer_load_dwordx4 v3, s[8:11], s28 offen offset:0 lds
v_mfma_f32_32x32x16_bf16 a[96:111], v[72:75], v[84:87], a[96:111]
ds_read_b64_tr_b16 v[52:53], v17 offset:16384
v_mfma_f32_32x32x16_bf16 a[112:127], v[76:79], v[84:87], a[112:127]
ds_read_b64_tr_b16 v[54:55], v17 offset:18432
v_mfma_f32_32x32x16_bf16 a[128:143], v[64:67], v[88:91], a[128:143]
ds_read_b64_tr_b16 v[56:57], v18 offset:16384
buffer_load_dwordx4 v4, s[8:11], s29 offen offset:1024 lds
v_mfma_f32_32x32x16_bf16 a[144:159], v[68:71], v[88:91], a[144:159]
ds_read_b64_tr_b16 v[58:59], v18 offset:18432
v_mfma_f32_32x32x16_bf16 a[160:175], v[72:75], v[88:91], a[160:175]
ds_read_b64_tr_b16 v[60:61], v19 offset:16384
v_mfma_f32_32x32x16_bf16 a[176:191], v[76:79], v[88:91], a[176:191]
ds_read_b64_tr_b16 v[62:63], v19 offset:18432
buffer_load_dwordx4 v3, s[8:11], s30 offen offset:2048 lds
v_mfma_f32_32x32x16_bf16 a[192:207], v[64:67], v[92:95], a[192:207]
v_mfma_f32_32x32x16_bf16 a[208:223], v[68:71], v[92:95], a[208:223]
v_mfma_f32_32x32x16_bf16 a[224:239], v[72:75], v[92:95], a[224:239]
buffer_load_dwordx4 v4, s[8:11], s31 offen offset:3072 lds
v_mfma_f32_32x32x16_bf16 a[240:255], v[76:79], v[92:95], a[240:255]
s_waitcnt lgkmcnt(0)
v_mfma_f32_32x32x16_bf16 a[0:15], v[32:35], v[48:51], a[0:15]
ds_read_b128 v[64:67], v11 offset:0
v_mfma_f32_32x32x16_bf16 a[16:31], v[36:39], v[48:51], a[16:31]
ds_read_b64_tr_b16 v[80:81], v16 offset:24576
v_add_u32 v1, 0x80, v1
v_add_u32 v2, 0x80, v2
v_add_u32 v3, 0x80000, v3
v_add_u32 v4, 0x80000, v4
v_mfma_f32_32x32x16_bf16 a[32:47], v[40:43], v[48:51], a[32:47]
ds_read_b64_tr_b16 v[82:83], v16 offset:26624
v_mfma_f32_32x32x16_bf16 a[48:63], v[44:47], v[48:51], a[48:63]
ds_read_b128 v[68:71], v11 offset:4096
buffer_load_dwordx4 v[24:27], v255, s[8:11], 0 offen
v_mfma_f32_32x32x16_bf16 a[64:79], v[32:35], v[52:55], a[64:79]
ds_read_b128 v[72:75], v11 offset:8192
v_add_u32 v255, 0x80000, v255
v_mfma_f32_32x32x16_bf16 a[80:95], v[36:39], v[52:55], a[80:95]
ds_read_b128 v[76:79], v11 offset:12288
v_mfma_f32_32x32x16_bf16 a[96:111], v[40:43], v[52:55], a[96:111]
ds_read_b64_tr_b16 v[84:85], v17 offset:24576
v_mfma_f32_32x32x16_bf16 a[112:127], v[44:47], v[52:55], a[112:127]
ds_read_b64_tr_b16 v[86:87], v17 offset:26624
v_mfma_f32_32x32x16_bf16 a[128:143], v[32:35], v[56:59], a[128:143]
ds_read_b64_tr_b16 v[88:89], v18 offset:24576
v_mfma_f32_32x32x16_bf16 a[144:159], v[36:39], v[56:59], a[144:159]
ds_read_b64_tr_b16 v[90:91], v18 offset:26624
v_mfma_f32_32x32x16_bf16 a[160:175], v[40:43], v[56:59], a[160:175]
ds_read_b64_tr_b16 v[92:93], v19 offset:24576
v_mfma_f32_32x32x16_bf16 a[176:191], v[44:47], v[56:59], a[176:191]
ds_read_b64_tr_b16 v[94:95], v19 offset:26624
v_mfma_f32_32x32x16_bf16 a[192:207], v[32:35], v[60:63], a[192:207]
v_mfma_f32_32x32x16_bf16 a[208:223], v[36:39], v[60:63], a[208:223]
v_mfma_f32_32x32x16_bf16 a[224:239], v[40:43], v[60:63], a[224:239]
v_mfma_f32_32x32x16_bf16 a[240:255], v[44:47], v[60:63], a[240:255]
s_sub_u32 s33, s33, 1
s_cmp_lg_u32 s33, 0
s_cbranch_scc1 k1_v_loop
s_load_dwordx2 s[36:37], s[0:1], 40
s_load_dwordx2 s[38:39], s[0:1], 64
s_lshl_b32 s33, s56, 17
s_mul_i32 s59, s56, 57344
s_add_u32 s16, s33, 0
s_add_u32 s20, s59, 0
s_add_u32 s24, s81, 0
s_add_u32 s17, s33, 31744
s_add_u32 s21, s59, 13312
s_add_u32 s25, s81, 6144
s_add_u32 s18, s33, 63488
s_add_u32 s22, s59, 26624
s_add_u32 s26, s81, 12288
s_add_u32 s19, s33, 95232
s_add_u32 s23, s59, 39936
s_add_u32 s27, s81, 18432
s_waitcnt lgkmcnt(0)
v_mfma_f32_32x32x16_bf16 a[0:15], v[64:67], v[80:83], a[0:15]
s_waitcnt vmcnt(1)
s_barrier
v_mfma_f32_32x32x16_bf16 a[16:31], v[68:71], v[80:83], a[16:31]
ds_read_b128 v[32:35], v12 offset:0
v_mfma_f32_32x32x16_bf16 a[32:47], v[72:75], v[80:83], a[32:47]
ds_read_b64_tr_b16 v[48:49], v20 offset:0
s_add_u32 m0, s100, 0
v_mfma_f32_32x32x16_bf16 a[48:63], v[76:79], v[80:83], a[48:63]
ds_read_b64_tr_b16 v[50:51], v20 offset:2048
buffer_load_dwordx4 v240, s[84:87], s24 offen offset:0 lds
v_mfma_f32_32x32x16_bf16 a[64:79], v[64:67], v[84:87], a[64:79]
ds_read_b128 v[36:39], v12 offset:4096
v_mfma_f32_32x32x16_bf16 a[80:95], v[68:71], v[84:87], a[80:95]
ds_read_b128 v[40:43], v12 offset:8192
buffer_load_dwordx4 v241, s[84:87], s25 offen offset:1024 lds
v_mfma_f32_32x32x16_bf16 a[96:111], v[72:75], v[84:87], a[96:111]
ds_read_b128 v[44:47], v12 offset:12288
v_mfma_f32_32x32x16_bf16 a[112:127], v[76:79], v[84:87], a[112:127]
ds_read_b64_tr_b16 v[52:53], v21 offset:0
buffer_load_dwordx4 v240, s[84:87], s26 offen offset:2048 lds
v_mfma_f32_32x32x16_bf16 a[128:143], v[64:67], v[88:91], a[128:143]
ds_read_b64_tr_b16 v[54:55], v21 offset:2048
v_mfma_f32_32x32x16_bf16 a[144:159], v[68:71], v[88:91], a[144:159]
ds_read_b64_tr_b16 v[56:57], v22 offset:0
buffer_load_dwordx4 v241, s[84:87], s27 offen offset:3072 lds
v_mfma_f32_32x32x16_bf16 a[160:175], v[72:75], v[88:91], a[160:175]
ds_read_b64_tr_b16 v[58:59], v22 offset:2048
v_add_u32 v240, 0x80, v240
v_add_u32 v241, 0x80, v241
s_add_u32 m0, s100, 16384
v_mfma_f32_32x32x16_bf16 a[176:191], v[76:79], v[88:91], a[176:191]
ds_read_b64_tr_b16 v[60:61], v23 offset:0
buffer_load_dwordx4 v240, s[84:87], s24 offen offset:0 lds
v_mfma_f32_32x32x16_bf16 a[192:207], v[64:67], v[92:95], a[192:207]
ds_read_b64_tr_b16 v[62:63], v23 offset:2048
v_mfma_f32_32x32x16_bf16 a[208:223], v[68:71], v[92:95], a[208:223]
buffer_load_dwordx4 v241, s[84:87], s25 offen offset:1024 lds
v_mfma_f32_32x32x16_bf16 a[224:239], v[72:75], v[92:95], a[224:239]
v_mfma_f32_32x32x16_bf16 a[240:255], v[76:79], v[92:95], a[240:255]
buffer_load_dwordx4 v240, s[84:87], s26 offen offset:2048 lds
s_waitcnt lgkmcnt(0)
v_mfma_f32_32x32x16_bf16 a[0:15], v[32:35], v[48:51], a[0:15]
ds_read_b128 v[64:67], v13 offset:0
v_mfma_f32_32x32x16_bf16 a[16:31], v[36:39], v[48:51], a[16:31]
ds_read_b64_tr_b16 v[80:81], v20 offset:8192
buffer_load_dwordx4 v241, s[84:87], s27 offen offset:3072 lds
v_mfma_f32_32x32x16_bf16 a[32:47], v[40:43], v[48:51], a[32:47]
ds_read_b64_tr_b16 v[82:83], v20 offset:10240
v_add_u32 v240, 0x80, v240
v_add_u32 v241, 0x80, v241
s_add_u32 m0, s100, 32768
v_mfma_f32_32x32x16_bf16 a[48:63], v[44:47], v[48:51], a[48:63]
ds_read_b128 v[68:71], v13 offset:4096
buffer_load_dwordx4 v240, s[84:87], s24 offen offset:0 lds
v_mfma_f32_32x32x16_bf16 a[64:79], v[32:35], v[52:55], a[64:79]
ds_read_b128 v[72:75], v13 offset:8192
v_mfma_f32_32x32x16_bf16 a[80:95], v[36:39], v[52:55], a[80:95]
ds_read_b128 v[76:79], v13 offset:12288
buffer_load_dwordx4 v241, s[84:87], s25 offen offset:1024 lds
v_mfma_f32_32x32x16_bf16 a[96:111], v[40:43], v[52:55], a[96:111]
ds_read_b64_tr_b16 v[84:85], v21 offset:8192
v_mfma_f32_32x32x16_bf16 a[112:127], v[44:47], v[52:55], a[112:127]
ds_read_b64_tr_b16 v[86:87], v21 offset:10240
buffer_load_dwordx4 v240, s[84:87], s26 offen offset:2048 lds
v_mfma_f32_32x32x16_bf16 a[128:143], v[32:35], v[56:59], a[128:143]
ds_read_b64_tr_b16 v[88:89], v22 offset:8192
v_mfma_f32_32x32x16_bf16 a[144:159], v[36:39], v[56:59], a[144:159]
ds_read_b64_tr_b16 v[90:91], v22 offset:10240
buffer_load_dwordx4 v241, s[84:87], s27 offen offset:3072 lds
v_mfma_f32_32x32x16_bf16 a[160:175], v[40:43], v[56:59], a[160:175]
ds_read_b64_tr_b16 v[92:93], v23 offset:8192
v_add_u32 v240, 0x80, v240
v_add_u32 v241, 0x80, v241
s_add_u32 m0, s100, 49152
v_mfma_f32_32x32x16_bf16 a[176:191], v[44:47], v[56:59], a[176:191]
ds_read_b64_tr_b16 v[94:95], v23 offset:10240
buffer_load_dwordx4 v240, s[84:87], s24 offen offset:0 lds
v_mfma_f32_32x32x16_bf16 a[192:207], v[32:35], v[60:63], a[192:207]
v_mfma_f32_32x32x16_bf16 a[208:223], v[36:39], v[60:63], a[208:223]
buffer_load_dwordx4 v241, s[84:87], s25 offen offset:1024 lds
v_mfma_f32_32x32x16_bf16 a[224:239], v[40:43], v[60:63], a[224:239]
v_mfma_f32_32x32x16_bf16 a[240:255], v[44:47], v[60:63], a[240:255]
buffer_load_dwordx4 v240, s[84:87], s26 offen offset:2048 lds
s_waitcnt lgkmcnt(0)
v_mfma_f32_32x32x16_bf16 a[0:15], v[64:67], v[80:83], a[0:15]
ds_read_b128 v[32:35], v14 offset:0
v_mfma_f32_32x32x16_bf16 a[16:31], v[68:71], v[80:83], a[16:31]
ds_read_b64_tr_b16 v[48:49], v20 offset:16384
buffer_load_dwordx4 v241, s[84:87], s27 offen offset:3072 lds
v_mfma_f32_32x32x16_bf16 a[32:47], v[72:75], v[80:83], a[32:47]
ds_read_b64_tr_b16 v[50:51], v20 offset:18432
v_add_u32 v240, 0x80, v240
v_add_u32 v241, 0x80, v241
s_add_u32 m0, s100, 131072
v_mfma_f32_32x32x16_bf16 a[48:63], v[76:79], v[80:83], a[48:63]
ds_read_b128 v[36:39], v14 offset:4096
buffer_load_dwordx4 v246, s[88:91], s16 offen offset:0 lds
v_mfma_f32_32x32x16_bf16 a[64:79], v[64:67], v[84:87], a[64:79]
ds_read_b128 v[40:43], v14 offset:8192
v_mfma_f32_32x32x16_bf16 a[80:95], v[68:71], v[84:87], a[80:95]
ds_read_b128 v[44:47], v14 offset:12288
buffer_load_dwordx4 v246, s[88:91], s17 offen offset:1024 lds
v_mfma_f32_32x32x16_bf16 a[96:111], v[72:75], v[84:87], a[96:111]
ds_read_b64_tr_b16 v[52:53], v21 offset:16384
v_mfma_f32_32x32x16_bf16 a[112:127], v[76:79], v[84:87], a[112:127]
ds_read_b64_tr_b16 v[54:55], v21 offset:18432
buffer_load_dwordx4 v246, s[88:91], s18 offen offset:2048 lds
v_mfma_f32_32x32x16_bf16 a[128:143], v[64:67], v[88:91], a[128:143]
ds_read_b64_tr_b16 v[56:57], v22 offset:16384
v_mfma_f32_32x32x16_bf16 a[144:159], v[68:71], v[88:91], a[144:159]
ds_read_b64_tr_b16 v[58:59], v22 offset:18432
buffer_load_dwordx4 v246, s[88:91], s19 offen offset:3072 lds
v_mfma_f32_32x32x16_bf16 a[160:175], v[72:75], v[88:91], a[160:175]
ds_read_b64_tr_b16 v[60:61], v23 offset:16384
v_add_u32 v246, 524288, v246
v_mfma_f32_32x32x16_bf16 a[176:191], v[76:79], v[88:91], a[176:191]
ds_read_b64_tr_b16 v[62:63], v23 offset:18432
s_mov_b32 m0, 147456
s_nop 0
buffer_load_dwordx4 v31, s[96:99], 0 offen lds
v_mfma_f32_32x32x16_bf16 a[192:207], v[64:67], v[92:95], a[192:207]
v_mfma_f32_32x32x16_bf16 a[208:223], v[68:71], v[92:95], a[208:223]
v_mfma_f32_32x32x16_bf16 a[224:239], v[72:75], v[92:95], a[224:239]
v_mfma_f32_32x32x16_bf16 a[240:255], v[76:79], v[92:95], a[240:255]
s_waitcnt lgkmcnt(0)
v_mfma_f32_32x32x16_bf16 a[0:15], v[32:35], v[48:51], a[0:15]
ds_read_b128 v[64:67], v15 offset:0
v_mfma_f32_32x32x16_bf16 a[16:31], v[36:39], v[48:51], a[16:31]
ds_read_b64_tr_b16 v[80:81], v20 offset:24576
v_mfma_f32_32x32x16_bf16 a[32:47], v[40:43], v[48:51], a[32:47]
ds_read_b64_tr_b16 v[82:83], v20 offset:26624
v_mfma_f32_32x32x16_bf16 a[48:63], v[44:47], v[48:51], a[48:63]
ds_read_b128 v[68:71], v15 offset:4096
v_mfma_f32_32x32x16_bf16 a[64:79], v[32:35], v[52:55], a[64:79]
ds_read_b128 v[72:75], v15 offset:8192
v_mfma_f32_32x32x16_bf16 a[80:95], v[36:39], v[52:55], a[80:95]
ds_read_b128 v[76:79], v15 offset:12288
v_mfma_f32_32x32x16_bf16 a[96:111], v[40:43], v[52:55], a[96:111]
ds_read_b64_tr_b16 v[84:85], v21 offset:24576
v_mfma_f32_32x32x16_bf16 a[112:127], v[44:47], v[52:55], a[112:127]
ds_read_b64_tr_b16 v[86:87], v21 offset:26624
v_mfma_f32_32x32x16_bf16 a[128:143], v[32:35], v[56:59], a[128:143]
ds_read_b64_tr_b16 v[88:89], v22 offset:24576
v_mfma_f32_32x32x16_bf16 a[144:159], v[36:39], v[56:59], a[144:159]
ds_read_b64_tr_b16 v[90:91], v22 offset:26624
v_mfma_f32_32x32x16_bf16 a[160:175], v[40:43], v[56:59], a[160:175]
ds_read_b64_tr_b16 v[92:93], v23 offset:24576
v_mfma_f32_32x32x16_bf16 a[176:191], v[44:47], v[56:59], a[176:191]
ds_read_b64_tr_b16 v[94:95], v23 offset:26624
v_mfma_f32_32x32x16_bf16 a[192:207], v[32:35], v[60:63], a[192:207]
v_mfma_f32_32x32x16_bf16 a[208:223], v[36:39], v[60:63], a[208:223]
v_mfma_f32_32x32x16_bf16 a[224:239], v[40:43], v[60:63], a[224:239]
v_mfma_f32_32x32x16_bf16 a[240:255], v[44:47], v[60:63], a[240:255]
s_waitcnt lgkmcnt(0)
v_mfma_f32_32x32x16_bf16 a[0:15], v[64:67], v[80:83], a[0:15]
s_barrier
s_waitcnt vmcnt(5)
v_add_u32 v12, 0x10000, v250
v_add_u32 v13, 0x10000, v251
v_add_u32 v14, 0x10000, v252
v_add_u32 v15, 0x10000, v253
v_mfma_f32_32x32x16_bf16 a[16:31], v[68:71], v[80:83], a[16:31]
v_add_u32 v16, 0x20000, v250
v_add_u32 v17, 0x20000, v251
v_add_u32 v18, 0x20000, v252
v_add_u32 v19, 0x20000, v253
ds_read_b128 v[128:131], v242 offset:0
ds_read_b128 v[132:135], v243 offset:0
v_mfma_f32_32x32x16_bf16 a[32:47], v[72:75], v[80:83], a[32:47]
ds_read_b128 v[136:139], v244 offset:0
ds_read_b128 v[140:143], v245 offset:0
s_add_u32 m0, s100, 65536
v_mfma_f32_32x32x16_bf16 a[48:63], v[76:79], v[80:83], a[48:63]
ds_read_b128 v[144:147], v242 offset:16384
ds_read_b128 v[148:151], v243 offset:16384
s_nop 0
v_mfma_f32_32x32x16_bf16 a[64:79], v[64:67], v[84:87], a[64:79]
ds_read_b128 v[152:155], v244 offset:16384
ds_read_b128 v[156:159], v245 offset:16384
buffer_load_dwordx4 v240, s[84:87], s24 offen offset:0 lds
buffer_load_dwordx4 v241, s[84:87], s25 offen offset:1024 lds
v_mfma_f32_32x32x16_bf16 a[80:95], v[68:71], v[84:87], a[80:95]
ds_read_b128 v[160:163], v242 offset:32768
ds_read_b128 v[164:167], v243 offset:32768
buffer_load_dwordx4 v240, s[84:87], s26 offen offset:2048 lds
v_mfma_f32_32x32x16_bf16 a[96:111], v[72:75], v[84:87], a[96:111]
ds_read_b128 v[168:171], v244 offset:32768
ds_read_b128 v[172:175], v245 offset:32768
buffer_load_dwordx4 v241, s[84:87], s27 offen offset:3072 lds
v_mfma_f32_32x32x16_bf16 a[112:127], v[76:79], v[84:87], a[112:127]
ds_read_b128 v[176:179], v242 offset:49152
ds_read_b128 v[180:183], v243 offset:49152
v_add_u32 v240, 0x80, v240
v_mfma_f32_32x32x16_bf16 a[128:143], v[64:67], v[88:91], a[128:143]
ds_read_b128 v[184:187], v244 offset:49152
ds_read_b128 v[188:191], v245 offset:49152
v_add_u32 v241, 0x80, v241
s_add_u32 m0, s100, 81920
v_mfma_f32_32x32x16_bf16 a[144:159], v[68:71], v[88:91], a[144:159]
s_nop 0
buffer_load_dwordx4 v240, s[84:87], s24 offen offset:0 lds
buffer_load_dwordx4 v241, s[84:87], s25 offen offset:1024 lds
v_mfma_f32_32x32x16_bf16 a[160:175], v[72:75], v[88:91], a[160:175]
buffer_load_dwordx4 v240, s[84:87], s26 offen offset:2048 lds
buffer_load_dwordx4 v241, s[84:87], s27 offen offset:3072 lds
v_add_u32 v240, 0x80, v240
v_mfma_f32_32x32x16_bf16 a[176:191], v[76:79], v[88:91], a[176:191]
v_add_u32 v241, 0x80, v241
s_add_u32 m0, s100, 98304
s_nop 0
v_mfma_f32_32x32x16_bf16 a[192:207], v[64:67], v[92:95], a[192:207]
buffer_load_dwordx4 v240, s[84:87], s24 offen offset:0 lds
buffer_load_dwordx4 v241, s[84:87], s25 offen offset:1024 lds
buffer_load_dwordx4 v240, s[84:87], s26 offen offset:2048 lds
v_mfma_f32_32x32x16_bf16 a[208:223], v[68:71], v[92:95], a[208:223]
buffer_load_dwordx4 v241, s[84:87], s27 offen offset:3072 lds
v_add_u32 v240, 0x80, v240
v_add_u32 v241, 0x80, v241
s_add_u32 m0, s100, 114688
v_mfma_f32_32x32x16_bf16 a[224:239], v[72:75], v[92:95], a[224:239]
s_nop 0
buffer_load_dwordx4 v246, s[88:91], s16 offen offset:0 lds
buffer_load_dwordx4 v246, s[88:91], s17 offen offset:1024 lds
v_mfma_f32_32x32x16_bf16 a[240:255], v[76:79], v[92:95], a[240:255]
buffer_load_dwordx4 v246, s[88:91], s18 offen offset:2048 lds
buffer_load_dwordx4 v246, s[88:91], s19 offen offset:3072 lds
v_add_u32 v246, 524288, v246
k1_epi:
v_add_u32 v242, 0x10000, v242
v_add_u32 v243, 0x10000, v243
v_add_u32 v244, 0x10000, v244
v_add_u32 v245, 0x10000, v245
s_lshl_b32 s59, s55, 17
s_lshl_b32 s33, s57, 16
s_add_u32 s59, s59, s33
s_lshl_b32 s33, s58, 13
s_add_u32 s35, s59, s33
s_add_u32 s4, s42, 33554432
s_addc_u32 s5, s43, 0
s_mov_b32 s6, 33554432
s_mov_b32 s7, 0x20000
s_lshl_b32 s28, s78, 20
s_lshl_b32 s33, s80, 14
s_add_u32 s28, s28, s33
s_lshl_b32 s29, s78, 19
s_lshl_b32 s33, s80, 13
s_add_u32 s29, s29, s33
s_add_u32 s29, s29, 16777216
s_lshl_b32 s30, s78, 14
s_lshl_b32 s33, s80, 8
s_add_u32 s30, s30, s33
s_add_u32 s30, s30, 25165824
s_lshl_b32 s31, s2, 6
s_add_u32 s31, s31, 26214400
s_mov_b32 s34, 0x3db8aa3b
s_cmp_lt_u32 s79, 8
s_cselect_b32 s33, 0x40000000, 0
v_or_b32 v255, s33, v31
s_waitcnt lgkmcnt(0)
s_waitcnt vmcnt(17)
s_barrier
ds_read_b64_tr_b16 v[32:33], v16 offset:0
ds_read_b64_tr_b16 v[34:35], v16 offset:1024
ds_read_b64_tr_b16 v[36:37], v17 offset:0
ds_read_b64_tr_b16 v[38:39], v17 offset:1024
ds_read_b64_tr_b16 v[40:41], v18 offset:0
ds_read_b64_tr_b16 v[42:43], v18 offset:1024
ds_read_b64_tr_b16 v[44:45], v19 offset:0
ds_read_b64_tr_b16 v[46:47], v19 offset:1024
ds_read_b64_tr_b16 v[48:49], v16 offset:4096
ds_read_b64_tr_b16 v[50:51], v16 offset:5120
ds_read_b64_tr_b16 v[52:53], v17 offset:4096
ds_read_b64_tr_b16 v[54:55], v17 offset:5120
ds_read_b64_tr_b16 v[56:57], v18 offset:4096
ds_read_b64_tr_b16 v[58:59], v18 offset:5120
ds_read_b64_tr_b16 v[60:61], v19 offset:4096
ds_read_b64_tr_b16 v[62:63], v19 offset:5120
v_accvgpr_read_b32 v96, a0
v_accvgpr_read_b32 v97, a1
v_accvgpr_read_b32 v98, a2
v_accvgpr_read_b32 v99, a3
v_accvgpr_read_b32 v100, a4
v_accvgpr_read_b32 v101, a5
v_accvgpr_read_b32 v102, a6
v_accvgpr_read_b32 v103, a7
v_cvt_pk_bf16_f32 v96, v96, v97
v_cvt_pk_bf16_f32 v97, v98, v99
v_cvt_pk_bf16_f32 v98, v100, v101
v_cvt_pk_bf16_f32 v99, v102, v103
s_add_u32 s33, s35, 0
buffer_store_dwordx4 v[96:99], v31, s[12:15], s33 offen
v_accvgpr_read_b32 v104, a8
v_accvgpr_read_b32 v105, a9
v_accvgpr_read_b32 v106, a10
v_accvgpr_read_b32 v107, a11
v_accvgpr_read_b32 v108, a12
v_accvgpr_read_b32 v109, a13
v_accvgpr_read_b32 v110, a14
v_accvgpr_read_b32 v111, a15
v_cvt_pk_bf16_f32 v104, v104, v105
v_cvt_pk_bf16_f32 v105, v106, v107
v_cvt_pk_bf16_f32 v106, v108, v109
v_cvt_pk_bf16_f32 v107, v110, v111
s_add_u32 s33, s35, 1024
buffer_store_dwordx4 v[104:107], v31, s[12:15], s33 offen
v_accvgpr_read_b32 v96, a16
v_accvgpr_read_b32 v97, a17
v_accvgpr_read_b32 v98, a18
v_accvgpr_read_b32 v99, a19
v_accvgpr_read_b32 v100, a20
v_accvgpr_read_b32 v101, a21
v_accvgpr_read_b32 v102, a22
v_accvgpr_read_b32 v103, a23
v_cvt_pk_bf16_f32 v96, v96, v97
v_cvt_pk_bf16_f32 v97, v98, v99
v_cvt_pk_bf16_f32 v98, v100, v101
v_cvt_pk_bf16_f32 v99, v102, v103
s_add_u32 s33, s35, 16384
buffer_store_dwordx4 v[96:99], v31, s[12:15], s33 offen
v_accvgpr_read_b32 v104, a24
v_accvgpr_read_b32 v105, a25
v_accvgpr_read_b32 v106, a26
v_accvgpr_read_b32 v107, a27
v_accvgpr_read_b32 v108, a28
v_accvgpr_read_b32 v109, a29
v_accvgpr_read_b32 v110, a30
v_accvgpr_read_b32 v111, a31
v_cvt_pk_bf16_f32 v104, v104, v105
v_cvt_pk_bf16_f32 v105, v106, v107
v_cvt_pk_bf16_f32 v106, v108, v109
v_cvt_pk_bf16_f32 v107, v110, v111
s_add_u32 s33, s35, 17408
buffer_store_dwordx4 v[104:107], v31, s[12:15], s33 offen
v_accvgpr_read_b32 v96, a32
v_accvgpr_read_b32 v97, a33
v_accvgpr_read_b32 v98, a34
v_accvgpr_read_b32 v99, a35
v_accvgpr_read_b32 v100, a36
v_accvgpr_read_b32 v101, a37
v_accvgpr_read_b32 v102, a38
v_accvgpr_read_b32 v103, a39
v_cvt_pk_bf16_f32 v96, v96, v97
v_cvt_pk_bf16_f32 v97, v98, v99
v_cvt_pk_bf16_f32 v98, v100, v101
v_cvt_pk_bf16_f32 v99, v102, v103
s_add_u32 s33, s35, 32768
buffer_store_dwordx4 v[96:99], v31, s[12:15], s33 offen
v_accvgpr_read_b32 v104, a40
v_accvgpr_read_b32 v105, a41
v_accvgpr_read_b32 v106, a42
v_accvgpr_read_b32 v107, a43
v_accvgpr_read_b32 v108, a44
v_accvgpr_read_b32 v109, a45
v_accvgpr_read_b32 v110, a46
v_accvgpr_read_b32 v111, a47
v_cvt_pk_bf16_f32 v104, v104, v105
v_cvt_pk_bf16_f32 v105, v106, v107
v_cvt_pk_bf16_f32 v106, v108, v109
v_cvt_pk_bf16_f32 v107, v110, v111
s_add_u32 s33, s35, 33792
buffer_store_dwordx4 v[104:107], v31, s[12:15], s33 offen
v_accvgpr_read_b32 v96, a48
v_accvgpr_read_b32 v97, a49
v_accvgpr_read_b32 v98, a50
v_accvgpr_read_b32 v99, a51
v_accvgpr_read_b32 v100, a52
v_accvgpr_read_b32 v101, a53
v_accvgpr_read_b32 v102, a54
v_accvgpr_read_b32 v103, a55
v_cvt_pk_bf16_f32 v96, v96, v97
v_cvt_pk_bf16_f32 v97, v98, v99
v_cvt_pk_bf16_f32 v98, v100, v101
v_cvt_pk_bf16_f32 v99, v102, v103
s_add_u32 s33, s35, 49152
buffer_store_dwordx4 v[96:99], v31, s[12:15], s33 offen
v_accvgpr_read_b32 v104, a56
v_accvgpr_read_b32 v105, a57
v_accvgpr_read_b32 v106, a58
v_accvgpr_read_b32 v107, a59
v_accvgpr_read_b32 v108, a60
v_accvgpr_read_b32 v109, a61
v_accvgpr_read_b32 v110, a62
v_accvgpr_read_b32 v111, a63
v_cvt_pk_bf16_f32 v104, v104, v105
v_cvt_pk_bf16_f32 v105, v106, v107
v_cvt_pk_bf16_f32 v106, v108, v109
v_cvt_pk_bf16_f32 v107, v110, v111
s_add_u32 s33, s35, 50176
buffer_store_dwordx4 v[104:107], v31, s[12:15], s33 offen
s_waitcnt lgkmcnt(8)
v_mfma_f32_32x32x16_bf16 a[0:15], v[32:35], v[128:131], 0
ds_read_b64_tr_b16 v[64:65], v16 offset:8192
ds_read_b64_tr_b16 v[66:67], v16 offset:9216
s_add_u32 m0, s100, 0
v_mfma_f32_32x32x16_bf16 a[16:31], v[36:39], v[128:131], 0
ds_read_b64_tr_b16 v[68:69], v17 offset:8192
ds_read_b64_tr_b16 v[70:71], v17 offset:9216
buffer_load_dwordx4 v246, s[88:91], s16 offen offset:0 lds
v_mfma_f32_32x32x16_bf16 a[32:47], v[40:43], v[128:131], 0
ds_read_b64_tr_b16 v[72:73], v18 offset:8192
ds_read_b64_tr_b16 v[74:75], v18 offset:9216
s_lshl_b32 s84, s78, 7
s_add_u32 s84, s84, 26238976
v_mfma_f32_32x32x16_bf16 a[48:63], v[44:47], v[128:131], 0
ds_read_b64_tr_b16 v[76:77], v19 offset:8192
ds_read_b64_tr_b16 v[78:79], v19 offset:9216
buffer_load_dwordx4 v246, s[88:91], s17 offen offset:1024 lds
v_and_b32 v29, 15, v6
s_waitcnt lgkmcnt(8)
v_mfma_f32_32x32x16_bf16 a[0:15], v[48:51], v[132:135], a[0:15]
ds_read_b64_tr_b16 v[32:33], v16 offset:12288
ds_read_b64_tr_b16 v[34:35], v16 offset:13312
v_lshlrev_b32 v29, 2, v29
v_mfma_f32_32x32x16_bf16 a[16:31], v[52:55], v[132:135], a[16:31]
ds_read_b64_tr_b16 v[36:37], v17 offset:12288
ds_read_b64_tr_b16 v[38:39], v17 offset:13312
buffer_load_dwordx4 v246, s[88:91], s18 offen offset:2048 lds
buffer_load_dword v30, v29, s[4:7], s84 offen sc1
v_mfma_f32_32x32x16_bf16 a[32:47], v[56:59], v[132:135], a[32:47]
ds_read_b64_tr_b16 v[40:41], v18 offset:12288
ds_read_b64_tr_b16 v[42:43], v18 offset:13312
v_accvgpr_read_b32 v96, a64
v_accvgpr_read_b32 v97, a65
v_accvgpr_read_b32 v98, a66
v_mfma_f32_32x32x16_bf16 a[48:63], v[60:63], v[132:135], a[48:63]
ds_read_b64_tr_b16 v[44:45], v19 offset:12288
ds_read_b64_tr_b16 v[46:47], v19 offset:13312
buffer_load_dwordx4 v246, s[88:91], s19 offen offset:3072 lds
v_add_u32 v246, 524288, v246
s_waitcnt lgkmcnt(8)
v_mfma_f32_32x32x16_bf16 a[0:15], v[64:67], v[136:139], a[0:15]
s_waitcnt vmcnt(13)
s_barrier
s_waitcnt vmcnt(17)
ds_read_b64_tr_b16 v[48:49], v12 offset:49152
ds_read_b64_tr_b16 v[50:51], v12 offset:50176
s_add_u32 m0, s100, 16384
v_accvgpr_read_b32 v99, a67
v_mfma_f32_32x32x16_bf16 a[16:31], v[68:71], v[136:139], a[16:31]
ds_read_b64_tr_b16 v[52:53], v13 offset:49152
ds_read_b64_tr_b16 v[54:55], v13 offset:50176
ds_read_b128 v[192:195], v242 offset:0
buffer_load_dwordx4 v246, s[88:91], s16 offen offset:0 lds
v_mfma_f32_32x32x16_bf16 a[32:47], v[72:75], v[136:139], a[32:47]
ds_read_b64_tr_b16 v[56:57], v14 offset:49152
ds_read_b64_tr_b16 v[58:59], v14 offset:50176
ds_read_b128 v[196:199], v243 offset:0
v_accvgpr_read_b32 v100, a68
v_accvgpr_read_b32 v101, a69
v_mfma_f32_32x32x16_bf16 a[48:63], v[76:79], v[136:139], a[48:63]
ds_read_b64_tr_b16 v[60:61], v15 offset:49152
ds_read_b64_tr_b16 v[62:63], v15 offset:50176
ds_read_b128 v[200:203], v244 offset:0
buffer_load_dwordx4 v246, s[88:91], s17 offen offset:1024 lds
s_waitcnt lgkmcnt(11)
v_mfma_f32_32x32x16_bf16 a[0:15], v[32:35], v[140:143], a[0:15]
ds_read_b64_tr_b16 v[64:65], v12 offset:53248
ds_read_b64_tr_b16 v[66:67], v12 offset:54272
v_accvgpr_read_b32 v102, a70
v_accvgpr_read_b32 v103, a71
v_cvt_pk_bf16_f32 v96, v96, v97
v_mfma_f32_32x32x16_bf16 a[16:31], v[36:39], v[140:143], a[16:31]
ds_read_b64_tr_b16 v[68:69], v13 offset:53248
ds_read_b64_tr_b16 v[70:71], v13 offset:54272
ds_read_b128 v[204:207], v245 offset:0
buffer_load_dwordx4 v246, s[88:91], s18 offen offset:2048 lds
v_mfma_f32_32x32x16_bf16 a[32:47], v[40:43], v[140:143], a[32:47]
ds_read_b64_tr_b16 v[72:73], v14 offset:53248
ds_read_b64_tr_b16 v[74:75], v14 offset:54272
ds_read_b128 v[208:211], v242 offset:16384
v_cvt_pk_bf16_f32 v97, v98, v99
v_cvt_pk_bf16_f32 v98, v100, v101
v_mfma_f32_32x32x16_bf16 a[48:63], v[44:47], v[140:143], a[48:63]
ds_read_b64_tr_b16 v[76:77], v15 offset:53248
ds_read_b64_tr_b16 v[78:79], v15 offset:54272
ds_read_b128 v[212:215], v243 offset:16384
buffer_load_dwordx4 v246, s[88:91], s19 offen offset:3072 lds
v_add_u32 v246, 524288, v246
s_waitcnt lgkmcnt(12)
v_mfma_f32_32x32x16_bf16 a[0:15], v[48:51], v[144:147], a[0:15]
ds_read_b64_tr_b16 v[32:33], v12 offset:57344
ds_read_b64_tr_b16 v[34:35], v12 offset:58368
s_add_u32 m0, s100, 32768
v_cvt_pk_bf16_f32 v99, v102, v103
v_mfma_f32_32x32x16_bf16 a[16:31], v[52:55], v[144:147], a[16:31]
ds_read_b64_tr_b16 v[36:37], v13 offset:57344
ds_read_b64_tr_b16 v[38:39], v13 offset:58368
ds_read_b128 v[216:219], v244 offset:16384
buffer_load_dwordx4 v246, s[88:91], s16 offen offset:0 lds
s_add_u32 s33, s35, 2048
v_mfma_f32_32x32x16_bf16 a[32:47], v[56:59], v[144:147], a[32:47]
ds_read_b64_tr_b16 v[40:41], v14 offset:57344
ds_read_b64_tr_b16 v[42:43], v14 offset:58368
ds_read_b128 v[220:223], v245 offset:16384
buffer_store_dwordx4 v[96:99], v31, s[12:15], s33 offen
v_mfma_f32_32x32x16_bf16 a[48:63], v[60:63], v[144:147], a[48:63]
ds_read_b64_tr_b16 v[44:45], v15 offset:57344
ds_read_b64_tr_b16 v[46:47], v15 offset:58368
ds_read_b128 v[224:227], v242 offset:32768
v_accvgpr_read_b32 v104, a72
v_accvgpr_read_b32 v105, a73
s_waitcnt lgkmcnt(12)
v_mfma_f32_32x32x16_bf16 a[0:15], v[64:67], v[148:151], a[0:15]
ds_read_b64_tr_b16 v[48:49], v12 offset:61440
ds_read_b64_tr_b16 v[50:51], v12 offset:62464
v_accvgpr_read_b32 v106, a74
v_accvgpr_read_b32 v107, a75
v_mfma_f32_32x32x16_bf16 a[16:31], v[68:71], v[148:151], a[16:31]
ds_read_b64_tr_b16 v[52:53], v13 offset:61440
ds_read_b64_tr_b16 v[54:55], v13 offset:62464
ds_read_b128 v[228:231], v243 offset:32768
buffer_load_dwordx4 v246, s[88:91], s17 offen offset:1024 lds
v_accvgpr_read_b32 v108, a76
v_mfma_f32_32x32x16_bf16 a[32:47], v[72:75], v[148:151], a[32:47]
ds_read_b64_tr_b16 v[56:57], v14 offset:61440
ds_read_b64_tr_b16 v[58:59], v14 offset:62464
ds_read_b128 v[232:235], v244 offset:32768
v_accvgpr_read_b32 v109, a77
v_mfma_f32_32x32x16_bf16 a[48:63], v[76:79], v[148:151], a[48:63]
ds_read_b64_tr_b16 v[60:61], v15 offset:61440
ds_read_b64_tr_b16 v[62:63], v15 offset:62464
ds_read_b128 v[236:239], v245 offset:32768
v_accvgpr_read_b32 v110, a78
v_accvgpr_read_b32 v111, a79
s_waitcnt lgkmcnt(12)
v_mfma_f32_32x32x16_bf16 a[0:15], v[32:35], v[152:155], a[0:15]
s_waitcnt lgkmcnt(0)
s_waitcnt vmcnt(7)
s_barrier
ds_read_b64_tr_b16 v[64:65], v250 offset:0
ds_read_b64_tr_b16 v[66:67], v250 offset:1024
v_cvt_pk_bf16_f32 v104, v104, v105
v_mfma_f32_32x32x16_bf16 a[16:31], v[36:39], v[152:155], a[16:31]
ds_read_b64_tr_b16 v[68:69], v251 offset:0
ds_read_b64_tr_b16 v[70:71], v251 offset:1024
buffer_load_dwordx4 v246, s[88:91], s18 offen offset:2048 lds
v_cvt_pk_bf16_f32 v105, v106, v107
v_cvt_pk_bf16_f32 v106, v108, v109
v_mfma_f32_32x32x16_bf16 a[32:47], v[40:43], v[152:155], a[32:47]
ds_read_b64_tr_b16 v[72:73], v252 offset:0
ds_read_b64_tr_b16 v[74:75], v252 offset:1024
v_cvt_pk_bf16_f32 v107, v110, v111
s_add_u32 s33, s35, 3072
v_mfma_f32_32x32x16_bf16 a[48:63], v[44:47], v[152:155], a[48:63]
ds_read_b64_tr_b16 v[76:77], v253 offset:0
ds_read_b64_tr_b16 v[78:79], v253 offset:1024
buffer_store_dwordx4 v[104:107], v31, s[12:15], s33 offen
v_accvgpr_read_b32 v96, a80
v_accvgpr_read_b32 v97, a81
s_waitcnt lgkmcnt(9)
v_mfma_f32_32x32x16_bf16 a[0:15], v[48:51], v[156:159], a[0:15]
ds_read_b64_tr_b16 v[32:33], v250 offset:4096
ds_read_b64_tr_b16 v[34:35], v250 offset:5120
v_accvgpr_read_b32 v98, a82
v_accvgpr_read_b32 v99, a83
v_accvgpr_read_b32 v100, a84
v_mfma_f32_32x32x16_bf16 a[16:31], v[52:55], v[156:159], a[16:31]
ds_read_b64_tr_b16 v[36:37], v251 offset:4096
ds_read_b64_tr_b16 v[38:39], v251 offset:5120
buffer_load_dwordx4 v246, s[88:91], s19 offen offset:3072 lds
v_add_u32 v246, 524288, v246
v_mfma_f32_32x32x16_bf16 a[32:47], v[56:59], v[156:159], a[32:47]
ds_read_b64_tr_b16 v[40:41], v252 offset:4096
ds_read_b64_tr_b16 v[42:43], v252 offset:5120
v_accvgpr_read_b32 v101, a85
v_accvgpr_read_b32 v102, a86
v_accvgpr_read_b32 v103, a87
v_mfma_f32_32x32x16_bf16 a[48:63], v[60:63], v[156:159], a[48:63]
ds_read_b64_tr_b16 v[44:45], v253 offset:4096
ds_read_b64_tr_b16 v[46:47], v253 offset:5120
v_cvt_pk_bf16_f32 v96, v96, v97
v_cvt_pk_bf16_f32 v97, v98, v99
s_waitcnt lgkmcnt(8)
v_mfma_f32_32x32x16_bf16 a[0:15], v[64:67], v[160:163], a[0:15]
ds_read_b64_tr_b16 v[48:49], v250 offset:8192
ds_read_b64_tr_b16 v[50:51], v250 offset:9216
s_add_u32 m0, s100, 49152
v_cvt_pk_bf16_f32 v98, v100, v101
v_cvt_pk_bf16_f32 v99, v102, v103
v_mfma_f32_32x32x16_bf16 a[16:31], v[68:71], v[160:163], a[16:31]
ds_read_b64_tr_b16 v[52:53], v251 offset:8192
ds_read_b64_tr_b16 v[54:55], v251 offset:9216
buffer_load_dwordx4 v246, s[88:91], s16 offen offset:0 lds
s_add_u32 s33, s35, 18432
v_mfma_f32_32x32x16_bf16 a[32:47], v[72:75], v[160:163], a[32:47]
ds_read_b64_tr_b16 v[56:57], v252 offset:8192
ds_read_b64_tr_b16 v[58:59], v252 offset:9216
buffer_store_dwordx4 v[96:99], v31, s[12:15], s33 offen
v_accvgpr_read_b32 v104, a88
v_accvgpr_read_b32 v105, a89
v_mfma_f32_32x32x16_bf16 a[48:63], v[76:79], v[160:163], a[48:63]
ds_read_b64_tr_b16 v[60:61], v253 offset:8192
ds_read_b64_tr_b16 v[62:63], v253 offset:9216
v_accvgpr_read_b32 v106, a90
v_accvgpr_read_b32 v107, a91
s_waitcnt lgkmcnt(8)
v_mfma_f32_32x32x16_bf16 a[0:15], v[32:35], v[164:167], a[0:15]
ds_read_b64_tr_b16 v[64:65], v250 offset:12288
ds_read_b64_tr_b16 v[66:67], v250 offset:13312
v_accvgpr_read_b32 v108, a92
v_accvgpr_read_b32 v109, a93
v_accvgpr_read_b32 v110, a94
v_mfma_f32_32x32x16_bf16 a[16:31], v[36:39], v[164:167], a[16:31]
ds_read_b64_tr_b16 v[68:69], v251 offset:12288
ds_read_b64_tr_b16 v[70:71], v251 offset:13312
buffer_load_dwordx4 v246, s[88:91], s17 offen offset:1024 lds
v_accvgpr_read_b32 v111, a95
v_mfma_f32_32x32x16_bf16 a[32:47], v[40:43], v[164:167], a[32:47]
ds_read_b64_tr_b16 v[72:73], v252 offset:12288
ds_read_b64_tr_b16 v[74:75], v252 offset:13312
v_cvt_pk_bf16_f32 v104, v104, v105
v_cvt_pk_bf16_f32 v105, v106, v107
v_cvt_pk_bf16_f32 v106, v108, v109
v_mfma_f32_32x32x16_bf16 a[48:63], v[44:47], v[164:167], a[48:63]
ds_read_b64_tr_b16 v[76:77], v253 offset:12288
ds_read_b64_tr_b16 v[78:79], v253 offset:13312
v_cvt_pk_bf16_f32 v107, v110, v111
s_add_u32 s33, s35, 19456
s_waitcnt lgkmcnt(8)
v_mfma_f32_32x32x16_bf16 a[0:15], v[48:51], v[168:171], a[0:15]
s_waitcnt vmcnt(9)
s_barrier
ds_read_b64_tr_b16 v[32:33], v250 offset:16384
ds_read_b64_tr_b16 v[34:35], v250 offset:17408
buffer_store_dwordx4 v[104:107], v31, s[12:15], s33 offen
v_accvgpr_read_b32 v96, a96
v_mfma_f32_32x32x16_bf16 a[16:31], v[52:55], v[168:171], a[16:31]
ds_read_b64_tr_b16 v[36:37], v251 offset:16384
ds_read_b64_tr_b16 v[38:39], v251 offset:17408
buffer_load_dwordx4 v246, s[88:91], s18 offen offset:2048 lds
v_accvgpr_read_b32 v97, a97
v_mfma_f32_32x32x16_bf16 a[32:47], v[56:59], v[168:171], a[32:47]
ds_read_b64_tr_b16 v[40:41], v252 offset:16384
ds_read_b64_tr_b16 v[42:43], v252 offset:17408
v_accvgpr_read_b32 v98, a98
v_accvgpr_read_b32 v99, a99
v_accvgpr_read_b32 v100, a100
v_mfma_f32_32x32x16_bf16 a[48:63], v[60:63], v[168:171], a[48:63]
ds_read_b64_tr_b16 v[44:45], v253 offset:16384
ds_read_b64_tr_b16 v[46:47], v253 offset:17408
v_accvgpr_read_b32 v101, a101
v_accvgpr_read_b32 v102, a102
s_waitcnt lgkmcnt(8)
v_mfma_f32_32x32x16_bf16 a[0:15], v[64:67], v[172:175], a[0:15]
ds_read_b64_tr_b16 v[48:49], v250 offset:20480
ds_read_b64_tr_b16 v[50:51], v250 offset:21504
v_accvgpr_read_b32 v103, a103
v_cvt_pk_bf16_f32 v96, v96, v97
v_cvt_pk_bf16_f32 v97, v98, v99
v_mfma_f32_32x32x16_bf16 a[16:31], v[68:71], v[172:175], a[16:31]
ds_read_b64_tr_b16 v[52:53], v251 offset:20480
ds_read_b64_tr_b16 v[54:55], v251 offset:21504
buffer_load_dwordx4 v246, s[88:91], s19 offen offset:3072 lds
v_add_u32 v246, 524288, v246
v_mfma_f32_32x32x16_bf16 a[32:47], v[72:75], v[172:175], a[32:47]
ds_read_b64_tr_b16 v[56:57], v252 offset:20480
ds_read_b64_tr_b16 v[58:59], v252 offset:21504
v_cvt_pk_bf16_f32 v98, v100, v101
v_cvt_pk_bf16_f32 v99, v102, v103
s_add_u32 s33, s35, 34816
v_mfma_f32_32x32x16_bf16 a[48:63], v[76:79], v[172:175], a[48:63]
ds_read_b64_tr_b16 v[60:61], v253 offset:20480
ds_read_b64_tr_b16 v[62:63], v253 offset:21504
buffer_store_dwordx4 v[96:99], v31, s[12:15], s33 offen
v_accvgpr_read_b32 v104, a104
v_accvgpr_read_b32 v105, a105
s_waitcnt lgkmcnt(8)
v_mfma_f32_32x32x16_bf16 a[0:15], v[32:35], v[176:179], a[0:15]
ds_read_b64_tr_b16 v[64:65], v250 offset:24576
ds_read_b64_tr_b16 v[66:67], v250 offset:25600
s_add_u32 m0, s100, 65536
v_accvgpr_read_b32 v106, a106
v_mfma_f32_32x32x16_bf16 a[16:31], v[36:39], v[176:179], a[16:31]
ds_read_b64_tr_b16 v[68:69], v251 offset:24576
ds_read_b64_tr_b16 v[70:71], v251 offset:25600
buffer_load_dwordx4 v246, s[88:91], s16 offen offset:0 lds
v_accvgpr_read_b32 v107, a107
v_accvgpr_read_b32 v108, a108
v_mfma_f32_32x32x16_bf16 a[32:47], v[40:43], v[176:179], a[32:47]
ds_read_b64_tr_b16 v[72:73], v252 offset:24576
ds_read_b64_tr_b16 v[74:75], v252 offset:25600
v_accvgpr_read_b32 v109, a109
v_accvgpr_read_b32 v110, a110
v_mfma_f32_32x32x16_bf16 a[48:63], v[44:47], v[176:179], a[48:63]
ds_read_b64_tr_b16 v[76:77], v253 offset:24576
ds_read_b64_tr_b16 v[78:79], v253 offset:25600
v_accvgpr_read_b32 v111, a111
v_cvt_pk_bf16_f32 v104, v104, v105
v_cvt_pk_bf16_f32 v105, v106, v107
s_waitcnt lgkmcnt(8)
v_mfma_f32_32x32x16_bf16 a[0:15], v[48:51], v[180:183], a[0:15]
ds_read_b64_tr_b16 v[32:33], v250 offset:28672
ds_read_b64_tr_b16 v[34:35], v250 offset:29696
v_cvt_pk_bf16_f32 v106, v108, v109
v_cvt_pk_bf16_f32 v107, v110, v111
v_mfma_f32_32x32x16_bf16 a[16:31], v[52:55], v[180:183], a[16:31]
ds_read_b64_tr_b16 v[36:37], v251 offset:28672
ds_read_b64_tr_b16 v[38:39], v251 offset:29696
buffer_load_dwordx4 v246, s[88:91], s17 offen offset:1024 lds
s_add_u32 s33, s35, 35840
buffer_store_dwordx4 v[104:107], v31, s[12:15], s33 offen
v_mfma_f32_32x32x16_bf16 a[32:47], v[56:59], v[180:183], a[32:47]
ds_read_b64_tr_b16 v[40:41], v252 offset:28672
ds_read_b64_tr_b16 v[42:43], v252 offset:29696
v_accvgpr_read_b32 v96, a112
v_accvgpr_read_b32 v97, a113
v_mfma_f32_32x32x16_bf16 a[48:63], v[60:63], v[180:183], a[48:63]
ds_read_b64_tr_b16 v[44:45], v253 offset:28672
ds_read_b64_tr_b16 v[46:47], v253 offset:29696
v_accvgpr_read_b32 v98, a114
v_accvgpr_read_b32 v99, a115
v_accvgpr_read_b32 v100, a116
s_waitcnt lgkmcnt(8)
v_mfma_f32_32x32x16_bf16 a[0:15], v[64:67], v[184:187], a[0:15]
s_waitcnt vmcnt(10)
s_barrier
ds_read_b64_tr_b16 v[48:49], v250 offset:32768
ds_read_b64_tr_b16 v[50:51], v250 offset:33792
v_accvgpr_read_b32 v101, a117
v_mfma_f32_32x32x16_bf16 a[16:31], v[68:71], v[184:187], a[16:31]
ds_read_b64_tr_b16 v[52:53], v251 offset:32768
ds_read_b64_tr_b16 v[54:55], v251 offset:33792
buffer_load_dwordx4 v246, s[88:91], s18 offen offset:2048 lds
v_accvgpr_read_b32 v102, a118
v_accvgpr_read_b32 v103, a119
v_mfma_f32_32x32x16_bf16 a[32:47], v[72:75], v[184:187], a[32:47]
ds_read_b64_tr_b16 v[56:57], v252 offset:32768
ds_read_b64_tr_b16 v[58:59], v252 offset:33792
v_cvt_pk_bf16_f32 v96, v96, v97
v_cvt_pk_bf16_f32 v97, v98, v99
v_mfma_f32_32x32x16_bf16 a[48:63], v[76:79], v[184:187], a[48:63]
ds_read_b64_tr_b16 v[60:61], v253 offset:32768
ds_read_b64_tr_b16 v[62:63], v253 offset:33792
v_cvt_pk_bf16_f32 v98, v100, v101
v_cvt_pk_bf16_f32 v99, v102, v103
s_add_u32 s33, s35, 51200
s_waitcnt lgkmcnt(8)
v_mfma_f32_32x32x16_bf16 a[0:15], v[32:35], v[188:191], a[0:15]
ds_read_b64_tr_b16 v[64:65], v250 offset:36864
ds_read_b64_tr_b16 v[66:67], v250 offset:37888
buffer_store_dwordx4 v[96:99], v31, s[12:15], s33 offen
v_accvgpr_read_b32 v104, a120
v_mfma_f32_32x32x16_bf16 a[16:31], v[36:39], v[188:191], a[16:31]
ds_read_b64_tr_b16 v[68:69], v251 offset:36864
ds_read_b64_tr_b16 v[70:71], v251 offset:37888
buffer_load_dwordx4 v246, s[88:91], s19 offen offset:3072 lds
v_add_u32 v246, 524288, v246
v_accvgpr_read_b32 v105, a121
v_mfma_f32_32x32x16_bf16 a[32:47], v[40:43], v[188:191], a[32:47]
ds_read_b64_tr_b16 v[72:73], v252 offset:36864
ds_read_b64_tr_b16 v[74:75], v252 offset:37888
v_accvgpr_read_b32 v106, a122
v_accvgpr_read_b32 v107, a123
v_mfma_f32_32x32x16_bf16 a[48:63], v[44:47], v[188:191], a[48:63]
ds_read_b64_tr_b16 v[76:77], v253 offset:36864
ds_read_b64_tr_b16 v[78:79], v253 offset:37888
v_accvgpr_read_b32 v108, a124
v_accvgpr_read_b32 v109, a125
v_accvgpr_read_b32 v110, a126
s_waitcnt lgkmcnt(8)
v_mfma_f32_32x32x16_bf16 a[0:15], v[48:51], v[192:195], a[0:15]
ds_read_b64_tr_b16 v[32:33], v250 offset:40960
ds_read_b64_tr_b16 v[34:35], v250 offset:41984
s_add_u32 m0, s100, 81920
v_accvgpr_read_b32 v111, a127
v_mfma_f32_32x32x16_bf16 a[16:31], v[52:55], v[192:195], a[16:31]
ds_read_b64_tr_b16 v[36:37], v251 offset:40960
ds_read_b64_tr_b16 v[38:39], v251 offset:41984
buffer_load_dwordx4 v247, s[88:91], s16 offen offset:0 lds
v_cvt_pk_bf16_f32 v104, v104, v105
v_cvt_pk_bf16_f32 v105, v106, v107
v_mfma_f32_32x32x16_bf16 a[32:47], v[56:59], v[192:195], a[32:47]
ds_read_b64_tr_b16 v[40:41], v252 offset:40960
ds_read_b64_tr_b16 v[42:43], v252 offset:41984
v_cvt_pk_bf16_f32 v106, v108, v109
v_cvt_pk_bf16_f32 v107, v110, v111
v_mfma_f32_32x32x16_bf16 a[48:63], v[60:63], v[192:195], a[48:63]
ds_read_b64_tr_b16 v[44:45], v253 offset:40960
ds_read_b64_tr_b16 v[46:47], v253 offset:41984
s_add_u32 s33, s35, 52224
buffer_store_dwordx4 v[104:107], v31, s[12:15], s33 offen
v_accvgpr_read_b32 v96, a128
s_waitcnt lgkmcnt(8)
v_mfma_f32_32x32x16_bf16 a[0:15], v[64:67], v[196:199], a[0:15]
ds_read_b64_tr_b16 v[48:49], v250 offset:45056
ds_read_b64_tr_b16 v[50:51], v250 offset:46080
v_accvgpr_read_b32 v97, a129
v_accvgpr_read_b32 v98, a130
v_accvgpr_read_b32 v99, a131
v_mfma_f32_32x32x16_bf16 a[16:31], v[68:71], v[196:199], a[16:31]
ds_read_b64_tr_b16 v[52:53], v251 offset:45056
ds_read_b64_tr_b16 v[54:55], v251 offset:46080
buffer_load_dwordx4 v247, s[88:91], s17 offen offset:1024 lds
v_accvgpr_read_b32 v100, a132
v_mfma_f32_32x32x16_bf16 a[32:47], v[72:75], v[196:199], a[32:47]
ds_read_b64_tr_b16 v[56:57], v252 offset:45056
ds_read_b64_tr_b16 v[58:59], v252 offset:46080
v_accvgpr_read_b32 v101, a133
v_accvgpr_read_b32 v102, a134
v_accvgpr_read_b32 v103, a135
v_mfma_f32_32x32x16_bf16 a[48:63], v[76:79], v[196:199], a[48:63]
ds_read_b64_tr_b16 v[60:61], v253 offset:45056
ds_read_b64_tr_b16 v[62:63], v253 offset:46080
v_cvt_pk_bf16_f32 v96, v96, v97
v_cvt_pk_bf16_f32 v97, v98, v99
s_waitcnt lgkmcnt(8)
v_mfma_f32_32x32x16_bf16 a[0:15], v[32:35], v[200:203], a[0:15]
s_waitcnt vmcnt(10)
s_barrier
ds_read_b64_tr_b16 v[64:65], v250 offset:49152
ds_read_b64_tr_b16 v[66:67], v250 offset:50176
v_cvt_pk_bf16_f32 v98, v100, v101
v_cvt_pk_bf16_f32 v99, v102, v103
v_mfma_f32_32x32x16_bf16 a[16:31], v[36:39], v[200:203], a[16:31]
ds_read_b64_tr_b16 v[68:69], v251 offset:49152
ds_read_b64_tr_b16 v[70:71], v251 offset:50176
buffer_load_dwordx4 v247, s[88:91], s18 offen offset:2048 lds
s_add_u32 s33, s35, 4096
v_mfma_f32_32x32x16_bf16 a[32:47], v[40:43], v[200:203], a[32:47]
ds_read_b64_tr_b16 v[72:73], v252 offset:49152
ds_read_b64_tr_b16 v[74:75], v252 offset:50176
buffer_store_dwordx4 v[96:99], v31, s[12:15], s33 offen
v_accvgpr_read_b32 v104, a136
v_accvgpr_read_b32 v105, a137
v_mfma_f32_32x32x16_bf16 a[48:63], v[44:47], v[200:203], a[48:63]
ds_read_b64_tr_b16 v[76:77], v253 offset:49152
ds_read_b64_tr_b16 v[78:79], v253 offset:50176
v_accvgpr_read_b32 v106, a138
v_accvgpr_read_b32 v107, a139
s_waitcnt lgkmcnt(8)
v_mfma_f32_32x32x16_bf16 a[0:15], v[48:51], v[204:207], a[0:15]
ds_read_b64_tr_b16 v[32:33], v250 offset:53248
ds_read_b64_tr_b16 v[34:35], v250 offset:54272
v_accvgpr_read_b32 v108, a140
v_accvgpr_read_b32 v109, a141
v_accvgpr_read_b32 v110, a142
v_mfma_f32_32x32x16_bf16 a[16:31], v[52:55], v[204:207], a[16:31]
ds_read_b64_tr_b16 v[36:37], v251 offset:53248
ds_read_b64_tr_b16 v[38:39], v251 offset:54272
buffer_load_dwordx4 v247, s[88:91], s19 offen offset:3072 lds
v_add_u32 v247, 524288, v247
v_mfma_f32_32x32x16_bf16 a[32:47], v[56:59], v[204:207], a[32:47]
ds_read_b64_tr_b16 v[40:41], v252 offset:53248
ds_read_b64_tr_b16 v[42:43], v252 offset:54272
v_accvgpr_read_b32 v111, a143
v_cvt_pk_bf16_f32 v104, v104, v105
v_cvt_pk_bf16_f32 v105, v106, v107
v_mfma_f32_32x32x16_bf16 a[48:63], v[60:63], v[204:207], a[48:63]
ds_read_b64_tr_b16 v[44:45], v253 offset:53248
ds_read_b64_tr_b16 v[46:47], v253 offset:54272
v_cvt_pk_bf16_f32 v106, v108, v109
v_cvt_pk_bf16_f32 v107, v110, v111
s_waitcnt lgkmcnt(8)
v_mfma_f32_32x32x16_bf16 a[0:15], v[64:67], v[208:211], a[0:15]
ds_read_b64_tr_b16 v[48:49], v250 offset:57344
ds_read_b64_tr_b16 v[50:51], v250 offset:58368
s_add_u32 m0, s100, 98304
s_add_u32 s33, s35, 5120
buffer_store_dwordx4 v[104:107], v31, s[12:15], s33 offen
v_mfma_f32_32x32x16_bf16 a[16:31], v[68:71], v[208:211], a[16:31]
ds_read_b64_tr_b16 v[52:53], v251 offset:57344
ds_read_b64_tr_b16 v[54:55], v251 offset:58368
buffer_load_dwordx4 v247, s[88:91], s16 offen offset:0 lds
v_accvgpr_read_b32 v96, a144
v_mfma_f32_32x32x16_bf16 a[32:47], v[72:75], v[208:211], a[32:47]
ds_read_b64_tr_b16 v[56:57], v252 offset:57344
ds_read_b64_tr_b16 v[58:59], v252 offset:58368
v_accvgpr_read_b32 v97, a145
v_accvgpr_read_b32 v98, a146
v_accvgpr_read_b32 v99, a147
v_mfma_f32_32x32x16_bf16 a[48:63], v[76:79], v[208:211], a[48:63]
ds_read_b64_tr_b16 v[60:61], v253 offset:57344
ds_read_b64_tr_b16 v[62:63], v253 offset:58368
v_accvgpr_read_b32 v100, a148
v_accvgpr_read_b32 v101, a149
s_waitcnt lgkmcnt(8)
v_mfma_f32_32x32x16_bf16 a[0:15], v[32:35], v[212:215], a[0:15]
ds_read_b64_tr_b16 v[64:65], v250 offset:61440
ds_read_b64_tr_b16 v[66:67], v250 offset:62464
v_accvgpr_read_b32 v102, a150
v_accvgpr_read_b32 v103, a151
v_cvt_pk_bf16_f32 v96, v96, v97
v_mfma_f32_32x32x16_bf16 a[16:31], v[36:39], v[212:215], a[16:31]
ds_read_b64_tr_b16 v[68:69], v251 offset:61440
ds_read_b64_tr_b16 v[70:71], v251 offset:62464
buffer_load_dwordx4 v247, s[88:91], s17 offen offset:1024 lds
v_cvt_pk_bf16_f32 v97, v98, v99
v_mfma_f32_32x32x16_bf16 a[32:47], v[40:43], v[212:215], a[32:47]
ds_read_b64_tr_b16 v[72:73], v252 offset:61440
ds_read_b64_tr_b16 v[74:75], v252 offset:62464
v_cvt_pk_bf16_f32 v98, v100, v101
v_cvt_pk_bf16_f32 v99, v102, v103
s_add_u32 s33, s35, 20480
v_mfma_f32_32x32x16_bf16 a[48:63], v[44:47], v[212:215], a[48:63]
ds_read_b64_tr_b16 v[76:77], v253 offset:61440
ds_read_b64_tr_b16 v[78:79], v253 offset:62464
buffer_store_dwordx4 v[96:99], v31, s[12:15], s33 offen
v_accvgpr_read_b32 v104, a152
v_accvgpr_read_b32 v105, a153
s_waitcnt lgkmcnt(8)
v_mfma_f32_32x32x16_bf16 a[0:15], v[48:51], v[216:219], a[0:15]
s_waitcnt vmcnt(10)
s_barrier
ds_read_b64_tr_b16 v[32:33], v12 offset:0
ds_read_b64_tr_b16 v[34:35], v12 offset:1024
v_accvgpr_read_b32 v106, a154
v_mfma_f32_32x32x16_bf16 a[16:31], v[52:55], v[216:219], a[16:31]
ds_read_b64_tr_b16 v[36:37], v13 offset:0
ds_read_b64_tr_b16 v[38:39], v13 offset:1024
buffer_load_dwordx4 v247, s[88:91], s18 offen offset:2048 lds
v_accvgpr_read_b32 v107, a155
v_accvgpr_read_b32 v108, a156
v_mfma_f32_32x32x16_bf16 a[32:47], v[56:59], v[216:219], a[32:47]
ds_read_b64_tr_b16 v[40:41], v14 offset:0
ds_read_b64_tr_b16 v[42:43], v14 offset:1024
v_accvgpr_read_b32 v109, a157
v_accvgpr_read_b32 v110, a158
v_mfma_f32_32x32x16_bf16 a[48:63], v[60:63], v[216:219], a[48:63]
ds_read_b64_tr_b16 v[44:45], v15 offset:0
ds_read_b64_tr_b16 v[46:47], v15 offset:1024
v_accvgpr_read_b32 v111, a159
v_cvt_pk_bf16_f32 v104, v104, v105
v_cvt_pk_bf16_f32 v105, v106, v107
s_waitcnt lgkmcnt(8)
v_mfma_f32_32x32x16_bf16 a[0:15], v[64:67], v[220:223], a[0:15]
ds_read_b64_tr_b16 v[48:49], v12 offset:4096
ds_read_b64_tr_b16 v[50:51], v12 offset:5120
v_cvt_pk_bf16_f32 v106, v108, v109
v_cvt_pk_bf16_f32 v107, v110, v111
v_mfma_f32_32x32x16_bf16 a[16:31], v[68:71], v[220:223], a[16:31]
ds_read_b64_tr_b16 v[52:53], v13 offset:4096
ds_read_b64_tr_b16 v[54:55], v13 offset:5120
buffer_load_dwordx4 v247, s[88:91], s19 offen offset:3072 lds
v_add_u32 v247, 524288, v247
s_add_u32 s33, s35, 21504
v_mfma_f32_32x32x16_bf16 a[32:47], v[72:75], v[220:223], a[32:47]
ds_read_b64_tr_b16 v[56:57], v14 offset:4096
ds_read_b64_tr_b16 v[58:59], v14 offset:5120
buffer_store_dwordx4 v[104:107], v31, s[12:15], s33 offen
v_accvgpr_read_b32 v96, a160
v_mfma_f32_32x32x16_bf16 a[48:63], v[76:79], v[220:223], a[48:63]
ds_read_b64_tr_b16 v[60:61], v15 offset:4096
ds_read_b64_tr_b16 v[62:63], v15 offset:5120
v_accvgpr_read_b32 v97, a161
v_accvgpr_read_b32 v98, a162
v_accvgpr_read_b32 v99, a163
s_waitcnt lgkmcnt(8)
v_mfma_f32_32x32x16_bf16 a[0:15], v[32:35], v[224:227], a[0:15]
ds_read_b64_tr_b16 v[64:65], v12 offset:8192
ds_read_b64_tr_b16 v[66:67], v12 offset:9216
s_add_u32 m0, s100, 131072
v_accvgpr_read_b32 v100, a164
v_mfma_f32_32x32x16_bf16 a[16:31], v[36:39], v[224:227], a[16:31]
ds_read_b64_tr_b16 v[68:69], v13 offset:8192
ds_read_b64_tr_b16 v[70:71], v13 offset:9216
buffer_load_dwordx4 v247, s[88:91], s16 offen offset:0 lds
v_accvgpr_read_b32 v101, a165
v_accvgpr_read_b32 v102, a166
v_mfma_f32_32x32x16_bf16 a[32:47], v[40:43], v[224:227], a[32:47]
ds_read_b64_tr_b16 v[72:73], v14 offset:8192
ds_read_b64_tr_b16 v[74:75], v14 offset:9216
v_accvgpr_read_b32 v103, a167
v_cvt_pk_bf16_f32 v96, v96, v97
v_mfma_f32_32x32x16_bf16 a[48:63], v[44:47], v[224:227], a[48:63]
ds_read_b64_tr_b16 v[76:77], v15 offset:8192
ds_read_b64_tr_b16 v[78:79], v15 offset:9216
v_cvt_pk_bf16_f32 v97, v98, v99
v_cvt_pk_bf16_f32 v98, v100, v101
v_cvt_pk_bf16_f32 v99, v102, v103
s_waitcnt lgkmcnt(8)
v_mfma_f32_32x32x16_bf16 a[0:15], v[48:51], v[228:231], a[0:15]
ds_read_b64_tr_b16 v[32:33], v12 offset:12288
ds_read_b64_tr_b16 v[34:35], v12 offset:13312
s_add_u32 s33, s35, 36864
buffer_store_dwordx4 v[96:99], v31, s[12:15], s33 offen
v_mfma_f32_32x32x16_bf16 a[16:31], v[52:55], v[228:231], a[16:31]
ds_read_b64_tr_b16 v[36:37], v13 offset:12288
ds_read_b64_tr_b16 v[38:39], v13 offset:13312
buffer_load_dwordx4 v247, s[88:91], s17 offen offset:1024 lds
v_accvgpr_read_b32 v104, a168
v_accvgpr_read_b32 v105, a169
v_mfma_f32_32x32x16_bf16 a[32:47], v[56:59], v[228:231], a[32:47]
ds_read_b64_tr_b16 v[40:41], v14 offset:12288
ds_read_b64_tr_b16 v[42:43], v14 offset:13312
v_accvgpr_read_b32 v106, a170
v_accvgpr_read_b32 v107, a171
v_mfma_f32_32x32x16_bf16 a[48:63], v[60:63], v[228:231], a[48:63]
ds_read_b64_tr_b16 v[44:45], v15 offset:12288
ds_read_b64_tr_b16 v[46:47], v15 offset:13312
v_accvgpr_read_b32 v108, a172
v_accvgpr_read_b32 v109, a173
v_accvgpr_read_b32 v110, a174
s_waitcnt lgkmcnt(8)
v_mfma_f32_32x32x16_bf16 a[0:15], v[64:67], v[232:235], a[0:15]
s_waitcnt vmcnt(10)
s_barrier
ds_read_b64_tr_b16 v[48:49], v12 offset:16384
ds_read_b64_tr_b16 v[50:51], v12 offset:17408
v_accvgpr_read_b32 v111, a175
v_mfma_f32_32x32x16_bf16 a[16:31], v[68:71], v[232:235], a[16:31]
ds_read_b64_tr_b16 v[52:53], v13 offset:16384
ds_read_b64_tr_b16 v[54:55], v13 offset:17408
buffer_load_dwordx4 v247, s[88:91], s18 offen offset:2048 lds
v_cvt_pk_bf16_f32 v104, v104, v105
v_cvt_pk_bf16_f32 v105, v106, v107
v_mfma_f32_32x32x16_bf16 a[32:47], v[72:75], v[232:235], a[32:47]
ds_read_b64_tr_b16 v[56:57], v14 offset:16384
ds_read_b64_tr_b16 v[58:59], v14 offset:17408
v_cvt_pk_bf16_f32 v106, v108, v109
v_cvt_pk_bf16_f32 v107, v110, v111
v_mfma_f32_32x32x16_bf16 a[48:63], v[76:79], v[232:235], a[48:63]
ds_read_b64_tr_b16 v[60:61], v15 offset:16384
ds_read_b64_tr_b16 v[62:63], v15 offset:17408
ds_read_b128 v[84:87], v249 offset:0
s_add_u32 s33, s35, 37888
buffer_store_dwordx4 v[104:107], v31, s[12:15], s33 offen
s_waitcnt lgkmcnt(9)
v_mfma_f32_32x32x16_bf16 a[0:15], v[32:35], v[236:239], a[0:15]
ds_read_b64_tr_b16 v[64:65], v12 offset:20480
ds_read_b64_tr_b16 v[66:67], v12 offset:21504
v_mfma_f32_32x32x16_bf16 a[16:31], v[36:39], v[236:239], a[16:31]
ds_read_b64_tr_b16 v[68:69], v13 offset:20480
ds_read_b64_tr_b16 v[70:71], v13 offset:21504
buffer_load_dwordx4 v247, s[88:91], s19 offen offset:3072 lds
v_add_u32 v247, 524288, v247
v_mfma_f32_32x32x16_bf16 a[32:47], v[40:43], v[236:239], a[32:47]
ds_read_b64_tr_b16 v[72:73], v14 offset:20480
ds_read_b64_tr_b16 v[74:75], v14 offset:21504
v_mfma_f32_32x32x16_bf16 a[48:63], v[44:47], v[236:239], a[48:63]
ds_read_b64_tr_b16 v[76:77], v15 offset:20480
ds_read_b64_tr_b16 v[78:79], v15 offset:21504
ds_read_b128 v[88:91], v249 offset:32
s_waitcnt lgkmcnt(9)
v_mfma_f32_32x32x16_bf16 a[64:79], v[48:51], v[128:131], 0
ds_read_b64_tr_b16 v[32:33], v12 offset:24576
ds_read_b64_tr_b16 v[34:35], v12 offset:25600
s_add_u32 m0, s100, 114688
v_mfma_f32_32x32x16_bf16 a[80:95], v[52:55], v[128:131], 0
ds_read_b64_tr_b16 v[36:37], v13 offset:24576
ds_read_b64_tr_b16 v[38:39], v13 offset:25600
buffer_load_dwordx4 v247, s[88:91], s16 offen offset:0 lds
s_waitcnt vmcnt(44)
s_getreg_b32 s85, hwreg(HW_REG_XCC_ID, 0, 4)
s_add_u32 s85, s85, s101
s_add_u32 s85, s85, 1
v_cmp_ne_u32 vcc, s85, v30
s_nop 3
s_cmp_eq_u64 vcc, 0
s_cselect_b32 s97, 1, 0
v_mfma_f32_32x32x16_bf16 a[96:111], v[56:59], v[128:131], 0
ds_read_b64_tr_b16 v[40:41], v14 offset:24576
ds_read_b64_tr_b16 v[42:43], v14 offset:25600
v_mfma_f32_32x32x16_bf16 a[112:127], v[60:63], v[128:131], 0
ds_read_b64_tr_b16 v[44:45], v15 offset:24576
ds_read_b64_tr_b16 v[46:47], v15 offset:25600
ds_read_b128 v[80:83], v249 offset:64
v_accvgpr_read_b32 v112, a0
v_accvgpr_read_b32 v96, a176
v_mfma_f32_32x32x16_bf16 a[160:175], v[84:87], v[128:131], 0
v_accvgpr_read_b32 v113, a1
v_accvgpr_read_b32 v97, a177
v_accvgpr_read_b32 v114, a2
v_accvgpr_read_b32 v98, a178
v_accvgpr_read_b32 v115, a3
s_waitcnt lgkmcnt(9)
v_mfma_f32_32x32x16_bf16 a[64:79], v[64:67], v[132:135], a[64:79]
ds_read_b64_tr_b16 v[48:49], v12 offset:28672
ds_read_b64_tr_b16 v[50:51], v12 offset:29696
v_accvgpr_read_b32 v116, a4
v_accvgpr_read_b32 v99, a179
v_accvgpr_read_b32 v117, a5
v_mfma_f32_32x32x16_bf16 a[80:95], v[68:71], v[132:135], a[80:95]
ds_read_b64_tr_b16 v[52:53], v13 offset:28672
ds_read_b64_tr_b16 v[54:55], v13 offset:29696
buffer_load_dwordx4 v247, s[88:91], s17 offen offset:1024 lds
v_accvgpr_read_b32 v100, a180
v_accvgpr_read_b32 v118, a6
v_mfma_f32_32x32x16_bf16 a[96:111], v[72:75], v[132:135], a[96:111]
ds_read_b64_tr_b16 v[56:57], v14 offset:28672
ds_read_b64_tr_b16 v[58:59], v14 offset:29696
v_accvgpr_read_b32 v119, a7
v_accvgpr_read_b32 v101, a181
v_mfma_f32_32x32x16_bf16 a[112:127], v[76:79], v[132:135], a[112:127]
ds_read_b64_tr_b16 v[60:61], v15 offset:28672
ds_read_b64_tr_b16 v[62:63], v15 offset:29696
ds_read_b128 v[84:87], v249 offset:96
v_mul_f32 v112, s34, v112
v_accvgpr_read_b32 v102, a182
v_mfma_f32_32x32x16_bf16 a[160:175], v[88:91], v[132:135], a[160:175]
v_mul_f32 v113, s34, v113
v_mul_f32 v114, s34, v114
v_accvgpr_read_b32 v103, a183
v_mul_f32 v115, s34, v115
v_cvt_pk_bf16_f32 v96, v96, v97
s_waitcnt lgkmcnt(9)
v_mfma_f32_32x32x16_bf16 a[64:79], v[32:35], v[136:139], a[64:79]
s_waitcnt vmcnt(9)
s_barrier
ds_read_b64_tr_b16 v[64:65], v12 offset:32768
ds_read_b64_tr_b16 v[66:67], v12 offset:33792
v_mul_f32 v116, s34, v116
v_cvt_pk_bf16_f32 v97, v98, v99
v_mfma_f32_32x32x16_bf16 a[80:95], v[36:39], v[136:139], a[80:95]
ds_read_b64_tr_b16 v[68:69], v13 offset:32768
ds_read_b64_tr_b16 v[70:71], v13 offset:33792
buffer_load_dwordx4 v247, s[88:91], s18 offen offset:2048 lds
v_mul_f32 v117, s34, v117
v_mul_f32 v118, s34, v118
v_mfma_f32_32x32x16_bf16 a[96:111], v[40:43], v[136:139], a[96:111]
ds_read_b64_tr_b16 v[72:73], v14 offset:32768
ds_read_b64_tr_b16 v[74:75], v14 offset:33792
v_cvt_pk_bf16_f32 v98, v100, v101
v_mul_f32 v119, s34, v119
v_cvt_pk_bf16_f32 v99, v102, v103
v_mfma_f32_32x32x16_bf16 a[112:127], v[44:47], v[136:139], a[112:127]
ds_read_b64_tr_b16 v[76:77], v15 offset:32768
ds_read_b64_tr_b16 v[78:79], v15 offset:33792
ds_read_b128 v[88:91], v249 offset:128
v_cvt_pk_bf16_f32 v112, v112, v113
v_cvt_pk_bf16_f32 v113, v114, v115
v_mfma_f32_32x32x16_bf16 a[160:175], v[80:83], v[136:139], a[160:175]
s_add_u32 s33, s35, 53248
v_cvt_pk_bf16_f32 v114, v116, v117
buffer_store_dwordx4 v[96:99], v31, s[12:15], s33 offen
v_cvt_pk_bf16_f32 v115, v118, v119
v_accvgpr_write_b32 a128, v112
s_waitcnt lgkmcnt(9)
v_mfma_f32_32x32x16_bf16 a[64:79], v[48:51], v[140:143], a[64:79]
ds_read_b64_tr_b16 v[32:33], v12 offset:36864
ds_read_b64_tr_b16 v[34:35], v12 offset:37888
v_accvgpr_read_b32 v104, a184
v_accvgpr_write_b32 a129, v113
v_mfma_f32_32x32x16_bf16 a[80:95], v[52:55], v[140:143], a[80:95]
ds_read_b64_tr_b16 v[36:37], v13 offset:36864
ds_read_b64_tr_b16 v[38:39], v13 offset:37888
buffer_load_dwordx4 v247, s[88:91], s19 offen offset:3072 lds
v_add_u32 v247, 524288, v247
v_accvgpr_read_b32 v105, a185
v_mfma_f32_32x32x16_bf16 a[96:111], v[56:59], v[140:143], a[96:111]
ds_read_b64_tr_b16 v[40:41], v14 offset:36864
ds_read_b64_tr_b16 v[42:43], v14 offset:37888
v_accvgpr_write_b32 a130, v114
v_accvgpr_write_b32 a131, v115
v_accvgpr_read_b32 v106, a186
v_mfma_f32_32x32x16_bf16 a[112:127], v[60:63], v[140:143], a[112:127]
ds_read_b64_tr_b16 v[44:45], v15 offset:36864
ds_read_b64_tr_b16 v[46:47], v15 offset:37888
ds_read_b128 v[80:83], v249 offset:160
s_add_u32 s40, s28, 0
v_accvgpr_read_b32 v107, a187
v_mfma_f32_32x32x16_bf16 a[160:175], v[84:87], v[140:143], a[160:175]
buffer_store_dwordx4 v[112:115], v255, s[4:7], s40 offen offset:0
v_accvgpr_read_b32 v108, a188
v_accvgpr_read_b32 v120, a8
v_accvgpr_read_b32 v121, a9
v_accvgpr_read_b32 v109, a189
s_waitcnt lgkmcnt(9)
v_mfma_f32_32x32x16_bf16 a[64:79], v[64:67], v[144:147], a[64:79]
ds_read_b64_tr_b16 v[48:49], v12 offset:40960
ds_read_b64_tr_b16 v[50:51], v12 offset:41984
s_add_u32 m0, s100, 0
v_accvgpr_read_b32 v122, a10
v_accvgpr_read_b32 v110, a190
v_mfma_f32_32x32x16_bf16 a[80:95], v[68:71], v[144:147], a[80:95]
ds_read_b64_tr_b16 v[52:53], v13 offset:40960
ds_read_b64_tr_b16 v[54:55], v13 offset:41984
buffer_load_dwordx4 v247, s[88:91], s16 offen offset:0 lds
v_accvgpr_read_b32 v123, a11
v_accvgpr_read_b32 v124, a12
v_mfma_f32_32x32x16_bf16 a[96:111], v[72:75], v[144:147], a[96:111]
ds_read_b64_tr_b16 v[56:57], v14 offset:40960
ds_read_b64_tr_b16 v[58:59], v14 offset:41984
v_accvgpr_read_b32 v111, a191
v_accvgpr_read_b32 v125, a13
v_cvt_pk_bf16_f32 v104, v104, v105
v_mfma_f32_32x32x16_bf16 a[112:127], v[76:79], v[144:147], a[112:127]
ds_read_b64_tr_b16 v[60:61], v15 offset:40960
ds_read_b64_tr_b16 v[62:63], v15 offset:41984
ds_read_b128 v[84:87], v249 offset:192
v_accvgpr_read_b32 v126, a14
v_mfma_f32_32x32x16_bf16 a[160:175], v[88:91], v[144:147], a[160:175]
v_accvgpr_read_b32 v127, a15
v_cvt_pk_bf16_f32 v105, v106, v107
v_mul_f32 v120, s34, v120
v_cvt_pk_bf16_f32 v106, v108, v109
v_mul_f32 v121, s34, v121
s_waitcnt lgkmcnt(9)
v_mfma_f32_32x32x16_bf16 a[64:79], v[32:35], v[148:151], a[64:79]
ds_read_b64_tr_b16 v[64:65], v12 offset:45056
ds_read_b64_tr_b16 v[66:67], v12 offset:46080
v_mul_f32 v122, s34, v122
v_cvt_pk_bf16_f32 v107, v110, v111
v_mul_f32 v123, s34, v123
v_mfma_f32_32x32x16_bf16 a[80:95], v[36:39], v[148:151], a[80:95]
ds_read_b64_tr_b16 v[68:69], v13 offset:45056
ds_read_b64_tr_b16 v[70:71], v13 offset:46080
buffer_load_dwordx4 v247, s[88:91], s17 offen offset:1024 lds
s_add_u32 s33, s35, 54272
v_mul_f32 v124, s34, v124
v_mfma_f32_32x32x16_bf16 a[96:111], v[40:43], v[148:151], a[96:111]
ds_read_b64_tr_b16 v[72:73], v14 offset:45056
ds_read_b64_tr_b16 v[74:75], v14 offset:46080
buffer_store_dwordx4 v[104:107], v31, s[12:15], s33 offen
v_mul_f32 v125, s34, v125
v_mul_f32 v126, s34, v126
v_mfma_f32_32x32x16_bf16 a[112:127], v[44:47], v[148:151], a[112:127]
ds_read_b64_tr_b16 v[76:77], v15 offset:45056
ds_read_b64_tr_b16 v[78:79], v15 offset:46080
ds_read_b128 v[88:91], v249 offset:224
v_accvgpr_read_b32 v96, a192
v_mul_f32 v127, s34, v127
v_mfma_f32_32x32x16_bf16 a[160:175], v[80:83], v[148:151], a[160:175]
v_accvgpr_read_b32 v97, a193
v_cvt_pk_bf16_f32 v120, v120, v121
v_cvt_pk_bf16_f32 v121, v122, v123
v_accvgpr_read_b32 v98, a194
v_cvt_pk_bf16_f32 v122, v124, v125
s_waitcnt lgkmcnt(9)
v_mfma_f32_32x32x16_bf16 a[64:79], v[48:51], v[152:155], a[64:79]
s_waitcnt vmcnt(9)
s_barrier
ds_read_b64_tr_b16 v[32:33], v16 offset:0
ds_read_b64_tr_b16 v[34:35], v16 offset:1024
v_accvgpr_read_b32 v99, a195
v_cvt_pk_bf16_f32 v123, v126, v127
v_mfma_f32_32x32x16_bf16 a[80:95], v[52:55], v[152:155], a[80:95]
ds_read_b64_tr_b16 v[36:37], v17 offset:0
ds_read_b64_tr_b16 v[38:39], v17 offset:1024
buffer_load_dwordx4 v247, s[88:91], s18 offen offset:2048 lds
v_accvgpr_write_b32 a132, v120
v_accvgpr_read_b32 v100, a196
v_mfma_f32_32x32x16_bf16 a[96:111], v[56:59], v[152:155], a[96:111]
ds_read_b64_tr_b16 v[40:41], v18 offset:0
ds_read_b64_tr_b16 v[42:43], v18 offset:1024
v_accvgpr_write_b32 a133, v121
v_accvgpr_read_b32 v101, a197
v_mfma_f32_32x32x16_bf16 a[112:127], v[60:63], v[152:155], a[112:127]
ds_read_b64_tr_b16 v[44:45], v19 offset:0
ds_read_b64_tr_b16 v[46:47], v19 offset:1024
ds_read_b128 v[80:83], v249 offset:256
v_accvgpr_write_b32 a134, v122
v_accvgpr_write_b32 a135, v123
v_mfma_f32_32x32x16_bf16 a[160:175], v[84:87], v[152:155], a[160:175]
v_accvgpr_read_b32 v102, a198
buffer_store_dwordx4 v[120:123], v255, s[4:7], s40 offen offset:1024
v_accvgpr_read_b32 v103, a199
v_accvgpr_read_b32 v112, a16
v_cvt_pk_bf16_f32 v96, v96, v97
s_waitcnt lgkmcnt(9)
v_mfma_f32_32x32x16_bf16 a[64:79], v[64:67], v[156:159], a[64:79]
ds_read_b64_tr_b16 v[48:49], v16 offset:4096
ds_read_b64_tr_b16 v[50:51], v16 offset:5120
v_accvgpr_read_b32 v113, a17
v_accvgpr_read_b32 v114, a18
v_cvt_pk_bf16_f32 v97, v98, v99
v_mfma_f32_32x32x16_bf16 a[80:95], v[68:71], v[156:159], a[80:95]
ds_read_b64_tr_b16 v[52:53], v17 offset:4096
ds_read_b64_tr_b16 v[54:55], v17 offset:5120
buffer_load_dwordx4 v247, s[88:91], s19 offen offset:3072 lds
v_add_u32 v247, 524288, v247
v_accvgpr_read_b32 v115, a19
v_mfma_f32_32x32x16_bf16 a[96:111], v[72:75], v[156:159], a[96:111]
ds_read_b64_tr_b16 v[56:57], v18 offset:4096
ds_read_b64_tr_b16 v[58:59], v18 offset:5120
v_cvt_pk_bf16_f32 v98, v100, v101
v_accvgpr_read_b32 v116, a20
v_accvgpr_read_b32 v117, a21
v_mfma_f32_32x32x16_bf16 a[112:127], v[76:79], v[156:159], a[112:127]
ds_read_b64_tr_b16 v[60:61], v19 offset:4096
ds_read_b64_tr_b16 v[62:63], v19 offset:5120
ds_read_b128 v[84:87], v249 offset:288
v_cvt_pk_bf16_f32 v99, v102, v103
v_accvgpr_read_b32 v118, a22
v_mfma_f32_32x32x16_bf16 a[160:175], v[88:91], v[156:159], a[160:175]
s_add_u32 s33, s35, 6144
v_accvgpr_read_b32 v119, a23
v_mul_f32 v112, s34, v112
buffer_store_dwordx4 v[96:99], v31, s[12:15], s33 offen
v_mul_f32 v113, s34, v113
s_waitcnt lgkmcnt(9)
v_mfma_f32_32x32x16_bf16 a[64:79], v[32:35], v[160:163], a[64:79]
ds_read_b64_tr_b16 v[64:65], v16 offset:8192
ds_read_b64_tr_b16 v[66:67], v16 offset:9216
s_add_u32 m0, s100, 16384
v_accvgpr_read_b32 v104, a200
v_mfma_f32_32x32x16_bf16 a[80:95], v[36:39], v[160:163], a[80:95]
ds_read_b64_tr_b16 v[68:69], v17 offset:8192
ds_read_b64_tr_b16 v[70:71], v17 offset:9216
buffer_load_dwordx4 v247, s[88:91], s16 offen offset:0 lds
v_mul_f32 v114, s34, v114
v_mul_f32 v115, s34, v115
v_mfma_f32_32x32x16_bf16 a[96:111], v[40:43], v[160:163], a[96:111]
ds_read_b64_tr_b16 v[72:73], v18 offset:8192
ds_read_b64_tr_b16 v[74:75], v18 offset:9216
v_accvgpr_read_b32 v105, a201
v_mul_f32 v116, s34, v116
v_accvgpr_read_b32 v106, a202
v_mfma_f32_32x32x16_bf16 a[112:127], v[44:47], v[160:163], a[112:127]
ds_read_b64_tr_b16 v[76:77], v19 offset:8192
ds_read_b64_tr_b16 v[78:79], v19 offset:9216
ds_read_b128 v[88:91], v249 offset:320
v_mul_f32 v117, s34, v117
v_accvgpr_read_b32 v107, a203
v_mfma_f32_32x32x16_bf16 a[160:175], v[80:83], v[160:163], a[160:175]
v_mul_f32 v118, s34, v118
v_mul_f32 v119, s34, v119
v_accvgpr_read_b32 v108, a204
v_cvt_pk_bf16_f32 v112, v112, v113
v_accvgpr_read_b32 v109, a205
s_waitcnt lgkmcnt(9)
v_mfma_f32_32x32x16_bf16 a[64:79], v[48:51], v[164:167], a[64:79]
ds_read_b64_tr_b16 v[32:33], v16 offset:12288
ds_read_b64_tr_b16 v[34:35], v16 offset:13312
v_cvt_pk_bf16_f32 v113, v114, v115
v_cvt_pk_bf16_f32 v114, v116, v117
v_accvgpr_read_b32 v110, a206
v_mfma_f32_32x32x16_bf16 a[80:95], v[52:55], v[164:167], a[80:95]
ds_read_b64_tr_b16 v[36:37], v17 offset:12288
ds_read_b64_tr_b16 v[38:39], v17 offset:13312
buffer_load_dwordx4 v247, s[88:91], s17 offen offset:1024 lds
v_cvt_pk_bf16_f32 v115, v118, v119
v_accvgpr_read_b32 v111, a207
v_mfma_f32_32x32x16_bf16 a[96:111], v[56:59], v[164:167], a[96:111]
ds_read_b64_tr_b16 v[40:41], v18 offset:12288
ds_read_b64_tr_b16 v[42:43], v18 offset:13312
v_accvgpr_write_b32 a136, v112
v_accvgpr_write_b32 a137, v113
v_cvt_pk_bf16_f32 v104, v104, v105
v_mfma_f32_32x32x16_bf16 a[112:127], v[60:63], v[164:167], a[112:127]
ds_read_b64_tr_b16 v[44:45], v19 offset:12288
ds_read_b64_tr_b16 v[46:47], v19 offset:13312
ds_read_b128 v[80:83], v249 offset:352
v_accvgpr_write_b32 a138, v114
v_cvt_pk_bf16_f32 v105, v106, v107
v_mfma_f32_32x32x16_bf16 a[160:175], v[84:87], v[164:167], a[160:175]
v_accvgpr_write_b32 a139, v115
buffer_store_dwordx4 v[112:115], v255, s[4:7], s40 offen offset:2048
v_cvt_pk_bf16_f32 v106, v108, v109
v_accvgpr_read_b32 v120, a24
s_waitcnt lgkmcnt(9)
v_mfma_f32_32x32x16_bf16 a[64:79], v[64:67], v[168:171], a[64:79]
s_waitcnt vmcnt(11)
s_barrier
ds_read_b64_tr_b16 v[48:49], v12 offset:49152
ds_read_b64_tr_b16 v[50:51], v12 offset:50176
v_cvt_pk_bf16_f32 v107, v110, v111
v_accvgpr_read_b32 v121, a25
v_mfma_f32_32x32x16_bf16 a[80:95], v[68:71], v[168:171], a[80:95]
ds_read_b64_tr_b16 v[52:53], v13 offset:49152
ds_read_b64_tr_b16 v[54:55], v13 offset:50176
buffer_load_dwordx4 v247, s[88:91], s18 offen offset:2048 lds
s_add_u32 s33, s35, 7168
v_accvgpr_read_b32 v122, a26
v_mfma_f32_32x32x16_bf16 a[96:111], v[72:75], v[168:171], a[96:111]
ds_read_b64_tr_b16 v[56:57], v14 offset:49152
ds_read_b64_tr_b16 v[58:59], v14 offset:50176
v_accvgpr_read_b32 v123, a27
buffer_store_dwordx4 v[104:107], v31, s[12:15], s33 offen
v_accvgpr_read_b32 v124, a28
v_mfma_f32_32x32x16_bf16 a[112:127], v[76:79], v[168:171], a[112:127]
ds_read_b64_tr_b16 v[60:61], v15 offset:49152
ds_read_b64_tr_b16 v[62:63], v15 offset:50176
ds_read_b128 v[84:87], v249 offset:384
v_accvgpr_read_b32 v96, a208
v_accvgpr_read_b32 v125, a29
v_mfma_f32_32x32x16_bf16 a[160:175], v[88:91], v[168:171], a[160:175]
v_accvgpr_read_b32 v126, a30
v_accvgpr_read_b32 v97, a209
v_accvgpr_read_b32 v127, a31
v_accvgpr_read_b32 v98, a210
v_mul_f32 v120, s34, v120
s_waitcnt lgkmcnt(9)
v_mfma_f32_32x32x16_bf16 a[64:79], v[32:35], v[172:175], a[64:79]
ds_read_b64_tr_b16 v[64:65], v12 offset:53248
ds_read_b64_tr_b16 v[66:67], v12 offset:54272
v_mul_f32 v121, s34, v121
v_accvgpr_read_b32 v99, a211
v_mul_f32 v122, s34, v122
v_mfma_f32_32x32x16_bf16 a[80:95], v[36:39], v[172:175], a[80:95]
ds_read_b64_tr_b16 v[68:69], v13 offset:53248
ds_read_b64_tr_b16 v[70:71], v13 offset:54272
buffer_load_dwordx4 v247, s[88:91], s19 offen offset:3072 lds
v_add_u32 v247, 524288, v247
v_accvgpr_read_b32 v100, a212
v_mfma_f32_32x32x16_bf16 a[96:111], v[40:43], v[172:175], a[96:111]
ds_read_b64_tr_b16 v[72:73], v14 offset:53248
ds_read_b64_tr_b16 v[74:75], v14 offset:54272
v_mul_f32 v123, s34, v123
v_mul_f32 v124, s34, v124
v_mfma_f32_32x32x16_bf16 a[112:127], v[44:47], v[172:175], a[112:127]
ds_read_b64_tr_b16 v[76:77], v15 offset:53248
ds_read_b64_tr_b16 v[78:79], v15 offset:54272
ds_read_b128 v[88:91], v249 offset:416
v_accvgpr_read_b32 v101, a213
v_mul_f32 v125, s34, v125
v_mfma_f32_32x32x16_bf16 a[160:175], v[80:83], v[172:175], a[160:175]
v_accvgpr_read_b32 v102, a214
v_mul_f32 v126, s34, v126
v_accvgpr_read_b32 v103, a215
v_mul_f32 v127, s34, v127
v_cvt_pk_bf16_f32 v120, v120, v121
s_waitcnt lgkmcnt(9)
v_mfma_f32_32x32x16_bf16 a[64:79], v[48:51], v[176:179], a[64:79]
ds_read_b64_tr_b16 v[32:33], v12 offset:57344
ds_read_b64_tr_b16 v[34:35], v12 offset:58368
s_add_u32 m0, s100, 32768
v_cvt_pk_bf16_f32 v96, v96, v97
v_cvt_pk_bf16_f32 v121, v122, v123
v_mfma_f32_32x32x16_bf16 a[80:95], v[52:55], v[176:179], a[80:95]
ds_read_b64_tr_b16 v[36:37], v13 offset:57344
ds_read_b64_tr_b16 v[38:39], v13 offset:58368
buffer_load_dwordx4 v247, s[88:91], s16 offen offset:0 lds
v_cvt_pk_bf16_f32 v97, v98, v99
v_cvt_pk_bf16_f32 v122, v124, v125
v_mfma_f32_32x32x16_bf16 a[96:111], v[56:59], v[176:179], a[96:111]
ds_read_b64_tr_b16 v[40:41], v14 offset:57344
ds_read_b64_tr_b16 v[42:43], v14 offset:58368
v_cvt_pk_bf16_f32 v123, v126, v127
v_cvt_pk_bf16_f32 v98, v100, v101
v_accvgpr_write_b32 a140, v120
v_mfma_f32_32x32x16_bf16 a[112:127], v[60:63], v[176:179], a[112:127]
ds_read_b64_tr_b16 v[44:45], v15 offset:57344
ds_read_b64_tr_b16 v[46:47], v15 offset:58368
ds_read_b128 v[80:83], v249 offset:448
v_cvt_pk_bf16_f32 v99, v102, v103
v_accvgpr_write_b32 a141, v121
v_mfma_f32_32x32x16_bf16 a[160:175], v[84:87], v[176:179], a[160:175]
s_mov_b32 s44, s36
s_mov_b32 s45, s37
v_accvgpr_write_b32 a142, v122
s_add_u32 s33, s35, 22528
v_accvgpr_write_b32 a143, v123
s_waitcnt lgkmcnt(9)
v_mfma_f32_32x32x16_bf16 a[64:79], v[64:67], v[180:183], a[64:79]
ds_read_b64_tr_b16 v[48:49], v12 offset:61440
ds_read_b64_tr_b16 v[50:51], v12 offset:62464
buffer_store_dwordx4 v[96:99], v31, s[12:15], s33 offen
buffer_store_dwordx4 v[120:123], v255, s[4:7], s40 offen offset:3072
v_mfma_f32_32x32x16_bf16 a[80:95], v[68:71], v[180:183], a[80:95]
ds_read_b64_tr_b16 v[52:53], v13 offset:61440
ds_read_b64_tr_b16 v[54:55], v13 offset:62464
buffer_load_dwordx4 v247, s[88:91], s17 offen offset:1024 lds
v_accvgpr_read_b32 v112, a32
v_accvgpr_read_b32 v104, a216
v_mfma_f32_32x32x16_bf16 a[96:111], v[72:75], v[180:183], a[96:111]
ds_read_b64_tr_b16 v[56:57], v14 offset:61440
ds_read_b64_tr_b16 v[58:59], v14 offset:62464
v_accvgpr_read_b32 v113, a33
v_accvgpr_read_b32 v105, a217
v_accvgpr_read_b32 v114, a34
v_mfma_f32_32x32x16_bf16 a[112:127], v[76:79], v[180:183], a[112:127]
ds_read_b64_tr_b16 v[60:61], v15 offset:61440
ds_read_b64_tr_b16 v[62:63], v15 offset:62464
ds_read_b128 v[84:87], v249 offset:480
v_accvgpr_read_b32 v106, a218
v_accvgpr_read_b32 v115, a35
v_mfma_f32_32x32x16_bf16 a[160:175], v[88:91], v[180:183], a[160:175]
s_mov_b32 s46, 3670016
s_mov_b32 s47, 0x20000
v_accvgpr_read_b32 v116, a36
v_accvgpr_read_b32 v107, a219
v_accvgpr_read_b32 v117, a37
s_waitcnt lgkmcnt(9)
v_mfma_f32_32x32x16_bf16 a[64:79], v[32:35], v[184:187], a[64:79]
s_waitcnt vmcnt(11)
s_barrier
ds_read_b64_tr_b16 v[64:65], v250 offset:0
ds_read_b64_tr_b16 v[66:67], v250 offset:1024
v_accvgpr_read_b32 v108, a220
v_accvgpr_read_b32 v118, a38
v_mfma_f32_32x32x16_bf16 a[80:95], v[36:39], v[184:187], a[80:95]
ds_read_b64_tr_b16 v[68:69], v251 offset:0
ds_read_b64_tr_b16 v[70:71], v251 offset:1024
buffer_load_dwordx4 v247, s[88:91], s18 offen offset:2048 lds
v_accvgpr_read_b32 v119, a39
v_accvgpr_read_b32 v109, a221
v_mfma_f32_32x32x16_bf16 a[96:111], v[40:43], v[184:187], a[96:111]
ds_read_b64_tr_b16 v[72:73], v252 offset:0
ds_read_b64_tr_b16 v[74:75], v252 offset:1024
v_mul_f32 v112, s34, v112
v_accvgpr_read_b32 v110, a222
v_mul_f32 v113, s34, v113
v_mfma_f32_32x32x16_bf16 a[112:127], v[44:47], v[184:187], a[112:127]
ds_read_b64_tr_b16 v[76:77], v253 offset:0
ds_read_b64_tr_b16 v[78:79], v253 offset:1024
ds_read_b128 v[88:91], v249 offset:512
v_mul_f32 v114, s34, v114
v_accvgpr_read_b32 v111, a223
v_mfma_f32_32x32x16_bf16 a[160:175], v[80:83], v[184:187], a[160:175]
s_mov_b32 s48, s38
v_mul_f32 v115, s34, v115
v_cvt_pk_bf16_f32 v104, v104, v105
v_mul_f32 v116, s34, v116
s_waitcnt lgkmcnt(9)
v_mfma_f32_32x32x16_bf16 a[64:79], v[48:51], v[188:191], a[64:79]
ds_read_b64_tr_b16 v[32:33], v250 offset:4096
ds_read_b64_tr_b16 v[34:35], v250 offset:5120
v_cvt_pk_bf16_f32 v105, v106, v107
v_mul_f32 v117, s34, v117
v_mul_f32 v118, s34, v118
v_mfma_f32_32x32x16_bf16 a[80:95], v[52:55], v[188:191], a[80:95]
ds_read_b64_tr_b16 v[36:37], v251 offset:4096
ds_read_b64_tr_b16 v[38:39], v251 offset:5120
buffer_load_dwordx4 v247, s[88:91], s19 offen offset:3072 lds
v_add_u32 v247, 524288, v247
v_cvt_pk_bf16_f32 v106, v108, v109
v_mfma_f32_32x32x16_bf16 a[96:111], v[56:59], v[188:191], a[96:111]
ds_read_b64_tr_b16 v[40:41], v252 offset:4096
ds_read_b64_tr_b16 v[42:43], v252 offset:5120
v_mul_f32 v119, s34, v119
v_cvt_pk_bf16_f32 v107, v110, v111
v_cvt_pk_bf16_f32 v112, v112, v113
v_mfma_f32_32x32x16_bf16 a[112:127], v[60:63], v[188:191], a[112:127]
ds_read_b64_tr_b16 v[44:45], v253 offset:4096
ds_read_b64_tr_b16 v[46:47], v253 offset:5120
ds_read_b128 v[80:83], v249 offset:544
v_cvt_pk_bf16_f32 v113, v114, v115
s_add_u32 s33, s35, 23552
v_mfma_f32_32x32x16_bf16 a[160:175], v[84:87], v[188:191], a[160:175]
s_mov_b32 s49, s39
s_mov_b32 s50, 1605632
v_cvt_pk_bf16_f32 v114, v116, v117
buffer_store_dwordx4 v[104:107], v31, s[12:15], s33 offen
v_cvt_pk_bf16_f32 v115, v118, v119
s_waitcnt lgkmcnt(9)
v_mfma_f32_32x32x16_bf16 a[64:79], v[64:67], v[192:195], a[64:79]
ds_read_b64_tr_b16 v[48:49], v250 offset:8192
ds_read_b64_tr_b16 v[50:51], v250 offset:9216
s_add_u32 m0, s100, 49152
v_accvgpr_write_b32 a144, v112
v_accvgpr_read_b32 v96, a224
v_mfma_f32_32x32x16_bf16 a[80:95], v[68:71], v[192:195], a[80:95]
ds_read_b64_tr_b16 v[52:53], v251 offset:8192
ds_read_b64_tr_b16 v[54:55], v251 offset:9216
buffer_load_dwordx4 v248, s[92:95], s20 offen offset:0 lds
v_accvgpr_write_b32 a145, v113
v_accvgpr_read_b32 v97, a225
v_mfma_f32_32x32x16_bf16 a[96:111], v[72:75], v[192:195], a[96:111]
ds_read_b64_tr_b16 v[56:57], v252 offset:8192
ds_read_b64_tr_b16 v[58:59], v252 offset:9216
v_accvgpr_write_b32 a146, v114
v_accvgpr_write_b32 a147, v115
v_mfma_f32_32x32x16_bf16 a[112:127], v[76:79], v[192:195], a[112:127]
ds_read_b64_tr_b16 v[60:61], v253 offset:8192
ds_read_b64_tr_b16 v[62:63], v253 offset:9216
ds_read_b128 v[84:87], v249 offset:576
v_accvgpr_read_b32 v98, a226
s_add_u32 s40, s28, 4096
v_mfma_f32_32x32x16_bf16 a[160:175], v[88:91], v[192:195], a[160:175]
s_mov_b32 s51, 0x20000
s_lshl_b32 s41, s2, 2
v_accvgpr_read_b32 v99, a227
buffer_store_dwordx4 v[112:115], v255, s[4:7], s40 offen offset:0
v_accvgpr_read_b32 v100, a228
s_waitcnt lgkmcnt(9)
v_mfma_f32_32x32x16_bf16 a[64:79], v[32:35], v[196:199], a[64:79]
ds_read_b64_tr_b16 v[64:65], v250 offset:12288
ds_read_b64_tr_b16 v[66:67], v250 offset:13312
v_accvgpr_read_b32 v120, a40
v_accvgpr_read_b32 v121, a41
v_accvgpr_read_b32 v101, a229
v_mfma_f32_32x32x16_bf16 a[80:95], v[36:39], v[196:199], a[80:95]
ds_read_b64_tr_b16 v[68:69], v251 offset:12288
ds_read_b64_tr_b16 v[70:71], v251 offset:13312
buffer_load_dwordx4 v248, s[92:95], s21 offen offset:1024 lds
v_accvgpr_read_b32 v122, a42
v_accvgpr_read_b32 v102, a230
v_mfma_f32_32x32x16_bf16 a[96:111], v[40:43], v[196:199], a[96:111]
ds_read_b64_tr_b16 v[72:73], v252 offset:12288
ds_read_b64_tr_b16 v[74:75], v252 offset:13312
v_accvgpr_read_b32 v123, a43
v_accvgpr_read_b32 v124, a44
v_accvgpr_read_b32 v103, a231
v_mfma_f32_32x32x16_bf16 a[112:127], v[44:47], v[196:199], a[112:127]
ds_read_b64_tr_b16 v[76:77], v253 offset:12288
ds_read_b64_tr_b16 v[78:79], v253 offset:13312
ds_read_b128 v[88:91], v249 offset:608
v_accvgpr_read_b32 v125, a45
v_cvt_pk_bf16_f32 v96, v96, v97
v_mfma_f32_32x32x16_bf16 a[160:175], v[80:83], v[196:199], a[160:175]
s_add_u32 s41, s41, s56
s_lshl_b32 s41, s41, 10
v_accvgpr_read_b32 v126, a46
v_accvgpr_read_b32 v127, a47
v_cvt_pk_bf16_f32 v97, v98, v99
s_waitcnt lgkmcnt(9)
v_mfma_f32_32x32x16_bf16 a[64:79], v[48:51], v[200:203], a[64:79]
s_waitcnt vmcnt(10)
s_barrier
ds_read_b64_tr_b16 v[32:33], v250 offset:16384
ds_read_b64_tr_b16 v[34:35], v250 offset:17408
v_mul_f32 v120, s34, v120
v_mfma_f32_32x32x16_bf16 a[80:95], v[52:55], v[200:203], a[80:95]
ds_read_b64_tr_b16 v[36:37], v251 offset:16384
ds_read_b64_tr_b16 v[38:39], v251 offset:17408
buffer_load_dwordx4 v248, s[92:95], s22 offen offset:2048 lds
v_cvt_pk_bf16_f32 v98, v100, v101
v_mul_f32 v121, s34, v121
v_mfma_f32_32x32x16_bf16 a[96:111], v[56:59], v[200:203], a[96:111]
ds_read_b64_tr_b16 v[40:41], v252 offset:16384
ds_read_b64_tr_b16 v[42:43], v252 offset:17408
v_mul_f32 v122, s34, v122
v_cvt_pk_bf16_f32 v99, v102, v103
v_mul_f32 v123, s34, v123
v_mfma_f32_32x32x16_bf16 a[112:127], v[60:63], v[200:203], a[112:127]
ds_read_b64_tr_b16 v[44:45], v253 offset:16384
ds_read_b64_tr_b16 v[46:47], v253 offset:17408
ds_read_b128 v[80:83], v249 offset:640
s_add_u32 s33, s35, 38912
v_mul_f32 v124, s34, v124
v_mfma_f32_32x32x16_bf16 a[160:175], v[84:87], v[200:203], a[160:175]
v_add_u32 v28, s41, v31
buffer_load_dwordx4 v[24:27], v28, s[44:47], 0 offen
buffer_store_dwordx4 v[96:99], v31, s[12:15], s33 offen
v_mul_f32 v125, s34, v125
v_mul_f32 v126, s34, v126
s_waitcnt lgkmcnt(9)
v_mfma_f32_32x32x16_bf16 a[64:79], v[64:67], v[204:207], a[64:79]
ds_read_b64_tr_b16 v[48:49], v250 offset:20480
ds_read_b64_tr_b16 v[50:51], v250 offset:21504
v_accvgpr_read_b32 v104, a232
v_mul_f32 v127, s34, v127
v_accvgpr_read_b32 v105, a233
v_mfma_f32_32x32x16_bf16 a[80:95], v[68:71], v[204:207], a[80:95]
ds_read_b64_tr_b16 v[52:53], v251 offset:20480
ds_read_b64_tr_b16 v[54:55], v251 offset:21504
buffer_load_dwordx4 v248, s[92:95], s23 offen offset:3072 lds
v_add_u32 v248, 229376, v248
v_cvt_pk_bf16_f32 v120, v120, v121
v_mfma_f32_32x32x16_bf16 a[96:111], v[72:75], v[204:207], a[96:111]
ds_read_b64_tr_b16 v[56:57], v252 offset:20480
ds_read_b64_tr_b16 v[58:59], v252 offset:21504
v_cvt_pk_bf16_f32 v121, v122, v123
v_accvgpr_read_b32 v106, a234
v_cvt_pk_bf16_f32 v122, v124, v125
v_mfma_f32_32x32x16_bf16 a[112:127], v[76:79], v[204:207], a[112:127]
ds_read_b64_tr_b16 v[60:61], v253 offset:20480
ds_read_b64_tr_b16 v[62:63], v253 offset:21504
ds_read_b128 v[84:87], v249 offset:672
v_accvgpr_read_b32 v107, a235
v_cvt_pk_bf16_f32 v123, v126, v127
v_mfma_f32_32x32x16_bf16 a[160:175], v[88:91], v[204:207], a[160:175]
v_add_u32 v28, 0x100000, v28
v_accvgpr_write_b32 a148, v120
v_accvgpr_read_b32 v108, a236
v_accvgpr_write_b32 a149, v121
s_waitcnt lgkmcnt(9)
v_mfma_f32_32x32x16_bf16 a[64:79], v[32:35], v[208:211], a[64:79]
ds_read_b64_tr_b16 v[64:65], v250 offset:24576
ds_read_b64_tr_b16 v[66:67], v250 offset:25600
s_add_u32 m0, s100, 65536
v_accvgpr_read_b32 v109, a237
v_accvgpr_write_b32 a150, v122
v_mfma_f32_32x32x16_bf16 a[80:95], v[36:39], v[208:211], a[80:95]
ds_read_b64_tr_b16 v[68:69], v251 offset:24576
ds_read_b64_tr_b16 v[70:71], v251 offset:25600
buffer_load_dwordx4 v248, s[92:95], s20 offen offset:0 lds
v_accvgpr_write_b32 a151, v123
v_accvgpr_read_b32 v110, a238
v_mfma_f32_32x32x16_bf16 a[96:111], v[40:43], v[208:211], a[96:111]
ds_read_b64_tr_b16 v[72:73], v252 offset:24576
ds_read_b64_tr_b16 v[74:75], v252 offset:25600
buffer_store_dwordx4 v[120:123], v255, s[4:7], s40 offen offset:1024
v_accvgpr_read_b32 v111, a239
v_accvgpr_read_b32 v112, a48
v_mfma_f32_32x32x16_bf16 a[112:127], v[44:47], v[208:211], a[112:127]
ds_read_b64_tr_b16 v[76:77], v253 offset:24576
ds_read_b64_tr_b16 v[78:79], v253 offset:25600
ds_read_b128 v[88:91], v249 offset:704
v_cvt_pk_bf16_f32 v104, v104, v105
v_accvgpr_read_b32 v113, a49
v_mfma_f32_32x32x16_bf16 a[160:175], v[80:83], v[208:211], a[160:175]
buffer_load_dwordx4 v[24:27], v28, s[44:47], 0 offen
v_add_u32 v28, 0x100000, v28
v_accvgpr_read_b32 v114, a50
v_cvt_pk_bf16_f32 v105, v106, v107
v_accvgpr_read_b32 v115, a51
s_waitcnt lgkmcnt(9)
v_mfma_f32_32x32x16_bf16 a[64:79], v[48:51], v[212:215], a[64:79]
ds_read_b64_tr_b16 v[32:33], v250 offset:28672
ds_read_b64_tr_b16 v[34:35], v250 offset:29696
v_cvt_pk_bf16_f32 v106, v108, v109
v_accvgpr_read_b32 v116, a52
v_accvgpr_read_b32 v117, a53
v_mfma_f32_32x32x16_bf16 a[80:95], v[52:55], v[212:215], a[80:95]
ds_read_b64_tr_b16 v[36:37], v251 offset:28672
ds_read_b64_tr_b16 v[38:39], v251 offset:29696
buffer_load_dwordx4 v248, s[92:95], s21 offen offset:1024 lds
v_cvt_pk_bf16_f32 v107, v110, v111
v_accvgpr_read_b32 v118, a54
v_mfma_f32_32x32x16_bf16 a[96:111], v[56:59], v[212:215], a[96:111]
ds_read_b64_tr_b16 v[40:41], v252 offset:28672
ds_read_b64_tr_b16 v[42:43], v252 offset:29696
s_add_u32 s33, s35, 39936
v_accvgpr_read_b32 v119, a55
v_mfma_f32_32x32x16_bf16 a[112:127], v[60:63], v[212:215], a[112:127]
ds_read_b64_tr_b16 v[44:45], v253 offset:28672
ds_read_b64_tr_b16 v[46:47], v253 offset:29696
ds_read_b128 v[80:83], v249 offset:736
v_mul_f32 v112, s34, v112
buffer_store_dwordx4 v[104:107], v31, s[12:15], s33 offen
v_mfma_f32_32x32x16_bf16 a[160:175], v[84:87], v[212:215], a[160:175]
buffer_load_dwordx4 v[24:27], v28, s[44:47], 0 offen
v_add_u32 v28, 0x100000, v28
v_mul_f32 v113, s34, v113
v_accvgpr_read_b32 v96, a240
v_mul_f32 v114, s34, v114
s_waitcnt lgkmcnt(9)
v_mfma_f32_32x32x16_bf16 a[64:79], v[64:67], v[216:219], a[64:79]
s_waitcnt vmcnt(14)
s_barrier
ds_read_b64_tr_b16 v[48:49], v250 offset:32768
ds_read_b64_tr_b16 v[50:51], v250 offset:33792
v_mul_f32 v115, s34, v115
v_accvgpr_read_b32 v97, a241
v_mfma_f32_32x32x16_bf16 a[80:95], v[68:71], v[216:219], a[80:95]
ds_read_b64_tr_b16 v[52:53], v251 offset:32768
ds_read_b64_tr_b16 v[54:55], v251 offset:33792
buffer_load_dwordx4 v248, s[92:95], s22 offen offset:2048 lds
v_mul_f32 v116, s34, v116
v_accvgpr_read_b32 v98, a242
v_mfma_f32_32x32x16_bf16 a[96:111], v[72:75], v[216:219], a[96:111]
ds_read_b64_tr_b16 v[56:57], v252 offset:32768
ds_read_b64_tr_b16 v[58:59], v252 offset:33792
v_mul_f32 v117, s34, v117
v_accvgpr_read_b32 v99, a243
v_mul_f32 v118, s34, v118
v_mfma_f32_32x32x16_bf16 a[112:127], v[76:79], v[216:219], a[112:127]
ds_read_b64_tr_b16 v[60:61], v253 offset:32768
ds_read_b64_tr_b16 v[62:63], v253 offset:33792
ds_read_b128 v[84:87], v249 offset:768
v_mul_f32 v119, s34, v119
v_accvgpr_read_b32 v100, a244
v_mfma_f32_32x32x16_bf16 a[160:175], v[88:91], v[216:219], a[160:175]
buffer_load_dwordx4 v[24:27], v28, s[44:47], 0 offen
v_add_u32 v28, 0x100000, v28
v_cvt_pk_bf16_f32 v112, v112, v113
v_accvgpr_read_b32 v101, a245
v_cvt_pk_bf16_f32 v113, v114, v115
s_waitcnt lgkmcnt(9)
v_mfma_f32_32x32x16_bf16 a[64:79], v[32:35], v[220:223], a[64:79]
ds_read_b64_tr_b16 v[64:65], v250 offset:36864
ds_read_b64_tr_b16 v[66:67], v250 offset:37888
v_cvt_pk_bf16_f32 v114, v116, v117
v_accvgpr_read_b32 v102, a246
v_cvt_pk_bf16_f32 v115, v118, v119
v_mfma_f32_32x32x16_bf16 a[80:95], v[36:39], v[220:223], a[80:95]
ds_read_b64_tr_b16 v[68:69], v251 offset:36864
ds_read_b64_tr_b16 v[70:71], v251 offset:37888
buffer_load_dwordx4 v248, s[92:95], s23 offen offset:3072 lds
v_add_u32 v248, 229376, v248
v_mfma_f32_32x32x16_bf16 a[96:111], v[40:43], v[220:223], a[96:111]
ds_read_b64_tr_b16 v[72:73], v252 offset:36864
ds_read_b64_tr_b16 v[74:75], v252 offset:37888
v_accvgpr_read_b32 v103, a247
v_accvgpr_write_b32 a152, v112
v_accvgpr_write_b32 a153, v113
v_mfma_f32_32x32x16_bf16 a[112:127], v[44:47], v[220:223], a[112:127]
ds_read_b64_tr_b16 v[76:77], v253 offset:36864
ds_read_b64_tr_b16 v[78:79], v253 offset:37888
ds_read_b128 v[88:91], v249 offset:800
v_cvt_pk_bf16_f32 v96, v96, v97
v_accvgpr_write_b32 a154, v114
v_mfma_f32_32x32x16_bf16 a[160:175], v[80:83], v[220:223], a[160:175]
v_add_u32 v28, s41, v31
v_cvt_pk_bf16_f32 v97, v98, v99
v_accvgpr_write_b32 a155, v115
buffer_store_dwordx4 v[112:115], v255, s[4:7], s40 offen offset:2048
v_cvt_pk_bf16_f32 v98, v100, v101
s_waitcnt lgkmcnt(9)
v_mfma_f32_32x32x16_bf16 a[64:79], v[48:51], v[224:227], a[64:79]
ds_read_b64_tr_b16 v[32:33], v250 offset:40960
ds_read_b64_tr_b16 v[34:35], v250 offset:41984
s_add_u32 m0, s100, 81920
v_accvgpr_read_b32 v120, a56
v_cvt_pk_bf16_f32 v99, v102, v103
v_mfma_f32_32x32x16_bf16 a[80:95], v[52:55], v[224:227], a[80:95]
ds_read_b64_tr_b16 v[36:37], v251 offset:40960
ds_read_b64_tr_b16 v[38:39], v251 offset:41984
buffer_load_dwordx4 v248, s[92:95], s20 offen offset:0 lds
v_accvgpr_read_b32 v121, a57
s_add_u32 s33, s35, 55296
v_mfma_f32_32x32x16_bf16 a[96:111], v[56:59], v[224:227], a[96:111]
ds_read_b64_tr_b16 v[40:41], v252 offset:40960
ds_read_b64_tr_b16 v[42:43], v252 offset:41984
v_accvgpr_read_b32 v122, a58
v_accvgpr_read_b32 v123, a59
buffer_store_dwordx4 v[96:99], v31, s[12:15], s33 offen
v_mfma_f32_32x32x16_bf16 a[112:127], v[60:63], v[224:227], a[112:127]
ds_read_b64_tr_b16 v[44:45], v253 offset:40960
ds_read_b64_tr_b16 v[46:47], v253 offset:41984
ds_read_b128 v[80:83], v249 offset:832
v_accvgpr_read_b32 v124, a60
v_accvgpr_read_b32 v104, a248
v_mfma_f32_32x32x16_bf16 a[160:175], v[84:87], v[224:227], a[160:175]
buffer_load_dwordx4 v[24:27], v28, s[48:51], 0 offen
v_add_u32 v28, 0x100000, v28
v_accvgpr_read_b32 v125, a61
v_accvgpr_read_b32 v126, a62
s_waitcnt lgkmcnt(9)
v_mfma_f32_32x32x16_bf16 a[64:79], v[64:67], v[228:231], a[64:79]
ds_read_b64_tr_b16 v[48:49], v250 offset:45056
ds_read_b64_tr_b16 v[50:51], v250 offset:46080
v_accvgpr_read_b32 v105, a249
v_accvgpr_read_b32 v127, a63
v_accvgpr_read_b32 v106, a250
v_mfma_f32_32x32x16_bf16 a[80:95], v[68:71], v[228:231], a[80:95]
ds_read_b64_tr_b16 v[52:53], v251 offset:45056
ds_read_b64_tr_b16 v[54:55], v251 offset:46080
buffer_load_dwordx4 v248, s[92:95], s21 offen offset:1024 lds
v_mul_f32 v120, s34, v120
v_mul_f32 v121, s34, v121
v_mfma_f32_32x32x16_bf16 a[96:111], v[72:75], v[228:231], a[96:111]
ds_read_b64_tr_b16 v[56:57], v252 offset:45056
ds_read_b64_tr_b16 v[58:59], v252 offset:46080
v_accvgpr_read_b32 v107, a251
v_mul_f32 v122, s34, v122
v_accvgpr_read_b32 v108, a252
v_mfma_f32_32x32x16_bf16 a[112:127], v[76:79], v[228:231], a[112:127]
ds_read_b64_tr_b16 v[60:61], v253 offset:45056
ds_read_b64_tr_b16 v[62:63], v253 offset:46080
ds_read_b128 v[84:87], v249 offset:864
v_mul_f32 v123, s34, v123
v_mul_f32 v124, s34, v124
v_mfma_f32_32x32x16_bf16 a[160:175], v[88:91], v[228:231], a[160:175]
buffer_load_dwordx4 v[24:27], v28, s[48:51], 0 offen
v_add_u32 v28, 0x100000, v28
v_accvgpr_read_b32 v109, a253
v_mul_f32 v125, s34, v125
v_accvgpr_read_b32 v110, a254
s_waitcnt lgkmcnt(9)
v_mfma_f32_32x32x16_bf16 a[64:79], v[32:35], v[232:235], a[64:79]
s_waitcnt vmcnt(15)
s_barrier
ds_read_b64_tr_b16 v[64:65], v250 offset:49152
ds_read_b64_tr_b16 v[66:67], v250 offset:50176
v_mul_f32 v126, s34, v126
v_accvgpr_read_b32 v111, a255
v_mfma_f32_32x32x16_bf16 a[80:95], v[36:39], v[232:235], a[80:95]
ds_read_b64_tr_b16 v[68:69], v251 offset:49152
ds_read_b64_tr_b16 v[70:71], v251 offset:50176
buffer_load_dwordx4 v248, s[92:95], s22 offen offset:2048 lds
v_mul_f32 v127, s34, v127
v_cvt_pk_bf16_f32 v120, v120, v121
v_mfma_f32_32x32x16_bf16 a[96:111], v[40:43], v[232:235], a[96:111]
ds_read_b64_tr_b16 v[72:73], v252 offset:49152
ds_read_b64_tr_b16 v[74:75], v252 offset:50176
v_cvt_pk_bf16_f32 v104, v104, v105
v_cvt_pk_bf16_f32 v121, v122, v123
v_mfma_f32_32x32x16_bf16 a[112:127], v[44:47], v[232:235], a[112:127]
ds_read_b64_tr_b16 v[76:77], v253 offset:49152
ds_read_b64_tr_b16 v[78:79], v253 offset:50176
v_cvt_pk_bf16_f32 v105, v106, v107
v_cvt_pk_bf16_f32 v122, v124, v125
v_cvt_pk_bf16_f32 v123, v126, v127
v_mfma_f32_32x32x16_bf16 a[160:175], v[80:83], v[232:235], a[160:175]
v_cvt_pk_bf16_f32 v106, v108, v109
v_accvgpr_write_b32 a156, v120
v_cvt_pk_bf16_f32 v107, v110, v111
v_accvgpr_write_b32 a157, v121
v_accvgpr_write_b32 a158, v122
s_waitcnt lgkmcnt(8)
v_mfma_f32_32x32x16_bf16 a[64:79], v[48:51], v[236:239], a[64:79]
ds_read_b64_tr_b16 v[32:33], v250 offset:53248
ds_read_b64_tr_b16 v[34:35], v250 offset:54272
s_add_u32 s33, s35, 56320
v_accvgpr_write_b32 a159, v123
buffer_store_dwordx4 v[104:107], v31, s[12:15], s33 offen
v_mfma_f32_32x32x16_bf16 a[80:95], v[52:55], v[236:239], a[80:95]
ds_read_b64_tr_b16 v[36:37], v251 offset:53248
ds_read_b64_tr_b16 v[38:39], v251 offset:54272
buffer_load_dwordx4 v248, s[92:95], s23 offen offset:3072 lds
v_add_u32 v248, 229376, v248
buffer_store_dwordx4 v[120:123], v255, s[4:7], s40 offen offset:3072
v_mfma_f32_32x32x16_bf16 a[96:111], v[56:59], v[236:239], a[96:111]
ds_read_b64_tr_b16 v[40:41], v252 offset:53248
ds_read_b64_tr_b16 v[42:43], v252 offset:54272
v_mfma_f32_32x32x16_bf16 a[112:127], v[60:63], v[236:239], a[112:127]
ds_read_b64_tr_b16 v[44:45], v253 offset:53248
ds_read_b64_tr_b16 v[46:47], v253 offset:54272
v_mfma_f32_32x32x16_bf16 a[160:175], v[84:87], v[236:239], a[160:175]
s_waitcnt lgkmcnt(8)
v_mfma_f32_32x32x16_bf16 a[0:15], v[64:67], v[128:131], 0
ds_read_b64_tr_b16 v[48:49], v250 offset:57344
ds_read_b64_tr_b16 v[50:51], v250 offset:58368
s_add_u32 m0, s100, 98304
v_mfma_f32_32x32x16_bf16 a[16:31], v[68:71], v[128:131], 0
ds_read_b64_tr_b16 v[52:53], v251 offset:57344
ds_read_b64_tr_b16 v[54:55], v251 offset:58368
buffer_load_dwordx4 v248, s[92:95], s20 offen offset:0 lds
v_mfma_f32_32x32x16_bf16 a[32:47], v[72:75], v[128:131], 0
ds_read_b64_tr_b16 v[56:57], v252 offset:57344
ds_read_b64_tr_b16 v[58:59], v252 offset:58368
v_mfma_f32_32x32x16_bf16 a[48:63], v[76:79], v[128:131], 0
ds_read_b64_tr_b16 v[60:61], v253 offset:57344
ds_read_b64_tr_b16 v[62:63], v253 offset:58368
v_accvgpr_read_b32 v92, a160
s_waitcnt lgkmcnt(8)
v_mfma_f32_32x32x16_bf16 a[0:15], v[32:35], v[132:135], a[0:15]
ds_read_b64_tr_b16 v[64:65], v250 offset:61440
ds_read_b64_tr_b16 v[66:67], v250 offset:62464
s_nop 0
v_mul_f32 v92, 0xbfb8aa3b, v92
v_mfma_f32_32x32x16_bf16 a[16:31], v[36:39], v[132:135], a[16:31]
ds_read_b64_tr_b16 v[68:69], v251 offset:61440
ds_read_b64_tr_b16 v[70:71], v251 offset:62464
buffer_load_dwordx4 v248, s[92:95], s21 offen offset:1024 lds
v_mfma_f32_32x32x16_bf16 a[32:47], v[40:43], v[132:135], a[32:47]
ds_read_b64_tr_b16 v[72:73], v252 offset:61440
ds_read_b64_tr_b16 v[74:75], v252 offset:62464
v_exp_f32 v92, v92
v_mfma_f32_32x32x16_bf16 a[48:63], v[44:47], v[132:135], a[48:63]
ds_read_b64_tr_b16 v[76:77], v253 offset:61440
ds_read_b64_tr_b16 v[78:79], v253 offset:62464
s_nop 0
v_add_f32 v92, 1.0, v92
s_waitcnt lgkmcnt(8)
v_mfma_f32_32x32x16_bf16 a[0:15], v[48:51], v[136:139], a[0:15]
s_waitcnt vmcnt(12)
s_barrier
ds_read_b64_tr_b16 v[32:33], v12 offset:0
ds_read_b64_tr_b16 v[34:35], v12 offset:1024
v_mfma_f32_32x32x16_bf16 a[16:31], v[52:55], v[136:139], a[16:31]
ds_read_b64_tr_b16 v[36:37], v13 offset:0
ds_read_b64_tr_b16 v[38:39], v13 offset:1024
buffer_load_dwordx4 v248, s[92:95], s22 offen offset:2048 lds
v_mfma_f32_32x32x16_bf16 a[32:47], v[56:59], v[136:139], a[32:47]
ds_read_b64_tr_b16 v[40:41], v14 offset:0
ds_read_b64_tr_b16 v[42:43], v14 offset:1024
v_rcp_f32 v92, v92
s_nop 0
v_mfma_f32_32x32x16_bf16 a[48:63], v[60:63], v[136:139], a[48:63]
ds_read_b64_tr_b16 v[44:45], v15 offset:0
ds_read_b64_tr_b16 v[46:47], v15 offset:1024
v_sub_f32 v93, 1.0, v92
s_waitcnt lgkmcnt(8)
v_mfma_f32_32x32x16_bf16 a[0:15], v[64:67], v[140:143], a[0:15]
ds_read_b64_tr_b16 v[48:49], v12 offset:4096
ds_read_b64_tr_b16 v[50:51], v12 offset:5120
v_accvgpr_read_b32 v112, a64
v_accvgpr_read_b32 v113, a65
v_accvgpr_read_b32 v114, a66
v_mfma_f32_32x32x16_bf16 a[16:31], v[68:71], v[140:143], a[16:31]
ds_read_b64_tr_b16 v[52:53], v13 offset:4096
ds_read_b64_tr_b16 v[54:55], v13 offset:5120
buffer_load_dwordx4 v248, s[92:95], s23 offen offset:3072 lds
v_add_u32 v248, 229376, v248
v_accvgpr_read_b32 v115, a67
v_accvgpr_read_b32 v116, a68
v_mfma_f32_32x32x16_bf16 a[32:47], v[72:75], v[140:143], a[32:47]
ds_read_b64_tr_b16 v[56:57], v14 offset:4096
ds_read_b64_tr_b16 v[58:59], v14 offset:5120
v_accvgpr_read_b32 v117, a69
v_accvgpr_read_b32 v118, a70
v_accvgpr_read_b32 v119, a71
v_mfma_f32_32x32x16_bf16 a[48:63], v[76:79], v[140:143], a[48:63]
ds_read_b64_tr_b16 v[60:61], v15 offset:4096
ds_read_b64_tr_b16 v[62:63], v15 offset:5120
v_mul_f32 v112, s34, v112
v_mul_f32 v113, s34, v113
v_mul_f32 v114, s34, v114
s_waitcnt lgkmcnt(8)
v_mfma_f32_32x32x16_bf16 a[0:15], v[32:35], v[144:147], a[0:15]
ds_read_b64_tr_b16 v[64:65], v12 offset:8192
ds_read_b64_tr_b16 v[66:67], v12 offset:9216
s_add_u32 m0, s100, 131072
v_mul_f32 v115, s34, v115
v_mul_f32 v116, s34, v116
v_mul_f32 v117, s34, v117
v_mfma_f32_32x32x16_bf16 a[16:31], v[36:39], v[144:147], a[16:31]
ds_read_b64_tr_b16 v[68:69], v13 offset:8192
ds_read_b64_tr_b16 v[70:71], v13 offset:9216
buffer_load_dwordx4 v248, s[92:95], s20 offen offset:0 lds
v_mul_f32 v118, s34, v118
v_mul_f32 v119, s34, v119
v_mfma_f32_32x32x16_bf16 a[32:47], v[40:43], v[144:147], a[32:47]
ds_read_b64_tr_b16 v[72:73], v14 offset:8192
ds_read_b64_tr_b16 v[74:75], v14 offset:9216
v_cvt_pk_bf16_f32 v112, v112, v113
v_cvt_pk_bf16_f32 v113, v114, v115
v_cvt_pk_bf16_f32 v114, v116, v117
v_mfma_f32_32x32x16_bf16 a[48:63], v[44:47], v[144:147], a[48:63]
ds_read_b64_tr_b16 v[76:77], v15 offset:8192
ds_read_b64_tr_b16 v[78:79], v15 offset:9216
v_cvt_pk_bf16_f32 v115, v118, v119
v_accvgpr_write_b32 a160, v112
v_accvgpr_write_b32 a161, v113
v_accvgpr_write_b32 a162, v114
s_waitcnt lgkmcnt(8)
v_mfma_f32_32x32x16_bf16 a[0:15], v[48:51], v[148:151], a[0:15]
ds_read_b64_tr_b16 v[32:33], v12 offset:12288
ds_read_b64_tr_b16 v[34:35], v12 offset:13312
v_accvgpr_write_b32 a163, v115
s_add_u32 s40, s28, 8192
buffer_store_dwordx4 v[112:115], v255, s[4:7], s40 offen offset:0
v_mfma_f32_32x32x16_bf16 a[16:31], v[52:55], v[148:151], a[16:31]
ds_read_b64_tr_b16 v[36:37], v13 offset:12288
ds_read_b64_tr_b16 v[38:39], v13 offset:13312
buffer_load_dwordx4 v248, s[92:95], s21 offen offset:1024 lds
v_accvgpr_read_b32 v120, a72
v_accvgpr_read_b32 v121, a73
v_mfma_f32_32x32x16_bf16 a[32:47], v[56:59], v[148:151], a[32:47]
ds_read_b64_tr_b16 v[40:41], v14 offset:12288
ds_read_b64_tr_b16 v[42:43], v14 offset:13312
v_accvgpr_read_b32 v122, a74
v_accvgpr_read_b32 v123, a75
v_accvgpr_read_b32 v124, a76
v_accvgpr_read_b32 v125, a77
v_mfma_f32_32x32x16_bf16 a[48:63], v[60:63], v[148:151], a[48:63]
ds_read_b64_tr_b16 v[44:45], v15 offset:12288
ds_read_b64_tr_b16 v[46:47], v15 offset:13312
v_accvgpr_read_b32 v126, a78
v_accvgpr_read_b32 v127, a79
v_mul_f32 v120, s34, v120
s_waitcnt lgkmcnt(8)
v_mfma_f32_32x32x16_bf16 a[0:15], v[64:67], v[152:155], a[0:15]
s_waitcnt vmcnt(8)
s_waitcnt vmcnt(9)
s_barrier
s_cmp_eq_u32 s56, 0
s_cbranch_scc1 k1_kvpub
k1_kvpubret:
ds_read_b64_tr_b16 v[48:49], v12 offset:16384
ds_read_b64_tr_b16 v[50:51], v12 offset:17408
v_mul_f32 v121, s34, v121
v_mul_f32 v122, s34, v122
v_mfma_f32_32x32x16_bf16 a[16:31], v[68:71], v[152:155], a[16:31]
ds_read_b64_tr_b16 v[52:53], v13 offset:16384
ds_read_b64_tr_b16 v[54:55], v13 offset:17408
buffer_load_dwordx4 v248, s[92:95], s22 offen offset:2048 lds
v_mul_f32 v123, s34, v123
v_mul_f32 v124, s34, v124
v_mul_f32 v125, s34, v125
v_mfma_f32_32x32x16_bf16 a[32:47], v[72:75], v[152:155], a[32:47]
ds_read_b64_tr_b16 v[56:57], v14 offset:16384
ds_read_b64_tr_b16 v[58:59], v14 offset:17408
v_mul_f32 v126, s34, v126
v_mul_f32 v127, s34, v127
v_cvt_pk_bf16_f32 v120, v120, v121
v_mfma_f32_32x32x16_bf16 a[48:63], v[76:79], v[152:155], a[48:63]
ds_read_b64_tr_b16 v[60:61], v15 offset:16384
ds_read_b64_tr_b16 v[62:63], v15 offset:17408
v_cvt_pk_bf16_f32 v121, v122, v123
v_cvt_pk_bf16_f32 v122, v124, v125
v_cvt_pk_bf16_f32 v123, v126, v127
s_waitcnt lgkmcnt(8)
v_mfma_f32_32x32x16_bf16 a[0:15], v[32:35], v[156:159], a[0:15]
ds_read_b64_tr_b16 v[64:65], v12 offset:20480
ds_read_b64_tr_b16 v[66:67], v12 offset:21504
v_accvgpr_write_b32 a164, v120
v_accvgpr_write_b32 a165, v121
v_accvgpr_write_b32 a166, v122
v_accvgpr_write_b32 a167, v123
v_mfma_f32_32x32x16_bf16 a[16:31], v[36:39], v[156:159], a[16:31]
ds_read_b64_tr_b16 v[68:69], v13 offset:20480
ds_read_b64_tr_b16 v[70:71], v13 offset:21504
buffer_load_dwordx4 v248, s[92:95], s23 offen offset:3072 lds
v_add_u32 v248, 229376, v248
buffer_store_dwordx4 v[120:123], v255, s[4:7], s40 offen offset:1024
v_mfma_f32_32x32x16_bf16 a[32:47], v[40:43], v[156:159], a[32:47]
ds_read_b64_tr_b16 v[72:73], v14 offset:20480
ds_read_b64_tr_b16 v[74:75], v14 offset:21504
v_accvgpr_read_b32 v112, a80
v_accvgpr_read_b32 v113, a81
v_accvgpr_read_b32 v114, a82
v_mfma_f32_32x32x16_bf16 a[48:63], v[44:47], v[156:159], a[48:63]
ds_read_b64_tr_b16 v[76:77], v15 offset:20480
ds_read_b64_tr_b16 v[78:79], v15 offset:21504
v_accvgpr_read_b32 v115, a83
v_accvgpr_read_b32 v116, a84
v_accvgpr_read_b32 v117, a85
s_waitcnt lgkmcnt(8)
v_mfma_f32_32x32x16_bf16 a[0:15], v[48:51], v[160:163], a[0:15]
ds_read_b64_tr_b16 v[32:33], v12 offset:24576
ds_read_b64_tr_b16 v[34:35], v12 offset:25600
s_add_u32 m0, s100, 114688
v_accvgpr_read_b32 v118, a86
v_accvgpr_read_b32 v119, a87
v_mul_f32 v112, s34, v112
v_mfma_f32_32x32x16_bf16 a[16:31], v[52:55], v[160:163], a[16:31]
ds_read_b64_tr_b16 v[36:37], v13 offset:24576
ds_read_b64_tr_b16 v[38:39], v13 offset:25600
buffer_load_dwordx4 v248, s[92:95], s20 offen offset:0 lds
v_mul_f32 v113, s34, v113
v_mul_f32 v114, s34, v114
v_mfma_f32_32x32x16_bf16 a[32:47], v[56:59], v[160:163], a[32:47]
ds_read_b64_tr_b16 v[40:41], v14 offset:24576
ds_read_b64_tr_b16 v[42:43], v14 offset:25600
v_mul_f32 v115, s34, v115
v_mul_f32 v116, s34, v116
v_mul_f32 v117, s34, v117
v_mfma_f32_32x32x16_bf16 a[48:63], v[60:63], v[160:163], a[48:63]
ds_read_b64_tr_b16 v[44:45], v15 offset:24576
ds_read_b64_tr_b16 v[46:47], v15 offset:25600
v_mul_f32 v118, s34, v118
v_mul_f32 v119, s34, v119
v_cvt_pk_bf16_f32 v112, v112, v113
v_cvt_pk_bf16_f32 v113, v114, v115
s_waitcnt lgkmcnt(8)
v_mfma_f32_32x32x16_bf16 a[0:15], v[64:67], v[164:167], a[0:15]
ds_read_b64_tr_b16 v[48:49], v12 offset:28672
ds_read_b64_tr_b16 v[50:51], v12 offset:29696
v_cvt_pk_bf16_f32 v114, v116, v117
v_cvt_pk_bf16_f32 v115, v118, v119
v_accvgpr_write_b32 a168, v112
v_mfma_f32_32x32x16_bf16 a[16:31], v[68:71], v[164:167], a[16:31]
ds_read_b64_tr_b16 v[52:53], v13 offset:28672
ds_read_b64_tr_b16 v[54:55], v13 offset:29696
buffer_load_dwordx4 v248, s[92:95], s21 offen offset:1024 lds
v_accvgpr_write_b32 a169, v113
v_accvgpr_write_b32 a170, v114
v_mfma_f32_32x32x16_bf16 a[32:47], v[72:75], v[164:167], a[32:47]
ds_read_b64_tr_b16 v[56:57], v14 offset:28672
ds_read_b64_tr_b16 v[58:59], v14 offset:29696
v_accvgpr_write_b32 a171, v115
buffer_store_dwordx4 v[112:115], v255, s[4:7], s40 offen offset:2048
v_accvgpr_read_b32 v120, a88
v_accvgpr_read_b32 v121, a89
v_mfma_f32_32x32x16_bf16 a[48:63], v[76:79], v[164:167], a[48:63]
ds_read_b64_tr_b16 v[60:61], v15 offset:28672
ds_read_b64_tr_b16 v[62:63], v15 offset:29696
v_accvgpr_read_b32 v122, a90
v_accvgpr_read_b32 v123, a91
v_accvgpr_read_b32 v124, a92
s_waitcnt lgkmcnt(8)
v_mfma_f32_32x32x16_bf16 a[0:15], v[32:35], v[168:171], a[0:15]
s_waitcnt vmcnt(9)
s_barrier
ds_read_b64_tr_b16 v[64:65], v12 offset:32768
ds_read_b64_tr_b16 v[66:67], v12 offset:33792
v_accvgpr_read_b32 v125, a93
v_accvgpr_read_b32 v126, a94
v_mfma_f32_32x32x16_bf16 a[16:31], v[36:39], v[168:171], a[16:31]
ds_read_b64_tr_b16 v[68:69], v13 offset:32768
ds_read_b64_tr_b16 v[70:71], v13 offset:33792
buffer_load_dwordx4 v248, s[92:95], s22 offen offset:2048 lds
v_accvgpr_read_b32 v127, a95
v_mul_f32 v120, s34, v120
v_mul_f32 v121, s34, v121
v_mfma_f32_32x32x16_bf16 a[32:47], v[40:43], v[168:171], a[32:47]
ds_read_b64_tr_b16 v[72:73], v14 offset:32768
ds_read_b64_tr_b16 v[74:75], v14 offset:33792
v_mul_f32 v122, s34, v122
v_mul_f32 v123, s34, v123
v_mul_f32 v124, s34, v124
v_mfma_f32_32x32x16_bf16 a[48:63], v[44:47], v[168:171], a[48:63]
ds_read_b64_tr_b16 v[76:77], v15 offset:32768
ds_read_b64_tr_b16 v[78:79], v15 offset:33792
v_mul_f32 v125, s34, v125
v_mul_f32 v126, s34, v126
v_mul_f32 v127, s34, v127
s_waitcnt lgkmcnt(8)
v_mfma_f32_32x32x16_bf16 a[0:15], v[48:51], v[172:175], a[0:15]
ds_read_b64_tr_b16 v[32:33], v12 offset:36864
ds_read_b64_tr_b16 v[34:35], v12 offset:37888
v_cvt_pk_bf16_f32 v120, v120, v121
v_cvt_pk_bf16_f32 v121, v122, v123
v_cvt_pk_bf16_f32 v122, v124, v125
v_cvt_pk_bf16_f32 v123, v126, v127
v_mfma_f32_32x32x16_bf16 a[16:31], v[52:55], v[172:175], a[16:31]
ds_read_b64_tr_b16 v[36:37], v13 offset:36864
ds_read_b64_tr_b16 v[38:39], v13 offset:37888
buffer_load_dwordx4 v248, s[92:95], s23 offen offset:3072 lds
v_add_u32 v248, 229376, v248
v_accvgpr_write_b32 a172, v120
v_mfma_f32_32x32x16_bf16 a[32:47], v[56:59], v[172:175], a[32:47]
ds_read_b64_tr_b16 v[40:41], v14 offset:36864
ds_read_b64_tr_b16 v[42:43], v14 offset:37888
v_accvgpr_write_b32 a173, v121
v_accvgpr_write_b32 a174, v122
v_accvgpr_write_b32 a175, v123
v_mfma_f32_32x32x16_bf16 a[48:63], v[60:63], v[172:175], a[48:63]
ds_read_b64_tr_b16 v[44:45], v15 offset:36864
ds_read_b64_tr_b16 v[46:47], v15 offset:37888
buffer_store_dwordx4 v[120:123], v255, s[4:7], s40 offen offset:3072
v_accvgpr_read_b32 v112, a96
v_accvgpr_read_b32 v113, a97
v_accvgpr_read_b32 v114, a98
s_waitcnt lgkmcnt(8)
v_mfma_f32_32x32x16_bf16 a[0:15], v[64:67], v[176:179], a[0:15]
ds_read_b64_tr_b16 v[48:49], v12 offset:40960
ds_read_b64_tr_b16 v[50:51], v12 offset:41984
s_add_u32 m0, s100, 0
v_accvgpr_read_b32 v115, a99
v_accvgpr_read_b32 v116, a100
v_mfma_f32_32x32x16_bf16 a[16:31], v[68:71], v[176:179], a[16:31]
ds_read_b64_tr_b16 v[52:53], v13 offset:40960
ds_read_b64_tr_b16 v[54:55], v13 offset:41984
buffer_load_dwordx4 v248, s[92:95], s20 offen offset:0 lds
v_accvgpr_read_b32 v117, a101
v_accvgpr_read_b32 v118, a102
v_mfma_f32_32x32x16_bf16 a[32:47], v[72:75], v[176:179], a[32:47]
ds_read_b64_tr_b16 v[56:57], v14 offset:40960
ds_read_b64_tr_b16 v[58:59], v14 offset:41984
v_accvgpr_read_b32 v119, a103
v_mul_f32 v112, s34, v112
v_mul_f32 v113, s34, v113
v_mul_f32 v114, s34, v114
v_mfma_f32_32x32x16_bf16 a[48:63], v[76:79], v[176:179], a[48:63]
ds_read_b64_tr_b16 v[60:61], v15 offset:40960
ds_read_b64_tr_b16 v[62:63], v15 offset:41984
v_mul_f32 v115, s34, v115
v_mul_f32 v116, s34, v116
v_mul_f32 v117, s34, v117
s_waitcnt lgkmcnt(8)
v_mfma_f32_32x32x16_bf16 a[0:15], v[32:35], v[180:183], a[0:15]
ds_read_b64_tr_b16 v[64:65], v12 offset:45056
ds_read_b64_tr_b16 v[66:67], v12 offset:46080
v_mul_f32 v118, s34, v118
v_mul_f32 v119, s34, v119
v_cvt_pk_bf16_f32 v112, v112, v113
v_mfma_f32_32x32x16_bf16 a[16:31], v[36:39], v[180:183], a[16:31]
ds_read_b64_tr_b16 v[68:69], v13 offset:45056
ds_read_b64_tr_b16 v[70:71], v13 offset:46080
buffer_load_dwordx4 v248, s[92:95], s21 offen offset:1024 lds
v_cvt_pk_bf16_f32 v113, v114, v115
v_cvt_pk_bf16_f32 v114, v116, v117
v_cvt_pk_bf16_f32 v115, v118, v119
v_mfma_f32_32x32x16_bf16 a[32:47], v[40:43], v[180:183], a[32:47]
ds_read_b64_tr_b16 v[72:73], v14 offset:45056
ds_read_b64_tr_b16 v[74:75], v14 offset:46080
v_accvgpr_write_b32 a176, v112
v_accvgpr_write_b32 a177, v113
v_accvgpr_write_b32 a178, v114
v_mfma_f32_32x32x16_bf16 a[48:63], v[44:47], v[180:183], a[48:63]
ds_read_b64_tr_b16 v[76:77], v15 offset:45056
ds_read_b64_tr_b16 v[78:79], v15 offset:46080
v_accvgpr_write_b32 a179, v115
s_add_u32 s40, s28, 12288
buffer_store_dwordx4 v[112:115], v255, s[4:7], s40 offen offset:0
s_waitcnt lgkmcnt(8)
v_mfma_f32_32x32x16_bf16 a[0:15], v[48:51], v[184:187], a[0:15]
s_waitcnt vmcnt(10)
s_barrier
ds_read_b64_tr_b16 v[32:33], v16 offset:0
ds_read_b64_tr_b16 v[34:35], v16 offset:1024
v_accvgpr_read_b32 v120, a104
v_accvgpr_read_b32 v121, a105
v_accvgpr_read_b32 v122, a106
v_mfma_f32_32x32x16_bf16 a[16:31], v[52:55], v[184:187], a[16:31]
ds_read_b64_tr_b16 v[36:37], v17 offset:0
ds_read_b64_tr_b16 v[38:39], v17 offset:1024
buffer_load_dwordx4 v248, s[92:95], s22 offen offset:2048 lds
v_accvgpr_read_b32 v123, a107
v_accvgpr_read_b32 v124, a108
v_mfma_f32_32x32x16_bf16 a[32:47], v[56:59], v[184:187], a[32:47]
ds_read_b64_tr_b16 v[40:41], v18 offset:0
ds_read_b64_tr_b16 v[42:43], v18 offset:1024
v_accvgpr_read_b32 v125, a109
v_accvgpr_read_b32 v126, a110
v_accvgpr_read_b32 v127, a111
v_mfma_f32_32x32x16_bf16 a[48:63], v[60:63], v[184:187], a[48:63]
ds_read_b64_tr_b16 v[44:45], v19 offset:0
ds_read_b64_tr_b16 v[46:47], v19 offset:1024
v_mul_f32 v120, s34, v120
v_mul_f32 v121, s34, v121
v_mul_f32 v122, s34, v122
v_mul_f32 v123, s34, v123
s_waitcnt lgkmcnt(8)
v_mfma_f32_32x32x16_bf16 a[0:15], v[64:67], v[188:191], a[0:15]
ds_read_b64_tr_b16 v[48:49], v16 offset:4096
ds_read_b64_tr_b16 v[50:51], v16 offset:5120
v_mul_f32 v124, s34, v124
v_mul_f32 v125, s34, v125
v_mul_f32 v126, s34, v126
v_mfma_f32_32x32x16_bf16 a[16:31], v[68:71], v[188:191], a[16:31]
ds_read_b64_tr_b16 v[52:53], v17 offset:4096
ds_read_b64_tr_b16 v[54:55], v17 offset:5120
buffer_load_dwordx4 v248, s[92:95], s23 offen offset:3072 lds
v_add_u32 v248, 229376, v248
v_mul_f32 v127, s34, v127
v_mfma_f32_32x32x16_bf16 a[32:47], v[72:75], v[188:191], a[32:47]
ds_read_b64_tr_b16 v[56:57], v18 offset:4096
ds_read_b64_tr_b16 v[58:59], v18 offset:5120
v_cvt_pk_bf16_f32 v120, v120, v121
v_cvt_pk_bf16_f32 v121, v122, v123
v_cvt_pk_bf16_f32 v122, v124, v125
v_cvt_pk_bf16_f32 v123, v126, v127
v_mfma_f32_32x32x16_bf16 a[48:63], v[76:79], v[188:191], a[48:63]
ds_read_b64_tr_b16 v[60:61], v19 offset:4096
ds_read_b64_tr_b16 v[62:63], v19 offset:5120
v_accvgpr_write_b32 a180, v120
v_accvgpr_write_b32 a181, v121
v_accvgpr_write_b32 a182, v122
s_waitcnt lgkmcnt(8)
v_mfma_f32_32x32x16_bf16 a[0:15], v[32:35], v[192:195], a[0:15]
ds_read_b64_tr_b16 v[64:65], v16 offset:8192
ds_read_b64_tr_b16 v[66:67], v16 offset:9216
v_accvgpr_write_b32 a183, v123
buffer_store_dwordx4 v[120:123], v255, s[4:7], s40 offen offset:1024
v_accvgpr_read_b32 v112, a112
v_mfma_f32_32x32x16_bf16 a[16:31], v[36:39], v[192:195], a[16:31]
ds_read_b64_tr_b16 v[68:69], v17 offset:8192
ds_read_b64_tr_b16 v[70:71], v17 offset:9216
v_accvgpr_read_b32 v113, a113
v_accvgpr_read_b32 v114, a114
v_accvgpr_read_b32 v115, a115
v_mfma_f32_32x32x16_bf16 a[32:47], v[40:43], v[192:195], a[32:47]
ds_read_b64_tr_b16 v[72:73], v18 offset:8192
ds_read_b64_tr_b16 v[74:75], v18 offset:9216
v_accvgpr_read_b32 v116, a116
v_accvgpr_read_b32 v117, a117
v_accvgpr_read_b32 v118, a118
v_accvgpr_read_b32 v119, a119
v_mfma_f32_32x32x16_bf16 a[48:63], v[44:47], v[192:195], a[48:63]
ds_read_b64_tr_b16 v[76:77], v19 offset:8192
ds_read_b64_tr_b16 v[78:79], v19 offset:9216
v_mul_f32 v112, s34, v112
v_mul_f32 v113, s34, v113
v_mul_f32 v114, s34, v114
s_waitcnt lgkmcnt(8)
v_mfma_f32_32x32x16_bf16 a[0:15], v[48:51], v[196:199], a[0:15]
ds_read_b64_tr_b16 v[32:33], v16 offset:12288
ds_read_b64_tr_b16 v[34:35], v16 offset:13312
v_mul_f32 v115, s34, v115
v_mul_f32 v116, s34, v116
v_mul_f32 v117, s34, v117
v_mfma_f32_32x32x16_bf16 a[16:31], v[52:55], v[196:199], a[16:31]
ds_read_b64_tr_b16 v[36:37], v17 offset:12288
ds_read_b64_tr_b16 v[38:39], v17 offset:13312
v_mul_f32 v118, s34, v118
v_mul_f32 v119, s34, v119
v_cvt_pk_bf16_f32 v112, v112, v113
v_cvt_pk_bf16_f32 v113, v114, v115
v_mfma_f32_32x32x16_bf16 a[32:47], v[56:59], v[196:199], a[32:47]
ds_read_b64_tr_b16 v[40:41], v18 offset:12288
ds_read_b64_tr_b16 v[42:43], v18 offset:13312
v_cvt_pk_bf16_f32 v114, v116, v117
v_cvt_pk_bf16_f32 v115, v118, v119
v_accvgpr_write_b32 a184, v112
v_mfma_f32_32x32x16_bf16 a[48:63], v[60:63], v[196:199], a[48:63]
ds_read_b64_tr_b16 v[44:45], v19 offset:12288
ds_read_b64_tr_b16 v[46:47], v19 offset:13312
v_accvgpr_write_b32 a185, v113
v_accvgpr_write_b32 a186, v114
v_accvgpr_write_b32 a187, v115
s_waitcnt lgkmcnt(8)
v_mfma_f32_32x32x16_bf16 a[0:15], v[64:67], v[200:203], a[0:15]
s_waitcnt vmcnt(7)
s_barrier
ds_read_b64_tr_b16 v[48:49], v12 offset:49152
ds_read_b64_tr_b16 v[50:51], v12 offset:50176
buffer_store_dwordx4 v[112:115], v255, s[4:7], s40 offen offset:2048
v_accvgpr_read_b32 v120, a120
v_accvgpr_read_b32 v121, a121
v_mfma_f32_32x32x16_bf16 a[16:31], v[68:71], v[200:203], a[16:31]
ds_read_b64_tr_b16 v[52:53], v13 offset:49152
ds_read_b64_tr_b16 v[54:55], v13 offset:50176
v_accvgpr_read_b32 v122, a122
v_accvgpr_read_b32 v123, a123
v_accvgpr_read_b32 v124, a124
v_mfma_f32_32x32x16_bf16 a[32:47], v[72:75], v[200:203], a[32:47]
ds_read_b64_tr_b16 v[56:57], v14 offset:49152
ds_read_b64_tr_b16 v[58:59], v14 offset:50176
v_accvgpr_read_b32 v125, a125
v_accvgpr_read_b32 v126, a126
v_accvgpr_read_b32 v127, a127
v_mfma_f32_32x32x16_bf16 a[48:63], v[76:79], v[200:203], a[48:63]
ds_read_b64_tr_b16 v[60:61], v15 offset:49152
ds_read_b64_tr_b16 v[62:63], v15 offset:50176
v_mul_f32 v120, s34, v120
v_mul_f32 v121, s34, v121
v_mul_f32 v122, s34, v122
v_mul_f32 v123, s34, v123
s_waitcnt lgkmcnt(8)
v_mfma_f32_32x32x16_bf16 a[0:15], v[32:35], v[204:207], a[0:15]
ds_read_b64_tr_b16 v[64:65], v12 offset:53248
ds_read_b64_tr_b16 v[66:67], v12 offset:54272
v_mul_f32 v124, s34, v124
v_mul_f32 v125, s34, v125
v_mul_f32 v126, s34, v126
v_mfma_f32_32x32x16_bf16 a[16:31], v[36:39], v[204:207], a[16:31]
ds_read_b64_tr_b16 v[68:69], v13 offset:53248
ds_read_b64_tr_b16 v[70:71], v13 offset:54272
v_mul_f32 v127, s34, v127
v_cvt_pk_bf16_f32 v120, v120, v121
v_cvt_pk_bf16_f32 v121, v122, v123
v_mfma_f32_32x32x16_bf16 a[32:47], v[40:43], v[204:207], a[32:47]
ds_read_b64_tr_b16 v[72:73], v14 offset:53248
ds_read_b64_tr_b16 v[74:75], v14 offset:54272
v_cvt_pk_bf16_f32 v122, v124, v125
v_cvt_pk_bf16_f32 v123, v126, v127
v_accvgpr_write_b32 a188, v120
v_accvgpr_write_b32 a189, v121
v_mfma_f32_32x32x16_bf16 a[48:63], v[44:47], v[204:207], a[48:63]
ds_read_b64_tr_b16 v[76:77], v15 offset:53248
ds_read_b64_tr_b16 v[78:79], v15 offset:54272
v_accvgpr_write_b32 a190, v122
v_accvgpr_write_b32 a191, v123
buffer_store_dwordx4 v[120:123], v255, s[4:7], s40 offen offset:3072
s_waitcnt lgkmcnt(8)
v_mfma_f32_32x32x16_bf16 a[0:15], v[48:51], v[208:211], a[0:15]
ds_read_b64_tr_b16 v[32:33], v12 offset:57344
ds_read_b64_tr_b16 v[34:35], v12 offset:58368
s_getpc_b64 s[82:83]
k1_pc1:
v_mfma_f32_32x32x16_bf16 a[16:31], v[52:55], v[208:211], a[16:31]
ds_read_b64_tr_b16 v[36:37], v13 offset:57344
ds_read_b64_tr_b16 v[38:39], v13 offset:58368
s_lshl_b32 s41, s56, 13
v_lshlrev_b32 v96, 7, v6
v_mfma_f32_32x32x16_bf16 a[32:47], v[56:59], v[208:211], a[32:47]
ds_read_b64_tr_b16 v[40:41], v14 offset:57344
ds_read_b64_tr_b16 v[42:43], v14 offset:58368
v_add_u32 v96, s41, v96
v_mfma_f32_32x32x16_bf16 a[48:63], v[60:63], v[208:211], a[48:63]
ds_read_b64_tr_b16 v[44:45], v15 offset:57344
ds_read_b64_tr_b16 v[46:47], v15 offset:58368
s_waitcnt lgkmcnt(8)
v_min_u32 v97, mix_end-k1_pc1, v96
v_mov_b32 v99, s83
v_mfma_f32_32x32x16_bf16 a[0:15], v[64:67], v[212:215], a[0:15]
ds_read_b64_tr_b16 v[48:49], v12 offset:61440
ds_read_b64_tr_b16 v[50:51], v12 offset:62464
v_add_co_u32 v98, vcc, s82, v97
v_addc_co_u32 v99, vcc, 0, v99, vcc
v_mfma_f32_32x32x16_bf16 a[16:31], v[68:71], v[212:215], a[16:31]
ds_read_b64_tr_b16 v[52:53], v13 offset:61440
ds_read_b64_tr_b16 v[54:55], v13 offset:62464
global_load_dword v100, v[98:99], off
v_add_u32 v96, 0x8000, v96
v_mfma_f32_32x32x16_bf16 a[32:47], v[72:75], v[212:215], a[32:47]
ds_read_b64_tr_b16 v[56:57], v14 offset:61440
ds_read_b64_tr_b16 v[58:59], v14 offset:62464
v_min_u32 v97, mix_end-k1_pc1, v96
v_mfma_f32_32x32x16_bf16 a[48:63], v[76:79], v[212:215], a[48:63]
ds_read_b64_tr_b16 v[60:61], v15 offset:61440
ds_read_b64_tr_b16 v[62:63], v15 offset:62464
s_waitcnt lgkmcnt(8)
v_mov_b32 v99, s83
v_add_co_u32 v98, vcc, s82, v97
v_mfma_f32_32x32x16_bf16 a[0:15], v[32:35], v[216:219], a[0:15]
s_waitcnt vmcnt(4)
s_barrier
ds_read_b64_tr_b16 v[64:65], v250 offset:0
ds_read_b64_tr_b16 v[66:67], v250 offset:1024
s_lshl_b32 s84, s78, 7
v_mfma_f32_32x32x16_bf16 a[16:31], v[36:39], v[216:219], a[16:31]
ds_read_b64_tr_b16 v[68:69], v251 offset:0
ds_read_b64_tr_b16 v[70:71], v251 offset:1024
s_add_u32 s84, s84, 26214400
v_addc_co_u32 v99, vcc, 0, v99, vcc
v_mfma_f32_32x32x16_bf16 a[32:47], v[40:43], v[216:219], a[32:47]
ds_read_b64_tr_b16 v[72:73], v252 offset:0
ds_read_b64_tr_b16 v[74:75], v252 offset:1024
s_sub_u32 s85, 15, s79
s_lshl_b32 s85, s85, 2
v_mfma_f32_32x32x16_bf16 a[48:63], v[44:47], v[216:219], a[48:63]
ds_read_b64_tr_b16 v[76:77], v253 offset:0
ds_read_b64_tr_b16 v[78:79], v253 offset:1024
s_add_u32 s85, s85, 64
s_waitcnt lgkmcnt(8)
global_load_dword v100, v[98:99], off
v_mfma_f32_32x32x16_bf16 a[0:15], v[48:51], v[220:223], a[0:15]
ds_read_b64_tr_b16 v[32:33], v250 offset:4096
ds_read_b64_tr_b16 v[34:35], v250 offset:5120
v_lshlrev_b32 v30, 2, v6
v_mov_b32 v29, s85
v_mfma_f32_32x32x16_bf16 a[16:31], v[52:55], v[220:223], a[16:31]
ds_read_b64_tr_b16 v[36:37], v251 offset:4096
ds_read_b64_tr_b16 v[38:39], v251 offset:5120
v_cmp_eq_u32 vcc, 16, v6
v_mfma_f32_32x32x16_bf16 a[32:47], v[56:59], v[220:223], a[32:47]
ds_read_b64_tr_b16 v[40:41], v252 offset:4096
ds_read_b64_tr_b16 v[42:43], v252 offset:5120
v_cndmask_b32 v30, v30, v29, vcc
v_and_b32 v30, 0x7f, v30
v_mfma_f32_32x32x16_bf16 a[48:63], v[60:63], v[220:223], a[48:63]
ds_read_b64_tr_b16 v[44:45], v253 offset:4096
ds_read_b64_tr_b16 v[46:47], v253 offset:5120
buffer_load_dword v29, v30, s[4:7], s84 offen sc1
s_waitcnt lgkmcnt(8)
v_add_u32 v96, 0x8000, v96
v_mfma_f32_32x32x16_bf16 a[0:15], v[64:67], v[224:227], a[0:15]
ds_read_b64_tr_b16 v[48:49], v250 offset:8192
ds_read_b64_tr_b16 v[50:51], v250 offset:9216
v_mfma_f32_32x32x16_bf16 a[16:31], v[68:71], v[224:227], a[16:31]
ds_read_b64_tr_b16 v[52:53], v251 offset:8192
ds_read_b64_tr_b16 v[54:55], v251 offset:9216
v_mfma_f32_32x32x16_bf16 a[32:47], v[72:75], v[224:227], a[32:47]
ds_read_b64_tr_b16 v[56:57], v252 offset:8192
ds_read_b64_tr_b16 v[58:59], v252 offset:9216
v_mfma_f32_32x32x16_bf16 a[48:63], v[76:79], v[224:227], a[48:63]
ds_read_b64_tr_b16 v[60:61], v253 offset:8192
ds_read_b64_tr_b16 v[62:63], v253 offset:9216
s_waitcnt lgkmcnt(8)
v_mfma_f32_32x32x16_bf16 a[0:15], v[32:35], v[228:231], a[0:15]
ds_read_b64_tr_b16 v[64:65], v250 offset:12288
ds_read_b64_tr_b16 v[66:67], v250 offset:13312
v_mfma_f32_32x32x16_bf16 a[16:31], v[36:39], v[228:231], a[16:31]
ds_read_b64_tr_b16 v[68:69], v251 offset:12288
ds_read_b64_tr_b16 v[70:71], v251 offset:13312
v_mfma_f32_32x32x16_bf16 a[32:47], v[40:43], v[228:231], a[32:47]
ds_read_b64_tr_b16 v[72:73], v252 offset:12288
ds_read_b64_tr_b16 v[74:75], v252 offset:13312
v_mfma_f32_32x32x16_bf16 a[48:63], v[44:47], v[228:231], a[48:63]
ds_read_b64_tr_b16 v[76:77], v253 offset:12288
ds_read_b64_tr_b16 v[78:79], v253 offset:13312
s_waitcnt lgkmcnt(8)
v_mfma_f32_32x32x16_bf16 a[0:15], v[48:51], v[232:235], a[0:15]
v_mfma_f32_32x32x16_bf16 a[16:31], v[52:55], v[232:235], a[16:31]
v_mfma_f32_32x32x16_bf16 a[32:47], v[56:59], v[232:235], a[32:47]
v_mfma_f32_32x32x16_bf16 a[48:63], v[60:63], v[232:235], a[48:63]
s_waitcnt lgkmcnt(0)
v_mfma_f32_32x32x16_bf16 a[0:15], v[64:67], v[236:239], a[0:15]
v_mfma_f32_32x32x16_bf16 a[16:31], v[68:71], v[236:239], a[16:31]
v_mfma_f32_32x32x16_bf16 a[32:47], v[72:75], v[236:239], a[32:47]
v_mfma_f32_32x32x16_bf16 a[48:63], v[76:79], v[236:239], a[48:63]
s_waitcnt vmcnt(0) lgkmcnt(0)
s_barrier
s_cmp_eq_u32 s56, 0
s_cbranch_scc0 k1_kvok
s_cmp_eq_u32 s97, 1
s_cbranch_scc1 k1_nowb
buffer_wbl2 sc1
s_waitcnt vmcnt(0)
s_lshl_b32 s33, s78, 7
s_add_u32 s33, s33, 26214400
s_lshl_b32 s59, s79, 2
s_add_u32 s59, s59, s33
v_mov_b32 v12, s101
v_mov_b32 v13, 0
s_mov_b64 exec, 1
buffer_store_dword v12, v13, s[4:7], s59 offen sc1
s_mov_b64 exec, -1
k1_nowb:
s_lshl_b32 s33, s78, 7
s_add_u32 s33, s33, 26214464
s_lshl_b32 s59, s79, 2
s_add_u32 s59, s59, s33
v_mov_b32 v12, s101
v_mov_b32 v13, 0
s_mov_b64 exec, 1
buffer_store_dword v12, v13, s[4:7], s59 offen sc1
s_mov_b64 exec, -1
k1_kvok:
s_branch k1_skipool
k1_kvpub:
s_cmp_eq_u32 s97, 1
s_cbranch_scc0 k1_kvpubret
s_lshl_b32 s86, s78, 7
s_add_u32 s86, s86, 26214400
s_lshl_b32 s87, s79, 2
s_add_u32 s87, s87, s86
v_mov_b32 v28, s101
v_mov_b32 v27, 0
s_mov_b64 exec, 1
buffer_store_dword v28, v27, s[4:7], s87 offen sc1
s_mov_b64 exec, -1
s_branch k1_kvpubret
k1_skipool:
s_load_dwordx2 s[88:89], s[0:1], 80
s_mov_b32 s90, 1835008
s_mov_b32 s91, 0x20000
s_load_dwordx2 s[42:43], s[0:1], 96
s_load_dwordx2 s[44:45], s[0:1], 40
s_load_dwordx2 s[46:47], s[0:1], 64
s_and_b32 s50, s2, 7
s_lshr_b32 s51, s2, 3
s_lshr_b32 s16, s51, 4
s_lshl_b32 s52, s50, 1
s_add_u32 s16, s16, s52
s_and_b32 s17, s51, 15
v_lshrrev_b32 v12, 6, v0
v_and_b32 v1, 63, v0
s_nop 0
v_readfirstlane_b32 s18, v12
v_lshlrev_b32 v2, 4, v1
v_and_b32 v12, 31, v1
v_lshrrev_b32 v13, 5, v1
v_lshlrev_b32 v13, 2, v13
v_sub_u32 v5, v12, v13
v_mov_b32 v8, 0xff800000
s_mov_b32 s34, 0x3f803f80
s_mov_b32 s35, 0x4e800000
s_mov_b32 s96, s17
s_cmp_lt_u32 s17, 7
s_cselect_b32 s19, 1, 0
s_sub_u32 s53, 15, s17
s_cmp_lt_u32 s17, 7
s_cselect_b32 s53, s53, s17
s_sub_u32 s54, s53, 8
s_lshl_b32 s55, s16, 3
s_add_u32 s41, s55, s54
s_lshl_b32 s55, s53, 2
s_add_u32 s32, s55, s18
s_sub_u32 s56, s55, 34
s_add_u32 s57, s55, 4
s_min_u32 s58, s57, 38
s_cmp_gt_u32 s57, 38
s_cselect_b32 s100, 1, 0
s_cmp_eq_u32 s19, 1
s_cselect_b32 s38, s56, s58
s_cselect_b32 s31, 38, 0
s_cselect_b32 s100, 0, s100
s_lshl_b32 s56, s16, 20
s_lshl_b32 s57, s18, 12
s_add_u32 s23, s56, s57
s_add_u32 s25, s23, 16777216
s_lshl_b32 s56, s31, 14
s_add_u32 s20, s23, s56
s_add_u32 s21, s25, s56
s_add_u32 s56, s55, 4
s_lshl_b32 s56, s56, 14
s_add_u32 s22, s23, s56
s_add_u32 s24, s25, s56
s_cmp_eq_u32 s19, 1
s_cselect_b32 s22, s22, -1
s_cselect_b32 s24, s24, -1
s_mov_b32 s26, s57
s_add_u32 s27, s57, 65536
s_mov_b32 s28, 0
s_mov_b32 s29, 65536
v_mov_b32 v3, v2
v_add_u32 v4, 65536, v2
s_mov_b32 s36, 0
s_mov_b32 s37, 0
s_waitcnt lgkmcnt(0)
s_mov_b32 s4, s42
s_mov_b32 s5, s43
s_mov_b32 s6, 0x10000000
s_mov_b32 s7, 0x20000
s_lshl_b32 s58, s17, 2
s_add_u32 s58, s58, s18
s_lshl_b32 s59, s53, 2
s_add_u32 s59, s59, s18
s_lshl_b32 s56, s16, 7
s_add_u32 s56, s56, 59768832
s_mov_b32 s57, 0
v_cmp_ne_u32 vcc, s101, v29
s_nop 3
s_and_b32 s58, vcc_lo, 0xffff
s_cbranch_scc0 k2_kvok
k2_kvpoll:
buffer_load_dword v29, v30, s[4:7], s56 offen sc1
s_add_u32 s57, s57, 1
s_cmp_ge_u32 s57, 131072
s_waitcnt vmcnt(0)
s_cbranch_scc1 k2_kvok
v_cmp_ne_u32 vcc, s101, v29
s_nop 3
s_and_b32 s58, vcc_lo, 0xffff
s_cbranch_scc1 k2_kvpoll
k2_kvok:
s_mov_b32 m0, s26
s_nop 0
buffer_load_dwordx4 v2, s[4:7], s20 offen offset:0 lds
buffer_load_dwordx4 v2, s[4:7], s20 offen offset:1024 lds
buffer_load_dwordx4 v2, s[4:7], s20 offen offset:2048 lds
buffer_load_dwordx4 v2, s[4:7], s20 offen offset:3072 lds
s_add_u32 s20, s20, 16384
s_cmp_eq_u32 s20, s22
s_cselect_b32 s20, s23, s20
s_add_u32 s26, s26, 16384
s_and_b32 s26, s26, 0xffff
s_mov_b32 m0, s26
s_nop 0
buffer_load_dwordx4 v2, s[4:7], s20 offen offset:0 lds
buffer_load_dwordx4 v2, s[4:7], s20 offen offset:1024 lds
buffer_load_dwordx4 v2, s[4:7], s20 offen offset:2048 lds
buffer_load_dwordx4 v2, s[4:7], s20 offen offset:3072 lds
s_add_u32 s20, s20, 16384
s_cmp_eq_u32 s20, s22
s_cselect_b32 s20, s23, s20
s_add_u32 s26, s26, 16384
s_and_b32 s26, s26, 0xffff
s_mov_b32 m0, s26
s_nop 0
buffer_load_dwordx4 v2, s[4:7], s20 offen offset:0 lds
buffer_load_dwordx4 v2, s[4:7], s20 offen offset:1024 lds
buffer_load_dwordx4 v2, s[4:7], s20 offen offset:2048 lds
buffer_load_dwordx4 v2, s[4:7], s20 offen offset:3072 lds
s_add_u32 s20, s20, 16384
s_cmp_eq_u32 s20, s22
s_cselect_b32 s20, s23, s20
s_add_u32 s26, s26, 16384
s_and_b32 s26, s26, 0xffff
s_mov_b32 m0, s27
s_nop 0
buffer_load_dwordx4 v2, s[4:7], s21 offen offset:0 lds
buffer_load_dwordx4 v2, s[4:7], s21 offen offset:1024 lds
buffer_load_dwordx4 v2, s[4:7], s21 offen offset:2048 lds
buffer_load_dwordx4 v2, s[4:7], s21 offen offset:3072 lds
s_add_u32 s21, s21, 16384
s_cmp_eq_u32 s21, s24
s_cselect_b32 s21, s25, s21
s_add_u32 s27, s27, 16384
s_cmp_ge_u32 s27, 147456
s_cselect_b32 s39, 81920, 0
s_sub_u32 s27, s27, s39
s_mov_b32 m0, s26
s_nop 0
buffer_load_dwordx4 v2, s[4:7], s20 offen offset:0 lds
buffer_load_dwordx4 v2, s[4:7], s20 offen offset:1024 lds
buffer_load_dwordx4 v2, s[4:7], s20 offen offset:2048 lds
buffer_load_dwordx4 v2, s[4:7], s20 offen offset:3072 lds
s_add_u32 s20, s20, 16384
s_cmp_eq_u32 s20, s22
s_cselect_b32 s20, s23, s20
s_add_u32 s26, s26, 16384
s_and_b32 s26, s26, 0xffff
s_mov_b32 m0, s27
s_nop 0
buffer_load_dwordx4 v2, s[4:7], s21 offen offset:0 lds
buffer_load_dwordx4 v2, s[4:7], s21 offen offset:1024 lds
buffer_load_dwordx4 v2, s[4:7], s21 offen offset:2048 lds
buffer_load_dwordx4 v2, s[4:7], s21 offen offset:3072 lds
s_add_u32 s21, s21, 16384
s_cmp_eq_u32 s21, s24
s_cselect_b32 s21, s25, s21
s_add_u32 s27, s27, 16384
s_cmp_ge_u32 s27, 147456
s_cselect_b32 s39, 81920, 0
s_sub_u32 s27, s27, s39
s_mov_b32 m0, s27
s_nop 0
buffer_load_dwordx4 v2, s[4:7], s21 offen offset:0 lds
buffer_load_dwordx4 v2, s[4:7], s21 offen offset:1024 lds
buffer_load_dwordx4 v2, s[4:7], s21 offen offset:2048 lds
buffer_load_dwordx4 v2, s[4:7], s21 offen offset:3072 lds
s_add_u32 s21, s21, 16384
s_cmp_eq_u32 s21, s24
s_cselect_b32 s21, s25, s21
s_add_u32 s27, s27, 16384
s_cmp_ge_u32 s27, 147456
s_cselect_b32 s39, 81920, 0
s_sub_u32 s27, s27, s39
s_cmp_eq_u32 s19, 1
s_cbranch_scc0 k2_nq0
buffer_load_dword v29, v30, s[4:7], s56 offen sc1
k2_nq0:
v_accvgpr_read_b32 v96, a0
v_accvgpr_read_b32 v97, a1
v_accvgpr_read_b32 v98, a2
v_accvgpr_read_b32 v99, a3
v_accvgpr_read_b32 v100, a4
v_accvgpr_read_b32 v101, a5
v_accvgpr_read_b32 v102, a6
v_accvgpr_read_b32 v103, a7
v_max_f32 v96, 0, v96
v_max_f32 v97, 0, v97
v_max_f32 v98, 0, v98
v_max_f32 v99, 0, v99
v_max_f32 v100, 0, v100
v_max_f32 v101, 0, v101
v_max_f32 v102, 0, v102
v_max_f32 v103, 0, v103
v_mul_f32 v96, v93, v96
v_mul_f32 v97, v93, v97
v_mul_f32 v98, v93, v98
v_mul_f32 v99, v93, v99
v_mul_f32 v100, v93, v100
v_mul_f32 v101, v93, v101
v_mul_f32 v102, v93, v102
v_mul_f32 v103, v93, v103
v_cvt_pk_bf16_f32 v160, v96, v97
v_cvt_pk_bf16_f32 v161, v98, v99
v_cvt_pk_bf16_f32 v162, v100, v101
v_cvt_pk_bf16_f32 v163, v102, v103
v_accvgpr_read_b32 v104, a8
v_accvgpr_read_b32 v105, a9
v_accvgpr_read_b32 v106, a10
v_accvgpr_read_b32 v107, a11
v_accvgpr_read_b32 v108, a12
v_accvgpr_read_b32 v109, a13
v_accvgpr_read_b32 v110, a14
v_accvgpr_read_b32 v111, a15
v_max_f32 v104, 0, v104
v_max_f32 v105, 0, v105
v_max_f32 v106, 0, v106
v_max_f32 v107, 0, v107
v_max_f32 v108, 0, v108
v_max_f32 v109, 0, v109
v_max_f32 v110, 0, v110
v_max_f32 v111, 0, v111
v_mul_f32 v104, v93, v104
v_mul_f32 v105, v93, v105
v_mul_f32 v106, v93, v106
v_mul_f32 v107, v93, v107
v_mul_f32 v108, v93, v108
v_mul_f32 v109, v93, v109
v_mul_f32 v110, v93, v110
v_mul_f32 v111, v93, v111
v_cvt_pk_bf16_f32 v164, v104, v105
v_cvt_pk_bf16_f32 v165, v106, v107
v_cvt_pk_bf16_f32 v166, v108, v109
v_cvt_pk_bf16_f32 v167, v110, v111
v_accvgpr_read_b32 v112, a16
v_accvgpr_read_b32 v113, a17
v_accvgpr_read_b32 v114, a18
v_accvgpr_read_b32 v115, a19
v_accvgpr_read_b32 v116, a20
v_accvgpr_read_b32 v117, a21
v_accvgpr_read_b32 v118, a22
v_accvgpr_read_b32 v119, a23
v_max_f32 v112, 0, v112
v_max_f32 v113, 0, v113
v_max_f32 v114, 0, v114
v_max_f32 v115, 0, v115
v_max_f32 v116, 0, v116
v_max_f32 v117, 0, v117
v_max_f32 v118, 0, v118
v_max_f32 v119, 0, v119
v_mul_f32 v112, v93, v112
v_mul_f32 v113, v93, v113
v_mul_f32 v114, v93, v114
v_mul_f32 v115, v93, v115
v_mul_f32 v116, v93, v116
v_mul_f32 v117, v93, v117
v_mul_f32 v118, v93, v118
v_mul_f32 v119, v93, v119
v_cvt_pk_bf16_f32 v168, v112, v113
v_cvt_pk_bf16_f32 v169, v114, v115
v_cvt_pk_bf16_f32 v170, v116, v117
v_cvt_pk_bf16_f32 v171, v118, v119
v_accvgpr_read_b32 v120, a24
v_accvgpr_read_b32 v121, a25
v_accvgpr_read_b32 v122, a26
v_accvgpr_read_b32 v123, a27
v_accvgpr_read_b32 v124, a28
v_accvgpr_read_b32 v125, a29
v_accvgpr_read_b32 v126, a30
v_accvgpr_read_b32 v127, a31
v_max_f32 v120, 0, v120
v_max_f32 v121, 0, v121
v_max_f32 v122, 0, v122
v_max_f32 v123, 0, v123
v_max_f32 v124, 0, v124
v_max_f32 v125, 0, v125
v_max_f32 v126, 0, v126
v_max_f32 v127, 0, v127
v_mul_f32 v120, v93, v120
v_mul_f32 v121, v93, v121
v_mul_f32 v122, v93, v122
v_mul_f32 v123, v93, v123
v_mul_f32 v124, v93, v124
v_mul_f32 v125, v93, v125
v_mul_f32 v126, v93, v126
v_mul_f32 v127, v93, v127
v_cvt_pk_bf16_f32 v172, v120, v121
v_cvt_pk_bf16_f32 v173, v122, v123
v_cvt_pk_bf16_f32 v174, v124, v125
v_cvt_pk_bf16_f32 v175, v126, v127
v_accvgpr_read_b32 v96, a32
v_accvgpr_read_b32 v97, a33
v_accvgpr_read_b32 v98, a34
v_accvgpr_read_b32 v99, a35
v_accvgpr_read_b32 v100, a36
v_accvgpr_read_b32 v101, a37
v_accvgpr_read_b32 v102, a38
v_accvgpr_read_b32 v103, a39
v_max_f32 v96, 0, v96
v_max_f32 v97, 0, v97
v_max_f32 v98, 0, v98
v_max_f32 v99, 0, v99
v_max_f32 v100, 0, v100
v_max_f32 v101, 0, v101
v_max_f32 v102, 0, v102
v_max_f32 v103, 0, v103
v_mul_f32 v96, v93, v96
v_mul_f32 v97, v93, v97
v_mul_f32 v98, v93, v98
v_mul_f32 v99, v93, v99
v_mul_f32 v100, v93, v100
v_mul_f32 v101, v93, v101
v_mul_f32 v102, v93, v102
v_mul_f32 v103, v93, v103
v_cvt_pk_bf16_f32 v176, v96, v97
v_cvt_pk_bf16_f32 v177, v98, v99
v_cvt_pk_bf16_f32 v178, v100, v101
v_cvt_pk_bf16_f32 v179, v102, v103
v_accvgpr_read_b32 v104, a40
v_accvgpr_read_b32 v105, a41
v_accvgpr_read_b32 v106, a42
v_accvgpr_read_b32 v107, a43
v_accvgpr_read_b32 v108, a44
v_accvgpr_read_b32 v109, a45
v_accvgpr_read_b32 v110, a46
v_accvgpr_read_b32 v111, a47
v_max_f32 v104, 0, v104
v_max_f32 v105, 0, v105
v_max_f32 v106, 0, v106
v_max_f32 v107, 0, v107
v_max_f32 v108, 0, v108
v_max_f32 v109, 0, v109
v_max_f32 v110, 0, v110
v_max_f32 v111, 0, v111
v_mul_f32 v104, v93, v104
v_mul_f32 v105, v93, v105
v_mul_f32 v106, v93, v106
v_mul_f32 v107, v93, v107
v_mul_f32 v108, v93, v108
v_mul_f32 v109, v93, v109
v_mul_f32 v110, v93, v110
v_mul_f32 v111, v93, v111
v_cvt_pk_bf16_f32 v180, v104, v105
v_cvt_pk_bf16_f32 v181, v106, v107
v_cvt_pk_bf16_f32 v182, v108, v109
v_cvt_pk_bf16_f32 v183, v110, v111
v_accvgpr_read_b32 v112, a48
v_accvgpr_read_b32 v113, a49
v_accvgpr_read_b32 v114, a50
v_accvgpr_read_b32 v115, a51
v_accvgpr_read_b32 v116, a52
v_accvgpr_read_b32 v117, a53
v_accvgpr_read_b32 v118, a54
v_accvgpr_read_b32 v119, a55
v_max_f32 v112, 0, v112
v_max_f32 v113, 0, v113
v_max_f32 v114, 0, v114
v_max_f32 v115, 0, v115
v_max_f32 v116, 0, v116
v_max_f32 v117, 0, v117
v_max_f32 v118, 0, v118
v_max_f32 v119, 0, v119
v_mul_f32 v112, v93, v112
v_mul_f32 v113, v93, v113
v_mul_f32 v114, v93, v114
v_mul_f32 v115, v93, v115
v_mul_f32 v116, v93, v116
v_mul_f32 v117, v93, v117
v_mul_f32 v118, v93, v118
v_mul_f32 v119, v93, v119
v_cvt_pk_bf16_f32 v184, v112, v113
v_cvt_pk_bf16_f32 v185, v114, v115
v_cvt_pk_bf16_f32 v186, v116, v117
v_cvt_pk_bf16_f32 v187, v118, v119
v_accvgpr_read_b32 v120, a56
v_accvgpr_read_b32 v121, a57
v_accvgpr_read_b32 v122, a58
v_accvgpr_read_b32 v123, a59
v_accvgpr_read_b32 v124, a60
v_accvgpr_read_b32 v125, a61
v_accvgpr_read_b32 v126, a62
v_accvgpr_read_b32 v127, a63
v_max_f32 v120, 0, v120
v_max_f32 v121, 0, v121
v_max_f32 v122, 0, v122
v_max_f32 v123, 0, v123
v_max_f32 v124, 0, v124
v_max_f32 v125, 0, v125
v_max_f32 v126, 0, v126
v_max_f32 v127, 0, v127
v_mul_f32 v120, v93, v120
v_mul_f32 v121, v93, v121
v_mul_f32 v122, v93, v122
v_mul_f32 v123, v93, v123
v_mul_f32 v124, v93, v124
v_mul_f32 v125, v93, v125
v_mul_f32 v126, v93, v126
v_mul_f32 v127, v93, v127
v_cvt_pk_bf16_f32 v188, v120, v121
v_cvt_pk_bf16_f32 v189, v122, v123
v_cvt_pk_bf16_f32 v190, v124, v125
v_cvt_pk_bf16_f32 v191, v126, v127
v_mov_b32 v11, v92
s_and_b32 s33, s16, 1
s_cmp_eq_u32 s33, 0
s_cbranch_scc1 k2_heven
v_mov_b32 v160, v164
v_mov_b32 v161, v165
v_mov_b32 v162, v166
v_mov_b32 v163, v167
v_mov_b32 v164, v168
v_mov_b32 v165, v169
v_mov_b32 v166, v170
v_mov_b32 v167, v171
v_mov_b32 v168, v172
v_mov_b32 v169, v173
v_mov_b32 v170, v174
v_mov_b32 v171, v175
v_mov_b32 v172, v176
v_mov_b32 v173, v177
v_mov_b32 v174, v178
v_mov_b32 v175, v179
v_mov_b32 v176, v180
v_mov_b32 v177, v181
v_mov_b32 v178, v182
v_mov_b32 v179, v183
v_mov_b32 v180, v184
v_mov_b32 v181, v185
v_mov_b32 v182, v186
v_mov_b32 v183, v187
v_mov_b32 v184, v188
v_mov_b32 v185, v189
v_mov_b32 v186, v190
v_mov_b32 v187, v191
k2_heven:
s_mul_i32 s56, s16, 229376
s_add_u32 s8, s44, s56
s_addc_u32 s9, s45, 0
s_sub_u32 s10, 3670016, s56
s_mov_b32 s11, 0x20000
s_mul_i32 s56, s16, 100352
s_add_u32 s12, s46, s56
s_addc_u32 s13, s47, 0
s_sub_u32 s14, 1605632, s56
s_mov_b32 s15, 0x20000
s_add_u32 s76, s12, 57344
s_addc_u32 s77, s13, 0
s_sub_u32 s78, s14, 57344
s_mov_b32 s79, 0x20000
s_mul_i32 s48, s18, 7168
s_mul_i32 s57, s18, 448
v_add_u32 v12, s57, v1
v_mul_u32_u24 v13, 2341, v12
v_lshrrev_b32 v13, 16, v13
v_mul_u32_u24 v14, 28, v13
v_sub_u32 v14, v12, v14
v_mul_u32_u24 v13, 896, v13
v_lshl_add_u32 v188, v14, 4, v13
v_add_u32 v12, s57, v1
v_add_u32 v12, 64, v12
v_mul_u32_u24 v13, 2341, v12
v_lshrrev_b32 v13, 16, v13
v_mul_u32_u24 v14, 28, v13
v_sub_u32 v14, v12, v14
v_mul_u32_u24 v13, 896, v13
v_lshl_add_u32 v189, v14, 4, v13
v_add_u32 v12, s57, v1
v_add_u32 v12, 128, v12
v_mul_u32_u24 v13, 2341, v12
v_lshrrev_b32 v13, 16, v13
v_mul_u32_u24 v14, 28, v13
v_sub_u32 v14, v12, v14
v_mul_u32_u24 v13, 896, v13
v_lshl_add_u32 v190, v14, 4, v13
v_add_u32 v12, s57, v1
v_add_u32 v12, 192, v12
v_mul_u32_u24 v13, 2341, v12
v_lshrrev_b32 v13, 16, v13
v_mul_u32_u24 v14, 28, v13
v_sub_u32 v14, v12, v14
v_mul_u32_u24 v13, 896, v13
v_lshl_add_u32 v191, v14, 4, v13
v_add_u32 v12, s57, v1
v_add_u32 v12, 256, v12
v_mul_u32_u24 v13, 2341, v12
v_lshrrev_b32 v13, 16, v13
v_mul_u32_u24 v14, 28, v13
v_sub_u32 v14, v12, v14
v_mul_u32_u24 v13, 896, v13
v_lshl_add_u32 v192, v14, 4, v13
v_add_u32 v12, s57, v1
v_add_u32 v12, 320, v12
v_mul_u32_u24 v13, 2341, v12
v_lshrrev_b32 v13, 16, v13
v_mul_u32_u24 v14, 28, v13
v_sub_u32 v14, v12, v14
v_mul_u32_u24 v13, 896, v13
v_lshl_add_u32 v193, v14, 4, v13
v_add_u32 v12, s57, v1
v_add_u32 v12, 384, v12
v_mul_u32_u24 v13, 2341, v12
v_lshrrev_b32 v13, 16, v13
v_mul_u32_u24 v14, 28, v13
v_sub_u32 v14, v12, v14
v_mul_u32_u24 v13, 896, v13
v_lshl_add_u32 v194, v14, 4, v13
v_lshrrev_b32 v12, 5, v1
v_lshlrev_b32 v12, 2, v12
v_bfe_u32 v13, v1, 2, 2
v_add_u32 v12, v12, v13
v_mul_u32_u24 v12, 448, v12
v_bfe_u32 v13, v1, 4, 1
v_lshl_add_u32 v12, v13, 5, v12
v_and_b32 v13, 3, v1
v_lshl_add_u32 v195, v13, 3, v12
v_add_u32 v196, 57344, v195
v_add_u32 v197, 114688, v195
s_lshl_b32 s49, s17, 4
s_add_u32 s49, s49, s16
s_lshl_b32 s49, s49, 2
s_add_u32 s49, s49, s18
s_mul_i32 s49, s49, 28672
s_add_u32 s49, s49, 100663296
s_cmp_eq_u32 s19, 1
s_cbranch_scc0 k2_noq2
v_accvgpr_mov_b32 a192, a128
v_accvgpr_mov_b32 a193, a129
v_accvgpr_mov_b32 a194, a130
v_accvgpr_mov_b32 a195, a131
v_accvgpr_mov_b32 a196, a132
v_accvgpr_mov_b32 a197, a133
v_accvgpr_mov_b32 a198, a134
v_accvgpr_mov_b32 a199, a135
v_accvgpr_mov_b32 a200, a136
v_accvgpr_mov_b32 a201, a137
v_accvgpr_mov_b32 a202, a138
v_accvgpr_mov_b32 a203, a139
v_accvgpr_mov_b32 a204, a140
v_accvgpr_mov_b32 a205, a141
v_accvgpr_mov_b32 a206, a142
v_accvgpr_mov_b32 a207, a143
v_accvgpr_mov_b32 a208, a144
v_accvgpr_mov_b32 a209, a145
v_accvgpr_mov_b32 a210, a146
v_accvgpr_mov_b32 a211, a147
v_accvgpr_mov_b32 a212, a148
v_accvgpr_mov_b32 a213, a149
v_accvgpr_mov_b32 a214, a150
v_accvgpr_mov_b32 a215, a151
v_accvgpr_mov_b32 a216, a152
v_accvgpr_mov_b32 a217, a153
v_accvgpr_mov_b32 a218, a154
v_accvgpr_mov_b32 a219, a155
v_accvgpr_mov_b32 a220, a156
v_accvgpr_mov_b32 a221, a157
v_accvgpr_mov_b32 a222, a158
v_accvgpr_mov_b32 a223, a159
v_accvgpr_mov_b32 a224, a160
v_accvgpr_mov_b32 a225, a161
v_accvgpr_mov_b32 a226, a162
v_accvgpr_mov_b32 a227, a163
v_accvgpr_mov_b32 a228, a164
v_accvgpr_mov_b32 a229, a165
v_accvgpr_mov_b32 a230, a166
v_accvgpr_mov_b32 a231, a167
v_accvgpr_mov_b32 a232, a168
v_accvgpr_mov_b32 a233, a169
v_accvgpr_mov_b32 a234, a170
v_accvgpr_mov_b32 a235, a171
v_accvgpr_mov_b32 a236, a172
v_accvgpr_mov_b32 a237, a173
v_accvgpr_mov_b32 a238, a174
v_accvgpr_mov_b32 a239, a175
v_accvgpr_mov_b32 a240, a176
v_accvgpr_mov_b32 a241, a177
v_accvgpr_mov_b32 a242, a178
v_accvgpr_mov_b32 a243, a179
v_accvgpr_mov_b32 a244, a180
v_accvgpr_mov_b32 a245, a181
v_accvgpr_mov_b32 a246, a182
v_accvgpr_mov_b32 a247, a183
v_accvgpr_mov_b32 a248, a184
v_accvgpr_mov_b32 a249, a185
v_accvgpr_mov_b32 a250, a186
v_accvgpr_mov_b32 a251, a187
v_accvgpr_mov_b32 a252, a188
v_accvgpr_mov_b32 a253, a189
v_accvgpr_mov_b32 a254, a190
v_accvgpr_mov_b32 a255, a191
s_lshl_b32 s56, s16, 7
s_add_u32 s56, s56, 59768832
s_mov_b32 s57, 0
s_waitcnt vmcnt(0)
k2_qpoll:
v_cmp_ne_u32 vcc, s101, v29
s_nop 3
s_and_b32 s58, vcc_lo, 0x10000
s_cbranch_scc0 k2_qok
buffer_load_dword v29, v30, s[4:7], s56 offen sc1
s_add_u32 s57, s57, 1
s_cmp_ge_u32 s57, 131072
s_waitcnt vmcnt(0)
s_cbranch_scc0 k2_qpoll
k2_qok:
s_lshl_b32 s56, s16, 20
s_lshl_b32 s57, s59, 14
s_add_u32 s56, s56, s57
s_add_u32 s56, s56, 33554432
buffer_load_dwordx4 a[128:131], v2, s[4:7], s56 offen offset:0
buffer_load_dwordx4 a[132:135], v2, s[4:7], s56 offen offset:1024
buffer_load_dwordx4 a[136:139], v2, s[4:7], s56 offen offset:2048
buffer_load_dwordx4 a[140:143], v2, s[4:7], s56 offen offset:3072
s_add_u32 s56, s56, 4096
buffer_load_dwordx4 a[144:147], v2, s[4:7], s56 offen offset:0
buffer_load_dwordx4 a[148:151], v2, s[4:7], s56 offen offset:1024
buffer_load_dwordx4 a[152:155], v2, s[4:7], s56 offen offset:2048
buffer_load_dwordx4 a[156:159], v2, s[4:7], s56 offen offset:3072
s_add_u32 s56, s56, 4096
buffer_load_dwordx4 a[160:163], v2, s[4:7], s56 offen offset:0
buffer_load_dwordx4 a[164:167], v2, s[4:7], s56 offen offset:1024
buffer_load_dwordx4 a[168:171], v2, s[4:7], s56 offen offset:2048
buffer_load_dwordx4 a[172:175], v2, s[4:7], s56 offen offset:3072
s_add_u32 s56, s56, 4096
buffer_load_dwordx4 a[176:179], v2, s[4:7], s56 offen offset:0
buffer_load_dwordx4 a[180:183], v2, s[4:7], s56 offen offset:1024
buffer_load_dwordx4 a[184:187], v2, s[4:7], s56 offen offset:2048
buffer_load_dwordx4 a[188:191], v2, s[4:7], s56 offen offset:3072
s_waitcnt vmcnt(0)
k2_noq2:
s_waitcnt vmcnt(24)
s_barrier
k2_seg:
v_mov_b32 v6, 0
ds_read_b128 v[96:99], v3 offset:0
ds_read_b128 v[100:103], v3 offset:1024
ds_read_b128 v[104:107], v3 offset:2048
ds_read_b128 v[108:111], v3 offset:3072
ds_read_b128 v[112:115], v3 offset:4096
ds_read_b128 v[116:119], v3 offset:5120
ds_read_b128 v[120:123], v3 offset:6144
ds_read_b128 v[124:127], v3 offset:7168
s_waitcnt lgkmcnt(4)
v_mfma_f32_32x32x16_bf16 v[16:31], v[96:99], a[128:131], 0
ds_read_b128 v[128:131], v3 offset:8192
v_accvgpr_write_b32 a0, 0
v_accvgpr_write_b32 a1, 0
v_accvgpr_write_b32 a2, 0
v_accvgpr_write_b32 a3, 0
v_mfma_f32_32x32x16_bf16 v[16:31], v[100:103], a[132:135], v[16:31]
ds_read_b128 v[132:135], v3 offset:9216
v_accvgpr_write_b32 a4, 0
v_accvgpr_write_b32 a5, 0
v_accvgpr_write_b32 a6, 0
v_accvgpr_write_b32 a7, 0
v_mfma_f32_32x32x16_bf16 v[16:31], v[104:107], a[136:139], v[16:31]
ds_read_b128 v[136:139], v3 offset:10240
v_accvgpr_write_b32 a8, 0
v_accvgpr_write_b32 a9, 0
v_accvgpr_write_b32 a10, 0
v_accvgpr_write_b32 a11, 0
v_mfma_f32_32x32x16_bf16 v[16:31], v[108:111], a[140:143], v[16:31]
ds_read_b128 v[140:143], v3 offset:11264
v_accvgpr_write_b32 a12, 0
v_accvgpr_write_b32 a13, 0
v_accvgpr_write_b32 a14, 0
v_accvgpr_write_b32 a15, 0
s_waitcnt lgkmcnt(4)
v_mfma_f32_32x32x16_bf16 v[16:31], v[112:115], a[144:147], v[16:31]
ds_read_b128 v[144:147], v3 offset:12288
v_accvgpr_write_b32 a16, 0
v_accvgpr_write_b32 a17, 0
v_accvgpr_write_b32 a18, 0
v_accvgpr_write_b32 a19, 0
v_mfma_f32_32x32x16_bf16 v[16:31], v[116:119], a[148:151], v[16:31]
ds_read_b128 v[148:151], v3 offset:13312
v_accvgpr_write_b32 a20, 0
v_accvgpr_write_b32 a21, 0
v_accvgpr_write_b32 a22, 0
v_accvgpr_write_b32 a23, 0
v_mfma_f32_32x32x16_bf16 v[16:31], v[120:123], a[152:155], v[16:31]
ds_read_b128 v[152:155], v3 offset:14336
v_accvgpr_write_b32 a24, 0
v_accvgpr_write_b32 a25, 0
v_accvgpr_write_b32 a26, 0
v_accvgpr_write_b32 a27, 0
v_mfma_f32_32x32x16_bf16 v[16:31], v[124:127], a[156:159], v[16:31]
ds_read_b128 v[156:159], v3 offset:15360
v_accvgpr_write_b32 a28, 0
v_accvgpr_write_b32 a29, 0
v_accvgpr_write_b32 a30, 0
v_accvgpr_write_b32 a31, 0
s_waitcnt lgkmcnt(4)
v_mfma_f32_32x32x16_bf16 v[16:31], v[128:131], a[160:163], v[16:31]
s_add_u32 s28, s28, 16384
s_and_b32 s28, s28, 0xffff
v_add_u32 v3, s28, v2
v_accvgpr_write_b32 a32, 0
v_accvgpr_write_b32 a33, 0
v_accvgpr_write_b32 a34, 0
v_accvgpr_write_b32 a35, 0
v_mfma_f32_32x32x16_bf16 v[16:31], v[132:135], a[164:167], v[16:31]
v_accvgpr_write_b32 a36, 0
v_accvgpr_write_b32 a37, 0
v_accvgpr_write_b32 a38, 0
v_accvgpr_write_b32 a39, 0
v_mfma_f32_32x32x16_bf16 v[16:31], v[136:139], a[168:171], v[16:31]
v_accvgpr_write_b32 a40, 0
v_accvgpr_write_b32 a41, 0
v_accvgpr_write_b32 a42, 0
v_accvgpr_write_b32 a43, 0
v_mfma_f32_32x32x16_bf16 v[16:31], v[140:143], a[172:175], v[16:31]
v_accvgpr_write_b32 a44, 0
v_accvgpr_write_b32 a45, 0
v_accvgpr_write_b32 a46, 0
v_accvgpr_write_b32 a47, 0
s_waitcnt lgkmcnt(0)
v_mfma_f32_32x32x16_bf16 v[16:31], v[144:147], a[176:179], v[16:31]
v_accvgpr_write_b32 a48, 0
v_accvgpr_write_b32 a49, 0
v_accvgpr_write_b32 a50, 0
v_accvgpr_write_b32 a51, 0
v_mfma_f32_32x32x16_bf16 v[16:31], v[148:151], a[180:183], v[16:31]
v_accvgpr_write_b32 a52, 0
v_accvgpr_write_b32 a53, 0
v_accvgpr_write_b32 a54, 0
v_accvgpr_write_b32 a55, 0
v_mfma_f32_32x32x16_bf16 v[16:31], v[152:155], a[184:187], v[16:31]
v_accvgpr_write_b32 a56, 0
v_accvgpr_write_b32 a57, 0
v_accvgpr_write_b32 a58, 0
v_accvgpr_write_b32 a59, 0
v_mfma_f32_32x32x16_bf16 v[16:31], v[156:159], a[188:191], v[16:31]
v_accvgpr_write_b32 a60, 0
v_accvgpr_write_b32 a61, 0
v_accvgpr_write_b32 a62, 0
v_accvgpr_write_b32 a63, 0
s_cmp_eq_u32 s36, 0
s_cbranch_scc0 k2_q0_2
s_cmp_eq_u32 s19, 0
s_cbranch_scc0 k2_q0_b
s_waitcnt vmcnt(20)
s_branch k2_q0_e
k2_q0_b:
s_waitcnt vmcnt(20)
s_branch k2_q0_e
k2_q0_2:
k2_q0_e:
s_barrier
ds_read_b128 v[96:99], v3 offset:0
ds_read_b128 v[100:103], v3 offset:1024
ds_read_b128 v[104:107], v3 offset:2048
ds_read_b128 v[108:111], v3 offset:3072
ds_read_b128 v[112:115], v3 offset:4096
ds_read_b128 v[116:119], v3 offset:5120
ds_read_b128 v[120:123], v3 offset:6144
ds_read_b128 v[124:127], v3 offset:7168
s_nop 7
s_nop 3
s_cmp_ge_u32 s31, s32
s_cbranch_scc0 k2_f_nomask
s_sub_u32 s33, s32, s31
s_lshl_b32 s33, s33, 5
v_add_u32 v9, s33, v5
v_cmp_gt_i32 vcc, 0, v9
v_cndmask_b32 v16, v16, v8, vcc
v_cmp_gt_i32 vcc, 1, v9
v_cndmask_b32 v17, v17, v8, vcc
v_cmp_gt_i32 vcc, 2, v9
v_cndmask_b32 v18, v18, v8, vcc
v_cmp_gt_i32 vcc, 3, v9
v_cndmask_b32 v19, v19, v8, vcc
v_cmp_gt_i32 vcc, 8, v9
v_cndmask_b32 v20, v20, v8, vcc
v_cmp_gt_i32 vcc, 9, v9
v_cndmask_b32 v21, v21, v8, vcc
v_cmp_gt_i32 vcc, 10, v9
v_cndmask_b32 v22, v22, v8, vcc
v_cmp_gt_i32 vcc, 11, v9
v_cndmask_b32 v23, v23, v8, vcc
v_cmp_gt_i32 vcc, 16, v9
v_cndmask_b32 v24, v24, v8, vcc
v_cmp_gt_i32 vcc, 17, v9
v_cndmask_b32 v25, v25, v8, vcc
v_cmp_gt_i32 vcc, 18, v9
v_cndmask_b32 v26, v26, v8, vcc
v_cmp_gt_i32 vcc, 19, v9
v_cndmask_b32 v27, v27, v8, vcc
v_cmp_gt_i32 vcc, 24, v9
v_cndmask_b32 v28, v28, v8, vcc
v_cmp_gt_i32 vcc, 25, v9
v_cndmask_b32 v29, v29, v8, vcc
v_cmp_gt_i32 vcc, 26, v9
v_cndmask_b32 v30, v30, v8, vcc
v_cmp_gt_i32 vcc, 27, v9
v_cndmask_b32 v31, v31, v8, vcc
k2_f_nomask:
v_max3_f32 v9, v16, v17, v18
v_max3_f32 v9, v9, v19, v20
v_max3_f32 v9, v9, v21, v22
v_max3_f32 v9, v9, v23, v24
v_max3_f32 v9, v9, v25, v26
v_max3_f32 v9, v9, v27, v28
v_max3_f32 v9, v9, v29, v30
v_max_f32 v9, v9, v31
v_mov_b32 v10, v9
s_nop 1
v_permlane32_swap_b32 v9, v10
s_nop 1
v_max_f32 v9, v9, v10
v_max_f32 v9, 0xf149f2ca, v9
v_sub_f32 v16, v16, v9
v_sub_f32 v17, v17, v9
v_sub_f32 v18, v18, v9
v_sub_f32 v19, v19, v9
v_sub_f32 v20, v20, v9
v_sub_f32 v21, v21, v9
v_sub_f32 v22, v22, v9
v_sub_f32 v23, v23, v9
v_sub_f32 v24, v24, v9
v_sub_f32 v25, v25, v9
v_sub_f32 v26, v26, v9
v_sub_f32 v27, v27, v9
v_sub_f32 v28, v28, v9
v_sub_f32 v29, v29, v9
v_sub_f32 v30, v30, v9
v_sub_f32 v31, v31, v9
v_sub_f32 v10, 0, v9
v_mov_b32 v48, v10
v_mov_b32 v49, v10
v_mov_b32 v50, v10
v_mov_b32 v51, v10
v_mov_b32 v52, v10
v_mov_b32 v53, v10
v_mov_b32 v54, v10
v_mov_b32 v55, v10
v_mov_b32 v56, v10
v_mov_b32 v57, v10
v_mov_b32 v58, v10
v_mov_b32 v59, v10
v_mov_b32 v60, v10
v_mov_b32 v61, v10
v_mov_b32 v62, v10
v_mov_b32 v63, v10
s_nop 1
s_waitcnt lgkmcnt(4)
v_mfma_f32_32x32x16_bf16 v[32:47], v[96:99], a[128:131], v[48:63]
ds_read_b128 v[128:131], v3 offset:8192
s_mov_b32 m0, s26
v_exp_f32 v80, v16
v_exp_f32 v81, v17
v_exp_f32 v82, v18
v_accvgpr_write_b32 a64, 0
v_accvgpr_write_b32 a65, 0
v_accvgpr_write_b32 a66, 0
v_accvgpr_write_b32 a67, 0
v_mfma_f32_32x32x16_bf16 v[32:47], v[100:103], a[132:135], v[32:47]
ds_read_b128 v[132:135], v3 offset:9216
buffer_load_dwordx4 v2, s[4:7], s20 offen offset:0 lds
v_exp_f32 v83, v19
v_cvt_pk_bf16_f32 v64, v80, v81
v_accvgpr_write_b32 a68, 0
v_accvgpr_write_b32 a69, 0
v_accvgpr_write_b32 a70, 0
v_accvgpr_write_b32 a71, 0
v_mfma_f32_32x32x16_bf16 v[32:47], v[104:107], a[136:139], v[32:47]
ds_read_b128 v[136:139], v3 offset:10240
v_add_f32 v7, v80, v81
v_exp_f32 v84, v20
v_exp_f32 v85, v21
v_accvgpr_write_b32 a72, 0
v_accvgpr_write_b32 a73, 0
v_accvgpr_write_b32 a74, 0
v_accvgpr_write_b32 a75, 0
v_mfma_f32_32x32x16_bf16 v[32:47], v[108:111], a[140:143], v[32:47]
ds_read_b128 v[140:143], v3 offset:11264
buffer_load_dwordx4 v2, s[4:7], s20 offen offset:1024 lds
v_cvt_pk_bf16_f32 v65, v82, v83
v_add_f32 v15, v82, v83
v_accvgpr_write_b32 a76, 0
v_accvgpr_write_b32 a77, 0
v_accvgpr_write_b32 a78, 0
v_accvgpr_write_b32 a79, 0
s_waitcnt lgkmcnt(4)
v_mfma_f32_32x32x16_bf16 v[32:47], v[112:115], a[144:147], v[32:47]
ds_read_b128 v[144:147], v3 offset:12288
v_exp_f32 v86, v22
v_exp_f32 v87, v23
v_cvt_pk_bf16_f32 v66, v84, v85
v_accvgpr_write_b32 a80, 0
v_accvgpr_write_b32 a81, 0
v_accvgpr_write_b32 a82, 0
v_accvgpr_write_b32 a83, 0
v_mfma_f32_32x32x16_bf16 v[32:47], v[116:119], a[148:151], v[32:47]
ds_read_b128 v[148:151], v3 offset:13312
buffer_load_dwordx4 v2, s[4:7], s20 offen offset:2048 lds
v_add_f32 v7, v7, v84
v_add_f32 v15, v15, v85
v_accvgpr_write_b32 a84, 0
v_accvgpr_write_b32 a85, 0
v_accvgpr_write_b32 a86, 0
v_accvgpr_write_b32 a87, 0
v_mfma_f32_32x32x16_bf16 v[32:47], v[120:123], a[152:155], v[32:47]
ds_read_b128 v[152:155], v3 offset:14336
v_exp_f32 v88, v24
v_exp_f32 v89, v25
v_cvt_pk_bf16_f32 v67, v86, v87
v_accvgpr_write_b32 a88, 0
v_accvgpr_write_b32 a89, 0
v_accvgpr_write_b32 a90, 0
v_accvgpr_write_b32 a91, 0
v_mfma_f32_32x32x16_bf16 v[32:47], v[124:127], a[156:159], v[32:47]
ds_read_b128 v[156:159], v3 offset:15360
buffer_load_dwordx4 v2, s[4:7], s20 offen offset:3072 lds
s_add_u32 s20, s20, 16384
s_cmp_eq_u32 s20, s22
s_cselect_b32 s20, s23, s20
v_add_f32 v7, v7, v86
v_add_f32 v15, v15, v87
v_accvgpr_write_b32 a92, 0
v_accvgpr_write_b32 a93, 0
v_accvgpr_write_b32 a94, 0
v_accvgpr_write_b32 a95, 0
s_waitcnt lgkmcnt(4)
v_mfma_f32_32x32x16_bf16 v[32:47], v[128:131], a[160:163], v[32:47]
s_add_u32 s28, s28, 16384
s_and_b32 s28, s28, 0xffff
v_add_u32 v3, s28, v2
v_exp_f32 v90, v26
v_exp_f32 v91, v27
v_accvgpr_write_b32 a96, 0
v_accvgpr_write_b32 a97, 0
v_accvgpr_write_b32 a98, 0
v_accvgpr_write_b32 a99, 0
v_mfma_f32_32x32x16_bf16 v[32:47], v[132:135], a[164:167], v[32:47]
v_cvt_pk_bf16_f32 v68, v88, v89
v_add_f32 v7, v7, v88
v_add_f32 v15, v15, v89
v_accvgpr_write_b32 a100, 0
v_accvgpr_write_b32 a101, 0
v_accvgpr_write_b32 a102, 0
v_accvgpr_write_b32 a103, 0
v_mfma_f32_32x32x16_bf16 v[32:47], v[136:139], a[168:171], v[32:47]
s_add_u32 s26, s26, 16384
s_and_b32 s26, s26, 0xffff
v_exp_f32 v92, v28
v_exp_f32 v93, v29
v_accvgpr_write_b32 a104, 0
v_accvgpr_write_b32 a105, 0
v_accvgpr_write_b32 a106, 0
v_accvgpr_write_b32 a107, 0
v_mfma_f32_32x32x16_bf16 v[32:47], v[140:143], a[172:175], v[32:47]
v_cvt_pk_bf16_f32 v69, v90, v91
v_add_f32 v7, v7, v90
v_add_f32 v15, v15, v91
v_accvgpr_write_b32 a108, 0
v_accvgpr_write_b32 a109, 0
v_accvgpr_write_b32 a110, 0
v_accvgpr_write_b32 a111, 0
s_waitcnt lgkmcnt(0)
v_mfma_f32_32x32x16_bf16 v[32:47], v[144:147], a[176:179], v[32:47]
v_exp_f32 v94, v30
v_exp_f32 v95, v31
v_accvgpr_write_b32 a112, 0
v_accvgpr_write_b32 a113, 0
v_accvgpr_write_b32 a114, 0
v_accvgpr_write_b32 a115, 0
v_mfma_f32_32x32x16_bf16 v[32:47], v[148:151], a[180:183], v[32:47]
v_cvt_pk_bf16_f32 v70, v92, v93
v_add_f32 v7, v7, v92
v_add_f32 v15, v15, v93
v_accvgpr_write_b32 a116, 0
v_accvgpr_write_b32 a117, 0
v_accvgpr_write_b32 a118, 0
v_accvgpr_write_b32 a119, 0
v_mfma_f32_32x32x16_bf16 v[32:47], v[152:155], a[184:187], v[32:47]
v_cvt_pk_bf16_f32 v71, v94, v95
v_add_f32 v7, v7, v94
v_accvgpr_write_b32 a120, 0
v_accvgpr_write_b32 a121, 0
v_accvgpr_write_b32 a122, 0
v_accvgpr_write_b32 a123, 0
v_mfma_f32_32x32x16_bf16 v[32:47], v[156:159], a[188:191], v[32:47]
v_add_f32 v15, v15, v95
v_add_f32 v7, v7, v15
v_accvgpr_write_b32 a124, 0
v_accvgpr_write_b32 a125, 0
v_accvgpr_write_b32 a126, 0
v_accvgpr_write_b32 a127, 0
s_nop 2
v_add_f32 v6, v6, v7
s_add_u32 s31, s31, 1
s_cmp_eq_u32 s36, 0
s_cbranch_scc0 k2_ha_2
s_cmp_eq_u32 s19, 0
s_cbranch_scc0 k2_ha_b
s_waitcnt vmcnt(16)
s_branch k2_ha_e
k2_ha_b:
s_waitcnt vmcnt(16)
s_branch k2_ha_e
k2_ha_2:
s_waitcnt vmcnt(33)
k2_ha_e:
s_barrier
s_sub_u32 s30, s38, 2
s_lshr_b32 s30, s30, 1
s_cmp_eq_u32 s30, 0
s_cbranch_scc1 k2_hb
ds_read_b128 v[96:99], v3 offset:0
ds_read_b128 v[100:103], v3 offset:1024
ds_read_b128 v[104:107], v3 offset:2048
ds_read_b128 v[108:111], v3 offset:3072
ds_read_b128 v[112:115], v3 offset:4096
ds_read_b128 v[116:119], v3 offset:5120
ds_read_b128 v[120:123], v3 offset:6144
ds_read_b128 v[124:127], v3 offset:7168
ds_read_b128 v[128:131], v3 offset:8192
ds_read_b128 v[132:135], v3 offset:9216
ds_read_b128 v[136:139], v3 offset:10240
ds_read_b128 v[140:143], v3 offset:11264
.p2align 6
k2_loop:
s_cmp_ge_u32 s31, s32
s_cbranch_scc1 k2_mask1
k2_maskret1:
s_waitcnt lgkmcnt(8)
v_mfma_f32_32x32x16_bf16 v[16:31], v[96:99], a[128:131], v[48:63]
ds_read_b128 v[144:147], v3 offset:12288
s_mov_b32 m0, s26
v_exp_f32 v80, v32
v_exp_f32 v81, v33
v_mfma_f32_32x32x16_bf16 v[16:31], v[100:103], a[132:135], v[16:31]
ds_read_b128 v[148:151], v3 offset:13312
buffer_load_dwordx4 v2, s[4:7], s20 offen offset:0 lds
v_exp_f32 v82, v34
v_mfma_f32_32x32x16_bf16 v[16:31], v[104:107], a[136:139], v[16:31]
ds_read_b128 v[152:155], v3 offset:14336
v_exp_f32 v83, v35
v_cvt_pk_bf16_f32 v72, v80, v81
v_mfma_f32_32x32x16_bf16 v[16:31], v[108:111], a[140:143], v[16:31]
ds_read_b128 v[156:159], v3 offset:15360
buffer_load_dwordx4 v2, s[4:7], s20 offen offset:1024 lds
v_add_f32 v7, v80, v81
s_waitcnt lgkmcnt(8)
v_mfma_f32_32x32x16_bf16 v[16:31], v[112:115], a[144:147], v[16:31]
ds_read_b128 v[96:99], v4 offset:0
s_add_u32 s28, s28, 16384
s_and_b32 s28, s28, 0xffff
v_add_u32 v3, s28, v2
v_exp_f32 v84, v36
v_mfma_f32_32x32x16_bf16 v[16:31], v[116:119], a[148:151], v[16:31]
ds_read_b128 v[100:103], v4 offset:2048
buffer_load_dwordx4 v2, s[4:7], s20 offen offset:2048 lds
v_exp_f32 v85, v37
v_cvt_pk_bf16_f32 v73, v82, v83
v_mfma_f32_32x32x16_bf16 v[16:31], v[120:123], a[152:155], v[16:31]
ds_read_b128 v[104:107], v4 offset:4096
v_add_f32 v15, v82, v83
v_mfma_f32_32x32x16_bf16 v[16:31], v[124:127], a[156:159], v[16:31]
ds_read_b128 v[108:111], v4 offset:6144
buffer_load_dwordx4 v2, s[4:7], s20 offen offset:3072 lds
s_add_u32 s20, s20, 16384
s_cmp_eq_u32 s20, s22
s_cselect_b32 s20, s23, s20
v_exp_f32 v86, v38
s_waitcnt lgkmcnt(8)
v_mfma_f32_32x32x16_bf16 v[16:31], v[128:131], a[160:163], v[16:31]
ds_read_b128 v[112:115], v4 offset:8192
s_mov_b32 m0, s27
v_exp_f32 v87, v39
v_cvt_pk_bf16_f32 v74, v84, v85
v_mfma_f32_32x32x16_bf16 v[16:31], v[132:135], a[164:167], v[16:31]
ds_read_b128 v[116:119], v4 offset:10240
buffer_load_dwordx4 v2, s[4:7], s21 offen offset:0 lds
v_add_f32 v7, v7, v84
v_mfma_f32_32x32x16_bf16 v[16:31], v[136:139], a[168:171], v[16:31]
ds_read_b128 v[120:123], v4 offset:12288
s_add_u32 s26, s26, 16384
s_and_b32 s26, s26, 0xffff
v_add_f32 v15, v15, v85
v_mfma_f32_32x32x16_bf16 v[16:31], v[140:143], a[172:175], v[16:31]
ds_read_b128 v[124:127], v4 offset:14336
buffer_load_dwordx4 v2, s[4:7], s21 offen offset:1024 lds
v_exp_f32 v88, v40
v_exp_f32 v89, v41
s_waitcnt lgkmcnt(8)
v_mfma_f32_32x32x16_bf16 v[16:31], v[144:147], a[176:179], v[16:31]
ds_read_b128 v[128:131], v4 offset:1024
v_cvt_pk_bf16_f32 v75, v86, v87
v_mfma_f32_32x32x16_bf16 v[16:31], v[148:151], a[180:183], v[16:31]
ds_read_b128 v[132:135], v4 offset:3072
buffer_load_dwordx4 v2, s[4:7], s21 offen offset:2048 lds
v_add_f32 v7, v7, v86
v_mfma_f32_32x32x16_bf16 v[16:31], v[152:155], a[184:187], v[16:31]
ds_read_b128 v[136:139], v4 offset:5120
v_add_f32 v15, v15, v87
v_exp_f32 v90, v42
v_mfma_f32_32x32x16_bf16 v[16:31], v[156:159], a[188:191], v[16:31]
ds_read_b128 v[140:143], v4 offset:7168
buffer_load_dwordx4 v2, s[4:7], s21 offen offset:3072 lds
s_add_u32 s21, s21, 16384
s_cmp_eq_u32 s21, s24
s_cselect_b32 s21, s25, s21
v_exp_f32 v91, v43
s_waitcnt lgkmcnt(8)
v_mfma_f32_32x32x16_bf16 a[0:15], v[96:99], v[64:67], a[0:15]
ds_read_b128 v[144:147], v4 offset:9216
v_cvt_pk_bf16_f32 v76, v88, v89
v_mfma_f32_32x32x16_bf16 a[16:31], v[100:103], v[64:67], a[16:31]
ds_read_b128 v[148:151], v4 offset:11264
s_add_u32 s27, s27, 16384
s_cmp_ge_u32 s27, 147456
s_cselect_b32 s39, 81920, 0
s_sub_u32 s27, s27, s39
v_add_f32 v7, v7, v88
v_add_f32 v15, v15, v89
v_mfma_f32_32x32x16_bf16 a[32:47], v[104:107], v[64:67], a[32:47]
ds_read_b128 v[152:155], v4 offset:13312
v_exp_f32 v92, v44
v_mfma_f32_32x32x16_bf16 a[48:63], v[108:111], v[64:67], a[48:63]
ds_read_b128 v[156:159], v4 offset:15360
s_waitcnt vmcnt(16)
s_barrier
v_exp_f32 v93, v45
s_waitcnt lgkmcnt(8)
v_mfma_f32_32x32x16_bf16 a[64:79], v[112:115], v[64:67], a[64:79]
ds_read_b128 v[96:99], v3 offset:0
v_cvt_pk_bf16_f32 v77, v90, v91
v_add_f32 v7, v7, v90
v_mfma_f32_32x32x16_bf16 a[80:95], v[116:119], v[64:67], a[80:95]
ds_read_b128 v[100:103], v3 offset:1024
s_add_u32 s29, s29, 16384
s_cmp_eq_u32 s29, 147456
s_cselect_b32 s29, 65536, s29
v_add_u32 v4, s29, v2
v_add_f32 v15, v15, v91
v_mfma_f32_32x32x16_bf16 a[96:111], v[120:123], v[64:67], a[96:111]
ds_read_b128 v[104:107], v3 offset:2048
v_exp_f32 v94, v46
v_mfma_f32_32x32x16_bf16 a[112:127], v[124:127], v[64:67], a[112:127]
ds_read_b128 v[108:111], v3 offset:3072
v_exp_f32 v95, v47
v_cvt_pk_bf16_f32 v78, v92, v93
s_waitcnt lgkmcnt(8)
v_mfma_f32_32x32x16_bf16 a[0:15], v[128:131], v[68:71], a[0:15]
ds_read_b128 v[112:115], v3 offset:4096
v_add_f32 v7, v7, v92
v_mfma_f32_32x32x16_bf16 a[16:31], v[132:135], v[68:71], a[16:31]
ds_read_b128 v[116:119], v3 offset:5120
v_add_f32 v15, v15, v93
v_mfma_f32_32x32x16_bf16 a[32:47], v[136:139], v[68:71], a[32:47]
ds_read_b128 v[120:123], v3 offset:6144
v_cvt_pk_bf16_f32 v79, v94, v95
v_add_f32 v7, v7, v94
v_mfma_f32_32x32x16_bf16 a[48:63], v[140:143], v[68:71], a[48:63]
ds_read_b128 v[124:127], v3 offset:7168
v_add_f32 v15, v15, v95
s_waitcnt lgkmcnt(8)
v_mfma_f32_32x32x16_bf16 a[64:79], v[144:147], v[68:71], a[64:79]
ds_read_b128 v[128:131], v3 offset:8192
v_add_f32 v7, v7, v15
v_mfma_f32_32x32x16_bf16 a[80:95], v[148:151], v[68:71], a[80:95]
ds_read_b128 v[132:135], v3 offset:9216
v_mfma_f32_32x32x16_bf16 a[96:111], v[152:155], v[68:71], a[96:111]
ds_read_b128 v[136:139], v3 offset:10240
s_add_u32 s31, s31, 1
v_mfma_f32_32x32x16_bf16 a[112:127], v[156:159], v[68:71], a[112:127]
ds_read_b128 v[140:143], v3 offset:11264
v_cmp_nge_f32 vcc, s35, v7
s_cbranch_vccnz k2_rare1
k2_rareret1:
v_add_f32 v6, v6, v7
s_cmp_ge_u32 s31, s32
s_cbranch_scc1 k2_mask2
k2_maskret2:
s_waitcnt lgkmcnt(8)
v_mfma_f32_32x32x16_bf16 v[32:47], v[96:99], a[128:131], v[48:63]
ds_read_b128 v[144:147], v3 offset:12288
s_mov_b32 m0, s26
v_exp_f32 v80, v16
v_exp_f32 v81, v17
v_mfma_f32_32x32x16_bf16 v[32:47], v[100:103], a[132:135], v[32:47]
ds_read_b128 v[148:151], v3 offset:13312
buffer_load_dwordx4 v2, s[4:7], s20 offen offset:0 lds
v_exp_f32 v82, v18
v_mfma_f32_32x32x16_bf16 v[32:47], v[104:107], a[136:139], v[32:47]
ds_read_b128 v[152:155], v3 offset:14336
v_exp_f32 v83, v19
v_cvt_pk_bf16_f32 v64, v80, v81
v_mfma_f32_32x32x16_bf16 v[32:47], v[108:111], a[140:143], v[32:47]
ds_read_b128 v[156:159], v3 offset:15360
buffer_load_dwordx4 v2, s[4:7], s20 offen offset:1024 lds
v_add_f32 v7, v80, v81
s_waitcnt lgkmcnt(8)
v_mfma_f32_32x32x16_bf16 v[32:47], v[112:115], a[144:147], v[32:47]
ds_read_b128 v[96:99], v4 offset:0
s_add_u32 s28, s28, 16384
s_and_b32 s28, s28, 0xffff
v_add_u32 v3, s28, v2
v_exp_f32 v84, v20
v_mfma_f32_32x32x16_bf16 v[32:47], v[116:119], a[148:151], v[32:47]
ds_read_b128 v[100:103], v4 offset:2048
buffer_load_dwordx4 v2, s[4:7], s20 offen offset:2048 lds
v_exp_f32 v85, v21
v_cvt_pk_bf16_f32 v65, v82, v83
v_mfma_f32_32x32x16_bf16 v[32:47], v[120:123], a[152:155], v[32:47]
ds_read_b128 v[104:107], v4 offset:4096
v_add_f32 v15, v82, v83
v_mfma_f32_32x32x16_bf16 v[32:47], v[124:127], a[156:159], v[32:47]
ds_read_b128 v[108:111], v4 offset:6144
buffer_load_dwordx4 v2, s[4:7], s20 offen offset:3072 lds
s_add_u32 s20, s20, 16384
s_cmp_eq_u32 s20, s22
s_cselect_b32 s20, s23, s20
v_exp_f32 v86, v22
s_waitcnt lgkmcnt(8)
v_mfma_f32_32x32x16_bf16 v[32:47], v[128:131], a[160:163], v[32:47]
ds_read_b128 v[112:115], v4 offset:8192
s_mov_b32 m0, s27
v_exp_f32 v87, v23
v_cvt_pk_bf16_f32 v66, v84, v85
v_mfma_f32_32x32x16_bf16 v[32:47], v[132:135], a[164:167], v[32:47]
ds_read_b128 v[116:119], v4 offset:10240
buffer_load_dwordx4 v2, s[4:7], s21 offen offset:0 lds
v_add_f32 v7, v7, v84
v_mfma_f32_32x32x16_bf16 v[32:47], v[136:139], a[168:171], v[32:47]
ds_read_b128 v[120:123], v4 offset:12288
s_add_u32 s26, s26, 16384
s_and_b32 s26, s26, 0xffff
v_add_f32 v15, v15, v85
v_mfma_f32_32x32x16_bf16 v[32:47], v[140:143], a[172:175], v[32:47]
ds_read_b128 v[124:127], v4 offset:14336
buffer_load_dwordx4 v2, s[4:7], s21 offen offset:1024 lds
v_exp_f32 v88, v24
v_exp_f32 v89, v25
s_waitcnt lgkmcnt(8)
v_mfma_f32_32x32x16_bf16 v[32:47], v[144:147], a[176:179], v[32:47]
ds_read_b128 v[128:131], v4 offset:1024
v_cvt_pk_bf16_f32 v67, v86, v87
v_mfma_f32_32x32x16_bf16 v[32:47], v[148:151], a[180:183], v[32:47]
ds_read_b128 v[132:135], v4 offset:3072
buffer_load_dwordx4 v2, s[4:7], s21 offen offset:2048 lds
v_add_f32 v7, v7, v86
v_mfma_f32_32x32x16_bf16 v[32:47], v[152:155], a[184:187], v[32:47]
ds_read_b128 v[136:139], v4 offset:5120
v_add_f32 v15, v15, v87
v_exp_f32 v90, v26
v_mfma_f32_32x32x16_bf16 v[32:47], v[156:159], a[188:191], v[32:47]
ds_read_b128 v[140:143], v4 offset:7168
buffer_load_dwordx4 v2, s[4:7], s21 offen offset:3072 lds
s_add_u32 s21, s21, 16384
s_cmp_eq_u32 s21, s24
s_cselect_b32 s21, s25, s21
v_exp_f32 v91, v27
s_waitcnt lgkmcnt(8)
v_mfma_f32_32x32x16_bf16 a[0:15], v[96:99], v[72:75], a[0:15]
ds_read_b128 v[144:147], v4 offset:9216
v_cvt_pk_bf16_f32 v68, v88, v89
v_mfma_f32_32x32x16_bf16 a[16:31], v[100:103], v[72:75], a[16:31]
ds_read_b128 v[148:151], v4 offset:11264
s_add_u32 s27, s27, 16384
s_cmp_ge_u32 s27, 147456
s_cselect_b32 s39, 81920, 0
s_sub_u32 s27, s27, s39
v_add_f32 v7, v7, v88
v_add_f32 v15, v15, v89
v_mfma_f32_32x32x16_bf16 a[32:47], v[104:107], v[72:75], a[32:47]
ds_read_b128 v[152:155], v4 offset:13312
v_exp_f32 v92, v28
v_mfma_f32_32x32x16_bf16 a[48:63], v[108:111], v[72:75], a[48:63]
ds_read_b128 v[156:159], v4 offset:15360
s_waitcnt vmcnt(16)
s_barrier
v_exp_f32 v93, v29
s_waitcnt lgkmcnt(8)
v_mfma_f32_32x32x16_bf16 a[64:79], v[112:115], v[72:75], a[64:79]
ds_read_b128 v[96:99], v3 offset:0
s_cmp_eq_u32 s37, 1
s_cbranch_scc1 k2_pub
k2_pubret:
v_cvt_pk_bf16_f32 v69, v90, v91
v_add_f32 v7, v7, v90
v_mfma_f32_32x32x16_bf16 a[80:95], v[116:119], v[72:75], a[80:95]
ds_read_b128 v[100:103], v3 offset:1024
s_add_u32 s29, s29, 16384
s_cmp_eq_u32 s29, 147456
s_cselect_b32 s29, 65536, s29
v_add_u32 v4, s29, v2
v_add_f32 v15, v15, v91
v_mfma_f32_32x32x16_bf16 a[96:111], v[120:123], v[72:75], a[96:111]
ds_read_b128 v[104:107], v3 offset:2048
v_exp_f32 v94, v30
v_mfma_f32_32x32x16_bf16 a[112:127], v[124:127], v[72:75], a[112:127]
ds_read_b128 v[108:111], v3 offset:3072
v_exp_f32 v95, v31
v_cvt_pk_bf16_f32 v70, v92, v93
s_waitcnt lgkmcnt(8)
v_mfma_f32_32x32x16_bf16 a[0:15], v[128:131], v[76:79], a[0:15]
ds_read_b128 v[112:115], v3 offset:4096
v_add_f32 v7, v7, v92
v_mfma_f32_32x32x16_bf16 a[16:31], v[132:135], v[76:79], a[16:31]
ds_read_b128 v[116:119], v3 offset:5120
v_add_f32 v15, v15, v93
v_mfma_f32_32x32x16_bf16 a[32:47], v[136:139], v[76:79], a[32:47]
ds_read_b128 v[120:123], v3 offset:6144
v_cvt_pk_bf16_f32 v71, v94, v95
v_add_f32 v7, v7, v94
v_mfma_f32_32x32x16_bf16 a[48:63], v[140:143], v[76:79], a[48:63]
ds_read_b128 v[124:127], v3 offset:7168
v_add_f32 v15, v15, v95
s_waitcnt lgkmcnt(8)
v_mfma_f32_32x32x16_bf16 a[64:79], v[144:147], v[76:79], a[64:79]
ds_read_b128 v[128:131], v3 offset:8192
v_add_f32 v7, v7, v15
v_mfma_f32_32x32x16_bf16 a[80:95], v[148:151], v[76:79], a[80:95]
ds_read_b128 v[132:135], v3 offset:9216
v_mfma_f32_32x32x16_bf16 a[96:111], v[152:155], v[76:79], a[96:111]
ds_read_b128 v[136:139], v3 offset:10240
s_add_u32 s31, s31, 1
v_mfma_f32_32x32x16_bf16 a[112:127], v[156:159], v[76:79], a[112:127]
ds_read_b128 v[140:143], v3 offset:11264
v_cmp_nge_f32 vcc, s35, v7
s_cbranch_vccnz k2_rare2
k2_rareret2:
v_add_f32 v6, v6, v7
s_sub_u32 s30, s30, 1
s_cmp_lg_u32 s30, 0
s_cbranch_scc1 k2_loop
k2_hb:
s_cmp_eq_u32 s19, 0
s_cbranch_scc1 k2_hbF
s_cmp_eq_u32 s36, 1
s_cbranch_scc1 k2_hbF
s_nop 7
s_nop 3
ds_read_b128 v[96:99], v4 offset:0
ds_read_b128 v[100:103], v4 offset:2048
ds_read_b128 v[104:107], v4 offset:4096
ds_read_b128 v[108:111], v4 offset:6144
ds_read_b128 v[112:115], v4 offset:8192
ds_read_b128 v[116:119], v4 offset:10240
ds_read_b128 v[120:123], v4 offset:12288
ds_read_b128 v[124:127], v4 offset:14336
s_cmp_ge_u32 s31, s32
s_cbranch_scc0 k2_hb_nomask
s_sub_u32 s33, s32, s31
s_lshl_b32 s33, s33, 5
v_add_u32 v9, s33, v5
v_cmp_gt_i32 vcc, 0, v9
v_cndmask_b32 v32, v32, v8, vcc
v_cmp_gt_i32 vcc, 1, v9
v_cndmask_b32 v33, v33, v8, vcc
v_cmp_gt_i32 vcc, 2, v9
v_cndmask_b32 v34, v34, v8, vcc
v_cmp_gt_i32 vcc, 3, v9
v_cndmask_b32 v35, v35, v8, vcc
v_cmp_gt_i32 vcc, 8, v9
v_cndmask_b32 v36, v36, v8, vcc
v_cmp_gt_i32 vcc, 9, v9
v_cndmask_b32 v37, v37, v8, vcc
v_cmp_gt_i32 vcc, 10, v9
v_cndmask_b32 v38, v38, v8, vcc
v_cmp_gt_i32 vcc, 11, v9
v_cndmask_b32 v39, v39, v8, vcc
v_cmp_gt_i32 vcc, 16, v9
v_cndmask_b32 v40, v40, v8, vcc
v_cmp_gt_i32 vcc, 17, v9
v_cndmask_b32 v41, v41, v8, vcc
v_cmp_gt_i32 vcc, 18, v9
v_cndmask_b32 v42, v42, v8, vcc
v_cmp_gt_i32 vcc, 19, v9
v_cndmask_b32 v43, v43, v8, vcc
v_cmp_gt_i32 vcc, 24, v9
v_cndmask_b32 v44, v44, v8, vcc
v_cmp_gt_i32 vcc, 25, v9
v_cndmask_b32 v45, v45, v8, vcc
v_cmp_gt_i32 vcc, 26, v9
v_cndmask_b32 v46, v46, v8, vcc
v_cmp_gt_i32 vcc, 27, v9
v_cndmask_b32 v47, v47, v8, vcc
k2_hb_nomask:
s_waitcnt lgkmcnt(4)
v_mfma_f32_32x32x16_bf16 a[0:15], v[96:99], v[64:67], a[0:15]
ds_read_b128 v[128:131], v4 offset:1024
s_mov_b32 m0, s26
v_exp_f32 v80, v32
v_exp_f32 v81, v33
v_exp_f32 v82, v34
v_mfma_f32_32x32x16_bf16 a[16:31], v[100:103], v[64:67], a[16:31]
ds_read_b128 v[132:135], v4 offset:3072
buffer_load_dwordx4 v2, s[4:7], s20 offen offset:0 lds
v_exp_f32 v83, v35
v_cvt_pk_bf16_f32 v72, v80, v81
v_mfma_f32_32x32x16_bf16 a[32:47], v[104:107], v[64:67], a[32:47]
ds_read_b128 v[136:139], v4 offset:5120
v_add_f32 v7, v80, v81
v_exp_f32 v84, v36
v_exp_f32 v85, v37
v_mfma_f32_32x32x16_bf16 a[48:63], v[108:111], v[64:67], a[48:63]
ds_read_b128 v[140:143], v4 offset:7168
buffer_load_dwordx4 v2, s[4:7], s20 offen offset:1024 lds
v_cvt_pk_bf16_f32 v73, v82, v83
v_add_f32 v15, v82, v83
s_waitcnt lgkmcnt(4)
v_mfma_f32_32x32x16_bf16 a[64:79], v[112:115], v[64:67], a[64:79]
ds_read_b128 v[144:147], v4 offset:9216
v_exp_f32 v86, v38
v_exp_f32 v87, v39
v_cvt_pk_bf16_f32 v74, v84, v85
v_mfma_f32_32x32x16_bf16 a[80:95], v[116:119], v[64:67], a[80:95]
ds_read_b128 v[148:151], v4 offset:11264
buffer_load_dwordx4 v2, s[4:7], s20 offen offset:2048 lds
v_add_f32 v7, v7, v84
v_add_f32 v15, v15, v85
v_mfma_f32_32x32x16_bf16 a[96:111], v[120:123], v[64:67], a[96:111]
ds_read_b128 v[152:155], v4 offset:13312
v_exp_f32 v88, v40
v_exp_f32 v89, v41
v_cvt_pk_bf16_f32 v75, v86, v87
v_mfma_f32_32x32x16_bf16 a[112:127], v[124:127], v[64:67], a[112:127]
ds_read_b128 v[156:159], v4 offset:15360
buffer_load_dwordx4 v2, s[4:7], s20 offen offset:3072 lds
s_add_u32 s20, s20, 16384
s_cmp_eq_u32 s20, s22
s_cselect_b32 s20, s23, s20
v_add_f32 v7, v7, v86
v_add_f32 v15, v15, v87
s_waitcnt lgkmcnt(4)
v_mfma_f32_32x32x16_bf16 a[0:15], v[128:131], v[68:71], a[0:15]
s_add_u32 s29, s29, 16384
s_cmp_eq_u32 s29, 147456
s_cselect_b32 s29, 65536, s29
v_add_u32 v4, s29, v2
s_mov_b32 m0, s27
v_exp_f32 v90, v42
v_exp_f32 v91, v43
v_mfma_f32_32x32x16_bf16 a[16:31], v[132:135], v[68:71], a[16:31]
buffer_load_dwordx4 v2, s[4:7], s21 offen offset:0 lds
v_cvt_pk_bf16_f32 v76, v88, v89
v_add_f32 v7, v7, v88
v_add_f32 v15, v15, v89
v_mfma_f32_32x32x16_bf16 a[32:47], v[136:139], v[68:71], a[32:47]
s_add_u32 s26, s26, 16384
s_and_b32 s26, s26, 0xffff
v_exp_f32 v92, v44
v_exp_f32 v93, v45
v_mfma_f32_32x32x16_bf16 a[48:63], v[140:143], v[68:71], a[48:63]
buffer_load_dwordx4 v2, s[4:7], s21 offen offset:1024 lds
v_cvt_pk_bf16_f32 v77, v90, v91
v_add_f32 v7, v7, v90
v_add_f32 v15, v15, v91
s_waitcnt lgkmcnt(0)
v_mfma_f32_32x32x16_bf16 a[64:79], v[144:147], v[68:71], a[64:79]
v_exp_f32 v94, v46
v_exp_f32 v95, v47
v_mfma_f32_32x32x16_bf16 a[80:95], v[148:151], v[68:71], a[80:95]
buffer_load_dwordx4 v2, s[4:7], s21 offen offset:2048 lds
v_cvt_pk_bf16_f32 v78, v92, v93
v_add_f32 v7, v7, v92
v_add_f32 v15, v15, v93
v_mfma_f32_32x32x16_bf16 a[96:111], v[152:155], v[68:71], a[96:111]
v_cvt_pk_bf16_f32 v79, v94, v95
v_add_f32 v7, v7, v94
v_mfma_f32_32x32x16_bf16 a[112:127], v[156:159], v[68:71], a[112:127]
buffer_load_dwordx4 v2, s[4:7], s21 offen offset:3072 lds
s_add_u32 s21, s21, 16384
s_cmp_eq_u32 s21, s24
s_cselect_b32 s21, s25, s21
s_add_u32 s27, s27, 16384
s_cmp_ge_u32 s27, 147456
s_cselect_b32 s39, 81920, 0
s_sub_u32 s27, s27, s39
v_add_f32 v15, v15, v95
v_add_f32 v7, v7, v15
s_nop 2
v_cmp_nge_f32 vcc, s35, v7
s_cbranch_vccnz k2_rare3
k2_rareret3:
v_add_f32 v6, v6, v7
s_waitcnt vmcnt(16)
s_barrier
ds_read_b128 v[96:99], v4 offset:0
ds_read_b128 v[100:103], v4 offset:2048
ds_read_b128 v[104:107], v4 offset:4096
ds_read_b128 v[108:111], v4 offset:6144
ds_read_b128 v[112:115], v4 offset:8192
ds_read_b128 v[116:119], v4 offset:10240
ds_read_b128 v[120:123], v4 offset:12288
ds_read_b128 v[124:127], v4 offset:14336
s_waitcnt lgkmcnt(4)
v_mfma_f32_32x32x16_bf16 a[0:15], v[96:99], v[72:75], a[0:15]
ds_read_b128 v[128:131], v4 offset:1024
s_mov_b32 m0, s27
v_mfma_f32_32x32x16_bf16 a[16:31], v[100:103], v[72:75], a[16:31]
ds_read_b128 v[132:135], v4 offset:3072
buffer_load_dwordx4 v2, s[4:7], s21 offen offset:0 lds
v_mfma_f32_32x32x16_bf16 a[32:47], v[104:107], v[72:75], a[32:47]
ds_read_b128 v[136:139], v4 offset:5120
v_mfma_f32_32x32x16_bf16 a[48:63], v[108:111], v[72:75], a[48:63]
ds_read_b128 v[140:143], v4 offset:7168
buffer_load_dwordx4 v2, s[4:7], s21 offen offset:1024 lds
s_waitcnt lgkmcnt(4)
v_mfma_f32_32x32x16_bf16 a[64:79], v[112:115], v[72:75], a[64:79]
ds_read_b128 v[144:147], v4 offset:9216
v_mfma_f32_32x32x16_bf16 a[80:95], v[116:119], v[72:75], a[80:95]
ds_read_b128 v[148:151], v4 offset:11264
buffer_load_dwordx4 v2, s[4:7], s21 offen offset:2048 lds
v_mfma_f32_32x32x16_bf16 a[96:111], v[120:123], v[72:75], a[96:111]
ds_read_b128 v[152:155], v4 offset:13312
v_mfma_f32_32x32x16_bf16 a[112:127], v[124:127], v[72:75], a[112:127]
ds_read_b128 v[156:159], v4 offset:15360
buffer_load_dwordx4 v2, s[4:7], s21 offen offset:3072 lds
s_add_u32 s21, s21, 16384
s_cmp_eq_u32 s21, s24
s_cselect_b32 s21, s25, s21
s_waitcnt lgkmcnt(4)
v_mfma_f32_32x32x16_bf16 a[0:15], v[128:131], v[76:79], a[0:15]
s_add_u32 s29, s29, 16384
s_cmp_eq_u32 s29, 147456
s_cselect_b32 s29, 65536, s29
v_add_u32 v4, s29, v2
v_mfma_f32_32x32x16_bf16 a[16:31], v[132:135], v[76:79], a[16:31]
s_add_u32 s27, s27, 16384
s_cmp_ge_u32 s27, 147456
s_cselect_b32 s39, 81920, 0
s_sub_u32 s27, s27, s39
v_mfma_f32_32x32x16_bf16 a[32:47], v[136:139], v[76:79], a[32:47]
v_mfma_f32_32x32x16_bf16 a[48:63], v[140:143], v[76:79], a[48:63]
s_waitcnt lgkmcnt(0)
v_mfma_f32_32x32x16_bf16 a[64:79], v[144:147], v[76:79], a[64:79]
v_mfma_f32_32x32x16_bf16 a[80:95], v[148:151], v[76:79], a[80:95]
v_mfma_f32_32x32x16_bf16 a[96:111], v[152:155], v[76:79], a[96:111]
v_mfma_f32_32x32x16_bf16 a[112:127], v[156:159], v[76:79], a[112:127]
s_lshl_b32 s56, s41, 16
s_lshl_b32 s57, s18, 14
s_add_u32 s56, s56, s57
s_add_u32 s56, s56, 67108864
v_sub_f32 v12, 0, v48
v_mov_b32 v13, v6
s_lshl_b32 s58, s41, 11
s_lshl_b32 s57, s18, 9
s_add_u32 s58, s58, s57
s_add_u32 s58, s58, 83886080
v_lshlrev_b32 v14, 3, v1
s_nop 7
s_cmp_eq_u32 s97, 1
s_cbranch_scc0 k2_pubwt
buffer_store_dwordx2 v[12:13], v14, s[4:7], s58 offen
v_accvgpr_read_b32 v200, a0
v_accvgpr_read_b32 v201, a1
v_accvgpr_read_b32 v202, a2
v_accvgpr_read_b32 v203, a3
v_accvgpr_read_b32 v204, a4
v_accvgpr_read_b32 v205, a5
v_accvgpr_read_b32 v206, a6
v_accvgpr_read_b32 v207, a7
v_cvt_pk_bf16_f32 v200, v200, v201
v_cvt_pk_bf16_f32 v201, v202, v203
v_cvt_pk_bf16_f32 v202, v204, v205
v_cvt_pk_bf16_f32 v203, v206, v207
buffer_store_dwordx4 v[200:203], v2, s[4:7], s56 offen offset:0
v_accvgpr_read_b32 v208, a8
v_accvgpr_read_b32 v209, a9
v_accvgpr_read_b32 v210, a10
v_accvgpr_read_b32 v211, a11
v_accvgpr_read_b32 v212, a12
v_accvgpr_read_b32 v213, a13
v_accvgpr_read_b32 v214, a14
v_accvgpr_read_b32 v215, a15
v_cvt_pk_bf16_f32 v208, v208, v209
v_cvt_pk_bf16_f32 v209, v210, v211
v_cvt_pk_bf16_f32 v210, v212, v213
v_cvt_pk_bf16_f32 v211, v214, v215
buffer_store_dwordx4 v[208:211], v2, s[4:7], s56 offen offset:1024
v_accvgpr_read_b32 v216, a16
v_accvgpr_read_b32 v217, a17
v_accvgpr_read_b32 v218, a18
v_accvgpr_read_b32 v219, a19
v_accvgpr_read_b32 v220, a20
v_accvgpr_read_b32 v221, a21
v_accvgpr_read_b32 v222, a22
v_accvgpr_read_b32 v223, a23
v_cvt_pk_bf16_f32 v216, v216, v217
v_cvt_pk_bf16_f32 v217, v218, v219
v_cvt_pk_bf16_f32 v218, v220, v221
v_cvt_pk_bf16_f32 v219, v222, v223
buffer_store_dwordx4 v[216:219], v2, s[4:7], s56 offen offset:2048
v_accvgpr_read_b32 v224, a24
v_accvgpr_read_b32 v225, a25
v_accvgpr_read_b32 v226, a26
v_accvgpr_read_b32 v227, a27
v_accvgpr_read_b32 v228, a28
v_accvgpr_read_b32 v229, a29
v_accvgpr_read_b32 v230, a30
v_accvgpr_read_b32 v231, a31
v_cvt_pk_bf16_f32 v224, v224, v225
v_cvt_pk_bf16_f32 v225, v226, v227
v_cvt_pk_bf16_f32 v226, v228, v229
v_cvt_pk_bf16_f32 v227, v230, v231
buffer_store_dwordx4 v[224:227], v2, s[4:7], s56 offen offset:3072
v_accvgpr_read_b32 v200, a32
v_accvgpr_read_b32 v201, a33
v_accvgpr_read_b32 v202, a34
v_accvgpr_read_b32 v203, a35
v_accvgpr_read_b32 v204, a36
v_accvgpr_read_b32 v205, a37
v_accvgpr_read_b32 v206, a38
v_accvgpr_read_b32 v207, a39
v_cvt_pk_bf16_f32 v200, v200, v201
v_cvt_pk_bf16_f32 v201, v202, v203
v_cvt_pk_bf16_f32 v202, v204, v205
v_cvt_pk_bf16_f32 v203, v206, v207
s_add_u32 s56, s56, 4096
buffer_store_dwordx4 v[200:203], v2, s[4:7], s56 offen offset:0
v_accvgpr_read_b32 v208, a40
v_accvgpr_read_b32 v209, a41
v_accvgpr_read_b32 v210, a42
v_accvgpr_read_b32 v211, a43
v_accvgpr_read_b32 v212, a44
v_accvgpr_read_b32 v213, a45
v_accvgpr_read_b32 v214, a46
v_accvgpr_read_b32 v215, a47
v_cvt_pk_bf16_f32 v208, v208, v209
v_cvt_pk_bf16_f32 v209, v210, v211
v_cvt_pk_bf16_f32 v210, v212, v213
v_cvt_pk_bf16_f32 v211, v214, v215
buffer_store_dwordx4 v[208:211], v2, s[4:7], s56 offen offset:1024
v_accvgpr_read_b32 v216, a48
v_accvgpr_read_b32 v217, a49
v_accvgpr_read_b32 v218, a50
v_accvgpr_read_b32 v219, a51
v_accvgpr_read_b32 v220, a52
v_accvgpr_read_b32 v221, a53
v_accvgpr_read_b32 v222, a54
v_accvgpr_read_b32 v223, a55
v_cvt_pk_bf16_f32 v216, v216, v217
v_cvt_pk_bf16_f32 v217, v218, v219
v_cvt_pk_bf16_f32 v218, v220, v221
v_cvt_pk_bf16_f32 v219, v222, v223
buffer_store_dwordx4 v[216:219], v2, s[4:7], s56 offen offset:2048
v_accvgpr_read_b32 v224, a56
v_accvgpr_read_b32 v225, a57
v_accvgpr_read_b32 v226, a58
v_accvgpr_read_b32 v227, a59
v_accvgpr_read_b32 v228, a60
v_accvgpr_read_b32 v229, a61
v_accvgpr_read_b32 v230, a62
v_accvgpr_read_b32 v231, a63
v_cvt_pk_bf16_f32 v224, v224, v225
v_cvt_pk_bf16_f32 v225, v226, v227
v_cvt_pk_bf16_f32 v226, v228, v229
v_cvt_pk_bf16_f32 v227, v230, v231
buffer_store_dwordx4 v[224:227], v2, s[4:7], s56 offen offset:3072
v_accvgpr_read_b32 v200, a64
v_accvgpr_read_b32 v201, a65
v_accvgpr_read_b32 v202, a66
v_accvgpr_read_b32 v203, a67
v_accvgpr_read_b32 v204, a68
v_accvgpr_read_b32 v205, a69
v_accvgpr_read_b32 v206, a70
v_accvgpr_read_b32 v207, a71
v_cvt_pk_bf16_f32 v200, v200, v201
v_cvt_pk_bf16_f32 v201, v202, v203
v_cvt_pk_bf16_f32 v202, v204, v205
v_cvt_pk_bf16_f32 v203, v206, v207
s_add_u32 s56, s56, 4096
buffer_store_dwordx4 v[200:203], v2, s[4:7], s56 offen offset:0
v_accvgpr_read_b32 v208, a72
v_accvgpr_read_b32 v209, a73
v_accvgpr_read_b32 v210, a74
v_accvgpr_read_b32 v211, a75
v_accvgpr_read_b32 v212, a76
v_accvgpr_read_b32 v213, a77
v_accvgpr_read_b32 v214, a78
v_accvgpr_read_b32 v215, a79
v_cvt_pk_bf16_f32 v208, v208, v209
v_cvt_pk_bf16_f32 v209, v210, v211
v_cvt_pk_bf16_f32 v210, v212, v213
v_cvt_pk_bf16_f32 v211, v214, v215
buffer_store_dwordx4 v[208:211], v2, s[4:7], s56 offen offset:1024
v_accvgpr_read_b32 v216, a80
v_accvgpr_read_b32 v217, a81
v_accvgpr_read_b32 v218, a82
v_accvgpr_read_b32 v219, a83
v_accvgpr_read_b32 v220, a84
v_accvgpr_read_b32 v221, a85
v_accvgpr_read_b32 v222, a86
v_accvgpr_read_b32 v223, a87
v_cvt_pk_bf16_f32 v216, v216, v217
v_cvt_pk_bf16_f32 v217, v218, v219
v_cvt_pk_bf16_f32 v218, v220, v221
v_cvt_pk_bf16_f32 v219, v222, v223
buffer_store_dwordx4 v[216:219], v2, s[4:7], s56 offen offset:2048
v_accvgpr_read_b32 v224, a88
v_accvgpr_read_b32 v225, a89
v_accvgpr_read_b32 v226, a90
v_accvgpr_read_b32 v227, a91
v_accvgpr_read_b32 v228, a92
v_accvgpr_read_b32 v229, a93
v_accvgpr_read_b32 v230, a94
v_accvgpr_read_b32 v231, a95
v_cvt_pk_bf16_f32 v224, v224, v225
v_cvt_pk_bf16_f32 v225, v226, v227
v_cvt_pk_bf16_f32 v226, v228, v229
v_cvt_pk_bf16_f32 v227, v230, v231
buffer_store_dwordx4 v[224:227], v2, s[4:7], s56 offen offset:3072
v_accvgpr_read_b32 v200, a96
v_accvgpr_read_b32 v201, a97
v_accvgpr_read_b32 v202, a98
v_accvgpr_read_b32 v203, a99
v_accvgpr_read_b32 v204, a100
v_accvgpr_read_b32 v205, a101
v_accvgpr_read_b32 v206, a102
v_accvgpr_read_b32 v207, a103
v_cvt_pk_bf16_f32 v200, v200, v201
v_cvt_pk_bf16_f32 v201, v202, v203
v_cvt_pk_bf16_f32 v202, v204, v205
v_cvt_pk_bf16_f32 v203, v206, v207
s_add_u32 s56, s56, 4096
buffer_store_dwordx4 v[200:203], v2, s[4:7], s56 offen offset:0
v_accvgpr_read_b32 v208, a104
v_accvgpr_read_b32 v209, a105
v_accvgpr_read_b32 v210, a106
v_accvgpr_read_b32 v211, a107
v_accvgpr_read_b32 v212, a108
v_accvgpr_read_b32 v213, a109
v_accvgpr_read_b32 v214, a110
v_accvgpr_read_b32 v215, a111
v_cvt_pk_bf16_f32 v208, v208, v209
v_cvt_pk_bf16_f32 v209, v210, v211
v_cvt_pk_bf16_f32 v210, v212, v213
v_cvt_pk_bf16_f32 v211, v214, v215
buffer_store_dwordx4 v[208:211], v2, s[4:7], s56 offen offset:1024
v_accvgpr_read_b32 v216, a112
v_accvgpr_read_b32 v217, a113
v_accvgpr_read_b32 v218, a114
v_accvgpr_read_b32 v219, a115
v_accvgpr_read_b32 v220, a116
v_accvgpr_read_b32 v221, a117
v_accvgpr_read_b32 v222, a118
v_accvgpr_read_b32 v223, a119
v_cvt_pk_bf16_f32 v216, v216, v217
v_cvt_pk_bf16_f32 v217, v218, v219
v_cvt_pk_bf16_f32 v218, v220, v221
v_cvt_pk_bf16_f32 v219, v222, v223
buffer_store_dwordx4 v[216:219], v2, s[4:7], s56 offen offset:2048
v_accvgpr_read_b32 v224, a120
v_accvgpr_read_b32 v225, a121
v_accvgpr_read_b32 v226, a122
v_accvgpr_read_b32 v227, a123
v_accvgpr_read_b32 v228, a124
v_accvgpr_read_b32 v229, a125
v_accvgpr_read_b32 v230, a126
v_accvgpr_read_b32 v231, a127
v_cvt_pk_bf16_f32 v224, v224, v225
v_cvt_pk_bf16_f32 v225, v226, v227
v_cvt_pk_bf16_f32 v226, v228, v229
v_cvt_pk_bf16_f32 v227, v230, v231
buffer_store_dwordx4 v[224:227], v2, s[4:7], s56 offen offset:3072
s_branch k2_pubdn
k2_pubwt:
buffer_store_dwordx2 v[12:13], v14, s[4:7], s58 offen sc1
v_accvgpr_read_b32 v200, a0
v_accvgpr_read_b32 v201, a1
v_accvgpr_read_b32 v202, a2
v_accvgpr_read_b32 v203, a3
v_accvgpr_read_b32 v204, a4
v_accvgpr_read_b32 v205, a5
v_accvgpr_read_b32 v206, a6
v_accvgpr_read_b32 v207, a7
v_cvt_pk_bf16_f32 v200, v200, v201
v_cvt_pk_bf16_f32 v201, v202, v203
v_cvt_pk_bf16_f32 v202, v204, v205
v_cvt_pk_bf16_f32 v203, v206, v207
buffer_store_dwordx4 v[200:203], v2, s[4:7], s56 offen offset:0 sc1
v_accvgpr_read_b32 v208, a8
v_accvgpr_read_b32 v209, a9
v_accvgpr_read_b32 v210, a10
v_accvgpr_read_b32 v211, a11
v_accvgpr_read_b32 v212, a12
v_accvgpr_read_b32 v213, a13
v_accvgpr_read_b32 v214, a14
v_accvgpr_read_b32 v215, a15
v_cvt_pk_bf16_f32 v208, v208, v209
v_cvt_pk_bf16_f32 v209, v210, v211
v_cvt_pk_bf16_f32 v210, v212, v213
v_cvt_pk_bf16_f32 v211, v214, v215
buffer_store_dwordx4 v[208:211], v2, s[4:7], s56 offen offset:1024 sc1
v_accvgpr_read_b32 v216, a16
v_accvgpr_read_b32 v217, a17
v_accvgpr_read_b32 v218, a18
v_accvgpr_read_b32 v219, a19
v_accvgpr_read_b32 v220, a20
v_accvgpr_read_b32 v221, a21
v_accvgpr_read_b32 v222, a22
v_accvgpr_read_b32 v223, a23
v_cvt_pk_bf16_f32 v216, v216, v217
v_cvt_pk_bf16_f32 v217, v218, v219
v_cvt_pk_bf16_f32 v218, v220, v221
v_cvt_pk_bf16_f32 v219, v222, v223
buffer_store_dwordx4 v[216:219], v2, s[4:7], s56 offen offset:2048 sc1
v_accvgpr_read_b32 v224, a24
v_accvgpr_read_b32 v225, a25
v_accvgpr_read_b32 v226, a26
v_accvgpr_read_b32 v227, a27
v_accvgpr_read_b32 v228, a28
v_accvgpr_read_b32 v229, a29
v_accvgpr_read_b32 v230, a30
v_accvgpr_read_b32 v231, a31
v_cvt_pk_bf16_f32 v224, v224, v225
v_cvt_pk_bf16_f32 v225, v226, v227
v_cvt_pk_bf16_f32 v226, v228, v229
v_cvt_pk_bf16_f32 v227, v230, v231
buffer_store_dwordx4 v[224:227], v2, s[4:7], s56 offen offset:3072 sc1
v_accvgpr_read_b32 v200, a32
v_accvgpr_read_b32 v201, a33
v_accvgpr_read_b32 v202, a34
v_accvgpr_read_b32 v203, a35
v_accvgpr_read_b32 v204, a36
v_accvgpr_read_b32 v205, a37
v_accvgpr_read_b32 v206, a38
v_accvgpr_read_b32 v207, a39
v_cvt_pk_bf16_f32 v200, v200, v201
v_cvt_pk_bf16_f32 v201, v202, v203
v_cvt_pk_bf16_f32 v202, v204, v205
v_cvt_pk_bf16_f32 v203, v206, v207
s_add_u32 s56, s56, 4096
buffer_store_dwordx4 v[200:203], v2, s[4:7], s56 offen offset:0 sc1
v_accvgpr_read_b32 v208, a40
v_accvgpr_read_b32 v209, a41
v_accvgpr_read_b32 v210, a42
v_accvgpr_read_b32 v211, a43
v_accvgpr_read_b32 v212, a44
v_accvgpr_read_b32 v213, a45
v_accvgpr_read_b32 v214, a46
v_accvgpr_read_b32 v215, a47
v_cvt_pk_bf16_f32 v208, v208, v209
v_cvt_pk_bf16_f32 v209, v210, v211
v_cvt_pk_bf16_f32 v210, v212, v213
v_cvt_pk_bf16_f32 v211, v214, v215
buffer_store_dwordx4 v[208:211], v2, s[4:7], s56 offen offset:1024 sc1
v_accvgpr_read_b32 v216, a48
v_accvgpr_read_b32 v217, a49
v_accvgpr_read_b32 v218, a50
v_accvgpr_read_b32 v219, a51
v_accvgpr_read_b32 v220, a52
v_accvgpr_read_b32 v221, a53
v_accvgpr_read_b32 v222, a54
v_accvgpr_read_b32 v223, a55
v_cvt_pk_bf16_f32 v216, v216, v217
v_cvt_pk_bf16_f32 v217, v218, v219
v_cvt_pk_bf16_f32 v218, v220, v221
v_cvt_pk_bf16_f32 v219, v222, v223
buffer_store_dwordx4 v[216:219], v2, s[4:7], s56 offen offset:2048 sc1
v_accvgpr_read_b32 v224, a56
v_accvgpr_read_b32 v225, a57
v_accvgpr_read_b32 v226, a58
v_accvgpr_read_b32 v227, a59
v_accvgpr_read_b32 v228, a60
v_accvgpr_read_b32 v229, a61
v_accvgpr_read_b32 v230, a62
v_accvgpr_read_b32 v231, a63
v_cvt_pk_bf16_f32 v224, v224, v225
v_cvt_pk_bf16_f32 v225, v226, v227
v_cvt_pk_bf16_f32 v226, v228, v229
v_cvt_pk_bf16_f32 v227, v230, v231
buffer_store_dwordx4 v[224:227], v2, s[4:7], s56 offen offset:3072 sc1
v_accvgpr_read_b32 v200, a64
v_accvgpr_read_b32 v201, a65
v_accvgpr_read_b32 v202, a66
v_accvgpr_read_b32 v203, a67
v_accvgpr_read_b32 v204, a68
v_accvgpr_read_b32 v205, a69
v_accvgpr_read_b32 v206, a70
v_accvgpr_read_b32 v207, a71
v_cvt_pk_bf16_f32 v200, v200, v201
v_cvt_pk_bf16_f32 v201, v202, v203
v_cvt_pk_bf16_f32 v202, v204, v205
v_cvt_pk_bf16_f32 v203, v206, v207
s_add_u32 s56, s56, 4096
buffer_store_dwordx4 v[200:203], v2, s[4:7], s56 offen offset:0 sc1
v_accvgpr_read_b32 v208, a72
v_accvgpr_read_b32 v209, a73
v_accvgpr_read_b32 v210, a74
v_accvgpr_read_b32 v211, a75
v_accvgpr_read_b32 v212, a76
v_accvgpr_read_b32 v213, a77
v_accvgpr_read_b32 v214, a78
v_accvgpr_read_b32 v215, a79
v_cvt_pk_bf16_f32 v208, v208, v209
v_cvt_pk_bf16_f32 v209, v210, v211
v_cvt_pk_bf16_f32 v210, v212, v213
v_cvt_pk_bf16_f32 v211, v214, v215
buffer_store_dwordx4 v[208:211], v2, s[4:7], s56 offen offset:1024 sc1
v_accvgpr_read_b32 v216, a80
v_accvgpr_read_b32 v217, a81
v_accvgpr_read_b32 v218, a82
v_accvgpr_read_b32 v219, a83
v_accvgpr_read_b32 v220, a84
v_accvgpr_read_b32 v221, a85
v_accvgpr_read_b32 v222, a86
v_accvgpr_read_b32 v223, a87
v_cvt_pk_bf16_f32 v216, v216, v217
v_cvt_pk_bf16_f32 v217, v218, v219
v_cvt_pk_bf16_f32 v218, v220, v221
v_cvt_pk_bf16_f32 v219, v222, v223
buffer_store_dwordx4 v[216:219], v2, s[4:7], s56 offen offset:2048 sc1
v_accvgpr_read_b32 v224, a88
v_accvgpr_read_b32 v225, a89
v_accvgpr_read_b32 v226, a90
v_accvgpr_read_b32 v227, a91
v_accvgpr_read_b32 v228, a92
v_accvgpr_read_b32 v229, a93
v_accvgpr_read_b32 v230, a94
v_accvgpr_read_b32 v231, a95
v_cvt_pk_bf16_f32 v224, v224, v225
v_cvt_pk_bf16_f32 v225, v226, v227
v_cvt_pk_bf16_f32 v226, v228, v229
v_cvt_pk_bf16_f32 v227, v230, v231
buffer_store_dwordx4 v[224:227], v2, s[4:7], s56 offen offset:3072 sc1
v_accvgpr_read_b32 v200, a96
v_accvgpr_read_b32 v201, a97
v_accvgpr_read_b32 v202, a98
v_accvgpr_read_b32 v203, a99
v_accvgpr_read_b32 v204, a100
v_accvgpr_read_b32 v205, a101
v_accvgpr_read_b32 v206, a102
v_accvgpr_read_b32 v207, a103
v_cvt_pk_bf16_f32 v200, v200, v201
v_cvt_pk_bf16_f32 v201, v202, v203
v_cvt_pk_bf16_f32 v202, v204, v205
v_cvt_pk_bf16_f32 v203, v206, v207
s_add_u32 s56, s56, 4096
buffer_store_dwordx4 v[200:203], v2, s[4:7], s56 offen offset:0 sc1
v_accvgpr_read_b32 v208, a104
v_accvgpr_read_b32 v209, a105
v_accvgpr_read_b32 v210, a106
v_accvgpr_read_b32 v211, a107
v_accvgpr_read_b32 v212, a108
v_accvgpr_read_b32 v213, a109
v_accvgpr_read_b32 v214, a110
v_accvgpr_read_b32 v215, a111
v_cvt_pk_bf16_f32 v208, v208, v209
v_cvt_pk_bf16_f32 v209, v210, v211
v_cvt_pk_bf16_f32 v210, v212, v213
v_cvt_pk_bf16_f32 v211, v214, v215
buffer_store_dwordx4 v[208:211], v2, s[4:7], s56 offen offset:1024 sc1
v_accvgpr_read_b32 v216, a112
v_accvgpr_read_b32 v217, a113
v_accvgpr_read_b32 v218, a114
v_accvgpr_read_b32 v219, a115
v_accvgpr_read_b32 v220, a116
v_accvgpr_read_b32 v221, a117
v_accvgpr_read_b32 v222, a118
v_accvgpr_read_b32 v223, a119
v_cvt_pk_bf16_f32 v216, v216, v217
v_cvt_pk_bf16_f32 v217, v218, v219
v_cvt_pk_bf16_f32 v218, v220, v221
v_cvt_pk_bf16_f32 v219, v222, v223
buffer_store_dwordx4 v[216:219], v2, s[4:7], s56 offen offset:2048 sc1
v_accvgpr_read_b32 v224, a120
v_accvgpr_read_b32 v225, a121
v_accvgpr_read_b32 v226, a122
v_accvgpr_read_b32 v227, a123
v_accvgpr_read_b32 v228, a124
v_accvgpr_read_b32 v229, a125
v_accvgpr_read_b32 v230, a126
v_accvgpr_read_b32 v231, a127
v_cvt_pk_bf16_f32 v224, v224, v225
v_cvt_pk_bf16_f32 v225, v226, v227
v_cvt_pk_bf16_f32 v226, v228, v229
v_cvt_pk_bf16_f32 v227, v230, v231
buffer_store_dwordx4 v[224:227], v2, s[4:7], s56 offen offset:3072 sc1
k2_pubdn:
v_accvgpr_mov_b32 a128, a192
v_accvgpr_mov_b32 a129, a193
v_accvgpr_mov_b32 a130, a194
v_accvgpr_mov_b32 a131, a195
v_accvgpr_mov_b32 a132, a196
v_accvgpr_mov_b32 a133, a197
v_accvgpr_mov_b32 a134, a198
v_accvgpr_mov_b32 a135, a199
v_accvgpr_mov_b32 a136, a200
v_accvgpr_mov_b32 a137, a201
v_accvgpr_mov_b32 a138, a202
v_accvgpr_mov_b32 a139, a203
v_accvgpr_mov_b32 a140, a204
v_accvgpr_mov_b32 a141, a205
v_accvgpr_mov_b32 a142, a206
v_accvgpr_mov_b32 a143, a207
v_accvgpr_mov_b32 a144, a208
v_accvgpr_mov_b32 a145, a209
v_accvgpr_mov_b32 a146, a210
v_accvgpr_mov_b32 a147, a211
v_accvgpr_mov_b32 a148, a212
v_accvgpr_mov_b32 a149, a213
v_accvgpr_mov_b32 a150, a214
v_accvgpr_mov_b32 a151, a215
v_accvgpr_mov_b32 a152, a216
v_accvgpr_mov_b32 a153, a217
v_accvgpr_mov_b32 a154, a218
v_accvgpr_mov_b32 a155, a219
v_accvgpr_mov_b32 a156, a220
v_accvgpr_mov_b32 a157, a221
v_accvgpr_mov_b32 a158, a222
v_accvgpr_mov_b32 a159, a223
v_accvgpr_mov_b32 a160, a224
v_accvgpr_mov_b32 a161, a225
v_accvgpr_mov_b32 a162, a226
v_accvgpr_mov_b32 a163, a227
v_accvgpr_mov_b32 a164, a228
v_accvgpr_mov_b32 a165, a229
v_accvgpr_mov_b32 a166, a230
v_accvgpr_mov_b32 a167, a231
v_accvgpr_mov_b32 a168, a232
v_accvgpr_mov_b32 a169, a233
v_accvgpr_mov_b32 a170, a234
v_accvgpr_mov_b32 a171, a235
v_accvgpr_mov_b32 a172, a236
v_accvgpr_mov_b32 a173, a237
v_accvgpr_mov_b32 a174, a238
v_accvgpr_mov_b32 a175, a239
v_accvgpr_mov_b32 a176, a240
v_accvgpr_mov_b32 a177, a241
v_accvgpr_mov_b32 a178, a242
v_accvgpr_mov_b32 a179, a243
v_accvgpr_mov_b32 a180, a244
v_accvgpr_mov_b32 a181, a245
v_accvgpr_mov_b32 a182, a246
v_accvgpr_mov_b32 a183, a247
v_accvgpr_mov_b32 a184, a248
v_accvgpr_mov_b32 a185, a249
v_accvgpr_mov_b32 a186, a250
v_accvgpr_mov_b32 a187, a251
v_accvgpr_mov_b32 a188, a252
v_accvgpr_mov_b32 a189, a253
v_accvgpr_mov_b32 a190, a254
v_accvgpr_mov_b32 a191, a255
s_mov_b32 s36, 1
s_mov_b32 s37, 1
s_mov_b32 s31, 0
s_sub_u32 s38, 30, s38
s_lshl_b32 s32, s17, 2
s_add_u32 s32, s32, s18
s_nop 1
s_branch k2_seg
k2_hbF:
s_waitcnt vmcnt(4)
s_barrier
s_lshl_b32 s56, s41, 7
s_add_u32 s56, s56, 59777024
v_mov_b32 v199, 0
s_mov_b32 s55, s56
buffer_load_dword v198, v199, s[4:7], s56 offen sc1
s_nop 7
s_nop 3
ds_read_b128 v[96:99], v4 offset:0
ds_read_b128 v[100:103], v4 offset:2048
ds_read_b128 v[104:107], v4 offset:4096
ds_read_b128 v[108:111], v4 offset:6144
ds_read_b128 v[112:115], v4 offset:8192
ds_read_b128 v[116:119], v4 offset:10240
ds_read_b128 v[120:123], v4 offset:12288
ds_read_b128 v[124:127], v4 offset:14336
s_cmp_ge_u32 s31, s32
s_cbranch_scc0 k2_hbF_nomask
s_sub_u32 s33, s32, s31
s_lshl_b32 s33, s33, 5
v_add_u32 v9, s33, v5
v_cmp_gt_i32 vcc, 0, v9
v_cndmask_b32 v32, v32, v8, vcc
v_cmp_gt_i32 vcc, 1, v9
v_cndmask_b32 v33, v33, v8, vcc
v_cmp_gt_i32 vcc, 2, v9
v_cndmask_b32 v34, v34, v8, vcc
v_cmp_gt_i32 vcc, 3, v9
v_cndmask_b32 v35, v35, v8, vcc
v_cmp_gt_i32 vcc, 8, v9
v_cndmask_b32 v36, v36, v8, vcc
v_cmp_gt_i32 vcc, 9, v9
v_cndmask_b32 v37, v37, v8, vcc
v_cmp_gt_i32 vcc, 10, v9
v_cndmask_b32 v38, v38, v8, vcc
v_cmp_gt_i32 vcc, 11, v9
v_cndmask_b32 v39, v39, v8, vcc
v_cmp_gt_i32 vcc, 16, v9
v_cndmask_b32 v40, v40, v8, vcc
v_cmp_gt_i32 vcc, 17, v9
v_cndmask_b32 v41, v41, v8, vcc
v_cmp_gt_i32 vcc, 18, v9
v_cndmask_b32 v42, v42, v8, vcc
v_cmp_gt_i32 vcc, 19, v9
v_cndmask_b32 v43, v43, v8, vcc
v_cmp_gt_i32 vcc, 24, v9
v_cndmask_b32 v44, v44, v8, vcc
v_cmp_gt_i32 vcc, 25, v9
v_cndmask_b32 v45, v45, v8, vcc
v_cmp_gt_i32 vcc, 26, v9
v_cndmask_b32 v46, v46, v8, vcc
v_cmp_gt_i32 vcc, 27, v9
v_cndmask_b32 v47, v47, v8, vcc
k2_hbF_nomask:
s_waitcnt lgkmcnt(4)
v_mfma_f32_32x32x16_bf16 a[0:15], v[96:99], v[64:67], a[0:15]
ds_read_b128 v[128:131], v4 offset:1024
v_exp_f32 v80, v32
v_exp_f32 v81, v33
v_exp_f32 v82, v34
v_mfma_f32_32x32x16_bf16 a[16:31], v[100:103], v[64:67], a[16:31]
ds_read_b128 v[132:135], v4 offset:3072
v_exp_f32 v83, v35
v_cvt_pk_bf16_f32 v72, v80, v81
s_add_u32 m0, s48, 0
v_mfma_f32_32x32x16_bf16 a[32:47], v[104:107], v[64:67], a[32:47]
ds_read_b128 v[136:139], v4 offset:5120
v_add_f32 v7, v80, v81
v_exp_f32 v84, v36
v_exp_f32 v85, v37
v_mfma_f32_32x32x16_bf16 a[48:63], v[108:111], v[64:67], a[48:63]
ds_read_b128 v[140:143], v4 offset:7168
v_cvt_pk_bf16_f32 v73, v82, v83
v_add_f32 v15, v82, v83
s_mov_b32 s52, 0
s_waitcnt lgkmcnt(4)
v_mfma_f32_32x32x16_bf16 a[64:79], v[112:115], v[64:67], a[64:79]
ds_read_b128 v[144:147], v4 offset:9216
v_exp_f32 v86, v38
v_exp_f32 v87, v39
v_cvt_pk_bf16_f32 v74, v84, v85
v_mfma_f32_32x32x16_bf16 a[80:95], v[116:119], v[64:67], a[80:95]
ds_read_b128 v[148:151], v4 offset:11264
v_add_f32 v7, v7, v84
v_add_f32 v15, v15, v85
buffer_load_dwordx4 v188, s[12:15], s52 offen lds
v_mfma_f32_32x32x16_bf16 a[96:111], v[120:123], v[64:67], a[96:111]
ds_read_b128 v[152:155], v4 offset:13312
v_exp_f32 v88, v40
v_exp_f32 v89, v41
v_cvt_pk_bf16_f32 v75, v86, v87
v_mfma_f32_32x32x16_bf16 a[112:127], v[124:127], v[64:67], a[112:127]
ds_read_b128 v[156:159], v4 offset:15360
v_add_f32 v7, v7, v86
v_add_f32 v15, v15, v87
s_add_u32 m0, s48, 1024
s_waitcnt lgkmcnt(4)
v_mfma_f32_32x32x16_bf16 a[0:15], v[128:131], v[68:71], a[0:15]
s_add_u32 s29, s29, 16384
s_cmp_eq_u32 s29, 147456
s_cselect_b32 s29, 65536, s29
v_add_u32 v4, s29, v2
v_exp_f32 v90, v42
v_exp_f32 v91, v43
v_mfma_f32_32x32x16_bf16 a[16:31], v[132:135], v[68:71], a[16:31]
v_cvt_pk_bf16_f32 v76, v88, v89
v_add_f32 v7, v7, v88
v_add_f32 v15, v15, v89
buffer_load_dwordx4 v189, s[12:15], s52 offen lds
v_mfma_f32_32x32x16_bf16 a[32:47], v[136:139], v[68:71], a[32:47]
v_exp_f32 v92, v44
v_exp_f32 v93, v45
s_add_u32 m0, s48, 2048
s_nop 0
buffer_load_dwordx4 v190, s[12:15], s52 offen lds
v_mfma_f32_32x32x16_bf16 a[48:63], v[140:143], v[68:71], a[48:63]
v_cvt_pk_bf16_f32 v77, v90, v91
v_add_f32 v7, v7, v90
v_add_f32 v15, v15, v91
s_add_u32 m0, s48, 3072
s_waitcnt lgkmcnt(0)
v_mfma_f32_32x32x16_bf16 a[64:79], v[144:147], v[68:71], a[64:79]
v_exp_f32 v94, v46
v_exp_f32 v95, v47
buffer_load_dwordx4 v191, s[12:15], s52 offen lds
s_add_u32 m0, s48, 4096
v_mfma_f32_32x32x16_bf16 a[80:95], v[148:151], v[68:71], a[80:95]
v_cvt_pk_bf16_f32 v78, v92, v93
v_add_f32 v7, v7, v92
v_add_f32 v15, v15, v93
buffer_load_dwordx4 v192, s[12:15], s52 offen lds
v_mfma_f32_32x32x16_bf16 a[96:111], v[152:155], v[68:71], a[96:111]
v_cvt_pk_bf16_f32 v79, v94, v95
v_add_f32 v7, v7, v94
s_add_u32 m0, s48, 5120
s_nop 0
buffer_load_dwordx4 v193, s[12:15], s52 offen lds
v_mfma_f32_32x32x16_bf16 a[112:127], v[156:159], v[68:71], a[112:127]
v_add_f32 v15, v15, v95
v_add_f32 v7, v7, v15
s_add_u32 m0, s48, 6144
s_nop 0
buffer_load_dwordx4 v194, s[12:15], s52 offen lds
s_nop 2
v_cmp_nge_f32 vcc, s35, v7
s_cbranch_vccnz k2_rare4
k2_rareret4:
v_add_f32 v6, v6, v7
s_cmp_eq_u32 s100, 0
s_cbranch_scc1 k2_plB
s_waitcnt vmcnt(7)
v_readfirstlane_b32 s57, v198
s_nop 3
s_cmp_eq_u32 s57, s101
s_cbranch_scc0 k2_poll
k2_pollend:
v_sub_f32 v9, 0, v48
s_lshl_b32 s56, s41, 11
s_lshl_b32 s57, s18, 9
s_add_u32 s56, s56, s57
s_add_u32 s56, s56, 83886080
v_lshlrev_b32 v14, 3, v1
buffer_load_dwordx2 v[12:13], v14, s[4:7], s56 offen
s_lshl_b32 s54, s41, 16
s_lshl_b32 s57, s18, 14
s_add_u32 s54, s54, s57
s_add_u32 s54, s54, 67108864
buffer_load_dwordx4 v[16:19], v2, s[4:7], s54 offen offset:0
buffer_load_dwordx4 v[20:23], v2, s[4:7], s54 offen offset:1024
buffer_load_dwordx4 v[24:27], v2, s[4:7], s54 offen offset:2048
buffer_load_dwordx4 v[28:31], v2, s[4:7], s54 offen offset:3072
s_add_u32 s54, s54, 4096
buffer_load_dwordx4 v[32:35], v2, s[4:7], s54 offen offset:0
buffer_load_dwordx4 v[36:39], v2, s[4:7], s54 offen offset:1024
buffer_load_dwordx4 v[40:43], v2, s[4:7], s54 offen offset:2048
buffer_load_dwordx4 v[44:47], v2, s[4:7], s54 offen offset:3072
s_add_u32 s54, s54, 4096
buffer_load_dwordx4 v[48:51], v2, s[4:7], s54 offen offset:0
buffer_load_dwordx4 v[52:55], v2, s[4:7], s54 offen offset:1024
buffer_load_dwordx4 v[56:59], v2, s[4:7], s54 offen offset:2048
buffer_load_dwordx4 v[60:63], v2, s[4:7], s54 offen offset:3072
ds_read_b128 v[96:99], v4 offset:0
ds_read_b128 v[100:103], v4 offset:2048
ds_read_b128 v[104:107], v4 offset:4096
ds_read_b128 v[108:111], v4 offset:6144
ds_read_b128 v[112:115], v4 offset:8192
ds_read_b128 v[116:119], v4 offset:10240
ds_read_b128 v[120:123], v4 offset:12288
ds_read_b128 v[124:127], v4 offset:14336
s_waitcnt lgkmcnt(4)
v_mfma_f32_32x32x16_bf16 a[0:15], v[96:99], v[72:75], a[0:15]
ds_read_b128 v[128:131], v4 offset:1024
s_add_u32 m0, s48, 28672
v_mfma_f32_32x32x16_bf16 a[16:31], v[100:103], v[72:75], a[16:31]
ds_read_b128 v[132:135], v4 offset:3072
v_mfma_f32_32x32x16_bf16 a[32:47], v[104:107], v[72:75], a[32:47]
ds_read_b128 v[136:139], v4 offset:5120
s_mov_b32 s52, 0
v_mfma_f32_32x32x16_bf16 a[48:63], v[108:111], v[72:75], a[48:63]
ds_read_b128 v[140:143], v4 offset:7168
s_waitcnt lgkmcnt(4)
v_mfma_f32_32x32x16_bf16 a[64:79], v[112:115], v[72:75], a[64:79]
ds_read_b128 v[144:147], v4 offset:9216
buffer_load_dwordx4 v188, s[76:79], s52 offen lds
v_mfma_f32_32x32x16_bf16 a[80:95], v[116:119], v[72:75], a[80:95]
ds_read_b128 v[148:151], v4 offset:11264
v_mfma_f32_32x32x16_bf16 a[96:111], v[120:123], v[72:75], a[96:111]
ds_read_b128 v[152:155], v4 offset:13312
s_add_u32 m0, s48, 29696
v_mfma_f32_32x32x16_bf16 a[112:127], v[124:127], v[72:75], a[112:127]
ds_read_b128 v[156:159], v4 offset:15360
s_waitcnt lgkmcnt(4)
v_mfma_f32_32x32x16_bf16 a[0:15], v[128:131], v[76:79], a[0:15]
s_add_u32 s29, s29, 16384
s_cmp_eq_u32 s29, 147456
s_cselect_b32 s29, 65536, s29
v_add_u32 v4, s29, v2
v_mfma_f32_32x32x16_bf16 a[16:31], v[132:135], v[76:79], a[16:31]
buffer_load_dwordx4 v189, s[76:79], s52 offen lds
s_add_u32 m0, s48, 30720
v_mfma_f32_32x32x16_bf16 a[32:47], v[136:139], v[76:79], a[32:47]
buffer_load_dwordx4 v190, s[76:79], s52 offen lds
v_mfma_f32_32x32x16_bf16 a[48:63], v[140:143], v[76:79], a[48:63]
s_add_u32 m0, s48, 31744
s_nop 0
buffer_load_dwordx4 v191, s[76:79], s52 offen lds
s_waitcnt lgkmcnt(0)
v_mfma_f32_32x32x16_bf16 a[64:79], v[144:147], v[76:79], a[64:79]
s_add_u32 m0, s48, 32768
v_mfma_f32_32x32x16_bf16 a[80:95], v[148:151], v[76:79], a[80:95]
buffer_load_dwordx4 v192, s[76:79], s52 offen lds
s_add_u32 m0, s48, 33792
v_mfma_f32_32x32x16_bf16 a[96:111], v[152:155], v[76:79], a[96:111]
buffer_load_dwordx4 v193, s[76:79], s52 offen lds
v_mfma_f32_32x32x16_bf16 a[112:127], v[156:159], v[76:79], a[112:127]
s_add_u32 m0, s48, 34816
s_nop 0
buffer_load_dwordx4 v194, s[76:79], s52 offen lds
s_waitcnt lgkmcnt(0)
s_waitcnt vmcnt(20)
s_barrier
s_add_u32 s54, s54, 4096
buffer_load_dwordx4 v[64:67], v2, s[4:7], s54 offen offset:0
buffer_load_dwordx4 v[68:71], v2, s[4:7], s54 offen offset:1024
buffer_load_dwordx4 v[72:75], v2, s[4:7], s54 offen offset:2048
buffer_load_dwordx4 v[76:79], v2, s[4:7], s54 offen offset:3072
ds_read_b64_tr_b16 v[96:97], v195 offset:0
ds_read_b64_tr_b16 v[98:99], v195 offset:3584
ds_read_b64_tr_b16 v[100:101], v195 offset:64
ds_read_b64_tr_b16 v[102:103], v195 offset:3648
ds_read_b64_tr_b16 v[104:105], v195 offset:128
ds_read_b64_tr_b16 v[106:107], v195 offset:3712
ds_read_b64_tr_b16 v[108:109], v195 offset:192
ds_read_b64_tr_b16 v[110:111], v195 offset:3776
ds_read_b64_tr_b16 v[112:113], v195 offset:256
ds_read_b64_tr_b16 v[114:115], v195 offset:3840
ds_read_b64_tr_b16 v[116:117], v195 offset:320
ds_read_b64_tr_b16 v[118:119], v195 offset:3904
ds_read_b64_tr_b16 v[120:121], v195 offset:384
ds_read_b64_tr_b16 v[122:123], v195 offset:3968
ds_read_b64_tr_b16 v[124:125], v195 offset:7168
ds_read_b64_tr_b16 v[126:127], v195 offset:10752
s_waitcnt lgkmcnt(8)
v_mfma_f32_32x32x16_bf16 a[128:143], v[96:99], v[160:163], 0
ds_read_b64_tr_b16 v[128:129], v195 offset:7232
ds_read_b64_tr_b16 v[130:131], v195 offset:10816
s_waitcnt vmcnt(23)
v_max_f32 v10, v9, v12
v_sub_f32 v9, v9, v10
v_sub_f32 v12, v12, v10
v_exp_f32 v9, v9
v_exp_f32 v12, v12
s_nop 0
v_mul_f32 v6, v6, v9
v_fma_f32 v6, v13, v12, v6
v_mov_b32 v13, v6
s_nop 1
v_permlane32_swap_b32 v6, v13
s_nop 1
v_add_f32 v6, v6, v13
v_rcp_f32 v6, v6
s_nop 0
v_mul_f32 v6, v6, v11
v_mul_f32 v9, v9, v6
v_mul_f32 v12, v12, v6
v_mfma_f32_32x32x16_bf16 a[144:159], v[100:103], v[160:163], 0
ds_read_b64_tr_b16 v[132:133], v195 offset:7296
ds_read_b64_tr_b16 v[134:135], v195 offset:10880
s_add_u32 m0, s48, 57344
v_mfma_f32_32x32x16_bf16 a[160:175], v[104:107], v[160:163], 0
ds_read_b64_tr_b16 v[136:137], v195 offset:7360
ds_read_b64_tr_b16 v[138:139], v195 offset:10944
s_mov_b32 s52, 0
s_waitcnt vmcnt(22)
v_accvgpr_read_b32 v200, a0
v_accvgpr_read_b32 v201, a1
v_lshlrev_b32 v202, 16, v16
v_mfma_f32_32x32x16_bf16 a[176:191], v[108:111], v[160:163], 0
ds_read_b64_tr_b16 v[140:141], v195 offset:7424
ds_read_b64_tr_b16 v[142:143], v195 offset:11008
buffer_load_dwordx4 v188, s[8:11], s52 offen lds
s_add_u32 m0, s48, 58368
v_and_b32 v203, 0xffff0000, v16
v_mul_f32 v200, v9, v200
s_waitcnt lgkmcnt(8)
v_mfma_f32_32x32x16_bf16 a[192:207], v[112:115], v[160:163], 0
ds_read_b64_tr_b16 v[144:145], v195 offset:7488
ds_read_b64_tr_b16 v[146:147], v195 offset:11072
buffer_load_dwordx4 v189, s[8:11], s52 offen lds
v_mul_f32 v201, v9, v201
v_fma_f32 v200, v202, v12, v200
v_fma_f32 v201, v203, v12, v201
v_cvt_pk_bf16_f32 v16, v200, v201
v_mfma_f32_32x32x16_bf16 a[208:223], v[116:119], v[160:163], 0
ds_read_b64_tr_b16 v[148:149], v195 offset:7552
ds_read_b64_tr_b16 v[150:151], v195 offset:11136
s_add_u32 m0, s48, 59392
v_accvgpr_read_b32 v204, a2
v_accvgpr_read_b32 v205, a3
v_lshlrev_b32 v206, 16, v17
v_and_b32 v207, 0xffff0000, v17
v_mfma_f32_32x32x16_bf16 a[224:239], v[120:123], v[160:163], 0
ds_read_b64_tr_b16 v[152:153], v195 offset:14336
ds_read_b64_tr_b16 v[154:155], v195 offset:17920
buffer_load_dwordx4 v190, s[8:11], s52 offen lds
v_mul_f32 v204, v9, v204
v_mul_f32 v205, v9, v205
v_fma_f32 v204, v206, v12, v204
v_fma_f32 v205, v207, v12, v205
v_mfma_f32_32x32x16_bf16 a[128:143], v[124:127], v[164:167], a[128:143]
ds_read_b64_tr_b16 v[156:157], v195 offset:14400
ds_read_b64_tr_b16 v[158:159], v195 offset:17984
s_add_u32 m0, s48, 60416
v_cvt_pk_bf16_f32 v17, v204, v205
v_accvgpr_read_b32 v208, a4
v_accvgpr_read_b32 v209, a5
s_waitcnt lgkmcnt(8)
v_mfma_f32_32x32x16_bf16 a[144:159], v[128:131], v[164:167], a[144:159]
ds_read_b64_tr_b16 v[96:97], v195 offset:14464
ds_read_b64_tr_b16 v[98:99], v195 offset:18048
buffer_load_dwordx4 v191, s[8:11], s52 offen lds
v_lshlrev_b32 v210, 16, v18
v_and_b32 v211, 0xffff0000, v18
v_mul_f32 v208, v9, v208
v_mul_f32 v209, v9, v209
v_mfma_f32_32x32x16_bf16 a[160:175], v[132:135], v[164:167], a[160:175]
ds_read_b64_tr_b16 v[100:101], v195 offset:14528
ds_read_b64_tr_b16 v[102:103], v195 offset:18112
s_add_u32 m0, s48, 61440
s_nop 0
buffer_load_dwordx4 v192, s[8:11], s52 offen lds
v_fma_f32 v208, v210, v12, v208
v_fma_f32 v209, v211, v12, v209
v_cvt_pk_bf16_f32 v18, v208, v209
v_mfma_f32_32x32x16_bf16 a[176:191], v[136:139], v[164:167], a[176:191]
ds_read_b64_tr_b16 v[104:105], v195 offset:14592
ds_read_b64_tr_b16 v[106:107], v195 offset:18176
s_add_u32 m0, s48, 62464
v_accvgpr_read_b32 v212, a6
v_accvgpr_read_b32 v213, a7
v_lshlrev_b32 v214, 16, v19
v_mfma_f32_32x32x16_bf16 a[192:207], v[140:143], v[164:167], a[192:207]
ds_read_b64_tr_b16 v[108:109], v195 offset:14656
ds_read_b64_tr_b16 v[110:111], v195 offset:18240
buffer_load_dwordx4 v193, s[8:11], s52 offen lds
v_and_b32 v215, 0xffff0000, v19
v_mul_f32 v212, v9, v212
v_mul_f32 v213, v9, v213
v_fma_f32 v212, v214, v12, v212
s_waitcnt lgkmcnt(8)
v_mfma_f32_32x32x16_bf16 a[208:223], v[144:147], v[164:167], a[208:223]
ds_read_b64_tr_b16 v[112:113], v195 offset:14720
ds_read_b64_tr_b16 v[114:115], v195 offset:18304
s_add_u32 m0, s48, 63488
v_fma_f32 v213, v215, v12, v213
v_cvt_pk_bf16_f32 v19, v212, v213
s_waitcnt vmcnt(27)
v_accvgpr_read_b32 v200, a8
v_mfma_f32_32x32x16_bf16 a[224:239], v[148:151], v[164:167], a[224:239]
ds_read_b64_tr_b16 v[116:117], v195 offset:21504
ds_read_b64_tr_b16 v[118:119], v195 offset:25088
buffer_load_dwordx4 v194, s[8:11], s52 offen lds
v_accvgpr_read_b32 v201, a9
v_lshlrev_b32 v202, 16, v20
v_and_b32 v203, 0xffff0000, v20
v_mfma_f32_32x32x16_bf16 a[128:143], v[152:155], v[168:171], a[128:143]
ds_read_b64_tr_b16 v[120:121], v195 offset:21568
ds_read_b64_tr_b16 v[122:123], v195 offset:25152
s_add_u32 m0, s48, 86016
s_mov_b32 s52, 57344
v_mul_f32 v200, v9, v200
v_mul_f32 v201, v9, v201
v_fma_f32 v200, v202, v12, v200
v_mfma_f32_32x32x16_bf16 a[144:159], v[156:159], v[168:171], a[144:159]
ds_read_b64_tr_b16 v[124:125], v195 offset:21632
ds_read_b64_tr_b16 v[126:127], v195 offset:25216
buffer_load_dwordx4 v188, s[8:11], s52 offen lds
v_fma_f32 v201, v203, v12, v201
v_cvt_pk_bf16_f32 v20, v200, v201
v_accvgpr_read_b32 v204, a10
v_accvgpr_read_b32 v205, a11
s_waitcnt lgkmcnt(8)
v_mfma_f32_32x32x16_bf16 a[160:175], v[96:99], v[168:171], a[160:175]
ds_read_b64_tr_b16 v[128:129], v195 offset:21696
ds_read_b64_tr_b16 v[130:131], v195 offset:25280
s_add_u32 m0, s48, 87040
v_lshlrev_b32 v206, 16, v21
v_and_b32 v207, 0xffff0000, v21
v_mul_f32 v204, v9, v204
v_mul_f32 v205, v9, v205
v_mfma_f32_32x32x16_bf16 a[176:191], v[100:103], v[168:171], a[176:191]
ds_read_b64_tr_b16 v[132:133], v195 offset:21760
ds_read_b64_tr_b16 v[134:135], v195 offset:25344
buffer_load_dwordx4 v189, s[8:11], s52 offen lds
v_fma_f32 v204, v206, v12, v204
v_fma_f32 v205, v207, v12, v205
v_cvt_pk_bf16_f32 v21, v204, v205
v_mfma_f32_32x32x16_bf16 a[192:207], v[104:107], v[168:171], a[192:207]
ds_read_b64_tr_b16 v[136:137], v195 offset:21824
ds_read_b64_tr_b16 v[138:139], v195 offset:25408
s_add_u32 m0, s48, 88064
v_accvgpr_read_b32 v208, a12
v_accvgpr_read_b32 v209, a13
v_lshlrev_b32 v210, 16, v22
v_and_b32 v211, 0xffff0000, v22
v_mfma_f32_32x32x16_bf16 a[208:223], v[108:111], v[168:171], a[208:223]
ds_read_b64_tr_b16 v[140:141], v195 offset:21888
ds_read_b64_tr_b16 v[142:143], v195 offset:25472
v_mul_f32 v208, v9, v208
v_mul_f32 v209, v9, v209
v_fma_f32 v208, v210, v12, v208
v_fma_f32 v209, v211, v12, v209
s_waitcnt vmcnt(13)
s_barrier
s_waitcnt lgkmcnt(8)
v_mfma_f32_32x32x16_bf16 a[224:239], v[112:115], v[168:171], a[224:239]
ds_read_b64_tr_b16 v[144:145], v195 offset:28672
ds_read_b64_tr_b16 v[146:147], v195 offset:32256
buffer_load_dwordx4 v190, s[8:11], s52 offen lds
s_add_u32 m0, s48, 89088
v_cvt_pk_bf16_f32 v22, v208, v209
v_accvgpr_read_b32 v212, a14
v_mfma_f32_32x32x16_bf16 a[128:143], v[116:119], v[172:175], a[128:143]
ds_read_b64_tr_b16 v[148:149], v195 offset:28736
ds_read_b64_tr_b16 v[150:151], v195 offset:32320
buffer_load_dwordx4 v191, s[8:11], s52 offen lds
v_accvgpr_read_b32 v213, a15
v_lshlrev_b32 v214, 16, v23
v_and_b32 v215, 0xffff0000, v23
v_mul_f32 v212, v9, v212
v_mfma_f32_32x32x16_bf16 a[144:159], v[120:123], v[172:175], a[144:159]
ds_read_b64_tr_b16 v[152:153], v195 offset:28800
ds_read_b64_tr_b16 v[154:155], v195 offset:32384
s_add_u32 m0, s48, 90112
v_mul_f32 v213, v9, v213
v_fma_f32 v212, v214, v12, v212
v_fma_f32 v213, v215, v12, v213
v_cvt_pk_bf16_f32 v23, v212, v213
v_mfma_f32_32x32x16_bf16 a[160:175], v[124:127], v[172:175], a[160:175]
ds_read_b64_tr_b16 v[156:157], v195 offset:28864
ds_read_b64_tr_b16 v[158:159], v195 offset:32448
buffer_load_dwordx4 v192, s[8:11], s52 offen lds
s_waitcnt vmcnt(32)
v_accvgpr_read_b32 v200, a16
v_accvgpr_read_b32 v201, a17
v_lshlrev_b32 v202, 16, v24
s_waitcnt lgkmcnt(8)
v_mfma_f32_32x32x16_bf16 a[176:191], v[128:131], v[172:175], a[176:191]
ds_read_b64_tr_b16 v[96:97], v195 offset:28928
ds_read_b64_tr_b16 v[98:99], v195 offset:32512
s_add_u32 m0, s48, 91136
v_and_b32 v203, 0xffff0000, v24
v_mul_f32 v200, v9, v200
v_mul_f32 v201, v9, v201
v_mfma_f32_32x32x16_bf16 a[192:207], v[132:135], v[172:175], a[192:207]
ds_read_b64_tr_b16 v[100:101], v195 offset:28992
ds_read_b64_tr_b16 v[102:103], v195 offset:32576
buffer_load_dwordx4 v193, s[8:11], s52 offen lds
v_fma_f32 v200, v202, v12, v200
v_fma_f32 v201, v203, v12, v201
v_cvt_pk_bf16_f32 v24, v200, v201
v_accvgpr_read_b32 v204, a18
v_mfma_f32_32x32x16_bf16 a[208:223], v[136:139], v[172:175], a[208:223]
ds_read_b64_tr_b16 v[104:105], v195 offset:29056
ds_read_b64_tr_b16 v[106:107], v195 offset:32640
s_add_u32 m0, s48, 92160
s_nop 0
buffer_load_dwordx4 v194, s[8:11], s52 offen lds
v_accvgpr_read_b32 v205, a19
v_lshlrev_b32 v206, 16, v25
v_and_b32 v207, 0xffff0000, v25
v_mfma_f32_32x32x16_bf16 a[224:239], v[140:143], v[172:175], a[224:239]
ds_read_b64_tr_b16 v[108:109], v195 offset:35840
ds_read_b64_tr_b16 v[110:111], v195 offset:39424
s_add_u32 m0, s48, 114688
v_mul_f32 v204, v9, v204
v_mul_f32 v205, v9, v205
v_fma_f32 v204, v206, v12, v204
s_waitcnt lgkmcnt(8)
v_mfma_f32_32x32x16_bf16 a[128:143], v[144:147], v[176:179], a[128:143]
ds_read_b64_tr_b16 v[112:113], v195 offset:35904
ds_read_b64_tr_b16 v[114:115], v195 offset:39488
s_mov_b32 s52, 114688
v_fma_f32 v205, v207, v12, v205
v_cvt_pk_bf16_f32 v25, v204, v205
v_accvgpr_read_b32 v208, a20
v_accvgpr_read_b32 v209, a21
v_mfma_f32_32x32x16_bf16 a[144:159], v[148:151], v[176:179], a[144:159]
ds_read_b64_tr_b16 v[116:117], v195 offset:35968
ds_read_b64_tr_b16 v[118:119], v195 offset:39552
buffer_load_dwordx4 v188, s[8:11], s52 offen lds
v_lshlrev_b32 v210, 16, v26
v_and_b32 v211, 0xffff0000, v26
v_mul_f32 v208, v9, v208
v_mul_f32 v209, v9, v209
v_mfma_f32_32x32x16_bf16 a[160:175], v[152:155], v[176:179], a[160:175]
ds_read_b64_tr_b16 v[120:121], v195 offset:36032
ds_read_b64_tr_b16 v[122:123], v195 offset:39616
s_add_u32 m0, s48, 115712
v_fma_f32 v208, v210, v12, v208
v_fma_f32 v209, v211, v12, v209
v_cvt_pk_bf16_f32 v26, v208, v209
v_mfma_f32_32x32x16_bf16 a[176:191], v[156:159], v[176:179], a[176:191]
ds_read_b64_tr_b16 v[124:125], v195 offset:36096
ds_read_b64_tr_b16 v[126:127], v195 offset:39680
buffer_load_dwordx4 v189, s[8:11], s52 offen lds
s_add_u32 m0, s48, 116736
v_accvgpr_read_b32 v212, a22
v_accvgpr_read_b32 v213, a23
v_lshlrev_b32 v214, 16, v27
s_waitcnt lgkmcnt(8)
v_mfma_f32_32x32x16_bf16 a[192:207], v[96:99], v[176:179], a[192:207]
ds_read_b64_tr_b16 v[128:129], v195 offset:36160
ds_read_b64_tr_b16 v[130:131], v195 offset:39744
buffer_load_dwordx4 v190, s[8:11], s52 offen lds
v_and_b32 v215, 0xffff0000, v27
v_mul_f32 v212, v9, v212
v_mul_f32 v213, v9, v213
v_fma_f32 v212, v214, v12, v212
v_mfma_f32_32x32x16_bf16 a[208:223], v[100:103], v[176:179], a[208:223]
ds_read_b64_tr_b16 v[132:133], v195 offset:36224
ds_read_b64_tr_b16 v[134:135], v195 offset:39808
s_add_u32 m0, s48, 117760
v_fma_f32 v213, v215, v12, v213
v_cvt_pk_bf16_f32 v27, v212, v213
s_waitcnt vmcnt(36)
v_accvgpr_read_b32 v200, a24
v_mfma_f32_32x32x16_bf16 a[224:239], v[104:107], v[176:179], a[224:239]
ds_read_b64_tr_b16 v[136:137], v195 offset:43008
ds_read_b64_tr_b16 v[138:139], v195 offset:46592
buffer_load_dwordx4 v191, s[8:11], s52 offen lds
v_accvgpr_read_b32 v201, a25
v_lshlrev_b32 v202, 16, v28
v_and_b32 v203, 0xffff0000, v28
v_mfma_f32_32x32x16_bf16 a[128:143], v[108:111], v[180:183], a[128:143]
ds_read_b64_tr_b16 v[140:141], v195 offset:43072
ds_read_b64_tr_b16 v[142:143], v195 offset:46656
s_add_u32 m0, s48, 118784
v_mul_f32 v200, v9, v200
v_mul_f32 v201, v9, v201
v_fma_f32 v200, v202, v12, v200
v_fma_f32 v201, v203, v12, v201
s_waitcnt lgkmcnt(8)
v_mfma_f32_32x32x16_bf16 a[144:159], v[112:115], v[180:183], a[144:159]
ds_read_b64_tr_b16 v[144:145], v195 offset:43136
ds_read_b64_tr_b16 v[146:147], v195 offset:46720
buffer_load_dwordx4 v192, s[8:11], s52 offen lds
v_cvt_pk_bf16_f32 v28, v200, v201
v_accvgpr_read_b32 v204, a26
v_accvgpr_read_b32 v205, a27
v_lshlrev_b32 v206, 16, v29
v_mfma_f32_32x32x16_bf16 a[160:175], v[116:119], v[180:183], a[160:175]
ds_read_b64_tr_b16 v[148:149], v195 offset:43200
ds_read_b64_tr_b16 v[150:151], v195 offset:46784
s_add_u32 m0, s48, 119808
s_nop 0
buffer_load_dwordx4 v193, s[8:11], s52 offen lds
v_and_b32 v207, 0xffff0000, v29
v_mul_f32 v204, v9, v204
v_mfma_f32_32x32x16_bf16 a[176:191], v[120:123], v[180:183], a[176:191]
ds_read_b64_tr_b16 v[152:153], v195 offset:43264
ds_read_b64_tr_b16 v[154:155], v195 offset:46848
s_add_u32 m0, s48, 120832
v_mul_f32 v205, v9, v205
v_fma_f32 v204, v206, v12, v204
v_fma_f32 v205, v207, v12, v205
v_cvt_pk_bf16_f32 v29, v204, v205
v_mfma_f32_32x32x16_bf16 a[192:207], v[124:127], v[180:183], a[192:207]
ds_read_b64_tr_b16 v[156:157], v195 offset:43328
ds_read_b64_tr_b16 v[158:159], v195 offset:46912
buffer_load_dwordx4 v194, s[8:11], s52 offen lds
v_accvgpr_read_b32 v208, a28
v_accvgpr_read_b32 v209, a29
v_lshlrev_b32 v210, 16, v30
v_and_b32 v211, 0xffff0000, v30
s_waitcnt lgkmcnt(8)
v_mfma_f32_32x32x16_bf16 a[208:223], v[128:131], v[180:183], a[208:223]
ds_read_b64_tr_b16 v[96:97], v195 offset:43392
ds_read_b64_tr_b16 v[98:99], v195 offset:46976
v_mul_f32 v208, v9, v208
v_mul_f32 v209, v9, v209
v_fma_f32 v208, v210, v12, v208
s_waitcnt vmcnt(14)
s_barrier
v_mfma_f32_32x32x16_bf16 a[224:239], v[132:135], v[180:183], a[224:239]
s_add_u32 m0, s48, 0
s_mov_b32 s52, 172032
ds_read_b64_tr_b16 v[100:101], v196 offset:0
ds_read_b64_tr_b16 v[102:103], v196 offset:3584
v_fma_f32 v209, v211, v12, v209
v_cvt_pk_bf16_f32 v30, v208, v209
v_accvgpr_read_b32 v212, a30
v_mfma_f32_32x32x16_bf16 a[128:143], v[136:139], v[184:187], a[128:143]
buffer_load_dwordx4 v188, s[8:11], s52 offen lds
ds_read_b64_tr_b16 v[104:105], v196 offset:64
ds_read_b64_tr_b16 v[106:107], v196 offset:3648
v_accvgpr_read_b32 v213, a31
v_lshlrev_b32 v214, 16, v31
v_and_b32 v215, 0xffff0000, v31
v_mul_f32 v212, v9, v212
v_mfma_f32_32x32x16_bf16 a[144:159], v[140:143], v[184:187], a[144:159]
ds_read_b64_tr_b16 v[108:109], v196 offset:128
ds_read_b64_tr_b16 v[110:111], v196 offset:3712
v_mul_f32 v213, v9, v213
v_fma_f32 v212, v214, v12, v212
v_fma_f32 v213, v215, v12, v213
v_cvt_pk_bf16_f32 v31, v212, v213
s_waitcnt vmcnt(40)
s_waitcnt lgkmcnt(8)
v_mfma_f32_32x32x16_bf16 a[160:175], v[144:147], v[184:187], a[160:175]
s_add_u32 m0, s48, 1024
ds_read_b64_tr_b16 v[112:113], v196 offset:192
ds_read_b64_tr_b16 v[114:115], v196 offset:3776
v_accvgpr_read_b32 v200, a32
v_accvgpr_read_b32 v201, a33
v_lshlrev_b32 v202, 16, v32
v_mfma_f32_32x32x16_bf16 a[176:191], v[148:151], v[184:187], a[176:191]
buffer_load_dwordx4 v189, s[8:11], s52 offen lds
ds_read_b64_tr_b16 v[116:117], v196 offset:256
ds_read_b64_tr_b16 v[118:119], v196 offset:3840
v_and_b32 v203, 0xffff0000, v32
v_mul_f32 v200, v9, v200
v_mul_f32 v201, v9, v201
v_fma_f32 v200, v202, v12, v200
v_mfma_f32_32x32x16_bf16 a[192:207], v[152:155], v[184:187], a[192:207]
ds_read_b64_tr_b16 v[120:121], v196 offset:320
ds_read_b64_tr_b16 v[122:123], v196 offset:3904
v_fma_f32 v201, v203, v12, v201
v_cvt_pk_bf16_f32 v32, v200, v201
v_accvgpr_read_b32 v204, a34
v_accvgpr_read_b32 v205, a35
v_lshlrev_b32 v206, 16, v33
v_mfma_f32_32x32x16_bf16 a[208:223], v[156:159], v[184:187], a[208:223]
s_add_u32 m0, s48, 2048
ds_read_b64_tr_b16 v[124:125], v196 offset:384
ds_read_b64_tr_b16 v[126:127], v196 offset:3968
v_and_b32 v207, 0xffff0000, v33
v_mul_f32 v204, v9, v204
v_mul_f32 v205, v9, v205
s_waitcnt lgkmcnt(8)
v_mfma_f32_32x32x16_bf16 a[224:239], v[96:99], v[184:187], a[224:239]
buffer_load_dwordx4 v190, s[8:11], s52 offen lds
ds_read_b64_tr_b16 v[128:129], v196 offset:7168
ds_read_b64_tr_b16 v[130:131], v196 offset:10752
v_fma_f32 v204, v206, v12, v204
v_fma_f32 v205, v207, v12, v205
v_cvt_pk_bf16_f32 v33, v204, v205
v_accvgpr_read_b32 v208, a36
v_mfma_f32_32x32x16_bf16 a[128:143], v[100:103], v[16:19], a[128:143]
ds_read_b64_tr_b16 v[132:133], v196 offset:7232
ds_read_b64_tr_b16 v[134:135], v196 offset:10816
v_accvgpr_read_b32 v209, a37
v_lshlrev_b32 v210, 16, v34
v_and_b32 v211, 0xffff0000, v34
v_mul_f32 v208, v9, v208
v_mul_f32 v209, v9, v209
v_mfma_f32_32x32x16_bf16 a[144:159], v[104:107], v[16:19], a[144:159]
s_add_u32 m0, s48, 3072
ds_read_b64_tr_b16 v[136:137], v196 offset:7296
ds_read_b64_tr_b16 v[138:139], v196 offset:10880
v_fma_f32 v208, v210, v12, v208
v_fma_f32 v209, v211, v12, v209
v_cvt_pk_bf16_f32 v34, v208, v209
v_accvgpr_read_b32 v212, a38
v_mfma_f32_32x32x16_bf16 a[160:175], v[108:111], v[16:19], a[160:175]
buffer_load_dwordx4 v191, s[8:11], s52 offen lds
ds_read_b64_tr_b16 v[140:141], v196 offset:7360
ds_read_b64_tr_b16 v[142:143], v196 offset:10944
v_accvgpr_read_b32 v213, a39
v_lshlrev_b32 v214, 16, v35
v_and_b32 v215, 0xffff0000, v35
s_waitcnt lgkmcnt(8)
v_mfma_f32_32x32x16_bf16 a[176:191], v[112:115], v[16:19], a[176:191]
ds_read_b64_tr_b16 v[144:145], v196 offset:7424
ds_read_b64_tr_b16 v[146:147], v196 offset:11008
v_mul_f32 v212, v9, v212
v_mul_f32 v213, v9, v213
v_fma_f32 v212, v214, v12, v212
v_fma_f32 v213, v215, v12, v213
v_cvt_pk_bf16_f32 v35, v212, v213
v_mfma_f32_32x32x16_bf16 a[192:207], v[116:119], v[16:19], a[192:207]
s_add_u32 m0, s48, 4096
ds_read_b64_tr_b16 v[148:149], v196 offset:7488
ds_read_b64_tr_b16 v[150:151], v196 offset:11072
s_waitcnt vmcnt(42)
v_accvgpr_read_b32 v200, a40
v_accvgpr_read_b32 v201, a41
v_lshlrev_b32 v202, 16, v36
v_mfma_f32_32x32x16_bf16 a[208:223], v[120:123], v[16:19], a[208:223]
buffer_load_dwordx4 v192, s[8:11], s52 offen lds
ds_read_b64_tr_b16 v[152:153], v196 offset:7552
ds_read_b64_tr_b16 v[154:155], v196 offset:11136
v_and_b32 v203, 0xffff0000, v36
v_mul_f32 v200, v9, v200
v_mul_f32 v201, v9, v201
v_mfma_f32_32x32x16_bf16 a[224:239], v[124:127], v[16:19], a[224:239]
ds_read_b64_tr_b16 v[156:157], v196 offset:14336
ds_read_b64_tr_b16 v[158:159], v196 offset:17920
v_fma_f32 v200, v202, v12, v200
v_fma_f32 v201, v203, v12, v201
v_cvt_pk_bf16_f32 v36, v200, v201
v_accvgpr_read_b32 v204, a42
v_accvgpr_read_b32 v205, a43
s_waitcnt lgkmcnt(8)
v_mfma_f32_32x32x16_bf16 a[128:143], v[128:131], v[20:23], a[128:143]
s_add_u32 m0, s48, 5120
ds_read_b64_tr_b16 v[96:97], v196 offset:14400
ds_read_b64_tr_b16 v[98:99], v196 offset:17984
v_lshlrev_b32 v206, 16, v37
v_and_b32 v207, 0xffff0000, v37
v_mul_f32 v204, v9, v204
v_mul_f32 v205, v9, v205
v_mfma_f32_32x32x16_bf16 a[144:159], v[132:135], v[20:23], a[144:159]
buffer_load_dwordx4 v193, s[8:11], s52 offen lds
ds_read_b64_tr_b16 v[100:101], v196 offset:14464
ds_read_b64_tr_b16 v[102:103], v196 offset:18048
v_fma_f32 v204, v206, v12, v204
v_fma_f32 v205, v207, v12, v205
v_cvt_pk_bf16_f32 v37, v204, v205
v_mfma_f32_32x32x16_bf16 a[160:175], v[136:139], v[20:23], a[160:175]
ds_read_b64_tr_b16 v[104:105], v196 offset:14528
ds_read_b64_tr_b16 v[106:107], v196 offset:18112
v_accvgpr_read_b32 v208, a44
v_accvgpr_read_b32 v209, a45
v_lshlrev_b32 v210, 16, v38
v_and_b32 v211, 0xffff0000, v38
v_mul_f32 v208, v9, v208
v_mfma_f32_32x32x16_bf16 a[176:191], v[140:143], v[20:23], a[176:191]
s_add_u32 m0, s48, 6144
ds_read_b64_tr_b16 v[108:109], v196 offset:14592
ds_read_b64_tr_b16 v[110:111], v196 offset:18176
v_mul_f32 v209, v9, v209
v_fma_f32 v208, v210, v12, v208
v_fma_f32 v209, v211, v12, v209
v_cvt_pk_bf16_f32 v38, v208, v209
s_waitcnt lgkmcnt(8)
v_mfma_f32_32x32x16_bf16 a[192:207], v[144:147], v[20:23], a[192:207]
buffer_load_dwordx4 v194, s[8:11], s52 offen lds
ds_read_b64_tr_b16 v[112:113], v196 offset:14656
ds_read_b64_tr_b16 v[114:115], v196 offset:18240
v_accvgpr_read_b32 v212, a46
v_accvgpr_read_b32 v213, a47
v_lshlrev_b32 v214, 16, v39
v_and_b32 v215, 0xffff0000, v39
v_mfma_f32_32x32x16_bf16 a[208:223], v[148:151], v[20:23], a[208:223]
ds_read_b64_tr_b16 v[116:117], v196 offset:14720
ds_read_b64_tr_b16 v[118:119], v196 offset:18304
v_mul_f32 v212, v9, v212
v_mul_f32 v213, v9, v213
v_fma_f32 v212, v214, v12, v212
v_fma_f32 v213, v215, v12, v213
v_mfma_f32_32x32x16_bf16 a[224:239], v[152:155], v[20:23], a[224:239]
ds_read_b64_tr_b16 v[120:121], v196 offset:21504
ds_read_b64_tr_b16 v[122:123], v196 offset:25088
v_cvt_pk_bf16_f32 v39, v212, v213
s_waitcnt vmcnt(44)
v_accvgpr_read_b32 v200, a48
v_accvgpr_read_b32 v201, a49
v_lshlrev_b32 v202, 16, v40
v_mfma_f32_32x32x16_bf16 a[128:143], v[156:159], v[24:27], a[128:143]
ds_read_b64_tr_b16 v[124:125], v196 offset:21568
ds_read_b64_tr_b16 v[126:127], v196 offset:25152
v_and_b32 v203, 0xffff0000, v40
v_mul_f32 v200, v9, v200
v_mul_f32 v201, v9, v201
v_fma_f32 v200, v202, v12, v200
v_fma_f32 v201, v203, v12, v201
s_waitcnt lgkmcnt(8)
v_mfma_f32_32x32x16_bf16 a[144:159], v[96:99], v[24:27], a[144:159]
ds_read_b64_tr_b16 v[128:129], v196 offset:21632
ds_read_b64_tr_b16 v[130:131], v196 offset:25216
v_cvt_pk_bf16_f32 v40, v200, v201
v_accvgpr_read_b32 v204, a50
v_accvgpr_read_b32 v205, a51
v_lshlrev_b32 v206, 16, v41
v_mfma_f32_32x32x16_bf16 a[160:175], v[100:103], v[24:27], a[160:175]
ds_read_b64_tr_b16 v[132:133], v196 offset:21696
ds_read_b64_tr_b16 v[134:135], v196 offset:25280
v_and_b32 v207, 0xffff0000, v41
v_mul_f32 v204, v9, v204
v_mul_f32 v205, v9, v205
v_fma_f32 v204, v206, v12, v204
v_fma_f32 v205, v207, v12, v205
v_mfma_f32_32x32x16_bf16 a[176:191], v[104:107], v[24:27], a[176:191]
ds_read_b64_tr_b16 v[136:137], v196 offset:21760
ds_read_b64_tr_b16 v[138:139], v196 offset:25344
v_cvt_pk_bf16_f32 v41, v204, v205
v_accvgpr_read_b32 v208, a52
v_accvgpr_read_b32 v209, a53
v_lshlrev_b32 v210, 16, v42
v_and_b32 v211, 0xffff0000, v42
v_mfma_f32_32x32x16_bf16 a[192:207], v[108:111], v[24:27], a[192:207]
ds_read_b64_tr_b16 v[140:141], v196 offset:21824
ds_read_b64_tr_b16 v[142:143], v196 offset:25408
v_mul_f32 v208, v9, v208
v_mul_f32 v209, v9, v209
v_fma_f32 v208, v210, v12, v208
v_fma_f32 v209, v211, v12, v209
v_cvt_pk_bf16_f32 v42, v208, v209
s_waitcnt lgkmcnt(8)
v_mfma_f32_32x32x16_bf16 a[208:223], v[112:115], v[24:27], a[208:223]
ds_read_b64_tr_b16 v[144:145], v196 offset:21888
ds_read_b64_tr_b16 v[146:147], v196 offset:25472
v_accvgpr_read_b32 v212, a54
v_accvgpr_read_b32 v213, a55
v_lshlrev_b32 v214, 16, v43
s_waitcnt vmcnt(14)
s_barrier
v_mfma_f32_32x32x16_bf16 a[224:239], v[116:119], v[24:27], a[224:239]
s_add_u32 m0, s48, 28672
s_mov_b32 s52, 448
ds_read_b64_tr_b16 v[148:149], v196 offset:28672
ds_read_b64_tr_b16 v[150:151], v196 offset:32256
v_and_b32 v215, 0xffff0000, v43
v_mul_f32 v212, v9, v212
v_mul_f32 v213, v9, v213
v_mfma_f32_32x32x16_bf16 a[128:143], v[120:123], v[28:31], a[128:143]
buffer_load_dwordx4 v188, s[12:15], s52 offen lds
ds_read_b64_tr_b16 v[152:153], v196 offset:28736
ds_read_b64_tr_b16 v[154:155], v196 offset:32320
v_fma_f32 v212, v214, v12, v212
v_fma_f32 v213, v215, v12, v213
v_cvt_pk_bf16_f32 v43, v212, v213
s_waitcnt vmcnt(44)
v_mfma_f32_32x32x16_bf16 a[144:159], v[124:127], v[28:31], a[144:159]
ds_read_b64_tr_b16 v[156:157], v196 offset:28800
ds_read_b64_tr_b16 v[158:159], v196 offset:32384
v_accvgpr_read_b32 v200, a56
v_accvgpr_read_b32 v201, a57
v_lshlrev_b32 v202, 16, v44
v_and_b32 v203, 0xffff0000, v44
s_waitcnt lgkmcnt(8)
v_mfma_f32_32x32x16_bf16 a[160:175], v[128:131], v[28:31], a[160:175]
s_add_u32 m0, s48, 29696
ds_read_b64_tr_b16 v[96:97], v196 offset:28864
ds_read_b64_tr_b16 v[98:99], v196 offset:32448
v_mul_f32 v200, v9, v200
v_mul_f32 v201, v9, v201
v_fma_f32 v200, v202, v12, v200
v_fma_f32 v201, v203, v12, v201
v_mfma_f32_32x32x16_bf16 a[176:191], v[132:135], v[28:31], a[176:191]
buffer_load_dwordx4 v189, s[12:15], s52 offen lds
ds_read_b64_tr_b16 v[100:101], v196 offset:28928
ds_read_b64_tr_b16 v[102:103], v196 offset:32512
v_cvt_pk_bf16_f32 v44, v200, v201
v_accvgpr_read_b32 v204, a58
v_accvgpr_read_b32 v205, a59
v_lshlrev_b32 v206, 16, v45
v_mfma_f32_32x32x16_bf16 a[192:207], v[136:139], v[28:31], a[192:207]
ds_read_b64_tr_b16 v[104:105], v196 offset:28992
ds_read_b64_tr_b16 v[106:107], v196 offset:32576
v_and_b32 v207, 0xffff0000, v45
v_mul_f32 v204, v9, v204
v_mul_f32 v205, v9, v205
v_fma_f32 v204, v206, v12, v204
v_mfma_f32_32x32x16_bf16 a[208:223], v[140:143], v[28:31], a[208:223]
s_add_u32 m0, s48, 30720
ds_read_b64_tr_b16 v[108:109], v196 offset:29056
ds_read_b64_tr_b16 v[110:111], v196 offset:32640
v_fma_f32 v205, v207, v12, v205
v_cvt_pk_bf16_f32 v45, v204, v205
v_accvgpr_read_b32 v208, a60
v_accvgpr_read_b32 v209, a61
s_waitcnt lgkmcnt(8)
v_mfma_f32_32x32x16_bf16 a[224:239], v[144:147], v[28:31], a[224:239]
buffer_load_dwordx4 v190, s[12:15], s52 offen lds
ds_read_b64_tr_b16 v[112:113], v196 offset:35840
ds_read_b64_tr_b16 v[114:115], v196 offset:39424
v_lshlrev_b32 v210, 16, v46
v_and_b32 v211, 0xffff0000, v46
v_mul_f32 v208, v9, v208
v_mul_f32 v209, v9, v209
v_mfma_f32_32x32x16_bf16 a[128:143], v[148:151], v[32:35], a[128:143]
ds_read_b64_tr_b16 v[116:117], v196 offset:35904
ds_read_b64_tr_b16 v[118:119], v196 offset:39488
v_fma_f32 v208, v210, v12, v208
v_fma_f32 v209, v211, v12, v209
v_cvt_pk_bf16_f32 v46, v208, v209
v_accvgpr_read_b32 v212, a62
v_accvgpr_read_b32 v213, a63
v_mfma_f32_32x32x16_bf16 a[144:159], v[152:155], v[32:35], a[144:159]
s_add_u32 m0, s48, 31744
ds_read_b64_tr_b16 v[120:121], v196 offset:35968
ds_read_b64_tr_b16 v[122:123], v196 offset:39552
v_lshlrev_b32 v214, 16, v47
v_and_b32 v215, 0xffff0000, v47
v_mul_f32 v212, v9, v212
v_mfma_f32_32x32x16_bf16 a[160:175], v[156:159], v[32:35], a[160:175]
buffer_load_dwordx4 v191, s[12:15], s52 offen lds
ds_read_b64_tr_b16 v[124:125], v196 offset:36032
ds_read_b64_tr_b16 v[126:127], v196 offset:39616
v_mul_f32 v213, v9, v213
v_fma_f32 v212, v214, v12, v212
v_fma_f32 v213, v215, v12, v213
v_cvt_pk_bf16_f32 v47, v212, v213
s_waitcnt lgkmcnt(8)
v_mfma_f32_32x32x16_bf16 a[176:191], v[96:99], v[32:35], a[176:191]
ds_read_b64_tr_b16 v[128:129], v196 offset:36096
ds_read_b64_tr_b16 v[130:131], v196 offset:39680
s_waitcnt vmcnt(46)
v_accvgpr_read_b32 v200, a64
v_accvgpr_read_b32 v201, a65
v_lshlrev_b32 v202, 16, v48
v_and_b32 v203, 0xffff0000, v48
v_mfma_f32_32x32x16_bf16 a[192:207], v[100:103], v[32:35], a[192:207]
s_add_u32 m0, s48, 32768
ds_read_b64_tr_b16 v[132:133], v196 offset:36160
ds_read_b64_tr_b16 v[134:135], v196 offset:39744
v_mul_f32 v200, v9, v200
v_mul_f32 v201, v9, v201
v_fma_f32 v200, v202, v12, v200
v_mfma_f32_32x32x16_bf16 a[208:223], v[104:107], v[32:35], a[208:223]
buffer_load_dwordx4 v192, s[12:15], s52 offen lds
ds_read_b64_tr_b16 v[136:137], v196 offset:36224
ds_read_b64_tr_b16 v[138:139], v196 offset:39808
v_fma_f32 v201, v203, v12, v201
v_cvt_pk_bf16_f32 v48, v200, v201
v_accvgpr_read_b32 v204, a66
v_accvgpr_read_b32 v205, a67
v_mfma_f32_32x32x16_bf16 a[224:239], v[108:111], v[32:35], a[224:239]
ds_read_b64_tr_b16 v[140:141], v196 offset:43008
ds_read_b64_tr_b16 v[142:143], v196 offset:46592
v_lshlrev_b32 v206, 16, v49
v_and_b32 v207, 0xffff0000, v49
v_mul_f32 v204, v9, v204
v_mul_f32 v205, v9, v205
v_fma_f32 v204, v206, v12, v204
s_waitcnt lgkmcnt(8)
v_mfma_f32_32x32x16_bf16 a[128:143], v[112:115], v[36:39], a[128:143]
s_add_u32 m0, s48, 33792
ds_read_b64_tr_b16 v[144:145], v196 offset:43072
ds_read_b64_tr_b16 v[146:147], v196 offset:46656
v_fma_f32 v205, v207, v12, v205
v_cvt_pk_bf16_f32 v49, v204, v205
v_accvgpr_read_b32 v208, a68
v_mfma_f32_32x32x16_bf16 a[144:159], v[116:119], v[36:39], a[144:159]
buffer_load_dwordx4 v193, s[12:15], s52 offen lds
ds_read_b64_tr_b16 v[148:149], v196 offset:43136
ds_read_b64_tr_b16 v[150:151], v196 offset:46720
v_accvgpr_read_b32 v209, a69
v_lshlrev_b32 v210, 16, v50
v_and_b32 v211, 0xffff0000, v50
v_mul_f32 v208, v9, v208
v_mfma_f32_32x32x16_bf16 a[160:175], v[120:123], v[36:39], a[160:175]
ds_read_b64_tr_b16 v[152:153], v196 offset:43200
ds_read_b64_tr_b16 v[154:155], v196 offset:46784
v_mul_f32 v209, v9, v209
v_fma_f32 v208, v210, v12, v208
v_fma_f32 v209, v211, v12, v209
v_cvt_pk_bf16_f32 v50, v208, v209
v_accvgpr_read_b32 v212, a70
v_mfma_f32_32x32x16_bf16 a[176:191], v[124:127], v[36:39], a[176:191]
s_add_u32 m0, s48, 34816
ds_read_b64_tr_b16 v[156:157], v196 offset:43264
ds_read_b64_tr_b16 v[158:159], v196 offset:46848
v_accvgpr_read_b32 v213, a71
v_lshlrev_b32 v214, 16, v51
v_and_b32 v215, 0xffff0000, v51
v_mul_f32 v212, v9, v212
s_waitcnt lgkmcnt(8)
v_mfma_f32_32x32x16_bf16 a[192:207], v[128:131], v[36:39], a[192:207]
buffer_load_dwordx4 v194, s[12:15], s52 offen lds
ds_read_b64_tr_b16 v[96:97], v196 offset:43328
ds_read_b64_tr_b16 v[98:99], v196 offset:46912
v_mul_f32 v213, v9, v213
v_fma_f32 v212, v214, v12, v212
v_fma_f32 v213, v215, v12, v213
v_mfma_f32_32x32x16_bf16 a[208:223], v[132:135], v[36:39], a[208:223]
ds_read_b64_tr_b16 v[100:101], v196 offset:43392
ds_read_b64_tr_b16 v[102:103], v196 offset:46976
v_cvt_pk_bf16_f32 v51, v212, v213
s_waitcnt vmcnt(48)
v_accvgpr_read_b32 v200, a72
v_accvgpr_read_b32 v201, a73
v_lshlrev_b32 v202, 16, v52
v_mfma_f32_32x32x16_bf16 a[224:239], v[136:139], v[36:39], a[224:239]
ds_read_b64_tr_b16 v[104:105], v196 offset:50176
ds_read_b64_tr_b16 v[106:107], v196 offset:53760
v_and_b32 v203, 0xffff0000, v52
v_mul_f32 v200, v9, v200
v_mul_f32 v201, v9, v201
v_fma_f32 v200, v202, v12, v200
v_fma_f32 v201, v203, v12, v201
v_mfma_f32_32x32x16_bf16 a[128:143], v[140:143], v[40:43], a[128:143]
ds_read_b64_tr_b16 v[108:109], v196 offset:50240
ds_read_b64_tr_b16 v[110:111], v196 offset:53824
v_cvt_pk_bf16_f32 v52, v200, v201
v_accvgpr_read_b32 v204, a74
v_accvgpr_read_b32 v205, a75
v_lshlrev_b32 v206, 16, v53
s_waitcnt lgkmcnt(8)
v_mfma_f32_32x32x16_bf16 a[144:159], v[144:147], v[40:43], a[144:159]
ds_read_b64_tr_b16 v[112:113], v196 offset:50304
ds_read_b64_tr_b16 v[114:115], v196 offset:53888
v_and_b32 v207, 0xffff0000, v53
v_mul_f32 v204, v9, v204
v_mul_f32 v205, v9, v205
v_fma_f32 v204, v206, v12, v204
v_fma_f32 v205, v207, v12, v205
v_mfma_f32_32x32x16_bf16 a[160:175], v[148:151], v[40:43], a[160:175]
ds_read_b64_tr_b16 v[116:117], v196 offset:50368
ds_read_b64_tr_b16 v[118:119], v196 offset:53952
v_cvt_pk_bf16_f32 v53, v204, v205
v_accvgpr_read_b32 v208, a76
v_accvgpr_read_b32 v209, a77
v_lshlrev_b32 v210, 16, v54
v_and_b32 v211, 0xffff0000, v54
v_mfma_f32_32x32x16_bf16 a[176:191], v[152:155], v[40:43], a[176:191]
ds_read_b64_tr_b16 v[120:121], v196 offset:50432
ds_read_b64_tr_b16 v[122:123], v196 offset:54016
v_mul_f32 v208, v9, v208
v_mul_f32 v209, v9, v209
v_fma_f32 v208, v210, v12, v208
v_fma_f32 v209, v211, v12, v209
v_cvt_pk_bf16_f32 v54, v208, v209
v_mfma_f32_32x32x16_bf16 a[192:207], v[156:159], v[40:43], a[192:207]
ds_read_b64_tr_b16 v[124:125], v196 offset:50496
ds_read_b64_tr_b16 v[126:127], v196 offset:54080
v_accvgpr_read_b32 v212, a78
v_accvgpr_read_b32 v213, a79
v_lshlrev_b32 v214, 16, v55
v_and_b32 v215, 0xffff0000, v55
s_waitcnt lgkmcnt(8)
v_mfma_f32_32x32x16_bf16 a[208:223], v[96:99], v[40:43], a[208:223]
ds_read_b64_tr_b16 v[128:129], v196 offset:50560
ds_read_b64_tr_b16 v[130:131], v196 offset:54144
v_mul_f32 v212, v9, v212
v_mul_f32 v213, v9, v213
v_fma_f32 v212, v214, v12, v212
v_fma_f32 v213, v215, v12, v213
s_waitcnt vmcnt(14)
s_barrier
v_mfma_f32_32x32x16_bf16 a[224:239], v[100:103], v[40:43], a[224:239]
s_add_u32 m0, s48, 57344
s_mov_b32 s52, 448
ds_read_b64_tr_b16 v[132:133], v197 offset:0
ds_read_b64_tr_b16 v[134:135], v197 offset:3584
v_cvt_pk_bf16_f32 v55, v212, v213
s_waitcnt vmcnt(47)
v_accvgpr_read_b32 v200, a80
v_mfma_f32_32x32x16_bf16 a[128:143], v[104:107], v[44:47], a[128:143]
buffer_load_dwordx4 v188, s[76:79], s52 offen lds
ds_read_b64_tr_b16 v[136:137], v197 offset:64
ds_read_b64_tr_b16 v[138:139], v197 offset:3648
v_accvgpr_read_b32 v201, a81
v_lshlrev_b32 v202, 16, v56
v_and_b32 v203, 0xffff0000, v56
v_mfma_f32_32x32x16_bf16 a[144:159], v[108:111], v[44:47], a[144:159]
ds_read_b64_tr_b16 v[140:141], v197 offset:128
ds_read_b64_tr_b16 v[142:143], v197 offset:3712
v_mul_f32 v200, v9, v200
v_mul_f32 v201, v9, v201
v_fma_f32 v200, v202, v12, v200
v_fma_f32 v201, v203, v12, v201
v_cvt_pk_bf16_f32 v56, v200, v201
s_waitcnt lgkmcnt(8)
v_mfma_f32_32x32x16_bf16 a[160:175], v[112:115], v[44:47], a[160:175]
s_add_u32 m0, s48, 58368
ds_read_b64_tr_b16 v[144:145], v197 offset:192
ds_read_b64_tr_b16 v[146:147], v197 offset:3776
v_accvgpr_read_b32 v204, a82
v_accvgpr_read_b32 v205, a83
v_lshlrev_b32 v206, 16, v57
v_and_b32 v207, 0xffff0000, v57
v_mfma_f32_32x32x16_bf16 a[176:191], v[116:119], v[44:47], a[176:191]
buffer_load_dwordx4 v189, s[76:79], s52 offen lds
ds_read_b64_tr_b16 v[148:149], v197 offset:256
ds_read_b64_tr_b16 v[150:151], v197 offset:3840
v_mul_f32 v204, v9, v204
v_mul_f32 v205, v9, v205
v_fma_f32 v204, v206, v12, v204
v_mfma_f32_32x32x16_bf16 a[192:207], v[120:123], v[44:47], a[192:207]
ds_read_b64_tr_b16 v[152:153], v197 offset:320
ds_read_b64_tr_b16 v[154:155], v197 offset:3904
v_fma_f32 v205, v207, v12, v205
v_cvt_pk_bf16_f32 v57, v204, v205
v_accvgpr_read_b32 v208, a84
v_accvgpr_read_b32 v209, a85
v_lshlrev_b32 v210, 16, v58
v_mfma_f32_32x32x16_bf16 a[208:223], v[124:127], v[44:47], a[208:223]
s_add_u32 m0, s48, 59392
ds_read_b64_tr_b16 v[156:157], v197 offset:384
ds_read_b64_tr_b16 v[158:159], v197 offset:3968
v_and_b32 v211, 0xffff0000, v58
v_mul_f32 v208, v9, v208
v_mul_f32 v209, v9, v209
v_fma_f32 v208, v210, v12, v208
s_waitcnt lgkmcnt(8)
v_mfma_f32_32x32x16_bf16 a[224:239], v[128:131], v[44:47], a[224:239]
buffer_load_dwordx4 v190, s[76:79], s52 offen lds
ds_read_b64_tr_b16 v[96:97], v197 offset:7168
ds_read_b64_tr_b16 v[98:99], v197 offset:10752
v_fma_f32 v209, v211, v12, v209
v_cvt_pk_bf16_f32 v58, v208, v209
v_accvgpr_read_b32 v212, a86
v_accvgpr_read_b32 v213, a87
v_mfma_f32_32x32x16_bf16 a[128:143], v[132:135], v[48:51], a[128:143]
ds_read_b64_tr_b16 v[100:101], v197 offset:7232
ds_read_b64_tr_b16 v[102:103], v197 offset:10816
v_lshlrev_b32 v214, 16, v59
v_and_b32 v215, 0xffff0000, v59
v_mul_f32 v212, v9, v212
v_mul_f32 v213, v9, v213
v_mfma_f32_32x32x16_bf16 a[144:159], v[136:139], v[48:51], a[144:159]
s_add_u32 m0, s48, 60416
ds_read_b64_tr_b16 v[104:105], v197 offset:7296
ds_read_b64_tr_b16 v[106:107], v197 offset:10880
v_fma_f32 v212, v214, v12, v212
v_fma_f32 v213, v215, v12, v213
v_cvt_pk_bf16_f32 v59, v212, v213
s_waitcnt vmcnt(49)
v_mfma_f32_32x32x16_bf16 a[160:175], v[140:143], v[48:51], a[160:175]
buffer_load_dwordx4 v191, s[76:79], s52 offen lds
ds_read_b64_tr_b16 v[108:109], v197 offset:7360
ds_read_b64_tr_b16 v[110:111], v197 offset:10944
v_accvgpr_read_b32 v200, a88
v_accvgpr_read_b32 v201, a89
v_lshlrev_b32 v202, 16, v60
v_and_b32 v203, 0xffff0000, v60
s_waitcnt lgkmcnt(8)
v_mfma_f32_32x32x16_bf16 a[176:191], v[144:147], v[48:51], a[176:191]
ds_read_b64_tr_b16 v[112:113], v197 offset:7424
ds_read_b64_tr_b16 v[114:115], v197 offset:11008
v_mul_f32 v200, v9, v200
v_mul_f32 v201, v9, v201
v_fma_f32 v200, v202, v12, v200
v_fma_f32 v201, v203, v12, v201
v_mfma_f32_32x32x16_bf16 a[192:207], v[148:151], v[48:51], a[192:207]
s_add_u32 m0, s48, 61440
ds_read_b64_tr_b16 v[116:117], v197 offset:7488
ds_read_b64_tr_b16 v[118:119], v197 offset:11072
v_cvt_pk_bf16_f32 v60, v200, v201
v_accvgpr_read_b32 v204, a90
v_accvgpr_read_b32 v205, a91
v_lshlrev_b32 v206, 16, v61
v_mfma_f32_32x32x16_bf16 a[208:223], v[152:155], v[48:51], a[208:223]
buffer_load_dwordx4 v192, s[76:79], s52 offen lds
ds_read_b64_tr_b16 v[120:121], v197 offset:7552
ds_read_b64_tr_b16 v[122:123], v197 offset:11136
v_and_b32 v207, 0xffff0000, v61
v_mul_f32 v204, v9, v204
v_mul_f32 v205, v9, v205
v_fma_f32 v204, v206, v12, v204
v_mfma_f32_32x32x16_bf16 a[224:239], v[156:159], v[48:51], a[224:239]
ds_read_b64_tr_b16 v[124:125], v197 offset:14336
ds_read_b64_tr_b16 v[126:127], v197 offset:17920
v_fma_f32 v205, v207, v12, v205
v_cvt_pk_bf16_f32 v61, v204, v205
v_accvgpr_read_b32 v208, a92
v_accvgpr_read_b32 v209, a93
v_lshlrev_b32 v210, 16, v62
s_waitcnt lgkmcnt(8)
v_mfma_f32_32x32x16_bf16 a[128:143], v[96:99], v[52:55], a[128:143]
s_add_u32 m0, s48, 62464
ds_read_b64_tr_b16 v[128:129], v197 offset:14400
ds_read_b64_tr_b16 v[130:131], v197 offset:17984
v_and_b32 v211, 0xffff0000, v62
v_mul_f32 v208, v9, v208
v_mul_f32 v209, v9, v209
v_mfma_f32_32x32x16_bf16 a[144:159], v[100:103], v[52:55], a[144:159]
buffer_load_dwordx4 v193, s[76:79], s52 offen lds
ds_read_b64_tr_b16 v[132:133], v197 offset:14464
ds_read_b64_tr_b16 v[134:135], v197 offset:18048
v_fma_f32 v208, v210, v12, v208
v_fma_f32 v209, v211, v12, v209
v_cvt_pk_bf16_f32 v62, v208, v209
v_accvgpr_read_b32 v212, a94
v_mfma_f32_32x32x16_bf16 a[160:175], v[104:107], v[52:55], a[160:175]
ds_read_b64_tr_b16 v[136:137], v197 offset:14528
ds_read_b64_tr_b16 v[138:139], v197 offset:18112
v_accvgpr_read_b32 v213, a95
v_lshlrev_b32 v214, 16, v63
v_and_b32 v215, 0xffff0000, v63
v_mul_f32 v212, v9, v212
v_mul_f32 v213, v9, v213
v_mfma_f32_32x32x16_bf16 a[176:191], v[108:111], v[52:55], a[176:191]
s_add_u32 m0, s48, 63488
ds_read_b64_tr_b16 v[140:141], v197 offset:14592
ds_read_b64_tr_b16 v[142:143], v197 offset:18176
v_fma_f32 v212, v214, v12, v212
v_fma_f32 v213, v215, v12, v213
v_cvt_pk_bf16_f32 v63, v212, v213
s_waitcnt lgkmcnt(8)
v_mfma_f32_32x32x16_bf16 a[192:207], v[112:115], v[52:55], a[192:207]
buffer_load_dwordx4 v194, s[76:79], s52 offen lds
ds_read_b64_tr_b16 v[144:145], v197 offset:14656
ds_read_b64_tr_b16 v[146:147], v197 offset:18240
s_waitcnt vmcnt(45)
v_accvgpr_read_b32 v200, a96
v_accvgpr_read_b32 v201, a97
v_lshlrev_b32 v202, 16, v64
v_mfma_f32_32x32x16_bf16 a[208:223], v[116:119], v[52:55], a[208:223]
ds_read_b64_tr_b16 v[148:149], v197 offset:14720
ds_read_b64_tr_b16 v[150:151], v197 offset:18304
v_and_b32 v203, 0xffff0000, v64
v_mul_f32 v200, v9, v200
v_mul_f32 v201, v9, v201
v_fma_f32 v200, v202, v12, v200
v_fma_f32 v201, v203, v12, v201
v_mfma_f32_32x32x16_bf16 a[224:239], v[120:123], v[52:55], a[224:239]
ds_read_b64_tr_b16 v[152:153], v197 offset:21504
ds_read_b64_tr_b16 v[154:155], v197 offset:25088
v_cvt_pk_bf16_f32 v64, v200, v201
v_accvgpr_read_b32 v204, a98
v_accvgpr_read_b32 v205, a99
v_lshlrev_b32 v206, 16, v65
v_mfma_f32_32x32x16_bf16 a[128:143], v[124:127], v[56:59], a[128:143]
ds_read_b64_tr_b16 v[156:157], v197 offset:21568
ds_read_b64_tr_b16 v[158:159], v197 offset:25152
v_and_b32 v207, 0xffff0000, v65
v_mul_f32 v204, v9, v204
v_mul_f32 v205, v9, v205
v_fma_f32 v204, v206, v12, v204
v_fma_f32 v205, v207, v12, v205
s_waitcnt lgkmcnt(8)
v_mfma_f32_32x32x16_bf16 a[144:159], v[128:131], v[56:59], a[144:159]
ds_read_b64_tr_b16 v[96:97], v197 offset:21632
ds_read_b64_tr_b16 v[98:99], v197 offset:25216
v_cvt_pk_bf16_f32 v65, v204, v205
v_accvgpr_read_b32 v208, a100
v_accvgpr_read_b32 v209, a101
v_lshlrev_b32 v210, 16, v66
v_and_b32 v211, 0xffff0000, v66
v_mfma_f32_32x32x16_bf16 a[160:175], v[132:135], v[56:59], a[160:175]
ds_read_b64_tr_b16 v[100:101], v197 offset:21696
ds_read_b64_tr_b16 v[102:103], v197 offset:25280
v_mul_f32 v208, v9, v208
v_mul_f32 v209, v9, v209
v_fma_f32 v208, v210, v12, v208
v_fma_f32 v209, v211, v12, v209
v_cvt_pk_bf16_f32 v66, v208, v209
v_mfma_f32_32x32x16_bf16 a[176:191], v[136:139], v[56:59], a[176:191]
ds_read_b64_tr_b16 v[104:105], v197 offset:21760
ds_read_b64_tr_b16 v[106:107], v197 offset:25344
v_accvgpr_read_b32 v212, a102
v_accvgpr_read_b32 v213, a103
v_lshlrev_b32 v214, 16, v67
v_and_b32 v215, 0xffff0000, v67
v_mfma_f32_32x32x16_bf16 a[192:207], v[140:143], v[56:59], a[192:207]
ds_read_b64_tr_b16 v[108:109], v197 offset:21824
ds_read_b64_tr_b16 v[110:111], v197 offset:25408
v_mul_f32 v212, v9, v212
v_mul_f32 v213, v9, v213
v_fma_f32 v212, v214, v12, v212
v_fma_f32 v213, v215, v12, v213
v_cvt_pk_bf16_f32 v67, v212, v213
s_waitcnt lgkmcnt(8)
v_mfma_f32_32x32x16_bf16 a[208:223], v[144:147], v[56:59], a[208:223]
ds_read_b64_tr_b16 v[112:113], v197 offset:21888
ds_read_b64_tr_b16 v[114:115], v197 offset:25472
s_waitcnt vmcnt(44)
v_accvgpr_read_b32 v200, a104
v_accvgpr_read_b32 v201, a105
v_lshlrev_b32 v202, 16, v68
s_waitcnt vmcnt(14)
s_barrier
v_mfma_f32_32x32x16_bf16 a[224:239], v[148:151], v[56:59], a[224:239]
s_add_u32 m0, s48, 86016
s_mov_b32 s52, 448
ds_read_b64_tr_b16 v[116:117], v195 offset:0
ds_read_b64_tr_b16 v[118:119], v195 offset:3584
v_and_b32 v203, 0xffff0000, v68
v_mul_f32 v200, v9, v200
v_mfma_f32_32x32x16_bf16 a[128:143], v[152:155], v[60:63], a[128:143]
buffer_load_dwordx4 v188, s[8:11], s52 offen lds
ds_read_b64_tr_b16 v[120:121], v195 offset:64
ds_read_b64_tr_b16 v[122:123], v195 offset:3648
v_mul_f32 v201, v9, v201
v_fma_f32 v200, v202, v12, v200
v_fma_f32 v201, v203, v12, v201
v_cvt_pk_bf16_f32 v68, v200, v201
v_mfma_f32_32x32x16_bf16 a[144:159], v[156:159], v[60:63], a[144:159]
ds_read_b64_tr_b16 v[124:125], v195 offset:128
ds_read_b64_tr_b16 v[126:127], v195 offset:3712
v_accvgpr_read_b32 v204, a106
v_accvgpr_read_b32 v205, a107
v_lshlrev_b32 v206, 16, v69
v_and_b32 v207, 0xffff0000, v69
v_mul_f32 v204, v9, v204
s_waitcnt lgkmcnt(8)
v_mfma_f32_32x32x16_bf16 a[160:175], v[96:99], v[60:63], a[160:175]
s_add_u32 m0, s48, 87040
ds_read_b64_tr_b16 v[128:129], v195 offset:192
ds_read_b64_tr_b16 v[130:131], v195 offset:3776
v_mul_f32 v205, v9, v205
v_fma_f32 v204, v206, v12, v204
v_fma_f32 v205, v207, v12, v205
v_mfma_f32_32x32x16_bf16 a[176:191], v[100:103], v[60:63], a[176:191]
buffer_load_dwordx4 v189, s[8:11], s52 offen lds
ds_read_b64_tr_b16 v[132:133], v195 offset:256
ds_read_b64_tr_b16 v[134:135], v195 offset:3840
v_cvt_pk_bf16_f32 v69, v204, v205
v_accvgpr_read_b32 v208, a108
v_accvgpr_read_b32 v209, a109
v_lshlrev_b32 v210, 16, v70
v_mfma_f32_32x32x16_bf16 a[192:207], v[104:107], v[60:63], a[192:207]
ds_read_b64_tr_b16 v[136:137], v195 offset:320
ds_read_b64_tr_b16 v[138:139], v195 offset:3904
v_and_b32 v211, 0xffff0000, v70
v_mul_f32 v208, v9, v208
v_mul_f32 v209, v9, v209
v_fma_f32 v208, v210, v12, v208
v_fma_f32 v209, v211, v12, v209
v_mfma_f32_32x32x16_bf16 a[208:223], v[108:111], v[60:63], a[208:223]
s_add_u32 m0, s48, 88064
ds_read_b64_tr_b16 v[140:141], v195 offset:384
ds_read_b64_tr_b16 v[142:143], v195 offset:3968
v_cvt_pk_bf16_f32 v70, v208, v209
v_accvgpr_read_b32 v212, a110
v_accvgpr_read_b32 v213, a111
v_lshlrev_b32 v214, 16, v71
s_waitcnt lgkmcnt(8)
v_mfma_f32_32x32x16_bf16 a[224:239], v[112:115], v[60:63], a[224:239]
buffer_load_dwordx4 v190, s[8:11], s52 offen lds
ds_read_b64_tr_b16 v[144:145], v195 offset:7168
ds_read_b64_tr_b16 v[146:147], v195 offset:10752
v_and_b32 v215, 0xffff0000, v71
v_mul_f32 v212, v9, v212
v_mul_f32 v213, v9, v213
v_mfma_f32_32x32x16_bf16 a[128:143], v[116:119], v[64:67], a[128:143]
ds_read_b64_tr_b16 v[148:149], v195 offset:7232
ds_read_b64_tr_b16 v[150:151], v195 offset:10816
v_fma_f32 v212, v214, v12, v212
v_fma_f32 v213, v215, v12, v213
v_cvt_pk_bf16_f32 v71, v212, v213
s_waitcnt vmcnt(46)
v_accvgpr_read_b32 v200, a112
v_mfma_f32_32x32x16_bf16 a[144:159], v[120:123], v[64:67], a[144:159]
s_add_u32 m0, s48, 89088
ds_read_b64_tr_b16 v[152:153], v195 offset:7296
ds_read_b64_tr_b16 v[154:155], v195 offset:10880
v_accvgpr_read_b32 v201, a113
v_lshlrev_b32 v202, 16, v72
v_and_b32 v203, 0xffff0000, v72
v_mul_f32 v200, v9, v200
v_mfma_f32_32x32x16_bf16 a[160:175], v[124:127], v[64:67], a[160:175]
buffer_load_dwordx4 v191, s[8:11], s52 offen lds
ds_read_b64_tr_b16 v[156:157], v195 offset:7360
ds_read_b64_tr_b16 v[158:159], v195 offset:10944
v_mul_f32 v201, v9, v201
v_fma_f32 v200, v202, v12, v200
v_fma_f32 v201, v203, v12, v201
s_waitcnt lgkmcnt(8)
v_mfma_f32_32x32x16_bf16 a[176:191], v[128:131], v[64:67], a[176:191]
ds_read_b64_tr_b16 v[96:97], v195 offset:7424
ds_read_b64_tr_b16 v[98:99], v195 offset:11008
v_cvt_pk_bf16_f32 v72, v200, v201
v_accvgpr_read_b32 v204, a114
v_accvgpr_read_b32 v205, a115
v_lshlrev_b32 v206, 16, v73
v_and_b32 v207, 0xffff0000, v73
v_mfma_f32_32x32x16_bf16 a[192:207], v[132:135], v[64:67], a[192:207]
s_add_u32 m0, s48, 90112
ds_read_b64_tr_b16 v[100:101], v195 offset:7488
ds_read_b64_tr_b16 v[102:103], v195 offset:11072
v_mul_f32 v204, v9, v204
v_mul_f32 v205, v9, v205
v_fma_f32 v204, v206, v12, v204
v_fma_f32 v205, v207, v12, v205
v_mfma_f32_32x32x16_bf16 a[208:223], v[136:139], v[64:67], a[208:223]
buffer_load_dwordx4 v192, s[8:11], s52 offen lds
ds_read_b64_tr_b16 v[104:105], v195 offset:7552
ds_read_b64_tr_b16 v[106:107], v195 offset:11136
v_cvt_pk_bf16_f32 v73, v204, v205
v_accvgpr_read_b32 v208, a116
v_accvgpr_read_b32 v209, a117
v_lshlrev_b32 v210, 16, v74
v_mfma_f32_32x32x16_bf16 a[224:239], v[140:143], v[64:67], a[224:239]
ds_read_b64_tr_b16 v[108:109], v195 offset:14336
ds_read_b64_tr_b16 v[110:111], v195 offset:17920
v_and_b32 v211, 0xffff0000, v74
v_mul_f32 v208, v9, v208
v_mul_f32 v209, v9, v209
v_fma_f32 v208, v210, v12, v208
s_waitcnt lgkmcnt(8)
v_mfma_f32_32x32x16_bf16 a[128:143], v[144:147], v[68:71], a[128:143]
s_add_u32 m0, s48, 91136
ds_read_b64_tr_b16 v[112:113], v195 offset:14400
ds_read_b64_tr_b16 v[114:115], v195 offset:17984
v_fma_f32 v209, v211, v12, v209
v_cvt_pk_bf16_f32 v74, v208, v209
v_accvgpr_read_b32 v212, a118
v_accvgpr_read_b32 v213, a119
v_mfma_f32_32x32x16_bf16 a[144:159], v[148:151], v[68:71], a[144:159]
buffer_load_dwordx4 v193, s[8:11], s52 offen lds
ds_read_b64_tr_b16 v[116:117], v195 offset:14464
ds_read_b64_tr_b16 v[118:119], v195 offset:18048
v_lshlrev_b32 v214, 16, v75
v_and_b32 v215, 0xffff0000, v75
v_mul_f32 v212, v9, v212
v_mul_f32 v213, v9, v213
v_mfma_f32_32x32x16_bf16 a[160:175], v[152:155], v[68:71], a[160:175]
ds_read_b64_tr_b16 v[120:121], v195 offset:14528
ds_read_b64_tr_b16 v[122:123], v195 offset:18112
v_fma_f32 v212, v214, v12, v212
v_fma_f32 v213, v215, v12, v213
v_cvt_pk_bf16_f32 v75, v212, v213
s_waitcnt vmcnt(48)
v_mfma_f32_32x32x16_bf16 a[176:191], v[156:159], v[68:71], a[176:191]
s_add_u32 m0, s48, 92160
ds_read_b64_tr_b16 v[124:125], v195 offset:14592
ds_read_b64_tr_b16 v[126:127], v195 offset:18176
v_accvgpr_read_b32 v200, a120
v_accvgpr_read_b32 v201, a121
v_lshlrev_b32 v202, 16, v76
v_and_b32 v203, 0xffff0000, v76
s_waitcnt lgkmcnt(8)
v_mfma_f32_32x32x16_bf16 a[192:207], v[96:99], v[68:71], a[192:207]
buffer_load_dwordx4 v194, s[8:11], s52 offen lds
ds_read_b64_tr_b16 v[128:129], v195 offset:14656
ds_read_b64_tr_b16 v[130:131], v195 offset:18240
v_mul_f32 v200, v9, v200
v_mul_f32 v201, v9, v201
v_fma_f32 v200, v202, v12, v200
v_fma_f32 v201, v203, v12, v201
v_mfma_f32_32x32x16_bf16 a[208:223], v[100:103], v[68:71], a[208:223]
ds_read_b64_tr_b16 v[132:133], v195 offset:14720
ds_read_b64_tr_b16 v[134:135], v195 offset:18304
v_cvt_pk_bf16_f32 v76, v200, v201
v_accvgpr_read_b32 v204, a122
v_accvgpr_read_b32 v205, a123
v_lshlrev_b32 v206, 16, v77
v_mfma_f32_32x32x16_bf16 a[224:239], v[104:107], v[68:71], a[224:239]
ds_read_b64_tr_b16 v[136:137], v195 offset:21504
ds_read_b64_tr_b16 v[138:139], v195 offset:25088
v_and_b32 v207, 0xffff0000, v77
v_mul_f32 v204, v9, v204
v_mul_f32 v205, v9, v205
v_fma_f32 v204, v206, v12, v204
v_fma_f32 v205, v207, v12, v205
v_mfma_f32_32x32x16_bf16 a[128:143], v[108:111], v[72:75], a[128:143]
ds_read_b64_tr_b16 v[140:141], v195 offset:21568
ds_read_b64_tr_b16 v[142:143], v195 offset:25152
v_cvt_pk_bf16_f32 v77, v204, v205
v_accvgpr_read_b32 v208, a124
v_accvgpr_read_b32 v209, a125
v_lshlrev_b32 v210, 16, v78
v_and_b32 v211, 0xffff0000, v78
s_waitcnt lgkmcnt(8)
v_mfma_f32_32x32x16_bf16 a[144:159], v[112:115], v[72:75], a[144:159]
ds_read_b64_tr_b16 v[144:145], v195 offset:21632
ds_read_b64_tr_b16 v[146:147], v195 offset:25216
v_mul_f32 v208, v9, v208
v_mul_f32 v209, v9, v209
v_fma_f32 v208, v210, v12, v208
v_fma_f32 v209, v211, v12, v209
v_cvt_pk_bf16_f32 v78, v208, v209
v_mfma_f32_32x32x16_bf16 a[160:175], v[116:119], v[72:75], a[160:175]
ds_read_b64_tr_b16 v[148:149], v195 offset:21696
ds_read_b64_tr_b16 v[150:151], v195 offset:25280
v_accvgpr_read_b32 v212, a126
v_accvgpr_read_b32 v213, a127
v_lshlrev_b32 v214, 16, v79
v_and_b32 v215, 0xffff0000, v79
v_mfma_f32_32x32x16_bf16 a[176:191], v[120:123], v[72:75], a[176:191]
ds_read_b64_tr_b16 v[152:153], v195 offset:21760
ds_read_b64_tr_b16 v[154:155], v195 offset:25344
v_mul_f32 v212, v9, v212
v_mul_f32 v213, v9, v213
v_fma_f32 v212, v214, v12, v212
v_fma_f32 v213, v215, v12, v213
v_cvt_pk_bf16_f32 v79, v212, v213
v_mfma_f32_32x32x16_bf16 a[192:207], v[124:127], v[72:75], a[192:207]
ds_read_b64_tr_b16 v[156:157], v195 offset:21824
ds_read_b64_tr_b16 v[158:159], v195 offset:25408
s_waitcnt lgkmcnt(8)
v_mfma_f32_32x32x16_bf16 a[208:223], v[128:131], v[72:75], a[208:223]
ds_read_b64_tr_b16 v[96:97], v195 offset:21888
ds_read_b64_tr_b16 v[98:99], v195 offset:25472
s_waitcnt vmcnt(14)
s_barrier
v_mfma_f32_32x32x16_bf16 a[224:239], v[132:135], v[72:75], a[224:239]
s_add_u32 m0, s48, 114688
s_mov_b32 s52, 57792
ds_read_b64_tr_b16 v[100:101], v195 offset:28672
ds_read_b64_tr_b16 v[102:103], v195 offset:32256
v_mfma_f32_32x32x16_bf16 a[128:143], v[136:139], v[76:79], a[128:143]
buffer_load_dwordx4 v188, s[8:11], s52 offen lds
ds_read_b64_tr_b16 v[104:105], v195 offset:28736
ds_read_b64_tr_b16 v[106:107], v195 offset:32320
v_mfma_f32_32x32x16_bf16 a[144:159], v[140:143], v[76:79], a[144:159]
ds_read_b64_tr_b16 v[108:109], v195 offset:28800
ds_read_b64_tr_b16 v[110:111], v195 offset:32384
s_waitcnt lgkmcnt(8)
v_mfma_f32_32x32x16_bf16 a[160:175], v[144:147], v[76:79], a[160:175]
s_add_u32 m0, s48, 115712
ds_read_b64_tr_b16 v[112:113], v195 offset:28864
ds_read_b64_tr_b16 v[114:115], v195 offset:32448
v_mfma_f32_32x32x16_bf16 a[176:191], v[148:151], v[76:79], a[176:191]
buffer_load_dwordx4 v189, s[8:11], s52 offen lds
ds_read_b64_tr_b16 v[116:117], v195 offset:28928
ds_read_b64_tr_b16 v[118:119], v195 offset:32512
v_mfma_f32_32x32x16_bf16 a[192:207], v[152:155], v[76:79], a[192:207]
ds_read_b64_tr_b16 v[120:121], v195 offset:28992
ds_read_b64_tr_b16 v[122:123], v195 offset:32576
v_mfma_f32_32x32x16_bf16 a[208:223], v[156:159], v[76:79], a[208:223]
s_add_u32 m0, s48, 116736
ds_read_b64_tr_b16 v[124:125], v195 offset:29056
ds_read_b64_tr_b16 v[126:127], v195 offset:32640
s_waitcnt lgkmcnt(8)
v_mfma_f32_32x32x16_bf16 a[224:239], v[96:99], v[76:79], a[224:239]
buffer_load_dwordx4 v190, s[8:11], s52 offen lds
ds_read_b64_tr_b16 v[128:129], v195 offset:35840
ds_read_b64_tr_b16 v[130:131], v195 offset:39424
s_branch k2_ph1
k2_plB:
ds_read_b128 v[96:99], v4 offset:0
ds_read_b128 v[100:103], v4 offset:2048
ds_read_b128 v[104:107], v4 offset:4096
ds_read_b128 v[108:111], v4 offset:6144
ds_read_b128 v[112:115], v4 offset:8192
ds_read_b128 v[116:119], v4 offset:10240
ds_read_b128 v[120:123], v4 offset:12288
ds_read_b128 v[124:127], v4 offset:14336
s_waitcnt lgkmcnt(4)
v_mfma_f32_32x32x16_bf16 a[0:15], v[96:99], v[72:75], a[0:15]
ds_read_b128 v[128:131], v4 offset:1024
s_add_u32 m0, s48, 28672
v_mfma_f32_32x32x16_bf16 a[16:31], v[100:103], v[72:75], a[16:31]
ds_read_b128 v[132:135], v4 offset:3072
v_mfma_f32_32x32x16_bf16 a[32:47], v[104:107], v[72:75], a[32:47]
ds_read_b128 v[136:139], v4 offset:5120
s_mov_b32 s52, 0
v_mfma_f32_32x32x16_bf16 a[48:63], v[108:111], v[72:75], a[48:63]
ds_read_b128 v[140:143], v4 offset:7168
s_waitcnt lgkmcnt(4)
v_mfma_f32_32x32x16_bf16 a[64:79], v[112:115], v[72:75], a[64:79]
ds_read_b128 v[144:147], v4 offset:9216
buffer_load_dwordx4 v188, s[76:79], s52 offen lds
v_mfma_f32_32x32x16_bf16 a[80:95], v[116:119], v[72:75], a[80:95]
ds_read_b128 v[148:151], v4 offset:11264
v_mfma_f32_32x32x16_bf16 a[96:111], v[120:123], v[72:75], a[96:111]
ds_read_b128 v[152:155], v4 offset:13312
s_add_u32 m0, s48, 29696
v_mfma_f32_32x32x16_bf16 a[112:127], v[124:127], v[72:75], a[112:127]
ds_read_b128 v[156:159], v4 offset:15360
s_waitcnt lgkmcnt(4)
v_mfma_f32_32x32x16_bf16 a[0:15], v[128:131], v[76:79], a[0:15]
s_add_u32 s29, s29, 16384
s_cmp_eq_u32 s29, 147456
s_cselect_b32 s29, 65536, s29
v_add_u32 v4, s29, v2
v_mfma_f32_32x32x16_bf16 a[16:31], v[132:135], v[76:79], a[16:31]
buffer_load_dwordx4 v189, s[76:79], s52 offen lds
s_add_u32 m0, s48, 30720
v_mfma_f32_32x32x16_bf16 a[32:47], v[136:139], v[76:79], a[32:47]
buffer_load_dwordx4 v190, s[76:79], s52 offen lds
v_mfma_f32_32x32x16_bf16 a[48:63], v[140:143], v[76:79], a[48:63]
s_add_u32 m0, s48, 31744
s_nop 0
buffer_load_dwordx4 v191, s[76:79], s52 offen lds
s_waitcnt lgkmcnt(0)
v_mfma_f32_32x32x16_bf16 a[64:79], v[144:147], v[76:79], a[64:79]
s_add_u32 m0, s48, 32768
v_mfma_f32_32x32x16_bf16 a[80:95], v[148:151], v[76:79], a[80:95]
buffer_load_dwordx4 v192, s[76:79], s52 offen lds
s_add_u32 m0, s48, 33792
v_mfma_f32_32x32x16_bf16 a[96:111], v[152:155], v[76:79], a[96:111]
buffer_load_dwordx4 v193, s[76:79], s52 offen lds
v_mfma_f32_32x32x16_bf16 a[112:127], v[156:159], v[76:79], a[112:127]
s_add_u32 m0, s48, 34816
s_nop 0
buffer_load_dwordx4 v194, s[76:79], s52 offen lds
s_waitcnt lgkmcnt(0)
s_waitcnt vmcnt(7)
s_barrier
ds_read_b64_tr_b16 v[96:97], v195 offset:0
ds_read_b64_tr_b16 v[98:99], v195 offset:3584
ds_read_b64_tr_b16 v[100:101], v195 offset:64
ds_read_b64_tr_b16 v[102:103], v195 offset:3648
ds_read_b64_tr_b16 v[104:105], v195 offset:128
ds_read_b64_tr_b16 v[106:107], v195 offset:3712
ds_read_b64_tr_b16 v[108:109], v195 offset:192
ds_read_b64_tr_b16 v[110:111], v195 offset:3776
ds_read_b64_tr_b16 v[112:113], v195 offset:256
ds_read_b64_tr_b16 v[114:115], v195 offset:3840
ds_read_b64_tr_b16 v[116:117], v195 offset:320
ds_read_b64_tr_b16 v[118:119], v195 offset:3904
ds_read_b64_tr_b16 v[120:121], v195 offset:384
ds_read_b64_tr_b16 v[122:123], v195 offset:3968
ds_read_b64_tr_b16 v[124:125], v195 offset:7168
ds_read_b64_tr_b16 v[126:127], v195 offset:10752
s_waitcnt lgkmcnt(8)
v_mfma_f32_32x32x16_bf16 a[128:143], v[96:99], v[160:163], 0
ds_read_b64_tr_b16 v[128:129], v195 offset:7232
ds_read_b64_tr_b16 v[130:131], v195 offset:10816
v_mov_b32 v13, v6
s_nop 1
v_permlane32_swap_b32 v6, v13
s_nop 1
v_add_f32 v6, v6, v13
v_rcp_f32 v6, v6
s_nop 0
v_mul_f32 v6, v6, v11
v_mfma_f32_32x32x16_bf16 a[144:159], v[100:103], v[160:163], 0
ds_read_b64_tr_b16 v[132:133], v195 offset:7296
ds_read_b64_tr_b16 v[134:135], v195 offset:10880
s_add_u32 m0, s48, 57344
v_mfma_f32_32x32x16_bf16 a[160:175], v[104:107], v[160:163], 0
ds_read_b64_tr_b16 v[136:137], v195 offset:7360
ds_read_b64_tr_b16 v[138:139], v195 offset:10944
s_mov_b32 s52, 0
v_accvgpr_read_b32 v200, a0
v_accvgpr_read_b32 v201, a1
v_mfma_f32_32x32x16_bf16 a[176:191], v[108:111], v[160:163], 0
ds_read_b64_tr_b16 v[140:141], v195 offset:7424
ds_read_b64_tr_b16 v[142:143], v195 offset:11008
buffer_load_dwordx4 v188, s[8:11], s52 offen lds
s_add_u32 m0, s48, 58368
v_mul_f32 v200, v6, v200
s_waitcnt lgkmcnt(8)
v_mfma_f32_32x32x16_bf16 a[192:207], v[112:115], v[160:163], 0
ds_read_b64_tr_b16 v[144:145], v195 offset:7488
ds_read_b64_tr_b16 v[146:147], v195 offset:11072
buffer_load_dwordx4 v189, s[8:11], s52 offen lds
v_mul_f32 v201, v6, v201
v_cvt_pk_bf16_f32 v16, v200, v201
v_mfma_f32_32x32x16_bf16 a[208:223], v[116:119], v[160:163], 0
ds_read_b64_tr_b16 v[148:149], v195 offset:7552
ds_read_b64_tr_b16 v[150:151], v195 offset:11136
s_add_u32 m0, s48, 59392
v_accvgpr_read_b32 v204, a2
v_accvgpr_read_b32 v205, a3
v_mfma_f32_32x32x16_bf16 a[224:239], v[120:123], v[160:163], 0
ds_read_b64_tr_b16 v[152:153], v195 offset:14336
ds_read_b64_tr_b16 v[154:155], v195 offset:17920
buffer_load_dwordx4 v190, s[8:11], s52 offen lds
v_mul_f32 v204, v6, v204
v_mfma_f32_32x32x16_bf16 a[128:143], v[124:127], v[164:167], a[128:143]
ds_read_b64_tr_b16 v[156:157], v195 offset:14400
ds_read_b64_tr_b16 v[158:159], v195 offset:17984
s_add_u32 m0, s48, 60416
v_mul_f32 v205, v6, v205
v_cvt_pk_bf16_f32 v17, v204, v205
s_waitcnt lgkmcnt(8)
v_mfma_f32_32x32x16_bf16 a[144:159], v[128:131], v[164:167], a[144:159]
ds_read_b64_tr_b16 v[96:97], v195 offset:14464
ds_read_b64_tr_b16 v[98:99], v195 offset:18048
buffer_load_dwordx4 v191, s[8:11], s52 offen lds
v_accvgpr_read_b32 v208, a4
v_accvgpr_read_b32 v209, a5
v_mfma_f32_32x32x16_bf16 a[160:175], v[132:135], v[164:167], a[160:175]
ds_read_b64_tr_b16 v[100:101], v195 offset:14528
ds_read_b64_tr_b16 v[102:103], v195 offset:18112
s_add_u32 m0, s48, 61440
s_nop 0
buffer_load_dwordx4 v192, s[8:11], s52 offen lds
v_mul_f32 v208, v6, v208
v_mfma_f32_32x32x16_bf16 a[176:191], v[136:139], v[164:167], a[176:191]
ds_read_b64_tr_b16 v[104:105], v195 offset:14592
ds_read_b64_tr_b16 v[106:107], v195 offset:18176
s_add_u32 m0, s48, 62464
v_mul_f32 v209, v6, v209
v_cvt_pk_bf16_f32 v18, v208, v209
v_mfma_f32_32x32x16_bf16 a[192:207], v[140:143], v[164:167], a[192:207]
ds_read_b64_tr_b16 v[108:109], v195 offset:14656
ds_read_b64_tr_b16 v[110:111], v195 offset:18240
buffer_load_dwordx4 v193, s[8:11], s52 offen lds
v_accvgpr_read_b32 v212, a6
v_accvgpr_read_b32 v213, a7
s_waitcnt lgkmcnt(8)
v_mfma_f32_32x32x16_bf16 a[208:223], v[144:147], v[164:167], a[208:223]
ds_read_b64_tr_b16 v[112:113], v195 offset:14720
ds_read_b64_tr_b16 v[114:115], v195 offset:18304
s_add_u32 m0, s48, 63488
v_mul_f32 v212, v6, v212
v_mul_f32 v213, v6, v213
v_mfma_f32_32x32x16_bf16 a[224:239], v[148:151], v[164:167], a[224:239]
ds_read_b64_tr_b16 v[116:117], v195 offset:21504
ds_read_b64_tr_b16 v[118:119], v195 offset:25088
buffer_load_dwordx4 v194, s[8:11], s52 offen lds
v_cvt_pk_bf16_f32 v19, v212, v213
v_accvgpr_read_b32 v200, a8
v_mfma_f32_32x32x16_bf16 a[128:143], v[152:155], v[168:171], a[128:143]
ds_read_b64_tr_b16 v[120:121], v195 offset:21568
ds_read_b64_tr_b16 v[122:123], v195 offset:25152
s_add_u32 m0, s48, 86016
s_mov_b32 s52, 57344
v_mfma_f32_32x32x16_bf16 a[144:159], v[156:159], v[168:171], a[144:159]
ds_read_b64_tr_b16 v[124:125], v195 offset:21632
ds_read_b64_tr_b16 v[126:127], v195 offset:25216
buffer_load_dwordx4 v188, s[8:11], s52 offen lds
v_accvgpr_read_b32 v201, a9
v_mul_f32 v200, v6, v200
s_waitcnt lgkmcnt(8)
v_mfma_f32_32x32x16_bf16 a[160:175], v[96:99], v[168:171], a[160:175]
ds_read_b64_tr_b16 v[128:129], v195 offset:21696
ds_read_b64_tr_b16 v[130:131], v195 offset:25280
s_add_u32 m0, s48, 87040
v_mul_f32 v201, v6, v201
v_cvt_pk_bf16_f32 v20, v200, v201
v_mfma_f32_32x32x16_bf16 a[176:191], v[100:103], v[168:171], a[176:191]
ds_read_b64_tr_b16 v[132:133], v195 offset:21760
ds_read_b64_tr_b16 v[134:135], v195 offset:25344
buffer_load_dwordx4 v189, s[8:11], s52 offen lds
v_accvgpr_read_b32 v204, a10
v_accvgpr_read_b32 v205, a11
v_mfma_f32_32x32x16_bf16 a[192:207], v[104:107], v[168:171], a[192:207]
ds_read_b64_tr_b16 v[136:137], v195 offset:21824
ds_read_b64_tr_b16 v[138:139], v195 offset:25408
s_add_u32 m0, s48, 88064
v_mul_f32 v204, v6, v204
v_mul_f32 v205, v6, v205
v_mfma_f32_32x32x16_bf16 a[208:223], v[108:111], v[168:171], a[208:223]
ds_read_b64_tr_b16 v[140:141], v195 offset:21888
ds_read_b64_tr_b16 v[142:143], v195 offset:25472
v_cvt_pk_bf16_f32 v21, v204, v205
v_accvgpr_read_b32 v208, a12
s_waitcnt vmcnt(9)
s_barrier
s_waitcnt lgkmcnt(8)
v_mfma_f32_32x32x16_bf16 a[224:239], v[112:115], v[168:171], a[224:239]
ds_read_b64_tr_b16 v[144:145], v195 offset:28672
ds_read_b64_tr_b16 v[146:147], v195 offset:32256
buffer_load_dwordx4 v190, s[8:11], s52 offen lds
s_add_u32 m0, s48, 89088
v_accvgpr_read_b32 v209, a13
v_mfma_f32_32x32x16_bf16 a[128:143], v[116:119], v[172:175], a[128:143]
ds_read_b64_tr_b16 v[148:149], v195 offset:28736
ds_read_b64_tr_b16 v[150:151], v195 offset:32320
buffer_load_dwordx4 v191, s[8:11], s52 offen lds
v_mul_f32 v208, v6, v208
v_mul_f32 v209, v6, v209
v_mfma_f32_32x32x16_bf16 a[144:159], v[120:123], v[172:175], a[144:159]
ds_read_b64_tr_b16 v[152:153], v195 offset:28800
ds_read_b64_tr_b16 v[154:155], v195 offset:32384
s_add_u32 m0, s48, 90112
v_cvt_pk_bf16_f32 v22, v208, v209
v_mfma_f32_32x32x16_bf16 a[160:175], v[124:127], v[172:175], a[160:175]
ds_read_b64_tr_b16 v[156:157], v195 offset:28864
ds_read_b64_tr_b16 v[158:159], v195 offset:32448
buffer_load_dwordx4 v192, s[8:11], s52 offen lds
v_accvgpr_read_b32 v212, a14
v_accvgpr_read_b32 v213, a15
s_waitcnt lgkmcnt(8)
v_mfma_f32_32x32x16_bf16 a[176:191], v[128:131], v[172:175], a[176:191]
ds_read_b64_tr_b16 v[96:97], v195 offset:28928
ds_read_b64_tr_b16 v[98:99], v195 offset:32512
s_add_u32 m0, s48, 91136
v_mul_f32 v212, v6, v212
v_mul_f32 v213, v6, v213
v_mfma_f32_32x32x16_bf16 a[192:207], v[132:135], v[172:175], a[192:207]
ds_read_b64_tr_b16 v[100:101], v195 offset:28992
ds_read_b64_tr_b16 v[102:103], v195 offset:32576
buffer_load_dwordx4 v193, s[8:11], s52 offen lds
v_cvt_pk_bf16_f32 v23, v212, v213
v_accvgpr_read_b32 v200, a16
v_mfma_f32_32x32x16_bf16 a[208:223], v[136:139], v[172:175], a[208:223]
ds_read_b64_tr_b16 v[104:105], v195 offset:29056
ds_read_b64_tr_b16 v[106:107], v195 offset:32640
s_add_u32 m0, s48, 92160
s_nop 0
buffer_load_dwordx4 v194, s[8:11], s52 offen lds
v_accvgpr_read_b32 v201, a17
v_mfma_f32_32x32x16_bf16 a[224:239], v[140:143], v[172:175], a[224:239]
ds_read_b64_tr_b16 v[108:109], v195 offset:35840
ds_read_b64_tr_b16 v[110:111], v195 offset:39424
s_add_u32 m0, s48, 114688
v_mul_f32 v200, v6, v200
v_mul_f32 v201, v6, v201
s_waitcnt lgkmcnt(8)
v_mfma_f32_32x32x16_bf16 a[128:143], v[144:147], v[176:179], a[128:143]
ds_read_b64_tr_b16 v[112:113], v195 offset:35904
ds_read_b64_tr_b16 v[114:115], v195 offset:39488
s_mov_b32 s52, 114688
v_cvt_pk_bf16_f32 v24, v200, v201
v_accvgpr_read_b32 v204, a18
v_mfma_f32_32x32x16_bf16 a[144:159], v[148:151], v[176:179], a[144:159]
ds_read_b64_tr_b16 v[116:117], v195 offset:35968
ds_read_b64_tr_b16 v[118:119], v195 offset:39552
buffer_load_dwordx4 v188, s[8:11], s52 offen lds
v_accvgpr_read_b32 v205, a19
v_mul_f32 v204, v6, v204
v_mfma_f32_32x32x16_bf16 a[160:175], v[152:155], v[176:179], a[160:175]
ds_read_b64_tr_b16 v[120:121], v195 offset:36032
ds_read_b64_tr_b16 v[122:123], v195 offset:39616
s_add_u32 m0, s48, 115712
v_mul_f32 v205, v6, v205
v_mfma_f32_32x32x16_bf16 a[176:191], v[156:159], v[176:179], a[176:191]
ds_read_b64_tr_b16 v[124:125], v195 offset:36096
ds_read_b64_tr_b16 v[126:127], v195 offset:39680
buffer_load_dwordx4 v189, s[8:11], s52 offen lds
s_add_u32 m0, s48, 116736
v_cvt_pk_bf16_f32 v25, v204, v205
s_waitcnt lgkmcnt(8)
v_mfma_f32_32x32x16_bf16 a[192:207], v[96:99], v[176:179], a[192:207]
ds_read_b64_tr_b16 v[128:129], v195 offset:36160
ds_read_b64_tr_b16 v[130:131], v195 offset:39744
buffer_load_dwordx4 v190, s[8:11], s52 offen lds
v_accvgpr_read_b32 v208, a20
v_accvgpr_read_b32 v209, a21
v_mfma_f32_32x32x16_bf16 a[208:223], v[100:103], v[176:179], a[208:223]
ds_read_b64_tr_b16 v[132:133], v195 offset:36224
ds_read_b64_tr_b16 v[134:135], v195 offset:39808
s_add_u32 m0, s48, 117760
v_mul_f32 v208, v6, v208
v_mul_f32 v209, v6, v209
v_mfma_f32_32x32x16_bf16 a[224:239], v[104:107], v[176:179], a[224:239]
ds_read_b64_tr_b16 v[136:137], v195 offset:43008
ds_read_b64_tr_b16 v[138:139], v195 offset:46592
buffer_load_dwordx4 v191, s[8:11], s52 offen lds
v_cvt_pk_bf16_f32 v26, v208, v209
v_accvgpr_read_b32 v212, a22
v_mfma_f32_32x32x16_bf16 a[128:143], v[108:111], v[180:183], a[128:143]
ds_read_b64_tr_b16 v[140:141], v195 offset:43072
ds_read_b64_tr_b16 v[142:143], v195 offset:46656
s_add_u32 m0, s48, 118784
v_accvgpr_read_b32 v213, a23
v_mul_f32 v212, v6, v212
s_waitcnt lgkmcnt(8)
v_mfma_f32_32x32x16_bf16 a[144:159], v[112:115], v[180:183], a[144:159]
ds_read_b64_tr_b16 v[144:145], v195 offset:43136
ds_read_b64_tr_b16 v[146:147], v195 offset:46720
buffer_load_dwordx4 v192, s[8:11], s52 offen lds
v_mul_f32 v213, v6, v213
v_cvt_pk_bf16_f32 v27, v212, v213
v_mfma_f32_32x32x16_bf16 a[160:175], v[116:119], v[180:183], a[160:175]
ds_read_b64_tr_b16 v[148:149], v195 offset:43200
ds_read_b64_tr_b16 v[150:151], v195 offset:46784
s_add_u32 m0, s48, 119808
s_nop 0
buffer_load_dwordx4 v193, s[8:11], s52 offen lds
v_accvgpr_read_b32 v200, a24
v_mfma_f32_32x32x16_bf16 a[176:191], v[120:123], v[180:183], a[176:191]
ds_read_b64_tr_b16 v[152:153], v195 offset:43264
ds_read_b64_tr_b16 v[154:155], v195 offset:46848
s_add_u32 m0, s48, 120832
v_accvgpr_read_b32 v201, a25
v_mul_f32 v200, v6, v200
v_mfma_f32_32x32x16_bf16 a[192:207], v[124:127], v[180:183], a[192:207]
ds_read_b64_tr_b16 v[156:157], v195 offset:43328
ds_read_b64_tr_b16 v[158:159], v195 offset:46912
buffer_load_dwordx4 v194, s[8:11], s52 offen lds
v_mul_f32 v201, v6, v201
s_waitcnt lgkmcnt(8)
v_mfma_f32_32x32x16_bf16 a[208:223], v[128:131], v[180:183], a[208:223]
ds_read_b64_tr_b16 v[96:97], v195 offset:43392
ds_read_b64_tr_b16 v[98:99], v195 offset:46976
v_cvt_pk_bf16_f32 v28, v200, v201
v_accvgpr_read_b32 v204, a26
s_waitcnt vmcnt(14)
s_barrier
v_mfma_f32_32x32x16_bf16 a[224:239], v[132:135], v[180:183], a[224:239]
s_add_u32 m0, s48, 0
s_mov_b32 s52, 172032
ds_read_b64_tr_b16 v[100:101], v196 offset:0
ds_read_b64_tr_b16 v[102:103], v196 offset:3584
v_accvgpr_read_b32 v205, a27
v_mfma_f32_32x32x16_bf16 a[128:143], v[136:139], v[184:187], a[128:143]
buffer_load_dwordx4 v188, s[8:11], s52 offen lds
ds_read_b64_tr_b16 v[104:105], v196 offset:64
ds_read_b64_tr_b16 v[106:107], v196 offset:3648
v_mul_f32 v204, v6, v204
v_mul_f32 v205, v6, v205
v_mfma_f32_32x32x16_bf16 a[144:159], v[140:143], v[184:187], a[144:159]
ds_read_b64_tr_b16 v[108:109], v196 offset:128
ds_read_b64_tr_b16 v[110:111], v196 offset:3712
v_cvt_pk_bf16_f32 v29, v204, v205
v_accvgpr_read_b32 v208, a28
v_accvgpr_read_b32 v209, a29
s_waitcnt lgkmcnt(8)
v_mfma_f32_32x32x16_bf16 a[160:175], v[144:147], v[184:187], a[160:175]
s_add_u32 m0, s48, 1024
ds_read_b64_tr_b16 v[112:113], v196 offset:192
ds_read_b64_tr_b16 v[114:115], v196 offset:3776
v_mul_f32 v208, v6, v208
v_mul_f32 v209, v6, v209
v_mfma_f32_32x32x16_bf16 a[176:191], v[148:151], v[184:187], a[176:191]
buffer_load_dwordx4 v189, s[8:11], s52 offen lds
ds_read_b64_tr_b16 v[116:117], v196 offset:256
ds_read_b64_tr_b16 v[118:119], v196 offset:3840
v_cvt_pk_bf16_f32 v30, v208, v209
v_accvgpr_read_b32 v212, a30
v_mfma_f32_32x32x16_bf16 a[192:207], v[152:155], v[184:187], a[192:207]
ds_read_b64_tr_b16 v[120:121], v196 offset:320
ds_read_b64_tr_b16 v[122:123], v196 offset:3904
v_accvgpr_read_b32 v213, a31
v_mul_f32 v212, v6, v212
v_mul_f32 v213, v6, v213
v_mfma_f32_32x32x16_bf16 a[208:223], v[156:159], v[184:187], a[208:223]
s_add_u32 m0, s48, 2048
ds_read_b64_tr_b16 v[124:125], v196 offset:384
ds_read_b64_tr_b16 v[126:127], v196 offset:3968
v_cvt_pk_bf16_f32 v31, v212, v213
s_waitcnt lgkmcnt(8)
v_mfma_f32_32x32x16_bf16 a[224:239], v[96:99], v[184:187], a[224:239]
buffer_load_dwordx4 v190, s[8:11], s52 offen lds
ds_read_b64_tr_b16 v[128:129], v196 offset:7168
ds_read_b64_tr_b16 v[130:131], v196 offset:10752
v_accvgpr_read_b32 v200, a32
v_accvgpr_read_b32 v201, a33
v_mfma_f32_32x32x16_bf16 a[128:143], v[100:103], v[16:19], a[128:143]
ds_read_b64_tr_b16 v[132:133], v196 offset:7232
ds_read_b64_tr_b16 v[134:135], v196 offset:10816
v_mul_f32 v200, v6, v200
v_mul_f32 v201, v6, v201
v_cvt_pk_bf16_f32 v32, v200, v201
v_mfma_f32_32x32x16_bf16 a[144:159], v[104:107], v[16:19], a[144:159]
s_add_u32 m0, s48, 3072
ds_read_b64_tr_b16 v[136:137], v196 offset:7296
ds_read_b64_tr_b16 v[138:139], v196 offset:10880
v_accvgpr_read_b32 v204, a34
v_accvgpr_read_b32 v205, a35
v_mfma_f32_32x32x16_bf16 a[160:175], v[108:111], v[16:19], a[160:175]
buffer_load_dwordx4 v191, s[8:11], s52 offen lds
ds_read_b64_tr_b16 v[140:141], v196 offset:7360
ds_read_b64_tr_b16 v[142:143], v196 offset:10944
v_mul_f32 v204, v6, v204
v_mul_f32 v205, v6, v205
s_waitcnt lgkmcnt(8)
v_mfma_f32_32x32x16_bf16 a[176:191], v[112:115], v[16:19], a[176:191]
ds_read_b64_tr_b16 v[144:145], v196 offset:7424
ds_read_b64_tr_b16 v[146:147], v196 offset:11008
v_cvt_pk_bf16_f32 v33, v204, v205
v_accvgpr_read_b32 v208, a36
v_accvgpr_read_b32 v209, a37
v_mfma_f32_32x32x16_bf16 a[192:207], v[116:119], v[16:19], a[192:207]
s_add_u32 m0, s48, 4096
ds_read_b64_tr_b16 v[148:149], v196 offset:7488
ds_read_b64_tr_b16 v[150:151], v196 offset:11072
v_mul_f32 v208, v6, v208
v_mul_f32 v209, v6, v209
v_mfma_f32_32x32x16_bf16 a[208:223], v[120:123], v[16:19], a[208:223]
buffer_load_dwordx4 v192, s[8:11], s52 offen lds
ds_read_b64_tr_b16 v[152:153], v196 offset:7552
ds_read_b64_tr_b16 v[154:155], v196 offset:11136
v_cvt_pk_bf16_f32 v34, v208, v209
v_accvgpr_read_b32 v212, a38
v_mfma_f32_32x32x16_bf16 a[224:239], v[124:127], v[16:19], a[224:239]
ds_read_b64_tr_b16 v[156:157], v196 offset:14336
ds_read_b64_tr_b16 v[158:159], v196 offset:17920
v_accvgpr_read_b32 v213, a39
v_mul_f32 v212, v6, v212
s_waitcnt lgkmcnt(8)
v_mfma_f32_32x32x16_bf16 a[128:143], v[128:131], v[20:23], a[128:143]
s_add_u32 m0, s48, 5120
ds_read_b64_tr_b16 v[96:97], v196 offset:14400
ds_read_b64_tr_b16 v[98:99], v196 offset:17984
v_mul_f32 v213, v6, v213
v_cvt_pk_bf16_f32 v35, v212, v213
v_mfma_f32_32x32x16_bf16 a[144:159], v[132:135], v[20:23], a[144:159]
buffer_load_dwordx4 v193, s[8:11], s52 offen lds
ds_read_b64_tr_b16 v[100:101], v196 offset:14464
ds_read_b64_tr_b16 v[102:103], v196 offset:18048
v_accvgpr_read_b32 v200, a40
v_accvgpr_read_b32 v201, a41
v_mfma_f32_32x32x16_bf16 a[160:175], v[136:139], v[20:23], a[160:175]
ds_read_b64_tr_b16 v[104:105], v196 offset:14528
ds_read_b64_tr_b16 v[106:107], v196 offset:18112
v_mul_f32 v200, v6, v200
v_mul_f32 v201, v6, v201
v_cvt_pk_bf16_f32 v36, v200, v201
v_mfma_f32_32x32x16_bf16 a[176:191], v[140:143], v[20:23], a[176:191]
s_add_u32 m0, s48, 6144
ds_read_b64_tr_b16 v[108:109], v196 offset:14592
ds_read_b64_tr_b16 v[110:111], v196 offset:18176
v_accvgpr_read_b32 v204, a42
v_accvgpr_read_b32 v205, a43
s_waitcnt lgkmcnt(8)
v_mfma_f32_32x32x16_bf16 a[192:207], v[144:147], v[20:23], a[192:207]
buffer_load_dwordx4 v194, s[8:11], s52 offen lds
ds_read_b64_tr_b16 v[112:113], v196 offset:14656
ds_read_b64_tr_b16 v[114:115], v196 offset:18240
v_mul_f32 v204, v6, v204
v_mul_f32 v205, v6, v205
v_mfma_f32_32x32x16_bf16 a[208:223], v[148:151], v[20:23], a[208:223]
ds_read_b64_tr_b16 v[116:117], v196 offset:14720
ds_read_b64_tr_b16 v[118:119], v196 offset:18304
v_cvt_pk_bf16_f32 v37, v204, v205
v_accvgpr_read_b32 v208, a44
v_accvgpr_read_b32 v209, a45
v_mfma_f32_32x32x16_bf16 a[224:239], v[152:155], v[20:23], a[224:239]
ds_read_b64_tr_b16 v[120:121], v196 offset:21504
ds_read_b64_tr_b16 v[122:123], v196 offset:25088
v_mul_f32 v208, v6, v208
v_mul_f32 v209, v6, v209
v_cvt_pk_bf16_f32 v38, v208, v209
v_mfma_f32_32x32x16_bf16 a[128:143], v[156:159], v[24:27], a[128:143]
ds_read_b64_tr_b16 v[124:125], v196 offset:21568
ds_read_b64_tr_b16 v[126:127], v196 offset:25152
v_accvgpr_read_b32 v212, a46
v_accvgpr_read_b32 v213, a47
v_mul_f32 v212, v6, v212
s_waitcnt lgkmcnt(8)
v_mfma_f32_32x32x16_bf16 a[144:159], v[96:99], v[24:27], a[144:159]
ds_read_b64_tr_b16 v[128:129], v196 offset:21632
ds_read_b64_tr_b16 v[130:131], v196 offset:25216
v_mul_f32 v213, v6, v213
v_cvt_pk_bf16_f32 v39, v212, v213
v_mfma_f32_32x32x16_bf16 a[160:175], v[100:103], v[24:27], a[160:175]
ds_read_b64_tr_b16 v[132:133], v196 offset:21696
ds_read_b64_tr_b16 v[134:135], v196 offset:25280
v_accvgpr_read_b32 v200, a48
v_accvgpr_read_b32 v201, a49
v_mul_f32 v200, v6, v200
v_mfma_f32_32x32x16_bf16 a[176:191], v[104:107], v[24:27], a[176:191]
ds_read_b64_tr_b16 v[136:137], v196 offset:21760
ds_read_b64_tr_b16 v[138:139], v196 offset:25344
v_mul_f32 v201, v6, v201
v_cvt_pk_bf16_f32 v40, v200, v201
v_accvgpr_read_b32 v204, a50
v_mfma_f32_32x32x16_bf16 a[192:207], v[108:111], v[24:27], a[192:207]
ds_read_b64_tr_b16 v[140:141], v196 offset:21824
ds_read_b64_tr_b16 v[142:143], v196 offset:25408
v_accvgpr_read_b32 v205, a51
v_mul_f32 v204, v6, v204
v_mul_f32 v205, v6, v205
s_waitcnt lgkmcnt(8)
v_mfma_f32_32x32x16_bf16 a[208:223], v[112:115], v[24:27], a[208:223]
ds_read_b64_tr_b16 v[144:145], v196 offset:21888
ds_read_b64_tr_b16 v[146:147], v196 offset:25472
v_cvt_pk_bf16_f32 v41, v204, v205
v_accvgpr_read_b32 v208, a52
s_waitcnt vmcnt(14)
s_barrier
v_mfma_f32_32x32x16_bf16 a[224:239], v[116:119], v[24:27], a[224:239]
s_add_u32 m0, s48, 28672
s_mov_b32 s52, 448
ds_read_b64_tr_b16 v[148:149], v196 offset:28672
ds_read_b64_tr_b16 v[150:151], v196 offset:32256
v_accvgpr_read_b32 v209, a53
v_mfma_f32_32x32x16_bf16 a[128:143], v[120:123], v[28:31], a[128:143]
buffer_load_dwordx4 v188, s[12:15], s52 offen lds
ds_read_b64_tr_b16 v[152:153], v196 offset:28736
ds_read_b64_tr_b16 v[154:155], v196 offset:32320
v_mul_f32 v208, v6, v208
v_mul_f32 v209, v6, v209
v_mfma_f32_32x32x16_bf16 a[144:159], v[124:127], v[28:31], a[144:159]
ds_read_b64_tr_b16 v[156:157], v196 offset:28800
ds_read_b64_tr_b16 v[158:159], v196 offset:32384
v_cvt_pk_bf16_f32 v42, v208, v209
v_accvgpr_read_b32 v212, a54
v_accvgpr_read_b32 v213, a55
s_waitcnt lgkmcnt(8)
v_mfma_f32_32x32x16_bf16 a[160:175], v[128:131], v[28:31], a[160:175]
s_add_u32 m0, s48, 29696
ds_read_b64_tr_b16 v[96:97], v196 offset:28864
ds_read_b64_tr_b16 v[98:99], v196 offset:32448
v_mul_f32 v212, v6, v212
v_mfma_f32_32x32x16_bf16 a[176:191], v[132:135], v[28:31], a[176:191]
buffer_load_dwordx4 v189, s[12:15], s52 offen lds
ds_read_b64_tr_b16 v[100:101], v196 offset:28928
ds_read_b64_tr_b16 v[102:103], v196 offset:32512
v_mul_f32 v213, v6, v213
v_cvt_pk_bf16_f32 v43, v212, v213
v_mfma_f32_32x32x16_bf16 a[192:207], v[136:139], v[28:31], a[192:207]
ds_read_b64_tr_b16 v[104:105], v196 offset:28992
ds_read_b64_tr_b16 v[106:107], v196 offset:32576
v_accvgpr_read_b32 v200, a56
v_accvgpr_read_b32 v201, a57
v_mul_f32 v200, v6, v200
v_mfma_f32_32x32x16_bf16 a[208:223], v[140:143], v[28:31], a[208:223]
s_add_u32 m0, s48, 30720
ds_read_b64_tr_b16 v[108:109], v196 offset:29056
ds_read_b64_tr_b16 v[110:111], v196 offset:32640
v_mul_f32 v201, v6, v201
v_cvt_pk_bf16_f32 v44, v200, v201
s_waitcnt lgkmcnt(8)
v_mfma_f32_32x32x16_bf16 a[224:239], v[144:147], v[28:31], a[224:239]
buffer_load_dwordx4 v190, s[12:15], s52 offen lds
ds_read_b64_tr_b16 v[112:113], v196 offset:35840
ds_read_b64_tr_b16 v[114:115], v196 offset:39424
v_accvgpr_read_b32 v204, a58
v_accvgpr_read_b32 v205, a59
v_mfma_f32_32x32x16_bf16 a[128:143], v[148:151], v[32:35], a[128:143]
ds_read_b64_tr_b16 v[116:117], v196 offset:35904
ds_read_b64_tr_b16 v[118:119], v196 offset:39488
v_mul_f32 v204, v6, v204
v_mul_f32 v205, v6, v205
v_cvt_pk_bf16_f32 v45, v204, v205
v_mfma_f32_32x32x16_bf16 a[144:159], v[152:155], v[32:35], a[144:159]
s_add_u32 m0, s48, 31744
ds_read_b64_tr_b16 v[120:121], v196 offset:35968
ds_read_b64_tr_b16 v[122:123], v196 offset:39552
v_accvgpr_read_b32 v208, a60
v_accvgpr_read_b32 v209, a61
v_mfma_f32_32x32x16_bf16 a[160:175], v[156:159], v[32:35], a[160:175]
buffer_load_dwordx4 v191, s[12:15], s52 offen lds
ds_read_b64_tr_b16 v[124:125], v196 offset:36032
ds_read_b64_tr_b16 v[126:127], v196 offset:39616
v_mul_f32 v208, v6, v208
v_mul_f32 v209, v6, v209
s_waitcnt lgkmcnt(8)
v_mfma_f32_32x32x16_bf16 a[176:191], v[96:99], v[32:35], a[176:191]
ds_read_b64_tr_b16 v[128:129], v196 offset:36096
ds_read_b64_tr_b16 v[130:131], v196 offset:39680
v_cvt_pk_bf16_f32 v46, v208, v209
v_accvgpr_read_b32 v212, a62
v_mfma_f32_32x32x16_bf16 a[192:207], v[100:103], v[32:35], a[192:207]
s_add_u32 m0, s48, 32768
ds_read_b64_tr_b16 v[132:133], v196 offset:36160
ds_read_b64_tr_b16 v[134:135], v196 offset:39744
v_accvgpr_read_b32 v213, a63
v_mul_f32 v212, v6, v212
v_mfma_f32_32x32x16_bf16 a[208:223], v[104:107], v[32:35], a[208:223]
buffer_load_dwordx4 v192, s[12:15], s52 offen lds
ds_read_b64_tr_b16 v[136:137], v196 offset:36224
ds_read_b64_tr_b16 v[138:139], v196 offset:39808
v_mul_f32 v213, v6, v213
v_cvt_pk_bf16_f32 v47, v212, v213
v_mfma_f32_32x32x16_bf16 a[224:239], v[108:111], v[32:35], a[224:239]
ds_read_b64_tr_b16 v[140:141], v196 offset:43008
ds_read_b64_tr_b16 v[142:143], v196 offset:46592
v_accvgpr_read_b32 v200, a64
v_accvgpr_read_b32 v201, a65
v_mul_f32 v200, v6, v200
s_waitcnt lgkmcnt(8)
v_mfma_f32_32x32x16_bf16 a[128:143], v[112:115], v[36:39], a[128:143]
s_add_u32 m0, s48, 33792
ds_read_b64_tr_b16 v[144:145], v196 offset:43072
ds_read_b64_tr_b16 v[146:147], v196 offset:46656
v_mul_f32 v201, v6, v201
v_cvt_pk_bf16_f32 v48, v200, v201
v_mfma_f32_32x32x16_bf16 a[144:159], v[116:119], v[36:39], a[144:159]
buffer_load_dwordx4 v193, s[12:15], s52 offen lds
ds_read_b64_tr_b16 v[148:149], v196 offset:43136
ds_read_b64_tr_b16 v[150:151], v196 offset:46720
v_accvgpr_read_b32 v204, a66
v_accvgpr_read_b32 v205, a67
v_mfma_f32_32x32x16_bf16 a[160:175], v[120:123], v[36:39], a[160:175]
ds_read_b64_tr_b16 v[152:153], v196 offset:43200
ds_read_b64_tr_b16 v[154:155], v196 offset:46784
v_mul_f32 v204, v6, v204
v_mul_f32 v205, v6, v205
v_cvt_pk_bf16_f32 v49, v204, v205
v_mfma_f32_32x32x16_bf16 a[176:191], v[124:127], v[36:39], a[176:191]
s_add_u32 m0, s48, 34816
ds_read_b64_tr_b16 v[156:157], v196 offset:43264
ds_read_b64_tr_b16 v[158:159], v196 offset:46848
v_accvgpr_read_b32 v208, a68
v_accvgpr_read_b32 v209, a69
s_waitcnt lgkmcnt(8)
v_mfma_f32_32x32x16_bf16 a[192:207], v[128:131], v[36:39], a[192:207]
buffer_load_dwordx4 v194, s[12:15], s52 offen lds
ds_read_b64_tr_b16 v[96:97], v196 offset:43328
ds_read_b64_tr_b16 v[98:99], v196 offset:46912
v_mul_f32 v208, v6, v208
v_mfma_f32_32x32x16_bf16 a[208:223], v[132:135], v[36:39], a[208:223]
ds_read_b64_tr_b16 v[100:101], v196 offset:43392
ds_read_b64_tr_b16 v[102:103], v196 offset:46976
v_mul_f32 v209, v6, v209
v_cvt_pk_bf16_f32 v50, v208, v209
v_accvgpr_read_b32 v212, a70
v_mfma_f32_32x32x16_bf16 a[224:239], v[136:139], v[36:39], a[224:239]
ds_read_b64_tr_b16 v[104:105], v196 offset:50176
ds_read_b64_tr_b16 v[106:107], v196 offset:53760
v_accvgpr_read_b32 v213, a71
v_mul_f32 v212, v6, v212
v_mul_f32 v213, v6, v213
v_mfma_f32_32x32x16_bf16 a[128:143], v[140:143], v[40:43], a[128:143]
ds_read_b64_tr_b16 v[108:109], v196 offset:50240
ds_read_b64_tr_b16 v[110:111], v196 offset:53824
v_cvt_pk_bf16_f32 v51, v212, v213
v_accvgpr_read_b32 v200, a72
v_accvgpr_read_b32 v201, a73
s_waitcnt lgkmcnt(8)
v_mfma_f32_32x32x16_bf16 a[144:159], v[144:147], v[40:43], a[144:159]
ds_read_b64_tr_b16 v[112:113], v196 offset:50304
ds_read_b64_tr_b16 v[114:115], v196 offset:53888
v_mul_f32 v200, v6, v200
v_mul_f32 v201, v6, v201
v_cvt_pk_bf16_f32 v52, v200, v201
v_mfma_f32_32x32x16_bf16 a[160:175], v[148:151], v[40:43], a[160:175]
ds_read_b64_tr_b16 v[116:117], v196 offset:50368
ds_read_b64_tr_b16 v[118:119], v196 offset:53952
v_accvgpr_read_b32 v204, a74
v_accvgpr_read_b32 v205, a75
v_mul_f32 v204, v6, v204
v_mfma_f32_32x32x16_bf16 a[176:191], v[152:155], v[40:43], a[176:191]
ds_read_b64_tr_b16 v[120:121], v196 offset:50432
ds_read_b64_tr_b16 v[122:123], v196 offset:54016
v_mul_f32 v205, v6, v205
v_cvt_pk_bf16_f32 v53, v204, v205
v_accvgpr_read_b32 v208, a76
v_mfma_f32_32x32x16_bf16 a[192:207], v[156:159], v[40:43], a[192:207]
ds_read_b64_tr_b16 v[124:125], v196 offset:50496
ds_read_b64_tr_b16 v[126:127], v196 offset:54080
v_accvgpr_read_b32 v209, a77
v_mul_f32 v208, v6, v208
v_mul_f32 v209, v6, v209
s_waitcnt lgkmcnt(8)
v_mfma_f32_32x32x16_bf16 a[208:223], v[96:99], v[40:43], a[208:223]
ds_read_b64_tr_b16 v[128:129], v196 offset:50560
ds_read_b64_tr_b16 v[130:131], v196 offset:54144
v_cvt_pk_bf16_f32 v54, v208, v209
v_accvgpr_read_b32 v212, a78
s_waitcnt vmcnt(14)
s_barrier
v_mfma_f32_32x32x16_bf16 a[224:239], v[100:103], v[40:43], a[224:239]
s_add_u32 m0, s48, 57344
s_mov_b32 s52, 448
ds_read_b64_tr_b16 v[132:133], v197 offset:0
ds_read_b64_tr_b16 v[134:135], v197 offset:3584
v_mfma_f32_32x32x16_bf16 a[128:143], v[104:107], v[44:47], a[128:143]
buffer_load_dwordx4 v188, s[76:79], s52 offen lds
ds_read_b64_tr_b16 v[136:137], v197 offset:64
ds_read_b64_tr_b16 v[138:139], v197 offset:3648
v_accvgpr_read_b32 v213, a79
v_mul_f32 v212, v6, v212
v_mfma_f32_32x32x16_bf16 a[144:159], v[108:111], v[44:47], a[144:159]
ds_read_b64_tr_b16 v[140:141], v197 offset:128
ds_read_b64_tr_b16 v[142:143], v197 offset:3712
v_mul_f32 v213, v6, v213
v_cvt_pk_bf16_f32 v55, v212, v213
v_accvgpr_read_b32 v200, a80
s_waitcnt lgkmcnt(8)
v_mfma_f32_32x32x16_bf16 a[160:175], v[112:115], v[44:47], a[160:175]
s_add_u32 m0, s48, 58368
ds_read_b64_tr_b16 v[144:145], v197 offset:192
ds_read_b64_tr_b16 v[146:147], v197 offset:3776
v_accvgpr_read_b32 v201, a81
v_mul_f32 v200, v6, v200
v_mfma_f32_32x32x16_bf16 a[176:191], v[116:119], v[44:47], a[176:191]
buffer_load_dwordx4 v189, s[76:79], s52 offen lds
ds_read_b64_tr_b16 v[148:149], v197 offset:256
ds_read_b64_tr_b16 v[150:151], v197 offset:3840
v_mul_f32 v201, v6, v201
v_cvt_pk_bf16_f32 v56, v200, v201
v_mfma_f32_32x32x16_bf16 a[192:207], v[120:123], v[44:47], a[192:207]
ds_read_b64_tr_b16 v[152:153], v197 offset:320
ds_read_b64_tr_b16 v[154:155], v197 offset:3904
v_accvgpr_read_b32 v204, a82
v_accvgpr_read_b32 v205, a83
v_mul_f32 v204, v6, v204
v_mfma_f32_32x32x16_bf16 a[208:223], v[124:127], v[44:47], a[208:223]
s_add_u32 m0, s48, 59392
ds_read_b64_tr_b16 v[156:157], v197 offset:384
ds_read_b64_tr_b16 v[158:159], v197 offset:3968
v_mul_f32 v205, v6, v205
v_cvt_pk_bf16_f32 v57, v204, v205
s_waitcnt lgkmcnt(8)
v_mfma_f32_32x32x16_bf16 a[224:239], v[128:131], v[44:47], a[224:239]
buffer_load_dwordx4 v190, s[76:79], s52 offen lds
ds_read_b64_tr_b16 v[96:97], v197 offset:7168
ds_read_b64_tr_b16 v[98:99], v197 offset:10752
v_accvgpr_read_b32 v208, a84
v_accvgpr_read_b32 v209, a85
v_mfma_f32_32x32x16_bf16 a[128:143], v[132:135], v[48:51], a[128:143]
ds_read_b64_tr_b16 v[100:101], v197 offset:7232
ds_read_b64_tr_b16 v[102:103], v197 offset:10816
v_mul_f32 v208, v6, v208
v_mul_f32 v209, v6, v209
v_mfma_f32_32x32x16_bf16 a[144:159], v[136:139], v[48:51], a[144:159]
s_add_u32 m0, s48, 60416
ds_read_b64_tr_b16 v[104:105], v197 offset:7296
ds_read_b64_tr_b16 v[106:107], v197 offset:10880
v_cvt_pk_bf16_f32 v58, v208, v209
v_accvgpr_read_b32 v212, a86
v_mfma_f32_32x32x16_bf16 a[160:175], v[140:143], v[48:51], a[160:175]
buffer_load_dwordx4 v191, s[76:79], s52 offen lds
ds_read_b64_tr_b16 v[108:109], v197 offset:7360
ds_read_b64_tr_b16 v[110:111], v197 offset:10944
v_accvgpr_read_b32 v213, a87
v_mul_f32 v212, v6, v212
s_waitcnt lgkmcnt(8)
v_mfma_f32_32x32x16_bf16 a[176:191], v[144:147], v[48:51], a[176:191]
ds_read_b64_tr_b16 v[112:113], v197 offset:7424
ds_read_b64_tr_b16 v[114:115], v197 offset:11008
v_mul_f32 v213, v6, v213
v_cvt_pk_bf16_f32 v59, v212, v213
v_accvgpr_read_b32 v200, a88
v_mfma_f32_32x32x16_bf16 a[192:207], v[148:151], v[48:51], a[192:207]
s_add_u32 m0, s48, 61440
ds_read_b64_tr_b16 v[116:117], v197 offset:7488
ds_read_b64_tr_b16 v[118:119], v197 offset:11072
v_accvgpr_read_b32 v201, a89
v_mul_f32 v200, v6, v200
v_mfma_f32_32x32x16_bf16 a[208:223], v[152:155], v[48:51], a[208:223]
buffer_load_dwordx4 v192, s[76:79], s52 offen lds
ds_read_b64_tr_b16 v[120:121], v197 offset:7552
ds_read_b64_tr_b16 v[122:123], v197 offset:11136
v_mul_f32 v201, v6, v201
v_cvt_pk_bf16_f32 v60, v200, v201
v_mfma_f32_32x32x16_bf16 a[224:239], v[156:159], v[48:51], a[224:239]
ds_read_b64_tr_b16 v[124:125], v197 offset:14336
ds_read_b64_tr_b16 v[126:127], v197 offset:17920
v_accvgpr_read_b32 v204, a90
v_accvgpr_read_b32 v205, a91
v_mul_f32 v204, v6, v204
s_waitcnt lgkmcnt(8)
v_mfma_f32_32x32x16_bf16 a[128:143], v[96:99], v[52:55], a[128:143]
s_add_u32 m0, s48, 62464
ds_read_b64_tr_b16 v[128:129], v197 offset:14400
ds_read_b64_tr_b16 v[130:131], v197 offset:17984
v_mul_f32 v205, v6, v205
v_cvt_pk_bf16_f32 v61, v204, v205
v_mfma_f32_32x32x16_bf16 a[144:159], v[100:103], v[52:55], a[144:159]
buffer_load_dwordx4 v193, s[76:79], s52 offen lds
ds_read_b64_tr_b16 v[132:133], v197 offset:14464
ds_read_b64_tr_b16 v[134:135], v197 offset:18048
v_accvgpr_read_b32 v208, a92
v_mfma_f32_32x32x16_bf16 a[160:175], v[104:107], v[52:55], a[160:175]
ds_read_b64_tr_b16 v[136:137], v197 offset:14528
ds_read_b64_tr_b16 v[138:139], v197 offset:18112
v_accvgpr_read_b32 v209, a93
v_mul_f32 v208, v6, v208
v_mul_f32 v209, v6, v209
v_mfma_f32_32x32x16_bf16 a[176:191], v[108:111], v[52:55], a[176:191]
s_add_u32 m0, s48, 63488
ds_read_b64_tr_b16 v[140:141], v197 offset:14592
ds_read_b64_tr_b16 v[142:143], v197 offset:18176
v_cvt_pk_bf16_f32 v62, v208, v209
v_accvgpr_read_b32 v212, a94
s_waitcnt lgkmcnt(8)
v_mfma_f32_32x32x16_bf16 a[192:207], v[112:115], v[52:55], a[192:207]
buffer_load_dwordx4 v194, s[76:79], s52 offen lds
ds_read_b64_tr_b16 v[144:145], v197 offset:14656
ds_read_b64_tr_b16 v[146:147], v197 offset:18240
v_accvgpr_read_b32 v213, a95
v_mul_f32 v212, v6, v212
v_mfma_f32_32x32x16_bf16 a[208:223], v[116:119], v[52:55], a[208:223]
ds_read_b64_tr_b16 v[148:149], v197 offset:14720
ds_read_b64_tr_b16 v[150:151], v197 offset:18304
v_mul_f32 v213, v6, v213
v_cvt_pk_bf16_f32 v63, v212, v213
v_accvgpr_read_b32 v200, a96
v_mfma_f32_32x32x16_bf16 a[224:239], v[120:123], v[52:55], a[224:239]
ds_read_b64_tr_b16 v[152:153], v197 offset:21504
ds_read_b64_tr_b16 v[154:155], v197 offset:25088
v_accvgpr_read_b32 v201, a97
v_mul_f32 v200, v6, v200
v_mul_f32 v201, v6, v201
v_mfma_f32_32x32x16_bf16 a[128:143], v[124:127], v[56:59], a[128:143]
ds_read_b64_tr_b16 v[156:157], v197 offset:21568
ds_read_b64_tr_b16 v[158:159], v197 offset:25152
v_cvt_pk_bf16_f32 v64, v200, v201
v_accvgpr_read_b32 v204, a98
v_accvgpr_read_b32 v205, a99
s_waitcnt lgkmcnt(8)
v_mfma_f32_32x32x16_bf16 a[144:159], v[128:131], v[56:59], a[144:159]
ds_read_b64_tr_b16 v[96:97], v197 offset:21632
ds_read_b64_tr_b16 v[98:99], v197 offset:25216
v_mul_f32 v204, v6, v204
v_mul_f32 v205, v6, v205
v_cvt_pk_bf16_f32 v65, v204, v205
v_mfma_f32_32x32x16_bf16 a[160:175], v[132:135], v[56:59], a[160:175]
ds_read_b64_tr_b16 v[100:101], v197 offset:21696
ds_read_b64_tr_b16 v[102:103], v197 offset:25280
v_accvgpr_read_b32 v208, a100
v_accvgpr_read_b32 v209, a101
v_mul_f32 v208, v6, v208
v_mfma_f32_32x32x16_bf16 a[176:191], v[136:139], v[56:59], a[176:191]
ds_read_b64_tr_b16 v[104:105], v197 offset:21760
ds_read_b64_tr_b16 v[106:107], v197 offset:25344
v_mul_f32 v209, v6, v209
v_cvt_pk_bf16_f32 v66, v208, v209
v_mfma_f32_32x32x16_bf16 a[192:207], v[140:143], v[56:59], a[192:207]
ds_read_b64_tr_b16 v[108:109], v197 offset:21824
ds_read_b64_tr_b16 v[110:111], v197 offset:25408
v_accvgpr_read_b32 v212, a102
v_accvgpr_read_b32 v213, a103
v_mul_f32 v212, v6, v212
s_waitcnt lgkmcnt(8)
v_mfma_f32_32x32x16_bf16 a[208:223], v[144:147], v[56:59], a[208:223]
ds_read_b64_tr_b16 v[112:113], v197 offset:21888
ds_read_b64_tr_b16 v[114:115], v197 offset:25472
v_mul_f32 v213, v6, v213
v_cvt_pk_bf16_f32 v67, v212, v213
s_waitcnt vmcnt(14)
s_barrier
v_mfma_f32_32x32x16_bf16 a[224:239], v[148:151], v[56:59], a[224:239]
s_add_u32 m0, s48, 86016
s_mov_b32 s52, 448
ds_read_b64_tr_b16 v[116:117], v195 offset:0
ds_read_b64_tr_b16 v[118:119], v195 offset:3584
v_accvgpr_read_b32 v200, a104
v_mfma_f32_32x32x16_bf16 a[128:143], v[152:155], v[60:63], a[128:143]
buffer_load_dwordx4 v188, s[8:11], s52 offen lds
ds_read_b64_tr_b16 v[120:121], v195 offset:64
ds_read_b64_tr_b16 v[122:123], v195 offset:3648
v_accvgpr_read_b32 v201, a105
v_mul_f32 v200, v6, v200
v_mfma_f32_32x32x16_bf16 a[144:159], v[156:159], v[60:63], a[144:159]
ds_read_b64_tr_b16 v[124:125], v195 offset:128
ds_read_b64_tr_b16 v[126:127], v195 offset:3712
v_mul_f32 v201, v6, v201
v_cvt_pk_bf16_f32 v68, v200, v201
v_accvgpr_read_b32 v204, a106
s_waitcnt lgkmcnt(8)
v_mfma_f32_32x32x16_bf16 a[160:175], v[96:99], v[60:63], a[160:175]
s_add_u32 m0, s48, 87040
ds_read_b64_tr_b16 v[128:129], v195 offset:192
ds_read_b64_tr_b16 v[130:131], v195 offset:3776
v_accvgpr_read_b32 v205, a107
v_mul_f32 v204, v6, v204
v_mfma_f32_32x32x16_bf16 a[176:191], v[100:103], v[60:63], a[176:191]
buffer_load_dwordx4 v189, s[8:11], s52 offen lds
ds_read_b64_tr_b16 v[132:133], v195 offset:256
ds_read_b64_tr_b16 v[134:135], v195 offset:3840
v_mul_f32 v205, v6, v205
v_cvt_pk_bf16_f32 v69, v204, v205
v_mfma_f32_32x32x16_bf16 a[192:207], v[104:107], v[60:63], a[192:207]
ds_read_b64_tr_b16 v[136:137], v195 offset:320
ds_read_b64_tr_b16 v[138:139], v195 offset:3904
v_accvgpr_read_b32 v208, a108
v_accvgpr_read_b32 v209, a109
v_mfma_f32_32x32x16_bf16 a[208:223], v[108:111], v[60:63], a[208:223]
s_add_u32 m0, s48, 88064
ds_read_b64_tr_b16 v[140:141], v195 offset:384
ds_read_b64_tr_b16 v[142:143], v195 offset:3968
v_mul_f32 v208, v6, v208
v_mul_f32 v209, v6, v209
s_waitcnt lgkmcnt(8)
v_mfma_f32_32x32x16_bf16 a[224:239], v[112:115], v[60:63], a[224:239]
buffer_load_dwordx4 v190, s[8:11], s52 offen lds
ds_read_b64_tr_b16 v[144:145], v195 offset:7168
ds_read_b64_tr_b16 v[146:147], v195 offset:10752
v_cvt_pk_bf16_f32 v70, v208, v209
v_accvgpr_read_b32 v212, a110
v_mfma_f32_32x32x16_bf16 a[128:143], v[116:119], v[64:67], a[128:143]
ds_read_b64_tr_b16 v[148:149], v195 offset:7232
ds_read_b64_tr_b16 v[150:151], v195 offset:10816
v_accvgpr_read_b32 v213, a111
v_mul_f32 v212, v6, v212
v_mul_f32 v213, v6, v213
v_mfma_f32_32x32x16_bf16 a[144:159], v[120:123], v[64:67], a[144:159]
s_add_u32 m0, s48, 89088
ds_read_b64_tr_b16 v[152:153], v195 offset:7296
ds_read_b64_tr_b16 v[154:155], v195 offset:10880
v_cvt_pk_bf16_f32 v71, v212, v213
v_accvgpr_read_b32 v200, a112
v_mfma_f32_32x32x16_bf16 a[160:175], v[124:127], v[64:67], a[160:175]
buffer_load_dwordx4 v191, s[8:11], s52 offen lds
ds_read_b64_tr_b16 v[156:157], v195 offset:7360
ds_read_b64_tr_b16 v[158:159], v195 offset:10944
v_accvgpr_read_b32 v201, a113
v_mul_f32 v200, v6, v200
s_waitcnt lgkmcnt(8)
v_mfma_f32_32x32x16_bf16 a[176:191], v[128:131], v[64:67], a[176:191]
ds_read_b64_tr_b16 v[96:97], v195 offset:7424
ds_read_b64_tr_b16 v[98:99], v195 offset:11008
v_mul_f32 v201, v6, v201
v_cvt_pk_bf16_f32 v72, v200, v201
v_accvgpr_read_b32 v204, a114
v_mfma_f32_32x32x16_bf16 a[192:207], v[132:135], v[64:67], a[192:207]
s_add_u32 m0, s48, 90112
ds_read_b64_tr_b16 v[100:101], v195 offset:7488
ds_read_b64_tr_b16 v[102:103], v195 offset:11072
v_accvgpr_read_b32 v205, a115
v_mul_f32 v204, v6, v204
v_mfma_f32_32x32x16_bf16 a[208:223], v[136:139], v[64:67], a[208:223]
buffer_load_dwordx4 v192, s[8:11], s52 offen lds
ds_read_b64_tr_b16 v[104:105], v195 offset:7552
ds_read_b64_tr_b16 v[106:107], v195 offset:11136
v_mul_f32 v205, v6, v205
v_mfma_f32_32x32x16_bf16 a[224:239], v[140:143], v[64:67], a[224:239]
ds_read_b64_tr_b16 v[108:109], v195 offset:14336
ds_read_b64_tr_b16 v[110:111], v195 offset:17920
v_cvt_pk_bf16_f32 v73, v204, v205
v_accvgpr_read_b32 v208, a116
v_accvgpr_read_b32 v209, a117
s_waitcnt lgkmcnt(8)
v_mfma_f32_32x32x16_bf16 a[128:143], v[144:147], v[68:71], a[128:143]
s_add_u32 m0, s48, 91136
ds_read_b64_tr_b16 v[112:113], v195 offset:14400
ds_read_b64_tr_b16 v[114:115], v195 offset:17984
v_mul_f32 v208, v6, v208
v_mul_f32 v209, v6, v209
v_mfma_f32_32x32x16_bf16 a[144:159], v[148:151], v[68:71], a[144:159]
buffer_load_dwordx4 v193, s[8:11], s52 offen lds
ds_read_b64_tr_b16 v[116:117], v195 offset:14464
ds_read_b64_tr_b16 v[118:119], v195 offset:18048
v_cvt_pk_bf16_f32 v74, v208, v209
v_accvgpr_read_b32 v212, a118
v_mfma_f32_32x32x16_bf16 a[160:175], v[152:155], v[68:71], a[160:175]
ds_read_b64_tr_b16 v[120:121], v195 offset:14528
ds_read_b64_tr_b16 v[122:123], v195 offset:18112
v_accvgpr_read_b32 v213, a119
v_mul_f32 v212, v6, v212
v_mul_f32 v213, v6, v213
v_mfma_f32_32x32x16_bf16 a[176:191], v[156:159], v[68:71], a[176:191]
s_add_u32 m0, s48, 92160
ds_read_b64_tr_b16 v[124:125], v195 offset:14592
ds_read_b64_tr_b16 v[126:127], v195 offset:18176
v_cvt_pk_bf16_f32 v75, v212, v213
v_accvgpr_read_b32 v200, a120
s_waitcnt lgkmcnt(8)
v_mfma_f32_32x32x16_bf16 a[192:207], v[96:99], v[68:71], a[192:207]
buffer_load_dwordx4 v194, s[8:11], s52 offen lds
ds_read_b64_tr_b16 v[128:129], v195 offset:14656
ds_read_b64_tr_b16 v[130:131], v195 offset:18240
v_accvgpr_read_b32 v201, a121
v_mul_f32 v200, v6, v200
v_mfma_f32_32x32x16_bf16 a[208:223], v[100:103], v[68:71], a[208:223]
ds_read_b64_tr_b16 v[132:133], v195 offset:14720
ds_read_b64_tr_b16 v[134:135], v195 offset:18304
v_mul_f32 v201, v6, v201
v_cvt_pk_bf16_f32 v76, v200, v201
v_accvgpr_read_b32 v204, a122
v_mfma_f32_32x32x16_bf16 a[224:239], v[104:107], v[68:71], a[224:239]
ds_read_b64_tr_b16 v[136:137], v195 offset:21504
ds_read_b64_tr_b16 v[138:139], v195 offset:25088
v_accvgpr_read_b32 v205, a123
v_mul_f32 v204, v6, v204
v_mfma_f32_32x32x16_bf16 a[128:143], v[108:111], v[72:75], a[128:143]
ds_read_b64_tr_b16 v[140:141], v195 offset:21568
ds_read_b64_tr_b16 v[142:143], v195 offset:25152
v_mul_f32 v205, v6, v205
v_cvt_pk_bf16_f32 v77, v204, v205
v_accvgpr_read_b32 v208, a124
s_waitcnt lgkmcnt(8)
v_mfma_f32_32x32x16_bf16 a[144:159], v[112:115], v[72:75], a[144:159]
ds_read_b64_tr_b16 v[144:145], v195 offset:21632
ds_read_b64_tr_b16 v[146:147], v195 offset:25216
v_accvgpr_read_b32 v209, a125
v_mul_f32 v208, v6, v208
v_mul_f32 v209, v6, v209
v_mfma_f32_32x32x16_bf16 a[160:175], v[116:119], v[72:75], a[160:175]
ds_read_b64_tr_b16 v[148:149], v195 offset:21696
ds_read_b64_tr_b16 v[150:151], v195 offset:25280
v_cvt_pk_bf16_f32 v78, v208, v209
v_accvgpr_read_b32 v212, a126
v_accvgpr_read_b32 v213, a127
v_mfma_f32_32x32x16_bf16 a[176:191], v[120:123], v[72:75], a[176:191]
ds_read_b64_tr_b16 v[152:153], v195 offset:21760
ds_read_b64_tr_b16 v[154:155], v195 offset:25344
v_mul_f32 v212, v6, v212
v_mul_f32 v213, v6, v213
v_cvt_pk_bf16_f32 v79, v212, v213
v_mfma_f32_32x32x16_bf16 a[192:207], v[124:127], v[72:75], a[192:207]
ds_read_b64_tr_b16 v[156:157], v195 offset:21824
ds_read_b64_tr_b16 v[158:159], v195 offset:25408
s_waitcnt lgkmcnt(8)
v_mfma_f32_32x32x16_bf16 a[208:223], v[128:131], v[72:75], a[208:223]
ds_read_b64_tr_b16 v[96:97], v195 offset:21888
ds_read_b64_tr_b16 v[98:99], v195 offset:25472
s_waitcnt vmcnt(14)
s_barrier
v_mfma_f32_32x32x16_bf16 a[224:239], v[132:135], v[72:75], a[224:239]
s_add_u32 m0, s48, 114688
s_mov_b32 s52, 57792
ds_read_b64_tr_b16 v[100:101], v195 offset:28672
ds_read_b64_tr_b16 v[102:103], v195 offset:32256
v_mfma_f32_32x32x16_bf16 a[128:143], v[136:139], v[76:79], a[128:143]
buffer_load_dwordx4 v188, s[8:11], s52 offen lds
ds_read_b64_tr_b16 v[104:105], v195 offset:28736
ds_read_b64_tr_b16 v[106:107], v195 offset:32320
v_mfma_f32_32x32x16_bf16 a[144:159], v[140:143], v[76:79], a[144:159]
ds_read_b64_tr_b16 v[108:109], v195 offset:28800
ds_read_b64_tr_b16 v[110:111], v195 offset:32384
s_waitcnt lgkmcnt(8)
v_mfma_f32_32x32x16_bf16 a[160:175], v[144:147], v[76:79], a[160:175]
s_add_u32 m0, s48, 115712
ds_read_b64_tr_b16 v[112:113], v195 offset:28864
ds_read_b64_tr_b16 v[114:115], v195 offset:32448
v_mfma_f32_32x32x16_bf16 a[176:191], v[148:151], v[76:79], a[176:191]
buffer_load_dwordx4 v189, s[8:11], s52 offen lds
ds_read_b64_tr_b16 v[116:117], v195 offset:28928
ds_read_b64_tr_b16 v[118:119], v195 offset:32512
v_mfma_f32_32x32x16_bf16 a[192:207], v[152:155], v[76:79], a[192:207]
ds_read_b64_tr_b16 v[120:121], v195 offset:28992
ds_read_b64_tr_b16 v[122:123], v195 offset:32576
v_mfma_f32_32x32x16_bf16 a[208:223], v[156:159], v[76:79], a[208:223]
s_add_u32 m0, s48, 116736
ds_read_b64_tr_b16 v[124:125], v195 offset:29056
ds_read_b64_tr_b16 v[126:127], v195 offset:32640
s_waitcnt lgkmcnt(8)
v_mfma_f32_32x32x16_bf16 a[224:239], v[96:99], v[76:79], a[224:239]
buffer_load_dwordx4 v190, s[8:11], s52 offen lds
ds_read_b64_tr_b16 v[128:129], v195 offset:35840
ds_read_b64_tr_b16 v[130:131], v195 offset:39424
k2_ph1:
v_mfma_f32_32x32x16_bf16 a[0:15], v[100:103], v[160:163], 0
ds_read_b64_tr_b16 v[132:133], v195 offset:35904
ds_read_b64_tr_b16 v[134:135], v195 offset:39488
v_mfma_f32_32x32x16_bf16 a[16:31], v[104:107], v[160:163], 0
s_add_u32 m0, s48, 117760
ds_read_b64_tr_b16 v[136:137], v195 offset:35968
ds_read_b64_tr_b16 v[138:139], v195 offset:39552
v_mfma_f32_32x32x16_bf16 a[32:47], v[108:111], v[160:163], 0
buffer_load_dwordx4 v191, s[8:11], s52 offen lds
ds_read_b64_tr_b16 v[140:141], v195 offset:36032
ds_read_b64_tr_b16 v[142:143], v195 offset:39616
s_waitcnt lgkmcnt(8)
v_mfma_f32_32x32x16_bf16 a[48:63], v[112:115], v[160:163], 0
ds_read_b64_tr_b16 v[144:145], v195 offset:36096
ds_read_b64_tr_b16 v[146:147], v195 offset:39680
v_accvgpr_read_b32 v200, a128
v_mfma_f32_32x32x16_bf16 a[64:79], v[116:119], v[160:163], 0
s_add_u32 m0, s48, 118784
ds_read_b64_tr_b16 v[148:149], v195 offset:36160
ds_read_b64_tr_b16 v[150:151], v195 offset:39744
v_accvgpr_read_b32 v201, a129
v_mfma_f32_32x32x16_bf16 a[80:95], v[120:123], v[160:163], 0
buffer_load_dwordx4 v192, s[8:11], s52 offen lds
ds_read_b64_tr_b16 v[152:153], v195 offset:36224
ds_read_b64_tr_b16 v[154:155], v195 offset:39808
v_mfma_f32_32x32x16_bf16 a[96:111], v[124:127], v[160:163], 0
ds_read_b64_tr_b16 v[156:157], v195 offset:43008
ds_read_b64_tr_b16 v[158:159], v195 offset:46592
v_accvgpr_read_b32 v202, a130
v_accvgpr_read_b32 v203, a131
s_waitcnt lgkmcnt(8)
v_mfma_f32_32x32x16_bf16 a[0:15], v[128:131], v[164:167], a[0:15]
s_add_u32 m0, s48, 119808
ds_read_b64_tr_b16 v[96:97], v195 offset:43072
ds_read_b64_tr_b16 v[98:99], v195 offset:46656
v_mfma_f32_32x32x16_bf16 a[16:31], v[132:135], v[164:167], a[16:31]
buffer_load_dwordx4 v193, s[8:11], s52 offen lds
ds_read_b64_tr_b16 v[100:101], v195 offset:43136
ds_read_b64_tr_b16 v[102:103], v195 offset:46720
v_mfma_f32_32x32x16_bf16 a[32:47], v[136:139], v[164:167], a[32:47]
ds_read_b64_tr_b16 v[104:105], v195 offset:43200
ds_read_b64_tr_b16 v[106:107], v195 offset:46784
v_accvgpr_read_b32 v204, a132
v_accvgpr_read_b32 v205, a133
v_mfma_f32_32x32x16_bf16 a[48:63], v[140:143], v[164:167], a[48:63]
s_add_u32 m0, s48, 120832
ds_read_b64_tr_b16 v[108:109], v195 offset:43264
ds_read_b64_tr_b16 v[110:111], v195 offset:46848
s_waitcnt lgkmcnt(8)
v_mfma_f32_32x32x16_bf16 a[64:79], v[144:147], v[164:167], a[64:79]
buffer_load_dwordx4 v194, s[8:11], s52 offen lds
ds_read_b64_tr_b16 v[112:113], v195 offset:43328
ds_read_b64_tr_b16 v[114:115], v195 offset:46912
v_accvgpr_read_b32 v206, a134
v_mfma_f32_32x32x16_bf16 a[80:95], v[148:151], v[164:167], a[80:95]
ds_read_b64_tr_b16 v[116:117], v195 offset:43392
ds_read_b64_tr_b16 v[118:119], v195 offset:46976
v_accvgpr_read_b32 v207, a135
v_mfma_f32_32x32x16_bf16 a[96:111], v[152:155], v[164:167], a[96:111]
ds_read_b64_tr_b16 v[120:121], v195 offset:50176
ds_read_b64_tr_b16 v[122:123], v195 offset:53760
v_cvt_pk_bf16_f32 v200, v200, v201
v_cvt_pk_bf16_f32 v201, v202, v203
v_mfma_f32_32x32x16_bf16 a[0:15], v[156:159], v[168:171], a[0:15]
ds_read_b64_tr_b16 v[124:125], v195 offset:50240
ds_read_b64_tr_b16 v[126:127], v195 offset:53824
v_cvt_pk_bf16_f32 v202, v204, v205
s_waitcnt lgkmcnt(8)
v_mfma_f32_32x32x16_bf16 a[16:31], v[96:99], v[168:171], a[16:31]
ds_read_b64_tr_b16 v[128:129], v195 offset:50304
ds_read_b64_tr_b16 v[130:131], v195 offset:53888
v_cvt_pk_bf16_f32 v203, v206, v207
v_mfma_f32_32x32x16_bf16 a[32:47], v[100:103], v[168:171], a[32:47]
ds_read_b64_tr_b16 v[132:133], v195 offset:50368
ds_read_b64_tr_b16 v[134:135], v195 offset:53952
s_add_u32 s53, s49, 0
buffer_store_dwordx4 v[200:203], v2, s[4:7], s53 offen offset:0 sc1
v_mfma_f32_32x32x16_bf16 a[48:63], v[104:107], v[168:171], a[48:63]
ds_read_b64_tr_b16 v[136:137], v195 offset:50432
ds_read_b64_tr_b16 v[138:139], v195 offset:54016
v_accvgpr_read_b32 v208, a136
v_mfma_f32_32x32x16_bf16 a[64:79], v[108:111], v[168:171], a[64:79]
ds_read_b64_tr_b16 v[140:141], v195 offset:50496
ds_read_b64_tr_b16 v[142:143], v195 offset:54080
v_accvgpr_read_b32 v209, a137
v_accvgpr_read_b32 v210, a138
s_waitcnt lgkmcnt(8)
v_mfma_f32_32x32x16_bf16 a[80:95], v[112:115], v[168:171], a[80:95]
ds_read_b64_tr_b16 v[144:145], v195 offset:50560
ds_read_b64_tr_b16 v[146:147], v195 offset:54144
s_waitcnt vmcnt(15)
s_barrier
v_mfma_f32_32x32x16_bf16 a[96:111], v[116:119], v[168:171], a[96:111]
s_add_u32 m0, s48, 0
s_mov_b32 s52, 115136
ds_read_b64_tr_b16 v[148:149], v196 offset:0
ds_read_b64_tr_b16 v[150:151], v196 offset:3584
v_mfma_f32_32x32x16_bf16 a[0:15], v[120:123], v[172:175], a[0:15]
buffer_load_dwordx4 v188, s[8:11], s52 offen lds
ds_read_b64_tr_b16 v[152:153], v196 offset:64
ds_read_b64_tr_b16 v[154:155], v196 offset:3648
v_mfma_f32_32x32x16_bf16 a[16:31], v[124:127], v[172:175], a[16:31]
ds_read_b64_tr_b16 v[156:157], v196 offset:128
ds_read_b64_tr_b16 v[158:159], v196 offset:3712
v_accvgpr_read_b32 v211, a139
v_accvgpr_read_b32 v212, a140
s_waitcnt lgkmcnt(8)
v_mfma_f32_32x32x16_bf16 a[32:47], v[128:131], v[172:175], a[32:47]
s_add_u32 m0, s48, 1024
ds_read_b64_tr_b16 v[96:97], v196 offset:192
ds_read_b64_tr_b16 v[98:99], v196 offset:3776
v_mfma_f32_32x32x16_bf16 a[48:63], v[132:135], v[172:175], a[48:63]
buffer_load_dwordx4 v189, s[8:11], s52 offen lds
ds_read_b64_tr_b16 v[100:101], v196 offset:256
ds_read_b64_tr_b16 v[102:103], v196 offset:3840
v_accvgpr_read_b32 v213, a141
v_mfma_f32_32x32x16_bf16 a[64:79], v[136:139], v[172:175], a[64:79]
ds_read_b64_tr_b16 v[104:105], v196 offset:320
ds_read_b64_tr_b16 v[106:107], v196 offset:3904
v_accvgpr_read_b32 v214, a142
v_mfma_f32_32x32x16_bf16 a[80:95], v[140:143], v[172:175], a[80:95]
s_add_u32 m0, s48, 2048
ds_read_b64_tr_b16 v[108:109], v196 offset:384
ds_read_b64_tr_b16 v[110:111], v196 offset:3968
v_accvgpr_read_b32 v215, a143
s_waitcnt lgkmcnt(8)
v_mfma_f32_32x32x16_bf16 a[96:111], v[144:147], v[172:175], a[96:111]
buffer_load_dwordx4 v190, s[8:11], s52 offen lds
ds_read_b64_tr_b16 v[112:113], v196 offset:7168
ds_read_b64_tr_b16 v[114:115], v196 offset:10752
v_mfma_f32_32x32x16_bf16 a[0:15], v[148:151], v[176:179], a[0:15]
ds_read_b64_tr_b16 v[116:117], v196 offset:7232
ds_read_b64_tr_b16 v[118:119], v196 offset:10816
v_cvt_pk_bf16_f32 v208, v208, v209
v_mfma_f32_32x32x16_bf16 a[16:31], v[152:155], v[176:179], a[16:31]
s_add_u32 m0, s48, 3072
ds_read_b64_tr_b16 v[120:121], v196 offset:7296
ds_read_b64_tr_b16 v[122:123], v196 offset:10880
v_cvt_pk_bf16_f32 v209, v210, v211
v_mfma_f32_32x32x16_bf16 a[32:47], v[156:159], v[176:179], a[32:47]
buffer_load_dwordx4 v191, s[8:11], s52 offen lds
ds_read_b64_tr_b16 v[124:125], v196 offset:7360
ds_read_b64_tr_b16 v[126:127], v196 offset:10944
s_waitcnt lgkmcnt(8)
v_mfma_f32_32x32x16_bf16 a[48:63], v[96:99], v[176:179], a[48:63]
ds_read_b64_tr_b16 v[128:129], v196 offset:7424
ds_read_b64_tr_b16 v[130:131], v196 offset:11008
v_cvt_pk_bf16_f32 v210, v212, v213
v_cvt_pk_bf16_f32 v211, v214, v215
v_mfma_f32_32x32x16_bf16 a[64:79], v[100:103], v[176:179], a[64:79]
s_add_u32 m0, s48, 4096
ds_read_b64_tr_b16 v[132:133], v196 offset:7488
ds_read_b64_tr_b16 v[134:135], v196 offset:11072
v_mfma_f32_32x32x16_bf16 a[80:95], v[104:107], v[176:179], a[80:95]
buffer_load_dwordx4 v192, s[8:11], s52 offen lds
ds_read_b64_tr_b16 v[136:137], v196 offset:7552
ds_read_b64_tr_b16 v[138:139], v196 offset:11136
v_mfma_f32_32x32x16_bf16 a[96:111], v[108:111], v[176:179], a[96:111]
ds_read_b64_tr_b16 v[140:141], v196 offset:14336
ds_read_b64_tr_b16 v[142:143], v196 offset:17920
buffer_store_dwordx4 v[208:211], v2, s[4:7], s53 offen offset:1024 sc1
v_accvgpr_read_b32 v216, a144
s_waitcnt lgkmcnt(8)
v_mfma_f32_32x32x16_bf16 a[0:15], v[112:115], v[180:183], a[0:15]
s_add_u32 m0, s48, 5120
ds_read_b64_tr_b16 v[144:145], v196 offset:14400
ds_read_b64_tr_b16 v[146:147], v196 offset:17984
v_mfma_f32_32x32x16_bf16 a[16:31], v[116:119], v[180:183], a[16:31]
buffer_load_dwordx4 v193, s[8:11], s52 offen lds
ds_read_b64_tr_b16 v[148:149], v196 offset:14464
ds_read_b64_tr_b16 v[150:151], v196 offset:18048
v_accvgpr_read_b32 v217, a145
v_mfma_f32_32x32x16_bf16 a[32:47], v[120:123], v[180:183], a[32:47]
ds_read_b64_tr_b16 v[152:153], v196 offset:14528
ds_read_b64_tr_b16 v[154:155], v196 offset:18112
v_accvgpr_read_b32 v218, a146
v_mfma_f32_32x32x16_bf16 a[48:63], v[124:127], v[180:183], a[48:63]
s_add_u32 m0, s48, 6144
ds_read_b64_tr_b16 v[156:157], v196 offset:14592
ds_read_b64_tr_b16 v[158:159], v196 offset:18176
v_accvgpr_read_b32 v219, a147
s_waitcnt lgkmcnt(8)
v_mfma_f32_32x32x16_bf16 a[64:79], v[128:131], v[180:183], a[64:79]
buffer_load_dwordx4 v194, s[8:11], s52 offen lds
ds_read_b64_tr_b16 v[96:97], v196 offset:14656
ds_read_b64_tr_b16 v[98:99], v196 offset:18240
v_mfma_f32_32x32x16_bf16 a[80:95], v[132:135], v[180:183], a[80:95]
ds_read_b64_tr_b16 v[100:101], v196 offset:14720
ds_read_b64_tr_b16 v[102:103], v196 offset:18304
s_waitcnt vmcnt(16)
s_barrier
v_mfma_f32_32x32x16_bf16 a[96:111], v[136:139], v[180:183], a[96:111]
s_add_u32 m0, s48, 28672
s_mov_b32 s52, 172480
ds_read_b64_tr_b16 v[104:105], v196 offset:28672
ds_read_b64_tr_b16 v[106:107], v196 offset:32256
v_mfma_f32_32x32x16_bf16 a[0:15], v[140:143], v[184:187], a[0:15]
buffer_load_dwordx4 v188, s[8:11], s52 offen lds
ds_read_b64_tr_b16 v[108:109], v196 offset:28736
ds_read_b64_tr_b16 v[110:111], v196 offset:32320
v_accvgpr_read_b32 v220, a148
s_waitcnt lgkmcnt(8)
v_mfma_f32_32x32x16_bf16 a[16:31], v[144:147], v[184:187], a[16:31]
ds_read_b64_tr_b16 v[112:113], v196 offset:28800
ds_read_b64_tr_b16 v[114:115], v196 offset:32384
v_accvgpr_read_b32 v221, a149
v_mfma_f32_32x32x16_bf16 a[32:47], v[148:151], v[184:187], a[32:47]
s_add_u32 m0, s48, 29696
ds_read_b64_tr_b16 v[116:117], v196 offset:28864
ds_read_b64_tr_b16 v[118:119], v196 offset:32448
v_accvgpr_read_b32 v222, a150
v_mfma_f32_32x32x16_bf16 a[48:63], v[152:155], v[184:187], a[48:63]
buffer_load_dwordx4 v189, s[8:11], s52 offen lds
ds_read_b64_tr_b16 v[120:121], v196 offset:28928
ds_read_b64_tr_b16 v[122:123], v196 offset:32512
v_mfma_f32_32x32x16_bf16 a[64:79], v[156:159], v[184:187], a[64:79]
ds_read_b64_tr_b16 v[124:125], v196 offset:28992
ds_read_b64_tr_b16 v[126:127], v196 offset:32576
v_accvgpr_read_b32 v223, a151
s_waitcnt lgkmcnt(8)
v_mfma_f32_32x32x16_bf16 a[80:95], v[96:99], v[184:187], a[80:95]
s_add_u32 m0, s48, 30720
ds_read_b64_tr_b16 v[128:129], v196 offset:29056
ds_read_b64_tr_b16 v[130:131], v196 offset:32640
v_cvt_pk_bf16_f32 v216, v216, v217
v_mfma_f32_32x32x16_bf16 a[96:111], v[100:103], v[184:187], a[96:111]
buffer_load_dwordx4 v190, s[8:11], s52 offen lds
ds_read_b64_tr_b16 v[132:133], v196 offset:35840
ds_read_b64_tr_b16 v[134:135], v196 offset:39424
v_mfma_f32_32x32x16_bf16 a[0:15], v[104:107], v[16:19], a[0:15]
ds_read_b64_tr_b16 v[136:137], v196 offset:35904
ds_read_b64_tr_b16 v[138:139], v196 offset:39488
v_cvt_pk_bf16_f32 v217, v218, v219
v_cvt_pk_bf16_f32 v218, v220, v221
v_mfma_f32_32x32x16_bf16 a[16:31], v[108:111], v[16:19], a[16:31]
s_add_u32 m0, s48, 31744
ds_read_b64_tr_b16 v[140:141], v196 offset:35968
ds_read_b64_tr_b16 v[142:143], v196 offset:39552
s_waitcnt lgkmcnt(8)
v_mfma_f32_32x32x16_bf16 a[32:47], v[112:115], v[16:19], a[32:47]
buffer_load_dwordx4 v191, s[8:11], s52 offen lds
ds_read_b64_tr_b16 v[144:145], v196 offset:36032
ds_read_b64_tr_b16 v[146:147], v196 offset:39616
v_mfma_f32_32x32x16_bf16 a[48:63], v[116:119], v[16:19], a[48:63]
ds_read_b64_tr_b16 v[148:149], v196 offset:36096
ds_read_b64_tr_b16 v[150:151], v196 offset:39680
v_cvt_pk_bf16_f32 v219, v222, v223
buffer_store_dwordx4 v[216:219], v2, s[4:7], s53 offen offset:2048 sc1
v_mfma_f32_32x32x16_bf16 a[64:79], v[120:123], v[16:19], a[64:79]
s_add_u32 m0, s48, 32768
ds_read_b64_tr_b16 v[152:153], v196 offset:36160
ds_read_b64_tr_b16 v[154:155], v196 offset:39744
v_mfma_f32_32x32x16_bf16 a[80:95], v[124:127], v[16:19], a[80:95]
buffer_load_dwordx4 v192, s[8:11], s52 offen lds
ds_read_b64_tr_b16 v[156:157], v196 offset:36224
ds_read_b64_tr_b16 v[158:159], v196 offset:39808
v_accvgpr_read_b32 v224, a152
s_waitcnt lgkmcnt(8)
v_mfma_f32_32x32x16_bf16 a[96:111], v[128:131], v[16:19], a[96:111]
ds_read_b64_tr_b16 v[96:97], v196 offset:43008
ds_read_b64_tr_b16 v[98:99], v196 offset:46592
v_accvgpr_read_b32 v225, a153
v_mfma_f32_32x32x16_bf16 a[0:15], v[132:135], v[20:23], a[0:15]
s_add_u32 m0, s48, 33792
ds_read_b64_tr_b16 v[100:101], v196 offset:43072
ds_read_b64_tr_b16 v[102:103], v196 offset:46656
v_accvgpr_read_b32 v226, a154
v_mfma_f32_32x32x16_bf16 a[16:31], v[136:139], v[20:23], a[16:31]
buffer_load_dwordx4 v193, s[8:11], s52 offen lds
ds_read_b64_tr_b16 v[104:105], v196 offset:43136
ds_read_b64_tr_b16 v[106:107], v196 offset:46720
v_mfma_f32_32x32x16_bf16 a[32:47], v[140:143], v[20:23], a[32:47]
ds_read_b64_tr_b16 v[108:109], v196 offset:43200
ds_read_b64_tr_b16 v[110:111], v196 offset:46784
v_accvgpr_read_b32 v227, a155
s_waitcnt lgkmcnt(8)
v_mfma_f32_32x32x16_bf16 a[48:63], v[144:147], v[20:23], a[48:63]
s_add_u32 m0, s48, 34816
ds_read_b64_tr_b16 v[112:113], v196 offset:43264
ds_read_b64_tr_b16 v[114:115], v196 offset:46848
v_accvgpr_read_b32 v228, a156
v_mfma_f32_32x32x16_bf16 a[64:79], v[148:151], v[20:23], a[64:79]
buffer_load_dwordx4 v194, s[8:11], s52 offen lds
ds_read_b64_tr_b16 v[116:117], v196 offset:43328
ds_read_b64_tr_b16 v[118:119], v196 offset:46912
v_mfma_f32_32x32x16_bf16 a[80:95], v[152:155], v[20:23], a[80:95]
ds_read_b64_tr_b16 v[120:121], v196 offset:43392
ds_read_b64_tr_b16 v[122:123], v196 offset:46976
v_accvgpr_read_b32 v229, a157
v_accvgpr_read_b32 v230, a158
v_mfma_f32_32x32x16_bf16 a[96:111], v[156:159], v[20:23], a[96:111]
ds_read_b64_tr_b16 v[124:125], v196 offset:50176
ds_read_b64_tr_b16 v[126:127], v196 offset:53760
v_accvgpr_read_b32 v231, a159
s_waitcnt lgkmcnt(8)
v_mfma_f32_32x32x16_bf16 a[0:15], v[96:99], v[24:27], a[0:15]
ds_read_b64_tr_b16 v[128:129], v196 offset:50240
ds_read_b64_tr_b16 v[130:131], v196 offset:53824
v_cvt_pk_bf16_f32 v224, v224, v225
v_mfma_f32_32x32x16_bf16 a[16:31], v[100:103], v[24:27], a[16:31]
ds_read_b64_tr_b16 v[132:133], v196 offset:50304
ds_read_b64_tr_b16 v[134:135], v196 offset:53888
v_cvt_pk_bf16_f32 v225, v226, v227
v_cvt_pk_bf16_f32 v226, v228, v229
v_mfma_f32_32x32x16_bf16 a[32:47], v[104:107], v[24:27], a[32:47]
ds_read_b64_tr_b16 v[136:137], v196 offset:50368
ds_read_b64_tr_b16 v[138:139], v196 offset:53952
v_cvt_pk_bf16_f32 v227, v230, v231
v_mfma_f32_32x32x16_bf16 a[48:63], v[108:111], v[24:27], a[48:63]
ds_read_b64_tr_b16 v[140:141], v196 offset:50432
ds_read_b64_tr_b16 v[142:143], v196 offset:54016
buffer_store_dwordx4 v[224:227], v2, s[4:7], s53 offen offset:3072 sc1
v_accvgpr_read_b32 v200, a160
s_waitcnt lgkmcnt(8)
v_mfma_f32_32x32x16_bf16 a[64:79], v[112:115], v[24:27], a[64:79]
ds_read_b64_tr_b16 v[144:145], v196 offset:50496
ds_read_b64_tr_b16 v[146:147], v196 offset:54080
v_accvgpr_read_b32 v201, a161
v_mfma_f32_32x32x16_bf16 a[80:95], v[116:119], v[24:27], a[80:95]
ds_read_b64_tr_b16 v[148:149], v196 offset:50560
ds_read_b64_tr_b16 v[150:151], v196 offset:54144
v_accvgpr_read_b32 v202, a162
s_waitcnt vmcnt(18)
s_barrier
v_mfma_f32_32x32x16_bf16 a[96:111], v[120:123], v[24:27], a[96:111]
ds_read_b64_tr_b16 v[152:153], v197 offset:0
ds_read_b64_tr_b16 v[154:155], v197 offset:3584
v_accvgpr_read_b32 v203, a163
v_mfma_f32_32x32x16_bf16 a[0:15], v[124:127], v[28:31], a[0:15]
ds_read_b64_tr_b16 v[156:157], v197 offset:64
ds_read_b64_tr_b16 v[158:159], v197 offset:3648
v_accvgpr_read_b32 v204, a164
s_waitcnt lgkmcnt(8)
v_mfma_f32_32x32x16_bf16 a[16:31], v[128:131], v[28:31], a[16:31]
ds_read_b64_tr_b16 v[96:97], v197 offset:128
ds_read_b64_tr_b16 v[98:99], v197 offset:3712
v_accvgpr_read_b32 v205, a165
v_accvgpr_read_b32 v206, a166
v_mfma_f32_32x32x16_bf16 a[32:47], v[132:135], v[28:31], a[32:47]
ds_read_b64_tr_b16 v[100:101], v197 offset:192
ds_read_b64_tr_b16 v[102:103], v197 offset:3776
v_accvgpr_read_b32 v207, a167
v_mfma_f32_32x32x16_bf16 a[48:63], v[136:139], v[28:31], a[48:63]
ds_read_b64_tr_b16 v[104:105], v197 offset:256
ds_read_b64_tr_b16 v[106:107], v197 offset:3840
v_cvt_pk_bf16_f32 v200, v200, v201
v_cvt_pk_bf16_f32 v201, v202, v203
v_mfma_f32_32x32x16_bf16 a[64:79], v[140:143], v[28:31], a[64:79]
ds_read_b64_tr_b16 v[108:109], v197 offset:320
ds_read_b64_tr_b16 v[110:111], v197 offset:3904
v_cvt_pk_bf16_f32 v202, v204, v205
s_waitcnt lgkmcnt(8)
v_mfma_f32_32x32x16_bf16 a[80:95], v[144:147], v[28:31], a[80:95]
ds_read_b64_tr_b16 v[112:113], v197 offset:384
ds_read_b64_tr_b16 v[114:115], v197 offset:3968
v_cvt_pk_bf16_f32 v203, v206, v207
v_mfma_f32_32x32x16_bf16 a[96:111], v[148:151], v[28:31], a[96:111]
ds_read_b64_tr_b16 v[116:117], v197 offset:7168
ds_read_b64_tr_b16 v[118:119], v197 offset:10752
s_add_u32 s53, s49, 4096
buffer_store_dwordx4 v[200:203], v2, s[4:7], s53 offen offset:0 sc1
v_mfma_f32_32x32x16_bf16 a[0:15], v[152:155], v[32:35], a[0:15]
ds_read_b64_tr_b16 v[120:121], v197 offset:7232
ds_read_b64_tr_b16 v[122:123], v197 offset:10816
v_accvgpr_read_b32 v208, a168
v_mfma_f32_32x32x16_bf16 a[16:31], v[156:159], v[32:35], a[16:31]
ds_read_b64_tr_b16 v[124:125], v197 offset:7296
ds_read_b64_tr_b16 v[126:127], v197 offset:10880
v_accvgpr_read_b32 v209, a169
v_accvgpr_read_b32 v210, a170
s_waitcnt lgkmcnt(8)
v_mfma_f32_32x32x16_bf16 a[32:47], v[96:99], v[32:35], a[32:47]
ds_read_b64_tr_b16 v[128:129], v197 offset:7360
ds_read_b64_tr_b16 v[130:131], v197 offset:10944
v_accvgpr_read_b32 v211, a171
v_mfma_f32_32x32x16_bf16 a[48:63], v[100:103], v[32:35], a[48:63]
ds_read_b64_tr_b16 v[132:133], v197 offset:7424
ds_read_b64_tr_b16 v[134:135], v197 offset:11008
v_accvgpr_read_b32 v212, a172
v_accvgpr_read_b32 v213, a173
v_mfma_f32_32x32x16_bf16 a[64:79], v[104:107], v[32:35], a[64:79]
ds_read_b64_tr_b16 v[136:137], v197 offset:7488
ds_read_b64_tr_b16 v[138:139], v197 offset:11072
v_accvgpr_read_b32 v214, a174
v_mfma_f32_32x32x16_bf16 a[80:95], v[108:111], v[32:35], a[80:95]
ds_read_b64_tr_b16 v[140:141], v197 offset:7552
ds_read_b64_tr_b16 v[142:143], v197 offset:11136
v_accvgpr_read_b32 v215, a175
s_waitcnt lgkmcnt(8)
v_mfma_f32_32x32x16_bf16 a[96:111], v[112:115], v[32:35], a[96:111]
ds_read_b64_tr_b16 v[144:145], v197 offset:14336
ds_read_b64_tr_b16 v[146:147], v197 offset:17920
v_cvt_pk_bf16_f32 v208, v208, v209
v_cvt_pk_bf16_f32 v209, v210, v211
v_mfma_f32_32x32x16_bf16 a[0:15], v[116:119], v[36:39], a[0:15]
ds_read_b64_tr_b16 v[148:149], v197 offset:14400
ds_read_b64_tr_b16 v[150:151], v197 offset:17984
v_cvt_pk_bf16_f32 v210, v212, v213
v_mfma_f32_32x32x16_bf16 a[16:31], v[120:123], v[36:39], a[16:31]
ds_read_b64_tr_b16 v[152:153], v197 offset:14464
ds_read_b64_tr_b16 v[154:155], v197 offset:18048
v_cvt_pk_bf16_f32 v211, v214, v215
buffer_store_dwordx4 v[208:211], v2, s[4:7], s53 offen offset:1024 sc1
v_mfma_f32_32x32x16_bf16 a[32:47], v[124:127], v[36:39], a[32:47]
ds_read_b64_tr_b16 v[156:157], v197 offset:14528
ds_read_b64_tr_b16 v[158:159], v197 offset:18112
v_accvgpr_read_b32 v216, a176
s_waitcnt lgkmcnt(8)
v_mfma_f32_32x32x16_bf16 a[48:63], v[128:131], v[36:39], a[48:63]
ds_read_b64_tr_b16 v[96:97], v197 offset:14592
ds_read_b64_tr_b16 v[98:99], v197 offset:18176
v_accvgpr_read_b32 v217, a177
v_mfma_f32_32x32x16_bf16 a[64:79], v[132:135], v[36:39], a[64:79]
ds_read_b64_tr_b16 v[100:101], v197 offset:14656
ds_read_b64_tr_b16 v[102:103], v197 offset:18240
v_accvgpr_read_b32 v218, a178
v_accvgpr_read_b32 v219, a179
v_mfma_f32_32x32x16_bf16 a[80:95], v[136:139], v[36:39], a[80:95]
ds_read_b64_tr_b16 v[104:105], v197 offset:14720
ds_read_b64_tr_b16 v[106:107], v197 offset:18304
v_accvgpr_read_b32 v220, a180
v_mfma_f32_32x32x16_bf16 a[96:111], v[140:143], v[36:39], a[96:111]
ds_read_b64_tr_b16 v[108:109], v197 offset:21504
ds_read_b64_tr_b16 v[110:111], v197 offset:25088
v_accvgpr_read_b32 v221, a181
v_accvgpr_read_b32 v222, a182
s_waitcnt lgkmcnt(8)
v_mfma_f32_32x32x16_bf16 a[0:15], v[144:147], v[40:43], a[0:15]
ds_read_b64_tr_b16 v[112:113], v197 offset:21568
ds_read_b64_tr_b16 v[114:115], v197 offset:25152
v_accvgpr_read_b32 v223, a183
v_mfma_f32_32x32x16_bf16 a[16:31], v[148:151], v[40:43], a[16:31]
ds_read_b64_tr_b16 v[116:117], v197 offset:21632
ds_read_b64_tr_b16 v[118:119], v197 offset:25216
v_cvt_pk_bf16_f32 v216, v216, v217
v_mfma_f32_32x32x16_bf16 a[32:47], v[152:155], v[40:43], a[32:47]
ds_read_b64_tr_b16 v[120:121], v197 offset:21696
ds_read_b64_tr_b16 v[122:123], v197 offset:25280
v_cvt_pk_bf16_f32 v217, v218, v219
v_cvt_pk_bf16_f32 v218, v220, v221
v_mfma_f32_32x32x16_bf16 a[48:63], v[156:159], v[40:43], a[48:63]
ds_read_b64_tr_b16 v[124:125], v197 offset:21760
ds_read_b64_tr_b16 v[126:127], v197 offset:25344
v_cvt_pk_bf16_f32 v219, v222, v223
s_waitcnt lgkmcnt(8)
v_mfma_f32_32x32x16_bf16 a[64:79], v[96:99], v[40:43], a[64:79]
ds_read_b64_tr_b16 v[128:129], v197 offset:21824
ds_read_b64_tr_b16 v[130:131], v197 offset:25408
buffer_store_dwordx4 v[216:219], v2, s[4:7], s53 offen offset:2048 sc1
v_accvgpr_read_b32 v224, a184
v_mfma_f32_32x32x16_bf16 a[80:95], v[100:103], v[40:43], a[80:95]
ds_read_b64_tr_b16 v[132:133], v197 offset:21888
ds_read_b64_tr_b16 v[134:135], v197 offset:25472
s_waitcnt vmcnt(12)
s_barrier
v_mfma_f32_32x32x16_bf16 a[96:111], v[104:107], v[40:43], a[96:111]
ds_read_b64_tr_b16 v[136:137], v195 offset:0
ds_read_b64_tr_b16 v[138:139], v195 offset:3584
v_accvgpr_read_b32 v225, a185
v_accvgpr_read_b32 v226, a186
v_mfma_f32_32x32x16_bf16 a[0:15], v[108:111], v[44:47], a[0:15]
ds_read_b64_tr_b16 v[140:141], v195 offset:64
ds_read_b64_tr_b16 v[142:143], v195 offset:3648
v_accvgpr_read_b32 v227, a187
s_waitcnt lgkmcnt(8)
v_mfma_f32_32x32x16_bf16 a[16:31], v[112:115], v[44:47], a[16:31]
ds_read_b64_tr_b16 v[144:145], v195 offset:128
ds_read_b64_tr_b16 v[146:147], v195 offset:3712
v_accvgpr_read_b32 v228, a188
v_mfma_f32_32x32x16_bf16 a[32:47], v[116:119], v[44:47], a[32:47]
ds_read_b64_tr_b16 v[148:149], v195 offset:192
ds_read_b64_tr_b16 v[150:151], v195 offset:3776
v_accvgpr_read_b32 v229, a189
v_accvgpr_read_b32 v230, a190
v_mfma_f32_32x32x16_bf16 a[48:63], v[120:123], v[44:47], a[48:63]
ds_read_b64_tr_b16 v[152:153], v195 offset:256
ds_read_b64_tr_b16 v[154:155], v195 offset:3840
v_accvgpr_read_b32 v231, a191
v_mfma_f32_32x32x16_bf16 a[64:79], v[124:127], v[44:47], a[64:79]
ds_read_b64_tr_b16 v[156:157], v195 offset:320
ds_read_b64_tr_b16 v[158:159], v195 offset:3904
v_cvt_pk_bf16_f32 v224, v224, v225
v_cvt_pk_bf16_f32 v225, v226, v227
s_waitcnt lgkmcnt(8)
v_mfma_f32_32x32x16_bf16 a[80:95], v[128:131], v[44:47], a[80:95]
ds_read_b64_tr_b16 v[96:97], v195 offset:384
ds_read_b64_tr_b16 v[98:99], v195 offset:3968
v_cvt_pk_bf16_f32 v226, v228, v229
v_mfma_f32_32x32x16_bf16 a[96:111], v[132:135], v[44:47], a[96:111]
ds_read_b64_tr_b16 v[100:101], v195 offset:7168
ds_read_b64_tr_b16 v[102:103], v195 offset:10752
v_cvt_pk_bf16_f32 v227, v230, v231
v_mfma_f32_32x32x16_bf16 a[0:15], v[136:139], v[48:51], a[0:15]
ds_read_b64_tr_b16 v[104:105], v195 offset:7232
ds_read_b64_tr_b16 v[106:107], v195 offset:10816
buffer_store_dwordx4 v[224:227], v2, s[4:7], s53 offen offset:3072 sc1
v_accvgpr_read_b32 v200, a192
v_mfma_f32_32x32x16_bf16 a[16:31], v[140:143], v[48:51], a[16:31]
ds_read_b64_tr_b16 v[108:109], v195 offset:7296
ds_read_b64_tr_b16 v[110:111], v195 offset:10880
v_accvgpr_read_b32 v201, a193
s_waitcnt lgkmcnt(8)
v_mfma_f32_32x32x16_bf16 a[32:47], v[144:147], v[48:51], a[32:47]
ds_read_b64_tr_b16 v[112:113], v195 offset:7360
ds_read_b64_tr_b16 v[114:115], v195 offset:10944
v_accvgpr_read_b32 v202, a194
v_accvgpr_read_b32 v203, a195
v_mfma_f32_32x32x16_bf16 a[48:63], v[148:151], v[48:51], a[48:63]
ds_read_b64_tr_b16 v[116:117], v195 offset:7424
ds_read_b64_tr_b16 v[118:119], v195 offset:11008
v_accvgpr_read_b32 v204, a196
v_mfma_f32_32x32x16_bf16 a[64:79], v[152:155], v[48:51], a[64:79]
ds_read_b64_tr_b16 v[120:121], v195 offset:7488
ds_read_b64_tr_b16 v[122:123], v195 offset:11072
v_accvgpr_read_b32 v205, a197
v_accvgpr_read_b32 v206, a198
v_mfma_f32_32x32x16_bf16 a[80:95], v[156:159], v[48:51], a[80:95]
ds_read_b64_tr_b16 v[124:125], v195 offset:7552
ds_read_b64_tr_b16 v[126:127], v195 offset:11136
v_accvgpr_read_b32 v207, a199
s_waitcnt lgkmcnt(8)
v_mfma_f32_32x32x16_bf16 a[96:111], v[96:99], v[48:51], a[96:111]
ds_read_b64_tr_b16 v[128:129], v195 offset:14336
ds_read_b64_tr_b16 v[130:131], v195 offset:17920
v_cvt_pk_bf16_f32 v200, v200, v201
v_mfma_f32_32x32x16_bf16 a[0:15], v[100:103], v[52:55], a[0:15]
ds_read_b64_tr_b16 v[132:133], v195 offset:14400
ds_read_b64_tr_b16 v[134:135], v195 offset:17984
v_cvt_pk_bf16_f32 v201, v202, v203
v_cvt_pk_bf16_f32 v202, v204, v205
v_mfma_f32_32x32x16_bf16 a[16:31], v[104:107], v[52:55], a[16:31]
ds_read_b64_tr_b16 v[136:137], v195 offset:14464
ds_read_b64_tr_b16 v[138:139], v195 offset:18048
v_cvt_pk_bf16_f32 v203, v206, v207
v_mfma_f32_32x32x16_bf16 a[32:47], v[108:111], v[52:55], a[32:47]
ds_read_b64_tr_b16 v[140:141], v195 offset:14528
ds_read_b64_tr_b16 v[142:143], v195 offset:18112
s_add_u32 s53, s49, 8192
buffer_store_dwordx4 v[200:203], v2, s[4:7], s53 offen offset:0 sc1
s_waitcnt lgkmcnt(8)
v_mfma_f32_32x32x16_bf16 a[48:63], v[112:115], v[52:55], a[48:63]
ds_read_b64_tr_b16 v[144:145], v195 offset:14592
ds_read_b64_tr_b16 v[146:147], v195 offset:18176
v_accvgpr_read_b32 v208, a200
v_mfma_f32_32x32x16_bf16 a[64:79], v[116:119], v[52:55], a[64:79]
ds_read_b64_tr_b16 v[148:149], v195 offset:14656
ds_read_b64_tr_b16 v[150:151], v195 offset:18240
v_accvgpr_read_b32 v209, a201
v_mfma_f32_32x32x16_bf16 a[80:95], v[120:123], v[52:55], a[80:95]
ds_read_b64_tr_b16 v[152:153], v195 offset:14720
ds_read_b64_tr_b16 v[154:155], v195 offset:18304
v_accvgpr_read_b32 v210, a202
v_accvgpr_read_b32 v211, a203
v_mfma_f32_32x32x16_bf16 a[96:111], v[124:127], v[52:55], a[96:111]
ds_read_b64_tr_b16 v[156:157], v195 offset:21504
ds_read_b64_tr_b16 v[158:159], v195 offset:25088
v_accvgpr_read_b32 v212, a204
s_waitcnt lgkmcnt(8)
v_mfma_f32_32x32x16_bf16 a[0:15], v[128:131], v[56:59], a[0:15]
ds_read_b64_tr_b16 v[96:97], v195 offset:21568
ds_read_b64_tr_b16 v[98:99], v195 offset:25152
v_accvgpr_read_b32 v213, a205
v_accvgpr_read_b32 v214, a206
v_mfma_f32_32x32x16_bf16 a[16:31], v[132:135], v[56:59], a[16:31]
ds_read_b64_tr_b16 v[100:101], v195 offset:21632
ds_read_b64_tr_b16 v[102:103], v195 offset:25216
v_accvgpr_read_b32 v215, a207
v_mfma_f32_32x32x16_bf16 a[32:47], v[136:139], v[56:59], a[32:47]
ds_read_b64_tr_b16 v[104:105], v195 offset:21696
ds_read_b64_tr_b16 v[106:107], v195 offset:25280
v_cvt_pk_bf16_f32 v208, v208, v209
v_mfma_f32_32x32x16_bf16 a[48:63], v[140:143], v[56:59], a[48:63]
ds_read_b64_tr_b16 v[108:109], v195 offset:21760
ds_read_b64_tr_b16 v[110:111], v195 offset:25344
v_cvt_pk_bf16_f32 v209, v210, v211
v_cvt_pk_bf16_f32 v210, v212, v213
s_waitcnt lgkmcnt(8)
v_mfma_f32_32x32x16_bf16 a[64:79], v[144:147], v[56:59], a[64:79]
ds_read_b64_tr_b16 v[112:113], v195 offset:21824
ds_read_b64_tr_b16 v[114:115], v195 offset:25408
v_cvt_pk_bf16_f32 v211, v214, v215
v_mfma_f32_32x32x16_bf16 a[80:95], v[148:151], v[56:59], a[80:95]
ds_read_b64_tr_b16 v[116:117], v195 offset:21888
ds_read_b64_tr_b16 v[118:119], v195 offset:25472
buffer_store_dwordx4 v[208:211], v2, s[4:7], s53 offen offset:1024 sc1
s_waitcnt vmcnt(7)
s_barrier
v_mfma_f32_32x32x16_bf16 a[96:111], v[152:155], v[56:59], a[96:111]
ds_read_b64_tr_b16 v[120:121], v195 offset:28672
ds_read_b64_tr_b16 v[122:123], v195 offset:32256
v_accvgpr_read_b32 v216, a208
v_mfma_f32_32x32x16_bf16 a[0:15], v[156:159], v[60:63], a[0:15]
ds_read_b64_tr_b16 v[124:125], v195 offset:28736
ds_read_b64_tr_b16 v[126:127], v195 offset:32320
v_accvgpr_read_b32 v217, a209
v_accvgpr_read_b32 v218, a210
s_waitcnt lgkmcnt(8)
v_mfma_f32_32x32x16_bf16 a[16:31], v[96:99], v[60:63], a[16:31]
ds_read_b64_tr_b16 v[128:129], v195 offset:28800
ds_read_b64_tr_b16 v[130:131], v195 offset:32384
v_accvgpr_read_b32 v219, a211
v_mfma_f32_32x32x16_bf16 a[32:47], v[100:103], v[60:63], a[32:47]
ds_read_b64_tr_b16 v[132:133], v195 offset:28864
ds_read_b64_tr_b16 v[134:135], v195 offset:32448
v_accvgpr_read_b32 v220, a212
v_mfma_f32_32x32x16_bf16 a[48:63], v[104:107], v[60:63], a[48:63]
ds_read_b64_tr_b16 v[136:137], v195 offset:28928
ds_read_b64_tr_b16 v[138:139], v195 offset:32512
v_accvgpr_read_b32 v221, a213
v_accvgpr_read_b32 v222, a214
v_mfma_f32_32x32x16_bf16 a[64:79], v[108:111], v[60:63], a[64:79]
ds_read_b64_tr_b16 v[140:141], v195 offset:28992
ds_read_b64_tr_b16 v[142:143], v195 offset:32576
v_accvgpr_read_b32 v223, a215
s_waitcnt lgkmcnt(8)
v_mfma_f32_32x32x16_bf16 a[80:95], v[112:115], v[60:63], a[80:95]
ds_read_b64_tr_b16 v[144:145], v195 offset:29056
ds_read_b64_tr_b16 v[146:147], v195 offset:32640
v_cvt_pk_bf16_f32 v216, v216, v217
v_cvt_pk_bf16_f32 v217, v218, v219
v_mfma_f32_32x32x16_bf16 a[96:111], v[116:119], v[60:63], a[96:111]
ds_read_b64_tr_b16 v[148:149], v195 offset:35840
ds_read_b64_tr_b16 v[150:151], v195 offset:39424
v_cvt_pk_bf16_f32 v218, v220, v221
v_mfma_f32_32x32x16_bf16 a[0:15], v[120:123], v[64:67], a[0:15]
ds_read_b64_tr_b16 v[152:153], v195 offset:35904
ds_read_b64_tr_b16 v[154:155], v195 offset:39488
v_cvt_pk_bf16_f32 v219, v222, v223
v_mfma_f32_32x32x16_bf16 a[16:31], v[124:127], v[64:67], a[16:31]
ds_read_b64_tr_b16 v[156:157], v195 offset:35968
ds_read_b64_tr_b16 v[158:159], v195 offset:39552
buffer_store_dwordx4 v[216:219], v2, s[4:7], s53 offen offset:2048 sc1
v_accvgpr_read_b32 v224, a216
s_waitcnt lgkmcnt(8)
v_mfma_f32_32x32x16_bf16 a[32:47], v[128:131], v[64:67], a[32:47]
ds_read_b64_tr_b16 v[96:97], v195 offset:36032
ds_read_b64_tr_b16 v[98:99], v195 offset:39616
v_accvgpr_read_b32 v225, a217
v_mfma_f32_32x32x16_bf16 a[48:63], v[132:135], v[64:67], a[48:63]
ds_read_b64_tr_b16 v[100:101], v195 offset:36096
ds_read_b64_tr_b16 v[102:103], v195 offset:39680
v_accvgpr_read_b32 v226, a218
v_accvgpr_read_b32 v227, a219
v_mfma_f32_32x32x16_bf16 a[64:79], v[136:139], v[64:67], a[64:79]
ds_read_b64_tr_b16 v[104:105], v195 offset:36160
ds_read_b64_tr_b16 v[106:107], v195 offset:39744
v_accvgpr_read_b32 v228, a220
v_mfma_f32_32x32x16_bf16 a[80:95], v[140:143], v[64:67], a[80:95]
ds_read_b64_tr_b16 v[108:109], v195 offset:36224
ds_read_b64_tr_b16 v[110:111], v195 offset:39808
v_accvgpr_read_b32 v229, a221
v_accvgpr_read_b32 v230, a222
s_waitcnt lgkmcnt(8)
v_mfma_f32_32x32x16_bf16 a[96:111], v[144:147], v[64:67], a[96:111]
ds_read_b64_tr_b16 v[112:113], v195 offset:43008
ds_read_b64_tr_b16 v[114:115], v195 offset:46592
v_accvgpr_read_b32 v231, a223
v_mfma_f32_32x32x16_bf16 a[0:15], v[148:151], v[68:71], a[0:15]
ds_read_b64_tr_b16 v[116:117], v195 offset:43072
ds_read_b64_tr_b16 v[118:119], v195 offset:46656
v_cvt_pk_bf16_f32 v224, v224, v225
v_mfma_f32_32x32x16_bf16 a[16:31], v[152:155], v[68:71], a[16:31]
ds_read_b64_tr_b16 v[120:121], v195 offset:43136
ds_read_b64_tr_b16 v[122:123], v195 offset:46720
v_cvt_pk_bf16_f32 v225, v226, v227
v_cvt_pk_bf16_f32 v226, v228, v229
v_mfma_f32_32x32x16_bf16 a[32:47], v[156:159], v[68:71], a[32:47]
ds_read_b64_tr_b16 v[124:125], v195 offset:43200
ds_read_b64_tr_b16 v[126:127], v195 offset:46784
v_cvt_pk_bf16_f32 v227, v230, v231
s_waitcnt lgkmcnt(8)
v_mfma_f32_32x32x16_bf16 a[48:63], v[96:99], v[68:71], a[48:63]
ds_read_b64_tr_b16 v[128:129], v195 offset:43264
ds_read_b64_tr_b16 v[130:131], v195 offset:46848
buffer_store_dwordx4 v[224:227], v2, s[4:7], s53 offen offset:3072 sc1
v_accvgpr_read_b32 v200, a224
v_mfma_f32_32x32x16_bf16 a[64:79], v[100:103], v[68:71], a[64:79]
ds_read_b64_tr_b16 v[132:133], v195 offset:43328
ds_read_b64_tr_b16 v[134:135], v195 offset:46912
v_accvgpr_read_b32 v201, a225
v_mfma_f32_32x32x16_bf16 a[80:95], v[104:107], v[68:71], a[80:95]
ds_read_b64_tr_b16 v[136:137], v195 offset:43392
ds_read_b64_tr_b16 v[138:139], v195 offset:46976
v_accvgpr_read_b32 v202, a226
v_mfma_f32_32x32x16_bf16 a[96:111], v[108:111], v[68:71], a[96:111]
ds_read_b64_tr_b16 v[140:141], v195 offset:50176
ds_read_b64_tr_b16 v[142:143], v195 offset:53760
v_accvgpr_read_b32 v203, a227
v_accvgpr_read_b32 v204, a228
s_waitcnt lgkmcnt(8)
v_mfma_f32_32x32x16_bf16 a[0:15], v[112:115], v[72:75], a[0:15]
ds_read_b64_tr_b16 v[144:145], v195 offset:50240
ds_read_b64_tr_b16 v[146:147], v195 offset:53824
v_accvgpr_read_b32 v205, a229
v_mfma_f32_32x32x16_bf16 a[16:31], v[116:119], v[72:75], a[16:31]
ds_read_b64_tr_b16 v[148:149], v195 offset:50304
ds_read_b64_tr_b16 v[150:151], v195 offset:53888
v_accvgpr_read_b32 v206, a230
v_accvgpr_read_b32 v207, a231
v_mfma_f32_32x32x16_bf16 a[32:47], v[120:123], v[72:75], a[32:47]
ds_read_b64_tr_b16 v[152:153], v195 offset:50368
ds_read_b64_tr_b16 v[154:155], v195 offset:53952
v_cvt_pk_bf16_f32 v200, v200, v201
v_mfma_f32_32x32x16_bf16 a[48:63], v[124:127], v[72:75], a[48:63]
ds_read_b64_tr_b16 v[156:157], v195 offset:50432
ds_read_b64_tr_b16 v[158:159], v195 offset:54016
v_cvt_pk_bf16_f32 v201, v202, v203
v_cvt_pk_bf16_f32 v202, v204, v205
s_waitcnt lgkmcnt(8)
v_mfma_f32_32x32x16_bf16 a[64:79], v[128:131], v[72:75], a[64:79]
ds_read_b64_tr_b16 v[96:97], v195 offset:50496
ds_read_b64_tr_b16 v[98:99], v195 offset:54080
v_cvt_pk_bf16_f32 v203, v206, v207
v_mfma_f32_32x32x16_bf16 a[80:95], v[132:135], v[72:75], a[80:95]
ds_read_b64_tr_b16 v[100:101], v195 offset:50560
ds_read_b64_tr_b16 v[102:103], v195 offset:54144
s_add_u32 s53, s49, 12288
v_mfma_f32_32x32x16_bf16 a[96:111], v[136:139], v[72:75], a[96:111]
buffer_store_dwordx4 v[200:203], v2, s[4:7], s53 offen offset:0 sc1
v_accvgpr_read_b32 v208, a232
v_accvgpr_read_b32 v209, a233
v_accvgpr_read_b32 v210, a234
v_mfma_f32_32x32x16_bf16 a[0:15], v[140:143], v[76:79], a[0:15]
v_accvgpr_read_b32 v211, a235
v_accvgpr_read_b32 v212, a236
v_accvgpr_read_b32 v213, a237
s_waitcnt lgkmcnt(4)
v_mfma_f32_32x32x16_bf16 a[16:31], v[144:147], v[76:79], a[16:31]
v_accvgpr_read_b32 v214, a238
v_accvgpr_read_b32 v215, a239
v_cvt_pk_bf16_f32 v208, v208, v209
v_cvt_pk_bf16_f32 v209, v210, v211
v_mfma_f32_32x32x16_bf16 a[32:47], v[148:151], v[76:79], a[32:47]
v_cvt_pk_bf16_f32 v210, v212, v213
v_cvt_pk_bf16_f32 v211, v214, v215
buffer_store_dwordx4 v[208:211], v2, s[4:7], s53 offen offset:1024 sc1
v_mfma_f32_32x32x16_bf16 a[48:63], v[152:155], v[76:79], a[48:63]
v_mfma_f32_32x32x16_bf16 a[64:79], v[156:159], v[76:79], a[64:79]
s_waitcnt lgkmcnt(0)
v_mfma_f32_32x32x16_bf16 a[80:95], v[96:99], v[76:79], a[80:95]
v_mfma_f32_32x32x16_bf16 a[96:111], v[100:103], v[76:79], a[96:111]
s_nop 7
s_nop 3
v_accvgpr_read_b32 v200, a0
v_accvgpr_read_b32 v201, a1
v_accvgpr_read_b32 v202, a2
v_accvgpr_read_b32 v203, a3
v_accvgpr_read_b32 v204, a4
v_accvgpr_read_b32 v205, a5
v_accvgpr_read_b32 v206, a6
v_accvgpr_read_b32 v207, a7
v_cvt_pk_bf16_f32 v200, v200, v201
v_cvt_pk_bf16_f32 v201, v202, v203
v_cvt_pk_bf16_f32 v202, v204, v205
v_cvt_pk_bf16_f32 v203, v206, v207
s_add_u32 s53, s49, 12288
buffer_store_dwordx4 v[200:203], v2, s[4:7], s53 offen offset:2048 sc1
v_accvgpr_read_b32 v208, a8
v_accvgpr_read_b32 v209, a9
v_accvgpr_read_b32 v210, a10
v_accvgpr_read_b32 v211, a11
v_accvgpr_read_b32 v212, a12
v_accvgpr_read_b32 v213, a13
v_accvgpr_read_b32 v214, a14
v_accvgpr_read_b32 v215, a15
v_cvt_pk_bf16_f32 v208, v208, v209
v_cvt_pk_bf16_f32 v209, v210, v211
v_cvt_pk_bf16_f32 v210, v212, v213
v_cvt_pk_bf16_f32 v211, v214, v215
buffer_store_dwordx4 v[208:211], v2, s[4:7], s53 offen offset:3072 sc1
v_accvgpr_read_b32 v216, a16
v_accvgpr_read_b32 v217, a17
v_accvgpr_read_b32 v218, a18
v_accvgpr_read_b32 v219, a19
v_accvgpr_read_b32 v220, a20
v_accvgpr_read_b32 v221, a21
v_accvgpr_read_b32 v222, a22
v_accvgpr_read_b32 v223, a23
v_cvt_pk_bf16_f32 v216, v216, v217
v_cvt_pk_bf16_f32 v217, v218, v219
v_cvt_pk_bf16_f32 v218, v220, v221
v_cvt_pk_bf16_f32 v219, v222, v223
s_add_u32 s53, s49, 16384
buffer_store_dwordx4 v[216:219], v2, s[4:7], s53 offen offset:0 sc1
v_accvgpr_read_b32 v224, a24
v_accvgpr_read_b32 v225, a25
v_accvgpr_read_b32 v226, a26
v_accvgpr_read_b32 v227, a27
v_accvgpr_read_b32 v228, a28
v_accvgpr_read_b32 v229, a29
v_accvgpr_read_b32 v230, a30
v_accvgpr_read_b32 v231, a31
v_cvt_pk_bf16_f32 v224, v224, v225
v_cvt_pk_bf16_f32 v225, v226, v227
v_cvt_pk_bf16_f32 v226, v228, v229
v_cvt_pk_bf16_f32 v227, v230, v231
buffer_store_dwordx4 v[224:227], v2, s[4:7], s53 offen offset:1024 sc1
v_accvgpr_read_b32 v200, a32
v_accvgpr_read_b32 v201, a33
v_accvgpr_read_b32 v202, a34
v_accvgpr_read_b32 v203, a35
v_accvgpr_read_b32 v204, a36
v_accvgpr_read_b32 v205, a37
v_accvgpr_read_b32 v206, a38
v_accvgpr_read_b32 v207, a39
v_cvt_pk_bf16_f32 v200, v200, v201
v_cvt_pk_bf16_f32 v201, v202, v203
v_cvt_pk_bf16_f32 v202, v204, v205
v_cvt_pk_bf16_f32 v203, v206, v207
buffer_store_dwordx4 v[200:203], v2, s[4:7], s53 offen offset:2048 sc1
v_accvgpr_read_b32 v208, a40
v_accvgpr_read_b32 v209, a41
v_accvgpr_read_b32 v210, a42
v_accvgpr_read_b32 v211, a43
v_accvgpr_read_b32 v212, a44
v_accvgpr_read_b32 v213, a45
v_accvgpr_read_b32 v214, a46
v_accvgpr_read_b32 v215, a47
v_cvt_pk_bf16_f32 v208, v208, v209
v_cvt_pk_bf16_f32 v209, v210, v211
v_cvt_pk_bf16_f32 v210, v212, v213
v_cvt_pk_bf16_f32 v211, v214, v215
buffer_store_dwordx4 v[208:211], v2, s[4:7], s53 offen offset:3072 sc1
v_accvgpr_read_b32 v216, a48
v_accvgpr_read_b32 v217, a49
v_accvgpr_read_b32 v218, a50
v_accvgpr_read_b32 v219, a51
v_accvgpr_read_b32 v220, a52
v_accvgpr_read_b32 v221, a53
v_accvgpr_read_b32 v222, a54
v_accvgpr_read_b32 v223, a55
v_cvt_pk_bf16_f32 v216, v216, v217
v_cvt_pk_bf16_f32 v217, v218, v219
v_cvt_pk_bf16_f32 v218, v220, v221
v_cvt_pk_bf16_f32 v219, v222, v223
s_add_u32 s53, s49, 20480
buffer_store_dwordx4 v[216:219], v2, s[4:7], s53 offen offset:0 sc1
v_accvgpr_read_b32 v224, a56
v_accvgpr_read_b32 v225, a57
v_accvgpr_read_b32 v226, a58
v_accvgpr_read_b32 v227, a59
v_accvgpr_read_b32 v228, a60
v_accvgpr_read_b32 v229, a61
v_accvgpr_read_b32 v230, a62
v_accvgpr_read_b32 v231, a63
v_cvt_pk_bf16_f32 v224, v224, v225
v_cvt_pk_bf16_f32 v225, v226, v227
v_cvt_pk_bf16_f32 v226, v228, v229
v_cvt_pk_bf16_f32 v227, v230, v231
buffer_store_dwordx4 v[224:227], v2, s[4:7], s53 offen offset:1024 sc1
v_accvgpr_read_b32 v200, a64
v_accvgpr_read_b32 v201, a65
v_accvgpr_read_b32 v202, a66
v_accvgpr_read_b32 v203, a67
v_accvgpr_read_b32 v204, a68
v_accvgpr_read_b32 v205, a69
v_accvgpr_read_b32 v206, a70
v_accvgpr_read_b32 v207, a71
v_cvt_pk_bf16_f32 v200, v200, v201
v_cvt_pk_bf16_f32 v201, v202, v203
v_cvt_pk_bf16_f32 v202, v204, v205
v_cvt_pk_bf16_f32 v203, v206, v207
buffer_store_dwordx4 v[200:203], v2, s[4:7], s53 offen offset:2048 sc1
v_accvgpr_read_b32 v208, a72
v_accvgpr_read_b32 v209, a73
v_accvgpr_read_b32 v210, a74
v_accvgpr_read_b32 v211, a75
v_accvgpr_read_b32 v212, a76
v_accvgpr_read_b32 v213, a77
v_accvgpr_read_b32 v214, a78
v_accvgpr_read_b32 v215, a79
v_cvt_pk_bf16_f32 v208, v208, v209
v_cvt_pk_bf16_f32 v209, v210, v211
v_cvt_pk_bf16_f32 v210, v212, v213
v_cvt_pk_bf16_f32 v211, v214, v215
buffer_store_dwordx4 v[208:211], v2, s[4:7], s53 offen offset:3072 sc1
v_accvgpr_read_b32 v216, a80
v_accvgpr_read_b32 v217, a81
v_accvgpr_read_b32 v218, a82
v_accvgpr_read_b32 v219, a83
v_accvgpr_read_b32 v220, a84
v_accvgpr_read_b32 v221, a85
v_accvgpr_read_b32 v222, a86
v_accvgpr_read_b32 v223, a87
v_cvt_pk_bf16_f32 v216, v216, v217
v_cvt_pk_bf16_f32 v217, v218, v219
v_cvt_pk_bf16_f32 v218, v220, v221
v_cvt_pk_bf16_f32 v219, v222, v223
s_add_u32 s53, s49, 24576
buffer_store_dwordx4 v[216:219], v2, s[4:7], s53 offen offset:0 sc1
v_accvgpr_read_b32 v224, a88
v_accvgpr_read_b32 v225, a89
v_accvgpr_read_b32 v226, a90
v_accvgpr_read_b32 v227, a91
v_accvgpr_read_b32 v228, a92
v_accvgpr_read_b32 v229, a93
v_accvgpr_read_b32 v230, a94
v_accvgpr_read_b32 v231, a95
v_cvt_pk_bf16_f32 v224, v224, v225
v_cvt_pk_bf16_f32 v225, v226, v227
v_cvt_pk_bf16_f32 v226, v228, v229
v_cvt_pk_bf16_f32 v227, v230, v231
buffer_store_dwordx4 v[224:227], v2, s[4:7], s53 offen offset:1024 sc1
v_accvgpr_read_b32 v200, a96
v_accvgpr_read_b32 v201, a97
v_accvgpr_read_b32 v202, a98
v_accvgpr_read_b32 v203, a99
v_accvgpr_read_b32 v204, a100
v_accvgpr_read_b32 v205, a101
v_accvgpr_read_b32 v206, a102
v_accvgpr_read_b32 v207, a103
v_cvt_pk_bf16_f32 v200, v200, v201
v_cvt_pk_bf16_f32 v201, v202, v203
v_cvt_pk_bf16_f32 v202, v204, v205
v_cvt_pk_bf16_f32 v203, v206, v207
buffer_store_dwordx4 v[200:203], v2, s[4:7], s53 offen offset:2048 sc1
v_accvgpr_read_b32 v208, a104
v_accvgpr_read_b32 v209, a105
v_accvgpr_read_b32 v210, a106
v_accvgpr_read_b32 v211, a107
v_accvgpr_read_b32 v212, a108
v_accvgpr_read_b32 v213, a109
v_accvgpr_read_b32 v214, a110
v_accvgpr_read_b32 v215, a111
v_cvt_pk_bf16_f32 v208, v208, v209
v_cvt_pk_bf16_f32 v209, v210, v211
v_cvt_pk_bf16_f32 v210, v212, v213
v_cvt_pk_bf16_f32 v211, v214, v215
buffer_store_dwordx4 v[208:211], v2, s[4:7], s53 offen offset:3072 sc1
s_waitcnt vmcnt(0)
s_barrier
s_cmp_eq_u32 s18, 0
s_cbranch_scc0 k2_rok
s_lshl_b32 s56, s17, 11
s_add_u32 s56, s56, 59801600
s_lshl_b32 s57, s16, 2
s_add_u32 s57, s57, s56
s_lshl_b32 s58, s16, 7
s_add_u32 s56, s56, s58
v_mov_b32 v12, s101
v_lshlrev_b32 v13, 7, v1
v_lshlrev_b32 v14, 2, v1
s_mov_b64 exec, 0xffff
buffer_store_dword v12, v13, s[4:7], s57 offen sc1
s_mov_b32 s58, 0
k2_rpoll:
buffer_load_dword v12, v14, s[4:7], s56 offen sc1
s_add_u32 s58, s58, 1
s_cmp_ge_u32 s58, 131072
s_waitcnt vmcnt(0)
s_cbranch_scc1 k2_rend
v_cmp_ne_u32 vcc, s101, v12
s_cbranch_vccnz k2_rpoll
k2_rend:
s_or_b32 s56, s16, s17
s_cmp_eq_u32 s56, 0
s_cbranch_scc0 k2_noep
v_mov_b32 v12, s101
v_mov_b32 v13, 0
s_mov_b64 exec, 1
s_mov_b32 s56, 59834368
buffer_store_dword v12, v13, s[4:7], s56 offen sc1
k2_noep:
s_mov_b64 exec, -1
k2_rok:
s_barrier
s_lshl_b32 s20, s16, 2
s_add_u32 s20, s20, s18
s_cmp_ge_u32 s20, 56
s_cbranch_scc1 k2_rskip
s_mul_i32 s21, s20, 4682
s_lshr_b32 s21, s21, 16
s_mul_i32 s25, s21, 14
s_sub_u32 s25, s20, s25
s_lshl_b32 s22, s17, 6
s_add_u32 s22, s22, s21
s_mul_i32 s22, s22, 28672
s_lshl_b32 s23, s25, 11
s_add_u32 s22, s22, s23
s_add_u32 s22, s22, 100663296
buffer_load_dwordx4 v[16:19], v2, s[4:7], s22 offen offset:0
buffer_load_dwordx4 v[20:23], v2, s[4:7], s22 offen offset:1024
s_add_u32 s22, s22, 114688
buffer_load_dwordx4 v[24:27], v2, s[4:7], s22 offen offset:0
buffer_load_dwordx4 v[28:31], v2, s[4:7], s22 offen offset:1024
s_add_u32 s22, s22, 114688
buffer_load_dwordx4 v[32:35], v2, s[4:7], s22 offen offset:0
buffer_load_dwordx4 v[36:39], v2, s[4:7], s22 offen offset:1024
s_add_u32 s22, s22, 114688
buffer_load_dwordx4 v[40:43], v2, s[4:7], s22 offen offset:0
buffer_load_dwordx4 v[44:47], v2, s[4:7], s22 offen offset:1024
s_add_u32 s22, s22, 114688
buffer_load_dwordx4 v[48:51], v2, s[4:7], s22 offen offset:0
buffer_load_dwordx4 v[52:55], v2, s[4:7], s22 offen offset:1024
s_add_u32 s22, s22, 114688
buffer_load_dwordx4 v[56:59], v2, s[4:7], s22 offen offset:0
buffer_load_dwordx4 v[60:63], v2, s[4:7], s22 offen offset:1024
s_add_u32 s22, s22, 114688
buffer_load_dwordx4 v[64:67], v2, s[4:7], s22 offen offset:0
buffer_load_dwordx4 v[68:71], v2, s[4:7], s22 offen offset:1024
s_add_u32 s22, s22, 114688
buffer_load_dwordx4 v[72:75], v2, s[4:7], s22 offen offset:0
buffer_load_dwordx4 v[76:79], v2, s[4:7], s22 offen offset:1024
s_add_u32 s22, s22, 114688
buffer_load_dwordx4 v[80:83], v2, s[4:7], s22 offen offset:0
buffer_load_dwordx4 v[84:87], v2, s[4:7], s22 offen offset:1024
s_add_u32 s22, s22, 114688
buffer_load_dwordx4 v[88:91], v2, s[4:7], s22 offen offset:0
buffer_load_dwordx4 v[92:95], v2, s[4:7], s22 offen offset:1024
s_add_u32 s22, s22, 114688
buffer_load_dwordx4 v[96:99], v2, s[4:7], s22 offen offset:0
buffer_load_dwordx4 v[100:103], v2, s[4:7], s22 offen offset:1024
s_add_u32 s22, s22, 114688
buffer_load_dwordx4 v[104:107], v2, s[4:7], s22 offen offset:0
buffer_load_dwordx4 v[108:111], v2, s[4:7], s22 offen offset:1024
s_add_u32 s22, s22, 114688
buffer_load_dwordx4 v[112:115], v2, s[4:7], s22 offen offset:0
buffer_load_dwordx4 v[116:119], v2, s[4:7], s22 offen offset:1024
s_add_u32 s22, s22, 114688
buffer_load_dwordx4 v[120:123], v2, s[4:7], s22 offen offset:0
buffer_load_dwordx4 v[124:127], v2, s[4:7], s22 offen offset:1024
s_add_u32 s22, s22, 114688
buffer_load_dwordx4 v[128:131], v2, s[4:7], s22 offen offset:0
buffer_load_dwordx4 v[132:135], v2, s[4:7], s22 offen offset:1024
s_add_u32 s22, s22, 114688
buffer_load_dwordx4 v[136:139], v2, s[4:7], s22 offen offset:0
buffer_load_dwordx4 v[140:143], v2, s[4:7], s22 offen offset:1024
v_and_b32 v3, 31, v1
v_mul_u32_u24 v3, 896, v3
v_lshrrev_b32 v4, 5, v1
v_lshl_add_u32 v3, v4, 4, v3
s_lshl_b32 s23, s17, 2
s_add_u32 s23, s23, s21
s_mul_i32 s23, s23, 28672
s_lshl_b32 s24, s25, 6
s_add_u32 s23, s23, s24
s_waitcnt vmcnt(30)
v_lshlrev_b32 v160, 16, v16
v_and_b32 v161, 0xffff0000, v16
v_lshlrev_b32 v162, 16, v17
v_and_b32 v163, 0xffff0000, v17
v_lshlrev_b32 v164, 16, v18
v_and_b32 v165, 0xffff0000, v18
v_lshlrev_b32 v166, 16, v19
v_and_b32 v167, 0xffff0000, v19
v_lshlrev_b32 v168, 16, v20
v_and_b32 v169, 0xffff0000, v20
v_lshlrev_b32 v170, 16, v21
v_and_b32 v171, 0xffff0000, v21
v_lshlrev_b32 v172, 16, v22
v_and_b32 v173, 0xffff0000, v22
v_lshlrev_b32 v174, 16, v23
v_and_b32 v175, 0xffff0000, v23
s_waitcnt vmcnt(28)
v_lshlrev_b32 v4, 16, v24
v_and_b32 v5, 0xffff0000, v24
v_add_f32 v160, v160, v4
v_add_f32 v161, v161, v5
v_lshlrev_b32 v4, 16, v25
v_and_b32 v5, 0xffff0000, v25
v_add_f32 v162, v162, v4
v_add_f32 v163, v163, v5
v_lshlrev_b32 v4, 16, v26
v_and_b32 v5, 0xffff0000, v26
v_add_f32 v164, v164, v4
v_add_f32 v165, v165, v5
v_lshlrev_b32 v4, 16, v27
v_and_b32 v5, 0xffff0000, v27
v_add_f32 v166, v166, v4
v_add_f32 v167, v167, v5
v_lshlrev_b32 v4, 16, v28
v_and_b32 v5, 0xffff0000, v28
v_add_f32 v168, v168, v4
v_add_f32 v169, v169, v5
v_lshlrev_b32 v4, 16, v29
v_and_b32 v5, 0xffff0000, v29
v_add_f32 v170, v170, v4
v_add_f32 v171, v171, v5
v_lshlrev_b32 v4, 16, v30
v_and_b32 v5, 0xffff0000, v30
v_add_f32 v172, v172, v4
v_add_f32 v173, v173, v5
v_lshlrev_b32 v4, 16, v31
v_and_b32 v5, 0xffff0000, v31
v_add_f32 v174, v174, v4
v_add_f32 v175, v175, v5
s_waitcnt vmcnt(26)
v_lshlrev_b32 v4, 16, v32
v_and_b32 v5, 0xffff0000, v32
v_add_f32 v160, v160, v4
v_add_f32 v161, v161, v5
v_lshlrev_b32 v4, 16, v33
v_and_b32 v5, 0xffff0000, v33
v_add_f32 v162, v162, v4
v_add_f32 v163, v163, v5
v_lshlrev_b32 v4, 16, v34
v_and_b32 v5, 0xffff0000, v34
v_add_f32 v164, v164, v4
v_add_f32 v165, v165, v5
v_lshlrev_b32 v4, 16, v35
v_and_b32 v5, 0xffff0000, v35
v_add_f32 v166, v166, v4
v_add_f32 v167, v167, v5
v_lshlrev_b32 v4, 16, v36
v_and_b32 v5, 0xffff0000, v36
v_add_f32 v168, v168, v4
v_add_f32 v169, v169, v5
v_lshlrev_b32 v4, 16, v37
v_and_b32 v5, 0xffff0000, v37
v_add_f32 v170, v170, v4
v_add_f32 v171, v171, v5
v_lshlrev_b32 v4, 16, v38
v_and_b32 v5, 0xffff0000, v38
v_add_f32 v172, v172, v4
v_add_f32 v173, v173, v5
v_lshlrev_b32 v4, 16, v39
v_and_b32 v5, 0xffff0000, v39
v_add_f32 v174, v174, v4
v_add_f32 v175, v175, v5
s_waitcnt vmcnt(24)
v_lshlrev_b32 v4, 16, v40
v_and_b32 v5, 0xffff0000, v40
v_add_f32 v160, v160, v4
v_add_f32 v161, v161, v5
v_lshlrev_b32 v4, 16, v41
v_and_b32 v5, 0xffff0000, v41
v_add_f32 v162, v162, v4
v_add_f32 v163, v163, v5
v_lshlrev_b32 v4, 16, v42
v_and_b32 v5, 0xffff0000, v42
v_add_f32 v164, v164, v4
v_add_f32 v165, v165, v5
v_lshlrev_b32 v4, 16, v43
v_and_b32 v5, 0xffff0000, v43
v_add_f32 v166, v166, v4
v_add_f32 v167, v167, v5
v_lshlrev_b32 v4, 16, v44
v_and_b32 v5, 0xffff0000, v44
v_add_f32 v168, v168, v4
v_add_f32 v169, v169, v5
v_lshlrev_b32 v4, 16, v45
v_and_b32 v5, 0xffff0000, v45
v_add_f32 v170, v170, v4
v_add_f32 v171, v171, v5
v_lshlrev_b32 v4, 16, v46
v_and_b32 v5, 0xffff0000, v46
v_add_f32 v172, v172, v4
v_add_f32 v173, v173, v5
v_lshlrev_b32 v4, 16, v47
v_and_b32 v5, 0xffff0000, v47
v_add_f32 v174, v174, v4
v_add_f32 v175, v175, v5
s_waitcnt vmcnt(22)
v_lshlrev_b32 v4, 16, v48
v_and_b32 v5, 0xffff0000, v48
v_add_f32 v160, v160, v4
v_add_f32 v161, v161, v5
v_lshlrev_b32 v4, 16, v49
v_and_b32 v5, 0xffff0000, v49
v_add_f32 v162, v162, v4
v_add_f32 v163, v163, v5
v_lshlrev_b32 v4, 16, v50
v_and_b32 v5, 0xffff0000, v50
v_add_f32 v164, v164, v4
v_add_f32 v165, v165, v5
v_lshlrev_b32 v4, 16, v51
v_and_b32 v5, 0xffff0000, v51
v_add_f32 v166, v166, v4
v_add_f32 v167, v167, v5
v_lshlrev_b32 v4, 16, v52
v_and_b32 v5, 0xffff0000, v52
v_add_f32 v168, v168, v4
v_add_f32 v169, v169, v5
v_lshlrev_b32 v4, 16, v53
v_and_b32 v5, 0xffff0000, v53
v_add_f32 v170, v170, v4
v_add_f32 v171, v171, v5
v_lshlrev_b32 v4, 16, v54
v_and_b32 v5, 0xffff0000, v54
v_add_f32 v172, v172, v4
v_add_f32 v173, v173, v5
v_lshlrev_b32 v4, 16, v55
v_and_b32 v5, 0xffff0000, v55
v_add_f32 v174, v174, v4
v_add_f32 v175, v175, v5
s_waitcnt vmcnt(20)
v_lshlrev_b32 v4, 16, v56
v_and_b32 v5, 0xffff0000, v56
v_add_f32 v160, v160, v4
v_add_f32 v161, v161, v5
v_lshlrev_b32 v4, 16, v57
v_and_b32 v5, 0xffff0000, v57
v_add_f32 v162, v162, v4
v_add_f32 v163, v163, v5
v_lshlrev_b32 v4, 16, v58
v_and_b32 v5, 0xffff0000, v58
v_add_f32 v164, v164, v4
v_add_f32 v165, v165, v5
v_lshlrev_b32 v4, 16, v59
v_and_b32 v5, 0xffff0000, v59
v_add_f32 v166, v166, v4
v_add_f32 v167, v167, v5
v_lshlrev_b32 v4, 16, v60
v_and_b32 v5, 0xffff0000, v60
v_add_f32 v168, v168, v4
v_add_f32 v169, v169, v5
v_lshlrev_b32 v4, 16, v61
v_and_b32 v5, 0xffff0000, v61
v_add_f32 v170, v170, v4
v_add_f32 v171, v171, v5
v_lshlrev_b32 v4, 16, v62
v_and_b32 v5, 0xffff0000, v62
v_add_f32 v172, v172, v4
v_add_f32 v173, v173, v5
v_lshlrev_b32 v4, 16, v63
v_and_b32 v5, 0xffff0000, v63
v_add_f32 v174, v174, v4
v_add_f32 v175, v175, v5
s_waitcnt vmcnt(18)
v_lshlrev_b32 v4, 16, v64
v_and_b32 v5, 0xffff0000, v64
v_add_f32 v160, v160, v4
v_add_f32 v161, v161, v5
v_lshlrev_b32 v4, 16, v65
v_and_b32 v5, 0xffff0000, v65
v_add_f32 v162, v162, v4
v_add_f32 v163, v163, v5
v_lshlrev_b32 v4, 16, v66
v_and_b32 v5, 0xffff0000, v66
v_add_f32 v164, v164, v4
v_add_f32 v165, v165, v5
v_lshlrev_b32 v4, 16, v67
v_and_b32 v5, 0xffff0000, v67
v_add_f32 v166, v166, v4
v_add_f32 v167, v167, v5
v_lshlrev_b32 v4, 16, v68
v_and_b32 v5, 0xffff0000, v68
v_add_f32 v168, v168, v4
v_add_f32 v169, v169, v5
v_lshlrev_b32 v4, 16, v69
v_and_b32 v5, 0xffff0000, v69
v_add_f32 v170, v170, v4
v_add_f32 v171, v171, v5
v_lshlrev_b32 v4, 16, v70
v_and_b32 v5, 0xffff0000, v70
v_add_f32 v172, v172, v4
v_add_f32 v173, v173, v5
v_lshlrev_b32 v4, 16, v71
v_and_b32 v5, 0xffff0000, v71
v_add_f32 v174, v174, v4
v_add_f32 v175, v175, v5
s_waitcnt vmcnt(16)
v_lshlrev_b32 v4, 16, v72
v_and_b32 v5, 0xffff0000, v72
v_add_f32 v160, v160, v4
v_add_f32 v161, v161, v5
v_lshlrev_b32 v4, 16, v73
v_and_b32 v5, 0xffff0000, v73
v_add_f32 v162, v162, v4
v_add_f32 v163, v163, v5
v_lshlrev_b32 v4, 16, v74
v_and_b32 v5, 0xffff0000, v74
v_add_f32 v164, v164, v4
v_add_f32 v165, v165, v5
v_lshlrev_b32 v4, 16, v75
v_and_b32 v5, 0xffff0000, v75
v_add_f32 v166, v166, v4
v_add_f32 v167, v167, v5
v_lshlrev_b32 v4, 16, v76
v_and_b32 v5, 0xffff0000, v76
v_add_f32 v168, v168, v4
v_add_f32 v169, v169, v5
v_lshlrev_b32 v4, 16, v77
v_and_b32 v5, 0xffff0000, v77
v_add_f32 v170, v170, v4
v_add_f32 v171, v171, v5
v_lshlrev_b32 v4, 16, v78
v_and_b32 v5, 0xffff0000, v78
v_add_f32 v172, v172, v4
v_add_f32 v173, v173, v5
v_lshlrev_b32 v4, 16, v79
v_and_b32 v5, 0xffff0000, v79
v_add_f32 v174, v174, v4
v_add_f32 v175, v175, v5
s_waitcnt vmcnt(14)
v_lshlrev_b32 v4, 16, v80
v_and_b32 v5, 0xffff0000, v80
v_add_f32 v160, v160, v4
v_add_f32 v161, v161, v5
v_lshlrev_b32 v4, 16, v81
v_and_b32 v5, 0xffff0000, v81
v_add_f32 v162, v162, v4
v_add_f32 v163, v163, v5
v_lshlrev_b32 v4, 16, v82
v_and_b32 v5, 0xffff0000, v82
v_add_f32 v164, v164, v4
v_add_f32 v165, v165, v5
v_lshlrev_b32 v4, 16, v83
v_and_b32 v5, 0xffff0000, v83
v_add_f32 v166, v166, v4
v_add_f32 v167, v167, v5
v_lshlrev_b32 v4, 16, v84
v_and_b32 v5, 0xffff0000, v84
v_add_f32 v168, v168, v4
v_add_f32 v169, v169, v5
v_lshlrev_b32 v4, 16, v85
v_and_b32 v5, 0xffff0000, v85
v_add_f32 v170, v170, v4
v_add_f32 v171, v171, v5
v_lshlrev_b32 v4, 16, v86
v_and_b32 v5, 0xffff0000, v86
v_add_f32 v172, v172, v4
v_add_f32 v173, v173, v5
v_lshlrev_b32 v4, 16, v87
v_and_b32 v5, 0xffff0000, v87
v_add_f32 v174, v174, v4
v_add_f32 v175, v175, v5
s_waitcnt vmcnt(12)
v_lshlrev_b32 v4, 16, v88
v_and_b32 v5, 0xffff0000, v88
v_add_f32 v160, v160, v4
v_add_f32 v161, v161, v5
v_lshlrev_b32 v4, 16, v89
v_and_b32 v5, 0xffff0000, v89
v_add_f32 v162, v162, v4
v_add_f32 v163, v163, v5
v_lshlrev_b32 v4, 16, v90
v_and_b32 v5, 0xffff0000, v90
v_add_f32 v164, v164, v4
v_add_f32 v165, v165, v5
v_lshlrev_b32 v4, 16, v91
v_and_b32 v5, 0xffff0000, v91
v_add_f32 v166, v166, v4
v_add_f32 v167, v167, v5
v_lshlrev_b32 v4, 16, v92
v_and_b32 v5, 0xffff0000, v92
v_add_f32 v168, v168, v4
v_add_f32 v169, v169, v5
v_lshlrev_b32 v4, 16, v93
v_and_b32 v5, 0xffff0000, v93
v_add_f32 v170, v170, v4
v_add_f32 v171, v171, v5
v_lshlrev_b32 v4, 16, v94
v_and_b32 v5, 0xffff0000, v94
v_add_f32 v172, v172, v4
v_add_f32 v173, v173, v5
v_lshlrev_b32 v4, 16, v95
v_and_b32 v5, 0xffff0000, v95
v_add_f32 v174, v174, v4
v_add_f32 v175, v175, v5
s_waitcnt vmcnt(10)
v_lshlrev_b32 v4, 16, v96
v_and_b32 v5, 0xffff0000, v96
v_add_f32 v160, v160, v4
v_add_f32 v161, v161, v5
v_lshlrev_b32 v4, 16, v97
v_and_b32 v5, 0xffff0000, v97
v_add_f32 v162, v162, v4
v_add_f32 v163, v163, v5
v_lshlrev_b32 v4, 16, v98
v_and_b32 v5, 0xffff0000, v98
v_add_f32 v164, v164, v4
v_add_f32 v165, v165, v5
v_lshlrev_b32 v4, 16, v99
v_and_b32 v5, 0xffff0000, v99
v_add_f32 v166, v166, v4
v_add_f32 v167, v167, v5
v_lshlrev_b32 v4, 16, v100
v_and_b32 v5, 0xffff0000, v100
v_add_f32 v168, v168, v4
v_add_f32 v169, v169, v5
v_lshlrev_b32 v4, 16, v101
v_and_b32 v5, 0xffff0000, v101
v_add_f32 v170, v170, v4
v_add_f32 v171, v171, v5
v_lshlrev_b32 v4, 16, v102
v_and_b32 v5, 0xffff0000, v102
v_add_f32 v172, v172, v4
v_add_f32 v173, v173, v5
v_lshlrev_b32 v4, 16, v103
v_and_b32 v5, 0xffff0000, v103
v_add_f32 v174, v174, v4
v_add_f32 v175, v175, v5
s_waitcnt vmcnt(8)
v_lshlrev_b32 v4, 16, v104
v_and_b32 v5, 0xffff0000, v104
v_add_f32 v160, v160, v4
v_add_f32 v161, v161, v5
v_lshlrev_b32 v4, 16, v105
v_and_b32 v5, 0xffff0000, v105
v_add_f32 v162, v162, v4
v_add_f32 v163, v163, v5
v_lshlrev_b32 v4, 16, v106
v_and_b32 v5, 0xffff0000, v106
v_add_f32 v164, v164, v4
v_add_f32 v165, v165, v5
v_lshlrev_b32 v4, 16, v107
v_and_b32 v5, 0xffff0000, v107
v_add_f32 v166, v166, v4
v_add_f32 v167, v167, v5
v_lshlrev_b32 v4, 16, v108
v_and_b32 v5, 0xffff0000, v108
v_add_f32 v168, v168, v4
v_add_f32 v169, v169, v5
v_lshlrev_b32 v4, 16, v109
v_and_b32 v5, 0xffff0000, v109
v_add_f32 v170, v170, v4
v_add_f32 v171, v171, v5
v_lshlrev_b32 v4, 16, v110
v_and_b32 v5, 0xffff0000, v110
v_add_f32 v172, v172, v4
v_add_f32 v173, v173, v5
v_lshlrev_b32 v4, 16, v111
v_and_b32 v5, 0xffff0000, v111
v_add_f32 v174, v174, v4
v_add_f32 v175, v175, v5
s_waitcnt vmcnt(6)
v_lshlrev_b32 v4, 16, v112
v_and_b32 v5, 0xffff0000, v112
v_add_f32 v160, v160, v4
v_add_f32 v161, v161, v5
v_lshlrev_b32 v4, 16, v113
v_and_b32 v5, 0xffff0000, v113
v_add_f32 v162, v162, v4
v_add_f32 v163, v163, v5
v_lshlrev_b32 v4, 16, v114
v_and_b32 v5, 0xffff0000, v114
v_add_f32 v164, v164, v4
v_add_f32 v165, v165, v5
v_lshlrev_b32 v4, 16, v115
v_and_b32 v5, 0xffff0000, v115
v_add_f32 v166, v166, v4
v_add_f32 v167, v167, v5
v_lshlrev_b32 v4, 16, v116
v_and_b32 v5, 0xffff0000, v116
v_add_f32 v168, v168, v4
v_add_f32 v169, v169, v5
v_lshlrev_b32 v4, 16, v117
v_and_b32 v5, 0xffff0000, v117
v_add_f32 v170, v170, v4
v_add_f32 v171, v171, v5
v_lshlrev_b32 v4, 16, v118
v_and_b32 v5, 0xffff0000, v118
v_add_f32 v172, v172, v4
v_add_f32 v173, v173, v5
v_lshlrev_b32 v4, 16, v119
v_and_b32 v5, 0xffff0000, v119
v_add_f32 v174, v174, v4
v_add_f32 v175, v175, v5
s_waitcnt vmcnt(4)
v_lshlrev_b32 v4, 16, v120
v_and_b32 v5, 0xffff0000, v120
v_add_f32 v160, v160, v4
v_add_f32 v161, v161, v5
v_lshlrev_b32 v4, 16, v121
v_and_b32 v5, 0xffff0000, v121
v_add_f32 v162, v162, v4
v_add_f32 v163, v163, v5
v_lshlrev_b32 v4, 16, v122
v_and_b32 v5, 0xffff0000, v122
v_add_f32 v164, v164, v4
v_add_f32 v165, v165, v5
v_lshlrev_b32 v4, 16, v123
v_and_b32 v5, 0xffff0000, v123
v_add_f32 v166, v166, v4
v_add_f32 v167, v167, v5
v_lshlrev_b32 v4, 16, v124
v_and_b32 v5, 0xffff0000, v124
v_add_f32 v168, v168, v4
v_add_f32 v169, v169, v5
v_lshlrev_b32 v4, 16, v125
v_and_b32 v5, 0xffff0000, v125
v_add_f32 v170, v170, v4
v_add_f32 v171, v171, v5
v_lshlrev_b32 v4, 16, v126
v_and_b32 v5, 0xffff0000, v126
v_add_f32 v172, v172, v4
v_add_f32 v173, v173, v5
v_lshlrev_b32 v4, 16, v127
v_and_b32 v5, 0xffff0000, v127
v_add_f32 v174, v174, v4
v_add_f32 v175, v175, v5
s_waitcnt vmcnt(2)
v_lshlrev_b32 v4, 16, v128
v_and_b32 v5, 0xffff0000, v128
v_add_f32 v160, v160, v4
v_add_f32 v161, v161, v5
v_lshlrev_b32 v4, 16, v129
v_and_b32 v5, 0xffff0000, v129
v_add_f32 v162, v162, v4
v_add_f32 v163, v163, v5
v_lshlrev_b32 v4, 16, v130
v_and_b32 v5, 0xffff0000, v130
v_add_f32 v164, v164, v4
v_add_f32 v165, v165, v5
v_lshlrev_b32 v4, 16, v131
v_and_b32 v5, 0xffff0000, v131
v_add_f32 v166, v166, v4
v_add_f32 v167, v167, v5
v_lshlrev_b32 v4, 16, v132
v_and_b32 v5, 0xffff0000, v132
v_add_f32 v168, v168, v4
v_add_f32 v169, v169, v5
v_lshlrev_b32 v4, 16, v133
v_and_b32 v5, 0xffff0000, v133
v_add_f32 v170, v170, v4
v_add_f32 v171, v171, v5
v_lshlrev_b32 v4, 16, v134
v_and_b32 v5, 0xffff0000, v134
v_add_f32 v172, v172, v4
v_add_f32 v173, v173, v5
v_lshlrev_b32 v4, 16, v135
v_and_b32 v5, 0xffff0000, v135
v_add_f32 v174, v174, v4
v_add_f32 v175, v175, v5
s_waitcnt vmcnt(0)
v_lshlrev_b32 v4, 16, v136
v_and_b32 v5, 0xffff0000, v136
v_add_f32 v160, v160, v4
v_add_f32 v161, v161, v5
v_lshlrev_b32 v4, 16, v137
v_and_b32 v5, 0xffff0000, v137
v_add_f32 v162, v162, v4
v_add_f32 v163, v163, v5
v_lshlrev_b32 v4, 16, v138
v_and_b32 v5, 0xffff0000, v138
v_add_f32 v164, v164, v4
v_add_f32 v165, v165, v5
v_lshlrev_b32 v4, 16, v139
v_and_b32 v5, 0xffff0000, v139
v_add_f32 v166, v166, v4
v_add_f32 v167, v167, v5
v_lshlrev_b32 v4, 16, v140
v_and_b32 v5, 0xffff0000, v140
v_add_f32 v168, v168, v4
v_add_f32 v169, v169, v5
v_lshlrev_b32 v4, 16, v141
v_and_b32 v5, 0xffff0000, v141
v_add_f32 v170, v170, v4
v_add_f32 v171, v171, v5
v_lshlrev_b32 v4, 16, v142
v_and_b32 v5, 0xffff0000, v142
v_add_f32 v172, v172, v4
v_add_f32 v173, v173, v5
v_lshlrev_b32 v4, 16, v143
v_and_b32 v5, 0xffff0000, v143
v_add_f32 v174, v174, v4
v_add_f32 v175, v175, v5
v_cvt_pk_bf16_f32 v8, v160, v161
v_cvt_pk_bf16_f32 v9, v162, v163
v_cvt_pk_bf16_f32 v10, v164, v165
v_cvt_pk_bf16_f32 v11, v166, v167
v_cvt_pk_bf16_f32 v12, v168, v169
v_cvt_pk_bf16_f32 v13, v170, v171
v_cvt_pk_bf16_f32 v14, v172, v173
v_cvt_pk_bf16_f32 v15, v174, v175
s_nop 1
v_permlane32_swap_b32 v8, v10
v_permlane32_swap_b32 v9, v11
v_permlane32_swap_b32 v12, v14
v_permlane32_swap_b32 v13, v15
s_nop 1
buffer_store_dwordx4 v[8:11], v3, s[88:91], s23 offen offset:0
buffer_store_dwordx4 v[12:15], v3, s[88:91], s23 offen offset:32
k2_rskip:
mix_done:
s_endpgm
k2_mask1:
s_sub_u32 s33, s32, s31
s_lshl_b32 s33, s33, 5
v_add_u32 v9, s33, v5
v_cmp_gt_i32 vcc, 0, v9
v_cndmask_b32 v32, v32, v8, vcc
v_cmp_gt_i32 vcc, 1, v9
v_cndmask_b32 v33, v33, v8, vcc
v_cmp_gt_i32 vcc, 2, v9
v_cndmask_b32 v34, v34, v8, vcc
v_cmp_gt_i32 vcc, 3, v9
v_cndmask_b32 v35, v35, v8, vcc
v_cmp_gt_i32 vcc, 8, v9
v_cndmask_b32 v36, v36, v8, vcc
v_cmp_gt_i32 vcc, 9, v9
v_cndmask_b32 v37, v37, v8, vcc
v_cmp_gt_i32 vcc, 10, v9
v_cndmask_b32 v38, v38, v8, vcc
v_cmp_gt_i32 vcc, 11, v9
v_cndmask_b32 v39, v39, v8, vcc
v_cmp_gt_i32 vcc, 16, v9
v_cndmask_b32 v40, v40, v8, vcc
v_cmp_gt_i32 vcc, 17, v9
v_cndmask_b32 v41, v41, v8, vcc
v_cmp_gt_i32 vcc, 18, v9
v_cndmask_b32 v42, v42, v8, vcc
v_cmp_gt_i32 vcc, 19, v9
v_cndmask_b32 v43, v43, v8, vcc
v_cmp_gt_i32 vcc, 24, v9
v_cndmask_b32 v44, v44, v8, vcc
v_cmp_gt_i32 vcc, 25, v9
v_cndmask_b32 v45, v45, v8, vcc
v_cmp_gt_i32 vcc, 26, v9
v_cndmask_b32 v46, v46, v8, vcc
v_cmp_gt_i32 vcc, 27, v9
v_cndmask_b32 v47, v47, v8, vcc
s_branch k2_maskret1
k2_rare1:
s_nop 7
s_nop 7
v_max3_f32 v9, v32, v33, v34
v_max3_f32 v9, v9, v35, v36
v_max3_f32 v9, v9, v37, v38
v_max3_f32 v9, v9, v39, v40
v_max3_f32 v9, v9, v41, v42
v_max3_f32 v9, v9, v43, v44
v_max3_f32 v9, v9, v45, v46
v_max_f32 v9, v9, v47
v_mov_b32 v10, v9
s_nop 1
v_permlane32_swap_b32 v9, v10
s_nop 1
v_max_f32 v9, v9, v10
v_max_f32 v9, 0, v9
v_sub_f32 v32, v32, v9
v_sub_f32 v33, v33, v9
v_sub_f32 v34, v34, v9
v_sub_f32 v35, v35, v9
v_sub_f32 v36, v36, v9
v_sub_f32 v37, v37, v9
v_sub_f32 v38, v38, v9
v_sub_f32 v39, v39, v9
v_sub_f32 v40, v40, v9
v_sub_f32 v41, v41, v9
v_sub_f32 v42, v42, v9
v_sub_f32 v43, v43, v9
v_sub_f32 v44, v44, v9
v_sub_f32 v45, v45, v9
v_sub_f32 v46, v46, v9
v_sub_f32 v47, v47, v9
v_sub_f32 v16, v16, v9
v_sub_f32 v17, v17, v9
v_sub_f32 v18, v18, v9
v_sub_f32 v19, v19, v9
v_sub_f32 v20, v20, v9
v_sub_f32 v21, v21, v9
v_sub_f32 v22, v22, v9
v_sub_f32 v23, v23, v9
v_sub_f32 v24, v24, v9
v_sub_f32 v25, v25, v9
v_sub_f32 v26, v26, v9
v_sub_f32 v27, v27, v9
v_sub_f32 v28, v28, v9
v_sub_f32 v29, v29, v9
v_sub_f32 v30, v30, v9
v_sub_f32 v31, v31, v9
v_sub_f32 v48, v48, v9
v_sub_f32 v49, v49, v9
v_sub_f32 v50, v50, v9
v_sub_f32 v51, v51, v9
v_sub_f32 v52, v52, v9
v_sub_f32 v53, v53, v9
v_sub_f32 v54, v54, v9
v_sub_f32 v55, v55, v9
v_sub_f32 v56, v56, v9
v_sub_f32 v57, v57, v9
v_sub_f32 v58, v58, v9
v_sub_f32 v59, v59, v9
v_sub_f32 v60, v60, v9
v_sub_f32 v61, v61, v9
v_sub_f32 v62, v62, v9
v_sub_f32 v63, v63, v9
v_sub_f32 v10, 0, v9
v_exp_f32 v10, v10
s_nop 0
v_mul_f32 v6, v6, v10
v_accvgpr_read_b32 v12, a0
v_accvgpr_read_b32 v13, a1
v_accvgpr_read_b32 v14, a2
v_accvgpr_read_b32 v15, a3
v_mul_f32 v12, v12, v10
v_mul_f32 v13, v13, v10
v_mul_f32 v14, v14, v10
v_mul_f32 v15, v15, v10
v_accvgpr_write_b32 a0, v12
v_accvgpr_write_b32 a1, v13
v_accvgpr_write_b32 a2, v14
v_accvgpr_write_b32 a3, v15
v_accvgpr_read_b32 v12, a4
v_accvgpr_read_b32 v13, a5
v_accvgpr_read_b32 v14, a6
v_accvgpr_read_b32 v15, a7
v_mul_f32 v12, v12, v10
v_mul_f32 v13, v13, v10
v_mul_f32 v14, v14, v10
v_mul_f32 v15, v15, v10
v_accvgpr_write_b32 a4, v12
v_accvgpr_write_b32 a5, v13
v_accvgpr_write_b32 a6, v14
v_accvgpr_write_b32 a7, v15
v_accvgpr_read_b32 v12, a8
v_accvgpr_read_b32 v13, a9
v_accvgpr_read_b32 v14, a10
v_accvgpr_read_b32 v15, a11
v_mul_f32 v12, v12, v10
v_mul_f32 v13, v13, v10
v_mul_f32 v14, v14, v10
v_mul_f32 v15, v15, v10
v_accvgpr_write_b32 a8, v12
v_accvgpr_write_b32 a9, v13
v_accvgpr_write_b32 a10, v14
v_accvgpr_write_b32 a11, v15
v_accvgpr_read_b32 v12, a12
v_accvgpr_read_b32 v13, a13
v_accvgpr_read_b32 v14, a14
v_accvgpr_read_b32 v15, a15
v_mul_f32 v12, v12, v10
v_mul_f32 v13, v13, v10
v_mul_f32 v14, v14, v10
v_mul_f32 v15, v15, v10
v_accvgpr_write_b32 a12, v12
v_accvgpr_write_b32 a13, v13
v_accvgpr_write_b32 a14, v14
v_accvgpr_write_b32 a15, v15
v_accvgpr_read_b32 v12, a16
v_accvgpr_read_b32 v13, a17
v_accvgpr_read_b32 v14, a18
v_accvgpr_read_b32 v15, a19
v_mul_f32 v12, v12, v10
v_mul_f32 v13, v13, v10
v_mul_f32 v14, v14, v10
v_mul_f32 v15, v15, v10
v_accvgpr_write_b32 a16, v12
v_accvgpr_write_b32 a17, v13
v_accvgpr_write_b32 a18, v14
v_accvgpr_write_b32 a19, v15
v_accvgpr_read_b32 v12, a20
v_accvgpr_read_b32 v13, a21
v_accvgpr_read_b32 v14, a22
v_accvgpr_read_b32 v15, a23
v_mul_f32 v12, v12, v10
v_mul_f32 v13, v13, v10
v_mul_f32 v14, v14, v10
v_mul_f32 v15, v15, v10
v_accvgpr_write_b32 a20, v12
v_accvgpr_write_b32 a21, v13
v_accvgpr_write_b32 a22, v14
v_accvgpr_write_b32 a23, v15
v_accvgpr_read_b32 v12, a24
v_accvgpr_read_b32 v13, a25
v_accvgpr_read_b32 v14, a26
v_accvgpr_read_b32 v15, a27
v_mul_f32 v12, v12, v10
v_mul_f32 v13, v13, v10
v_mul_f32 v14, v14, v10
v_mul_f32 v15, v15, v10
v_accvgpr_write_b32 a24, v12
v_accvgpr_write_b32 a25, v13
v_accvgpr_write_b32 a26, v14
v_accvgpr_write_b32 a27, v15
v_accvgpr_read_b32 v12, a28
v_accvgpr_read_b32 v13, a29
v_accvgpr_read_b32 v14, a30
v_accvgpr_read_b32 v15, a31
v_mul_f32 v12, v12, v10
v_mul_f32 v13, v13, v10
v_mul_f32 v14, v14, v10
v_mul_f32 v15, v15, v10
v_accvgpr_write_b32 a28, v12
v_accvgpr_write_b32 a29, v13
v_accvgpr_write_b32 a30, v14
v_accvgpr_write_b32 a31, v15
v_accvgpr_read_b32 v12, a32
v_accvgpr_read_b32 v13, a33
v_accvgpr_read_b32 v14, a34
v_accvgpr_read_b32 v15, a35
v_mul_f32 v12, v12, v10
v_mul_f32 v13, v13, v10
v_mul_f32 v14, v14, v10
v_mul_f32 v15, v15, v10
v_accvgpr_write_b32 a32, v12
v_accvgpr_write_b32 a33, v13
v_accvgpr_write_b32 a34, v14
v_accvgpr_write_b32 a35, v15
v_accvgpr_read_b32 v12, a36
v_accvgpr_read_b32 v13, a37
v_accvgpr_read_b32 v14, a38
v_accvgpr_read_b32 v15, a39
v_mul_f32 v12, v12, v10
v_mul_f32 v13, v13, v10
v_mul_f32 v14, v14, v10
v_mul_f32 v15, v15, v10
v_accvgpr_write_b32 a36, v12
v_accvgpr_write_b32 a37, v13
v_accvgpr_write_b32 a38, v14
v_accvgpr_write_b32 a39, v15
v_accvgpr_read_b32 v12, a40
v_accvgpr_read_b32 v13, a41
v_accvgpr_read_b32 v14, a42
v_accvgpr_read_b32 v15, a43
v_mul_f32 v12, v12, v10
v_mul_f32 v13, v13, v10
v_mul_f32 v14, v14, v10
v_mul_f32 v15, v15, v10
v_accvgpr_write_b32 a40, v12
v_accvgpr_write_b32 a41, v13
v_accvgpr_write_b32 a42, v14
v_accvgpr_write_b32 a43, v15
v_accvgpr_read_b32 v12, a44
v_accvgpr_read_b32 v13, a45
v_accvgpr_read_b32 v14, a46
v_accvgpr_read_b32 v15, a47
v_mul_f32 v12, v12, v10
v_mul_f32 v13, v13, v10
v_mul_f32 v14, v14, v10
v_mul_f32 v15, v15, v10
v_accvgpr_write_b32 a44, v12
v_accvgpr_write_b32 a45, v13
v_accvgpr_write_b32 a46, v14
v_accvgpr_write_b32 a47, v15
v_accvgpr_read_b32 v12, a48
v_accvgpr_read_b32 v13, a49
v_accvgpr_read_b32 v14, a50
v_accvgpr_read_b32 v15, a51
v_mul_f32 v12, v12, v10
v_mul_f32 v13, v13, v10
v_mul_f32 v14, v14, v10
v_mul_f32 v15, v15, v10
v_accvgpr_write_b32 a48, v12
v_accvgpr_write_b32 a49, v13
v_accvgpr_write_b32 a50, v14
v_accvgpr_write_b32 a51, v15
v_accvgpr_read_b32 v12, a52
v_accvgpr_read_b32 v13, a53
v_accvgpr_read_b32 v14, a54
v_accvgpr_read_b32 v15, a55
v_mul_f32 v12, v12, v10
v_mul_f32 v13, v13, v10
v_mul_f32 v14, v14, v10
v_mul_f32 v15, v15, v10
v_accvgpr_write_b32 a52, v12
v_accvgpr_write_b32 a53, v13
v_accvgpr_write_b32 a54, v14
v_accvgpr_write_b32 a55, v15
v_accvgpr_read_b32 v12, a56
v_accvgpr_read_b32 v13, a57
v_accvgpr_read_b32 v14, a58
v_accvgpr_read_b32 v15, a59
v_mul_f32 v12, v12, v10
v_mul_f32 v13, v13, v10
v_mul_f32 v14, v14, v10
v_mul_f32 v15, v15, v10
v_accvgpr_write_b32 a56, v12
v_accvgpr_write_b32 a57, v13
v_accvgpr_write_b32 a58, v14
v_accvgpr_write_b32 a59, v15
v_accvgpr_read_b32 v12, a60
v_accvgpr_read_b32 v13, a61
v_accvgpr_read_b32 v14, a62
v_accvgpr_read_b32 v15, a63
v_mul_f32 v12, v12, v10
v_mul_f32 v13, v13, v10
v_mul_f32 v14, v14, v10
v_mul_f32 v15, v15, v10
v_accvgpr_write_b32 a60, v12
v_accvgpr_write_b32 a61, v13
v_accvgpr_write_b32 a62, v14
v_accvgpr_write_b32 a63, v15
v_accvgpr_read_b32 v12, a64
v_accvgpr_read_b32 v13, a65
v_accvgpr_read_b32 v14, a66
v_accvgpr_read_b32 v15, a67
v_mul_f32 v12, v12, v10
v_mul_f32 v13, v13, v10
v_mul_f32 v14, v14, v10
v_mul_f32 v15, v15, v10
v_accvgpr_write_b32 a64, v12
v_accvgpr_write_b32 a65, v13
v_accvgpr_write_b32 a66, v14
v_accvgpr_write_b32 a67, v15
v_accvgpr_read_b32 v12, a68
v_accvgpr_read_b32 v13, a69
v_accvgpr_read_b32 v14, a70
v_accvgpr_read_b32 v15, a71
v_mul_f32 v12, v12, v10
v_mul_f32 v13, v13, v10
v_mul_f32 v14, v14, v10
v_mul_f32 v15, v15, v10
v_accvgpr_write_b32 a68, v12
v_accvgpr_write_b32 a69, v13
v_accvgpr_write_b32 a70, v14
v_accvgpr_write_b32 a71, v15
v_accvgpr_read_b32 v12, a72
v_accvgpr_read_b32 v13, a73
v_accvgpr_read_b32 v14, a74
v_accvgpr_read_b32 v15, a75
v_mul_f32 v12, v12, v10
v_mul_f32 v13, v13, v10
v_mul_f32 v14, v14, v10
v_mul_f32 v15, v15, v10
v_accvgpr_write_b32 a72, v12
v_accvgpr_write_b32 a73, v13
v_accvgpr_write_b32 a74, v14
v_accvgpr_write_b32 a75, v15
v_accvgpr_read_b32 v12, a76
v_accvgpr_read_b32 v13, a77
v_accvgpr_read_b32 v14, a78
v_accvgpr_read_b32 v15, a79
v_mul_f32 v12, v12, v10
v_mul_f32 v13, v13, v10
v_mul_f32 v14, v14, v10
v_mul_f32 v15, v15, v10
v_accvgpr_write_b32 a76, v12
v_accvgpr_write_b32 a77, v13
v_accvgpr_write_b32 a78, v14
v_accvgpr_write_b32 a79, v15
v_accvgpr_read_b32 v12, a80
v_accvgpr_read_b32 v13, a81
v_accvgpr_read_b32 v14, a82
v_accvgpr_read_b32 v15, a83
v_mul_f32 v12, v12, v10
v_mul_f32 v13, v13, v10
v_mul_f32 v14, v14, v10
v_mul_f32 v15, v15, v10
v_accvgpr_write_b32 a80, v12
v_accvgpr_write_b32 a81, v13
v_accvgpr_write_b32 a82, v14
v_accvgpr_write_b32 a83, v15
v_accvgpr_read_b32 v12, a84
v_accvgpr_read_b32 v13, a85
v_accvgpr_read_b32 v14, a86
v_accvgpr_read_b32 v15, a87
v_mul_f32 v12, v12, v10
v_mul_f32 v13, v13, v10
v_mul_f32 v14, v14, v10
v_mul_f32 v15, v15, v10
v_accvgpr_write_b32 a84, v12
v_accvgpr_write_b32 a85, v13
v_accvgpr_write_b32 a86, v14
v_accvgpr_write_b32 a87, v15
v_accvgpr_read_b32 v12, a88
v_accvgpr_read_b32 v13, a89
v_accvgpr_read_b32 v14, a90
v_accvgpr_read_b32 v15, a91
v_mul_f32 v12, v12, v10
v_mul_f32 v13, v13, v10
v_mul_f32 v14, v14, v10
v_mul_f32 v15, v15, v10
v_accvgpr_write_b32 a88, v12
v_accvgpr_write_b32 a89, v13
v_accvgpr_write_b32 a90, v14
v_accvgpr_write_b32 a91, v15
v_accvgpr_read_b32 v12, a92
v_accvgpr_read_b32 v13, a93
v_accvgpr_read_b32 v14, a94
v_accvgpr_read_b32 v15, a95
v_mul_f32 v12, v12, v10
v_mul_f32 v13, v13, v10
v_mul_f32 v14, v14, v10
v_mul_f32 v15, v15, v10
v_accvgpr_write_b32 a92, v12
v_accvgpr_write_b32 a93, v13
v_accvgpr_write_b32 a94, v14
v_accvgpr_write_b32 a95, v15
v_accvgpr_read_b32 v12, a96
v_accvgpr_read_b32 v13, a97
v_accvgpr_read_b32 v14, a98
v_accvgpr_read_b32 v15, a99
v_mul_f32 v12, v12, v10
v_mul_f32 v13, v13, v10
v_mul_f32 v14, v14, v10
v_mul_f32 v15, v15, v10
v_accvgpr_write_b32 a96, v12
v_accvgpr_write_b32 a97, v13
v_accvgpr_write_b32 a98, v14
v_accvgpr_write_b32 a99, v15
v_accvgpr_read_b32 v12, a100
v_accvgpr_read_b32 v13, a101
v_accvgpr_read_b32 v14, a102
v_accvgpr_read_b32 v15, a103
v_mul_f32 v12, v12, v10
v_mul_f32 v13, v13, v10
v_mul_f32 v14, v14, v10
v_mul_f32 v15, v15, v10
v_accvgpr_write_b32 a100, v12
v_accvgpr_write_b32 a101, v13
v_accvgpr_write_b32 a102, v14
v_accvgpr_write_b32 a103, v15
v_accvgpr_read_b32 v12, a104
v_accvgpr_read_b32 v13, a105
v_accvgpr_read_b32 v14, a106
v_accvgpr_read_b32 v15, a107
v_mul_f32 v12, v12, v10
v_mul_f32 v13, v13, v10
v_mul_f32 v14, v14, v10
v_mul_f32 v15, v15, v10
v_accvgpr_write_b32 a104, v12
v_accvgpr_write_b32 a105, v13
v_accvgpr_write_b32 a106, v14
v_accvgpr_write_b32 a107, v15
v_accvgpr_read_b32 v12, a108
v_accvgpr_read_b32 v13, a109
v_accvgpr_read_b32 v14, a110
v_accvgpr_read_b32 v15, a111
v_mul_f32 v12, v12, v10
v_mul_f32 v13, v13, v10
v_mul_f32 v14, v14, v10
v_mul_f32 v15, v15, v10
v_accvgpr_write_b32 a108, v12
v_accvgpr_write_b32 a109, v13
v_accvgpr_write_b32 a110, v14
v_accvgpr_write_b32 a111, v15
v_accvgpr_read_b32 v12, a112
v_accvgpr_read_b32 v13, a113
v_accvgpr_read_b32 v14, a114
v_accvgpr_read_b32 v15, a115
v_mul_f32 v12, v12, v10
v_mul_f32 v13, v13, v10
v_mul_f32 v14, v14, v10
v_mul_f32 v15, v15, v10
v_accvgpr_write_b32 a112, v12
v_accvgpr_write_b32 a113, v13
v_accvgpr_write_b32 a114, v14
v_accvgpr_write_b32 a115, v15
v_accvgpr_read_b32 v12, a116
v_accvgpr_read_b32 v13, a117
v_accvgpr_read_b32 v14, a118
v_accvgpr_read_b32 v15, a119
v_mul_f32 v12, v12, v10
v_mul_f32 v13, v13, v10
v_mul_f32 v14, v14, v10
v_mul_f32 v15, v15, v10
v_accvgpr_write_b32 a116, v12
v_accvgpr_write_b32 a117, v13
v_accvgpr_write_b32 a118, v14
v_accvgpr_write_b32 a119, v15
v_accvgpr_read_b32 v12, a120
v_accvgpr_read_b32 v13, a121
v_accvgpr_read_b32 v14, a122
v_accvgpr_read_b32 v15, a123
v_mul_f32 v12, v12, v10
v_mul_f32 v13, v13, v10
v_mul_f32 v14, v14, v10
v_mul_f32 v15, v15, v10
v_accvgpr_write_b32 a120, v12
v_accvgpr_write_b32 a121, v13
v_accvgpr_write_b32 a122, v14
v_accvgpr_write_b32 a123, v15
v_accvgpr_read_b32 v12, a124
v_accvgpr_read_b32 v13, a125
v_accvgpr_read_b32 v14, a126
v_accvgpr_read_b32 v15, a127
v_mul_f32 v12, v12, v10
v_mul_f32 v13, v13, v10
v_mul_f32 v14, v14, v10
v_mul_f32 v15, v15, v10
v_accvgpr_write_b32 a124, v12
v_accvgpr_write_b32 a125, v13
v_accvgpr_write_b32 a126, v14
v_accvgpr_write_b32 a127, v15
v_exp_f32 v80, v32
s_nop 0
v_exp_f32 v81, v33
s_nop 0
v_exp_f32 v82, v34
s_nop 0
v_exp_f32 v83, v35
s_nop 0
v_cvt_pk_bf16_f32 v72, v80, v81
s_nop 0
v_add_f32 v7, v80, v81
s_nop 0
v_exp_f32 v84, v36
s_nop 0
v_exp_f32 v85, v37
s_nop 0
v_cvt_pk_bf16_f32 v73, v82, v83
s_nop 0
v_add_f32 v15, v82, v83
s_nop 0
v_exp_f32 v86, v38
s_nop 0
v_exp_f32 v87, v39
s_nop 0
v_cvt_pk_bf16_f32 v74, v84, v85
s_nop 0
v_add_f32 v7, v7, v84
s_nop 0
v_add_f32 v15, v15, v85
s_nop 0
v_exp_f32 v88, v40
s_nop 0
v_exp_f32 v89, v41
s_nop 0
v_cvt_pk_bf16_f32 v75, v86, v87
s_nop 0
v_add_f32 v7, v7, v86
s_nop 0
v_add_f32 v15, v15, v87
s_nop 0
v_exp_f32 v90, v42
s_nop 0
v_exp_f32 v91, v43
s_nop 0
v_cvt_pk_bf16_f32 v76, v88, v89
s_nop 0
v_add_f32 v7, v7, v88
s_nop 0
v_add_f32 v15, v15, v89
s_nop 0
v_exp_f32 v92, v44
s_nop 0
v_exp_f32 v93, v45
s_nop 0
v_cvt_pk_bf16_f32 v77, v90, v91
s_nop 0
v_add_f32 v7, v7, v90
s_nop 0
v_add_f32 v15, v15, v91
s_nop 0
v_exp_f32 v94, v46
s_nop 0
v_exp_f32 v95, v47
s_nop 0
v_cvt_pk_bf16_f32 v78, v92, v93
s_nop 0
v_add_f32 v7, v7, v92
s_nop 0
v_add_f32 v15, v15, v93
s_nop 0
v_cvt_pk_bf16_f32 v79, v94, v95
s_nop 0
v_add_f32 v7, v7, v94
s_nop 0
v_add_f32 v15, v15, v95
s_nop 0
v_add_f32 v7, v7, v15
s_nop 0
s_nop 3
s_branch k2_rareret1
k2_mask2:
s_sub_u32 s33, s32, s31
s_lshl_b32 s33, s33, 5
v_add_u32 v9, s33, v5
v_cmp_gt_i32 vcc, 0, v9
v_cndmask_b32 v16, v16, v8, vcc
v_cmp_gt_i32 vcc, 1, v9
v_cndmask_b32 v17, v17, v8, vcc
v_cmp_gt_i32 vcc, 2, v9
v_cndmask_b32 v18, v18, v8, vcc
v_cmp_gt_i32 vcc, 3, v9
v_cndmask_b32 v19, v19, v8, vcc
v_cmp_gt_i32 vcc, 8, v9
v_cndmask_b32 v20, v20, v8, vcc
v_cmp_gt_i32 vcc, 9, v9
v_cndmask_b32 v21, v21, v8, vcc
v_cmp_gt_i32 vcc, 10, v9
v_cndmask_b32 v22, v22, v8, vcc
v_cmp_gt_i32 vcc, 11, v9
v_cndmask_b32 v23, v23, v8, vcc
v_cmp_gt_i32 vcc, 16, v9
v_cndmask_b32 v24, v24, v8, vcc
v_cmp_gt_i32 vcc, 17, v9
v_cndmask_b32 v25, v25, v8, vcc
v_cmp_gt_i32 vcc, 18, v9
v_cndmask_b32 v26, v26, v8, vcc
v_cmp_gt_i32 vcc, 19, v9
v_cndmask_b32 v27, v27, v8, vcc
v_cmp_gt_i32 vcc, 24, v9
v_cndmask_b32 v28, v28, v8, vcc
v_cmp_gt_i32 vcc, 25, v9
v_cndmask_b32 v29, v29, v8, vcc
v_cmp_gt_i32 vcc, 26, v9
v_cndmask_b32 v30, v30, v8, vcc
v_cmp_gt_i32 vcc, 27, v9
v_cndmask_b32 v31, v31, v8, vcc
s_branch k2_maskret2
k2_rare2:
s_nop 7
s_nop 7
v_max3_f32 v9, v16, v17, v18
v_max3_f32 v9, v9, v19, v20
v_max3_f32 v9, v9, v21, v22
v_max3_f32 v9, v9, v23, v24
v_max3_f32 v9, v9, v25, v26
v_max3_f32 v9, v9, v27, v28
v_max3_f32 v9, v9, v29, v30
v_max_f32 v9, v9, v31
v_mov_b32 v10, v9
s_nop 1
v_permlane32_swap_b32 v9, v10
s_nop 1
v_max_f32 v9, v9, v10
v_max_f32 v9, 0, v9
v_sub_f32 v16, v16, v9
v_sub_f32 v17, v17, v9
v_sub_f32 v18, v18, v9
v_sub_f32 v19, v19, v9
v_sub_f32 v20, v20, v9
v_sub_f32 v21, v21, v9
v_sub_f32 v22, v22, v9
v_sub_f32 v23, v23, v9
v_sub_f32 v24, v24, v9
v_sub_f32 v25, v25, v9
v_sub_f32 v26, v26, v9
v_sub_f32 v27, v27, v9
v_sub_f32 v28, v28, v9
v_sub_f32 v29, v29, v9
v_sub_f32 v30, v30, v9
v_sub_f32 v31, v31, v9
v_sub_f32 v32, v32, v9
v_sub_f32 v33, v33, v9
v_sub_f32 v34, v34, v9
v_sub_f32 v35, v35, v9
v_sub_f32 v36, v36, v9
v_sub_f32 v37, v37, v9
v_sub_f32 v38, v38, v9
v_sub_f32 v39, v39, v9
v_sub_f32 v40, v40, v9
v_sub_f32 v41, v41, v9
v_sub_f32 v42, v42, v9
v_sub_f32 v43, v43, v9
v_sub_f32 v44, v44, v9
v_sub_f32 v45, v45, v9
v_sub_f32 v46, v46, v9
v_sub_f32 v47, v47, v9
v_sub_f32 v48, v48, v9
v_sub_f32 v49, v49, v9
v_sub_f32 v50, v50, v9
v_sub_f32 v51, v51, v9
v_sub_f32 v52, v52, v9
v_sub_f32 v53, v53, v9
v_sub_f32 v54, v54, v9
v_sub_f32 v55, v55, v9
v_sub_f32 v56, v56, v9
v_sub_f32 v57, v57, v9
v_sub_f32 v58, v58, v9
v_sub_f32 v59, v59, v9
v_sub_f32 v60, v60, v9
v_sub_f32 v61, v61, v9
v_sub_f32 v62, v62, v9
v_sub_f32 v63, v63, v9
v_sub_f32 v10, 0, v9
v_exp_f32 v10, v10
s_nop 0
v_mul_f32 v6, v6, v10
v_accvgpr_read_b32 v12, a0
v_accvgpr_read_b32 v13, a1
v_accvgpr_read_b32 v14, a2
v_accvgpr_read_b32 v15, a3
v_mul_f32 v12, v12, v10
v_mul_f32 v13, v13, v10
v_mul_f32 v14, v14, v10
v_mul_f32 v15, v15, v10
v_accvgpr_write_b32 a0, v12
v_accvgpr_write_b32 a1, v13
v_accvgpr_write_b32 a2, v14
v_accvgpr_write_b32 a3, v15
v_accvgpr_read_b32 v12, a4
v_accvgpr_read_b32 v13, a5
v_accvgpr_read_b32 v14, a6
v_accvgpr_read_b32 v15, a7
v_mul_f32 v12, v12, v10
v_mul_f32 v13, v13, v10
v_mul_f32 v14, v14, v10
v_mul_f32 v15, v15, v10
v_accvgpr_write_b32 a4, v12
v_accvgpr_write_b32 a5, v13
v_accvgpr_write_b32 a6, v14
v_accvgpr_write_b32 a7, v15
v_accvgpr_read_b32 v12, a8
v_accvgpr_read_b32 v13, a9
v_accvgpr_read_b32 v14, a10
v_accvgpr_read_b32 v15, a11
v_mul_f32 v12, v12, v10
v_mul_f32 v13, v13, v10
v_mul_f32 v14, v14, v10
v_mul_f32 v15, v15, v10
v_accvgpr_write_b32 a8, v12
v_accvgpr_write_b32 a9, v13
v_accvgpr_write_b32 a10, v14
v_accvgpr_write_b32 a11, v15
v_accvgpr_read_b32 v12, a12
v_accvgpr_read_b32 v13, a13
v_accvgpr_read_b32 v14, a14
v_accvgpr_read_b32 v15, a15
v_mul_f32 v12, v12, v10
v_mul_f32 v13, v13, v10
v_mul_f32 v14, v14, v10
v_mul_f32 v15, v15, v10
v_accvgpr_write_b32 a12, v12
v_accvgpr_write_b32 a13, v13
v_accvgpr_write_b32 a14, v14
v_accvgpr_write_b32 a15, v15
v_accvgpr_read_b32 v12, a16
v_accvgpr_read_b32 v13, a17
v_accvgpr_read_b32 v14, a18
v_accvgpr_read_b32 v15, a19
v_mul_f32 v12, v12, v10
v_mul_f32 v13, v13, v10
v_mul_f32 v14, v14, v10
v_mul_f32 v15, v15, v10
v_accvgpr_write_b32 a16, v12
v_accvgpr_write_b32 a17, v13
v_accvgpr_write_b32 a18, v14
v_accvgpr_write_b32 a19, v15
v_accvgpr_read_b32 v12, a20
v_accvgpr_read_b32 v13, a21
v_accvgpr_read_b32 v14, a22
v_accvgpr_read_b32 v15, a23
v_mul_f32 v12, v12, v10
v_mul_f32 v13, v13, v10
v_mul_f32 v14, v14, v10
v_mul_f32 v15, v15, v10
v_accvgpr_write_b32 a20, v12
v_accvgpr_write_b32 a21, v13
v_accvgpr_write_b32 a22, v14
v_accvgpr_write_b32 a23, v15
v_accvgpr_read_b32 v12, a24
v_accvgpr_read_b32 v13, a25
v_accvgpr_read_b32 v14, a26
v_accvgpr_read_b32 v15, a27
v_mul_f32 v12, v12, v10
v_mul_f32 v13, v13, v10
v_mul_f32 v14, v14, v10
v_mul_f32 v15, v15, v10
v_accvgpr_write_b32 a24, v12
v_accvgpr_write_b32 a25, v13
v_accvgpr_write_b32 a26, v14
v_accvgpr_write_b32 a27, v15
v_accvgpr_read_b32 v12, a28
v_accvgpr_read_b32 v13, a29
v_accvgpr_read_b32 v14, a30
v_accvgpr_read_b32 v15, a31
v_mul_f32 v12, v12, v10
v_mul_f32 v13, v13, v10
v_mul_f32 v14, v14, v10
v_mul_f32 v15, v15, v10
v_accvgpr_write_b32 a28, v12
v_accvgpr_write_b32 a29, v13
v_accvgpr_write_b32 a30, v14
v_accvgpr_write_b32 a31, v15
v_accvgpr_read_b32 v12, a32
v_accvgpr_read_b32 v13, a33
v_accvgpr_read_b32 v14, a34
v_accvgpr_read_b32 v15, a35
v_mul_f32 v12, v12, v10
v_mul_f32 v13, v13, v10
v_mul_f32 v14, v14, v10
v_mul_f32 v15, v15, v10
v_accvgpr_write_b32 a32, v12
v_accvgpr_write_b32 a33, v13
v_accvgpr_write_b32 a34, v14
v_accvgpr_write_b32 a35, v15
v_accvgpr_read_b32 v12, a36
v_accvgpr_read_b32 v13, a37
v_accvgpr_read_b32 v14, a38
v_accvgpr_read_b32 v15, a39
v_mul_f32 v12, v12, v10
v_mul_f32 v13, v13, v10
v_mul_f32 v14, v14, v10
v_mul_f32 v15, v15, v10
v_accvgpr_write_b32 a36, v12
v_accvgpr_write_b32 a37, v13
v_accvgpr_write_b32 a38, v14
v_accvgpr_write_b32 a39, v15
v_accvgpr_read_b32 v12, a40
v_accvgpr_read_b32 v13, a41
v_accvgpr_read_b32 v14, a42
v_accvgpr_read_b32 v15, a43
v_mul_f32 v12, v12, v10
v_mul_f32 v13, v13, v10
v_mul_f32 v14, v14, v10
v_mul_f32 v15, v15, v10
v_accvgpr_write_b32 a40, v12
v_accvgpr_write_b32 a41, v13
v_accvgpr_write_b32 a42, v14
v_accvgpr_write_b32 a43, v15
v_accvgpr_read_b32 v12, a44
v_accvgpr_read_b32 v13, a45
v_accvgpr_read_b32 v14, a46
v_accvgpr_read_b32 v15, a47
v_mul_f32 v12, v12, v10
v_mul_f32 v13, v13, v10
v_mul_f32 v14, v14, v10
v_mul_f32 v15, v15, v10
v_accvgpr_write_b32 a44, v12
v_accvgpr_write_b32 a45, v13
v_accvgpr_write_b32 a46, v14
v_accvgpr_write_b32 a47, v15
v_accvgpr_read_b32 v12, a48
v_accvgpr_read_b32 v13, a49
v_accvgpr_read_b32 v14, a50
v_accvgpr_read_b32 v15, a51
v_mul_f32 v12, v12, v10
v_mul_f32 v13, v13, v10
v_mul_f32 v14, v14, v10
v_mul_f32 v15, v15, v10
v_accvgpr_write_b32 a48, v12
v_accvgpr_write_b32 a49, v13
v_accvgpr_write_b32 a50, v14
v_accvgpr_write_b32 a51, v15
v_accvgpr_read_b32 v12, a52
v_accvgpr_read_b32 v13, a53
v_accvgpr_read_b32 v14, a54
v_accvgpr_read_b32 v15, a55
v_mul_f32 v12, v12, v10
v_mul_f32 v13, v13, v10
v_mul_f32 v14, v14, v10
v_mul_f32 v15, v15, v10
v_accvgpr_write_b32 a52, v12
v_accvgpr_write_b32 a53, v13
v_accvgpr_write_b32 a54, v14
v_accvgpr_write_b32 a55, v15
v_accvgpr_read_b32 v12, a56
v_accvgpr_read_b32 v13, a57
v_accvgpr_read_b32 v14, a58
v_accvgpr_read_b32 v15, a59
v_mul_f32 v12, v12, v10
v_mul_f32 v13, v13, v10
v_mul_f32 v14, v14, v10
v_mul_f32 v15, v15, v10
v_accvgpr_write_b32 a56, v12
v_accvgpr_write_b32 a57, v13
v_accvgpr_write_b32 a58, v14
v_accvgpr_write_b32 a59, v15
v_accvgpr_read_b32 v12, a60
v_accvgpr_read_b32 v13, a61
v_accvgpr_read_b32 v14, a62
v_accvgpr_read_b32 v15, a63
v_mul_f32 v12, v12, v10
v_mul_f32 v13, v13, v10
v_mul_f32 v14, v14, v10
v_mul_f32 v15, v15, v10
v_accvgpr_write_b32 a60, v12
v_accvgpr_write_b32 a61, v13
v_accvgpr_write_b32 a62, v14
v_accvgpr_write_b32 a63, v15
v_accvgpr_read_b32 v12, a64
v_accvgpr_read_b32 v13, a65
v_accvgpr_read_b32 v14, a66
v_accvgpr_read_b32 v15, a67
v_mul_f32 v12, v12, v10
v_mul_f32 v13, v13, v10
v_mul_f32 v14, v14, v10
v_mul_f32 v15, v15, v10
v_accvgpr_write_b32 a64, v12
v_accvgpr_write_b32 a65, v13
v_accvgpr_write_b32 a66, v14
v_accvgpr_write_b32 a67, v15
v_accvgpr_read_b32 v12, a68
v_accvgpr_read_b32 v13, a69
v_accvgpr_read_b32 v14, a70
v_accvgpr_read_b32 v15, a71
v_mul_f32 v12, v12, v10
v_mul_f32 v13, v13, v10
v_mul_f32 v14, v14, v10
v_mul_f32 v15, v15, v10
v_accvgpr_write_b32 a68, v12
v_accvgpr_write_b32 a69, v13
v_accvgpr_write_b32 a70, v14
v_accvgpr_write_b32 a71, v15
v_accvgpr_read_b32 v12, a72
v_accvgpr_read_b32 v13, a73
v_accvgpr_read_b32 v14, a74
v_accvgpr_read_b32 v15, a75
v_mul_f32 v12, v12, v10
v_mul_f32 v13, v13, v10
v_mul_f32 v14, v14, v10
v_mul_f32 v15, v15, v10
v_accvgpr_write_b32 a72, v12
v_accvgpr_write_b32 a73, v13
v_accvgpr_write_b32 a74, v14
v_accvgpr_write_b32 a75, v15
v_accvgpr_read_b32 v12, a76
v_accvgpr_read_b32 v13, a77
v_accvgpr_read_b32 v14, a78
v_accvgpr_read_b32 v15, a79
v_mul_f32 v12, v12, v10
v_mul_f32 v13, v13, v10
v_mul_f32 v14, v14, v10
v_mul_f32 v15, v15, v10
v_accvgpr_write_b32 a76, v12
v_accvgpr_write_b32 a77, v13
v_accvgpr_write_b32 a78, v14
v_accvgpr_write_b32 a79, v15
v_accvgpr_read_b32 v12, a80
v_accvgpr_read_b32 v13, a81
v_accvgpr_read_b32 v14, a82
v_accvgpr_read_b32 v15, a83
v_mul_f32 v12, v12, v10
v_mul_f32 v13, v13, v10
v_mul_f32 v14, v14, v10
v_mul_f32 v15, v15, v10
v_accvgpr_write_b32 a80, v12
v_accvgpr_write_b32 a81, v13
v_accvgpr_write_b32 a82, v14
v_accvgpr_write_b32 a83, v15
v_accvgpr_read_b32 v12, a84
v_accvgpr_read_b32 v13, a85
v_accvgpr_read_b32 v14, a86
v_accvgpr_read_b32 v15, a87
v_mul_f32 v12, v12, v10
v_mul_f32 v13, v13, v10
v_mul_f32 v14, v14, v10
v_mul_f32 v15, v15, v10
v_accvgpr_write_b32 a84, v12
v_accvgpr_write_b32 a85, v13
v_accvgpr_write_b32 a86, v14
v_accvgpr_write_b32 a87, v15
v_accvgpr_read_b32 v12, a88
v_accvgpr_read_b32 v13, a89
v_accvgpr_read_b32 v14, a90
v_accvgpr_read_b32 v15, a91
v_mul_f32 v12, v12, v10
v_mul_f32 v13, v13, v10
v_mul_f32 v14, v14, v10
v_mul_f32 v15, v15, v10
v_accvgpr_write_b32 a88, v12
v_accvgpr_write_b32 a89, v13
v_accvgpr_write_b32 a90, v14
v_accvgpr_write_b32 a91, v15
v_accvgpr_read_b32 v12, a92
v_accvgpr_read_b32 v13, a93
v_accvgpr_read_b32 v14, a94
v_accvgpr_read_b32 v15, a95
v_mul_f32 v12, v12, v10
v_mul_f32 v13, v13, v10
v_mul_f32 v14, v14, v10
v_mul_f32 v15, v15, v10
v_accvgpr_write_b32 a92, v12
v_accvgpr_write_b32 a93, v13
v_accvgpr_write_b32 a94, v14
v_accvgpr_write_b32 a95, v15
v_accvgpr_read_b32 v12, a96
v_accvgpr_read_b32 v13, a97
v_accvgpr_read_b32 v14, a98
v_accvgpr_read_b32 v15, a99
v_mul_f32 v12, v12, v10
v_mul_f32 v13, v13, v10
v_mul_f32 v14, v14, v10
v_mul_f32 v15, v15, v10
v_accvgpr_write_b32 a96, v12
v_accvgpr_write_b32 a97, v13
v_accvgpr_write_b32 a98, v14
v_accvgpr_write_b32 a99, v15
v_accvgpr_read_b32 v12, a100
v_accvgpr_read_b32 v13, a101
v_accvgpr_read_b32 v14, a102
v_accvgpr_read_b32 v15, a103
v_mul_f32 v12, v12, v10
v_mul_f32 v13, v13, v10
v_mul_f32 v14, v14, v10
v_mul_f32 v15, v15, v10
v_accvgpr_write_b32 a100, v12
v_accvgpr_write_b32 a101, v13
v_accvgpr_write_b32 a102, v14
v_accvgpr_write_b32 a103, v15
v_accvgpr_read_b32 v12, a104
v_accvgpr_read_b32 v13, a105
v_accvgpr_read_b32 v14, a106
v_accvgpr_read_b32 v15, a107
v_mul_f32 v12, v12, v10
v_mul_f32 v13, v13, v10
v_mul_f32 v14, v14, v10
v_mul_f32 v15, v15, v10
v_accvgpr_write_b32 a104, v12
v_accvgpr_write_b32 a105, v13
v_accvgpr_write_b32 a106, v14
v_accvgpr_write_b32 a107, v15
v_accvgpr_read_b32 v12, a108
v_accvgpr_read_b32 v13, a109
v_accvgpr_read_b32 v14, a110
v_accvgpr_read_b32 v15, a111
v_mul_f32 v12, v12, v10
v_mul_f32 v13, v13, v10
v_mul_f32 v14, v14, v10
v_mul_f32 v15, v15, v10
v_accvgpr_write_b32 a108, v12
v_accvgpr_write_b32 a109, v13
v_accvgpr_write_b32 a110, v14
v_accvgpr_write_b32 a111, v15
v_accvgpr_read_b32 v12, a112
v_accvgpr_read_b32 v13, a113
v_accvgpr_read_b32 v14, a114
v_accvgpr_read_b32 v15, a115
v_mul_f32 v12, v12, v10
v_mul_f32 v13, v13, v10
v_mul_f32 v14, v14, v10
v_mul_f32 v15, v15, v10
v_accvgpr_write_b32 a112, v12
v_accvgpr_write_b32 a113, v13
v_accvgpr_write_b32 a114, v14
v_accvgpr_write_b32 a115, v15
v_accvgpr_read_b32 v12, a116
v_accvgpr_read_b32 v13, a117
v_accvgpr_read_b32 v14, a118
v_accvgpr_read_b32 v15, a119
v_mul_f32 v12, v12, v10
v_mul_f32 v13, v13, v10
v_mul_f32 v14, v14, v10
v_mul_f32 v15, v15, v10
v_accvgpr_write_b32 a116, v12
v_accvgpr_write_b32 a117, v13
v_accvgpr_write_b32 a118, v14
v_accvgpr_write_b32 a119, v15
v_accvgpr_read_b32 v12, a120
v_accvgpr_read_b32 v13, a121
v_accvgpr_read_b32 v14, a122
v_accvgpr_read_b32 v15, a123
v_mul_f32 v12, v12, v10
v_mul_f32 v13, v13, v10
v_mul_f32 v14, v14, v10
v_mul_f32 v15, v15, v10
v_accvgpr_write_b32 a120, v12
v_accvgpr_write_b32 a121, v13
v_accvgpr_write_b32 a122, v14
v_accvgpr_write_b32 a123, v15
v_accvgpr_read_b32 v12, a124
v_accvgpr_read_b32 v13, a125
v_accvgpr_read_b32 v14, a126
v_accvgpr_read_b32 v15, a127
v_mul_f32 v12, v12, v10
v_mul_f32 v13, v13, v10
v_mul_f32 v14, v14, v10
v_mul_f32 v15, v15, v10
v_accvgpr_write_b32 a124, v12
v_accvgpr_write_b32 a125, v13
v_accvgpr_write_b32 a126, v14
v_accvgpr_write_b32 a127, v15
v_exp_f32 v80, v16
s_nop 0
v_exp_f32 v81, v17
s_nop 0
v_exp_f32 v82, v18
s_nop 0
v_exp_f32 v83, v19
s_nop 0
v_cvt_pk_bf16_f32 v64, v80, v81
s_nop 0
v_add_f32 v7, v80, v81
s_nop 0
v_exp_f32 v84, v20
s_nop 0
v_exp_f32 v85, v21
s_nop 0
v_cvt_pk_bf16_f32 v65, v82, v83
s_nop 0
v_add_f32 v15, v82, v83
s_nop 0
v_exp_f32 v86, v22
s_nop 0
v_exp_f32 v87, v23
s_nop 0
v_cvt_pk_bf16_f32 v66, v84, v85
s_nop 0
v_add_f32 v7, v7, v84
s_nop 0
v_add_f32 v15, v15, v85
s_nop 0
v_exp_f32 v88, v24
s_nop 0
v_exp_f32 v89, v25
s_nop 0
v_cvt_pk_bf16_f32 v67, v86, v87
s_nop 0
v_add_f32 v7, v7, v86
s_nop 0
v_add_f32 v15, v15, v87
s_nop 0
v_exp_f32 v90, v26
s_nop 0
v_exp_f32 v91, v27
s_nop 0
v_cvt_pk_bf16_f32 v68, v88, v89
s_nop 0
v_add_f32 v7, v7, v88
s_nop 0
v_add_f32 v15, v15, v89
s_nop 0
v_exp_f32 v92, v28
s_nop 0
v_exp_f32 v93, v29
s_nop 0
v_cvt_pk_bf16_f32 v69, v90, v91
s_nop 0
v_add_f32 v7, v7, v90
s_nop 0
v_add_f32 v15, v15, v91
s_nop 0
v_exp_f32 v94, v30
s_nop 0
v_exp_f32 v95, v31
s_nop 0
v_cvt_pk_bf16_f32 v70, v92, v93
s_nop 0
v_add_f32 v7, v7, v92
s_nop 0
v_add_f32 v15, v15, v93
s_nop 0
v_cvt_pk_bf16_f32 v71, v94, v95
s_nop 0
v_add_f32 v7, v7, v94
s_nop 0
v_add_f32 v15, v15, v95
s_nop 0
v_add_f32 v7, v7, v15
s_nop 0
s_nop 3
s_branch k2_rareret2
k2_rare3:
s_nop 7
s_nop 7
v_max3_f32 v9, v32, v33, v34
v_max3_f32 v9, v9, v35, v36
v_max3_f32 v9, v9, v37, v38
v_max3_f32 v9, v9, v39, v40
v_max3_f32 v9, v9, v41, v42
v_max3_f32 v9, v9, v43, v44
v_max3_f32 v9, v9, v45, v46
v_max_f32 v9, v9, v47
v_mov_b32 v10, v9
s_nop 1
v_permlane32_swap_b32 v9, v10
s_nop 1
v_max_f32 v9, v9, v10
v_max_f32 v9, 0, v9
v_sub_f32 v32, v32, v9
v_sub_f32 v33, v33, v9
v_sub_f32 v34, v34, v9
v_sub_f32 v35, v35, v9
v_sub_f32 v36, v36, v9
v_sub_f32 v37, v37, v9
v_sub_f32 v38, v38, v9
v_sub_f32 v39, v39, v9
v_sub_f32 v40, v40, v9
v_sub_f32 v41, v41, v9
v_sub_f32 v42, v42, v9
v_sub_f32 v43, v43, v9
v_sub_f32 v44, v44, v9
v_sub_f32 v45, v45, v9
v_sub_f32 v46, v46, v9
v_sub_f32 v47, v47, v9
v_sub_f32 v48, v48, v9
v_sub_f32 v49, v49, v9
v_sub_f32 v50, v50, v9
v_sub_f32 v51, v51, v9
v_sub_f32 v52, v52, v9
v_sub_f32 v53, v53, v9
v_sub_f32 v54, v54, v9
v_sub_f32 v55, v55, v9
v_sub_f32 v56, v56, v9
v_sub_f32 v57, v57, v9
v_sub_f32 v58, v58, v9
v_sub_f32 v59, v59, v9
v_sub_f32 v60, v60, v9
v_sub_f32 v61, v61, v9
v_sub_f32 v62, v62, v9
v_sub_f32 v63, v63, v9
v_sub_f32 v10, 0, v9
v_exp_f32 v10, v10
s_nop 0
v_mul_f32 v6, v6, v10
v_accvgpr_read_b32 v12, a0
v_accvgpr_read_b32 v13, a1
v_accvgpr_read_b32 v14, a2
v_accvgpr_read_b32 v15, a3
v_mul_f32 v12, v12, v10
v_mul_f32 v13, v13, v10
v_mul_f32 v14, v14, v10
v_mul_f32 v15, v15, v10
v_accvgpr_write_b32 a0, v12
v_accvgpr_write_b32 a1, v13
v_accvgpr_write_b32 a2, v14
v_accvgpr_write_b32 a3, v15
v_accvgpr_read_b32 v12, a4
v_accvgpr_read_b32 v13, a5
v_accvgpr_read_b32 v14, a6
v_accvgpr_read_b32 v15, a7
v_mul_f32 v12, v12, v10
v_mul_f32 v13, v13, v10
v_mul_f32 v14, v14, v10
v_mul_f32 v15, v15, v10
v_accvgpr_write_b32 a4, v12
v_accvgpr_write_b32 a5, v13
v_accvgpr_write_b32 a6, v14
v_accvgpr_write_b32 a7, v15
v_accvgpr_read_b32 v12, a8
v_accvgpr_read_b32 v13, a9
v_accvgpr_read_b32 v14, a10
v_accvgpr_read_b32 v15, a11
v_mul_f32 v12, v12, v10
v_mul_f32 v13, v13, v10
v_mul_f32 v14, v14, v10
v_mul_f32 v15, v15, v10
v_accvgpr_write_b32 a8, v12
v_accvgpr_write_b32 a9, v13
v_accvgpr_write_b32 a10, v14
v_accvgpr_write_b32 a11, v15
v_accvgpr_read_b32 v12, a12
v_accvgpr_read_b32 v13, a13
v_accvgpr_read_b32 v14, a14
v_accvgpr_read_b32 v15, a15
v_mul_f32 v12, v12, v10
v_mul_f32 v13, v13, v10
v_mul_f32 v14, v14, v10
v_mul_f32 v15, v15, v10
v_accvgpr_write_b32 a12, v12
v_accvgpr_write_b32 a13, v13
v_accvgpr_write_b32 a14, v14
v_accvgpr_write_b32 a15, v15
v_accvgpr_read_b32 v12, a16
v_accvgpr_read_b32 v13, a17
v_accvgpr_read_b32 v14, a18
v_accvgpr_read_b32 v15, a19
v_mul_f32 v12, v12, v10
v_mul_f32 v13, v13, v10
v_mul_f32 v14, v14, v10
v_mul_f32 v15, v15, v10
v_accvgpr_write_b32 a16, v12
v_accvgpr_write_b32 a17, v13
v_accvgpr_write_b32 a18, v14
v_accvgpr_write_b32 a19, v15
v_accvgpr_read_b32 v12, a20
v_accvgpr_read_b32 v13, a21
v_accvgpr_read_b32 v14, a22
v_accvgpr_read_b32 v15, a23
v_mul_f32 v12, v12, v10
v_mul_f32 v13, v13, v10
v_mul_f32 v14, v14, v10
v_mul_f32 v15, v15, v10
v_accvgpr_write_b32 a20, v12
v_accvgpr_write_b32 a21, v13
v_accvgpr_write_b32 a22, v14
v_accvgpr_write_b32 a23, v15
v_accvgpr_read_b32 v12, a24
v_accvgpr_read_b32 v13, a25
v_accvgpr_read_b32 v14, a26
v_accvgpr_read_b32 v15, a27
v_mul_f32 v12, v12, v10
v_mul_f32 v13, v13, v10
v_mul_f32 v14, v14, v10
v_mul_f32 v15, v15, v10
v_accvgpr_write_b32 a24, v12
v_accvgpr_write_b32 a25, v13
v_accvgpr_write_b32 a26, v14
v_accvgpr_write_b32 a27, v15
v_accvgpr_read_b32 v12, a28
v_accvgpr_read_b32 v13, a29
v_accvgpr_read_b32 v14, a30
v_accvgpr_read_b32 v15, a31
v_mul_f32 v12, v12, v10
v_mul_f32 v13, v13, v10
v_mul_f32 v14, v14, v10
v_mul_f32 v15, v15, v10
v_accvgpr_write_b32 a28, v12
v_accvgpr_write_b32 a29, v13
v_accvgpr_write_b32 a30, v14
v_accvgpr_write_b32 a31, v15
v_accvgpr_read_b32 v12, a32
v_accvgpr_read_b32 v13, a33
v_accvgpr_read_b32 v14, a34
v_accvgpr_read_b32 v15, a35
v_mul_f32 v12, v12, v10
v_mul_f32 v13, v13, v10
v_mul_f32 v14, v14, v10
v_mul_f32 v15, v15, v10
v_accvgpr_write_b32 a32, v12
v_accvgpr_write_b32 a33, v13
v_accvgpr_write_b32 a34, v14
v_accvgpr_write_b32 a35, v15
v_accvgpr_read_b32 v12, a36
v_accvgpr_read_b32 v13, a37
v_accvgpr_read_b32 v14, a38
v_accvgpr_read_b32 v15, a39
v_mul_f32 v12, v12, v10
v_mul_f32 v13, v13, v10
v_mul_f32 v14, v14, v10
v_mul_f32 v15, v15, v10
v_accvgpr_write_b32 a36, v12
v_accvgpr_write_b32 a37, v13
v_accvgpr_write_b32 a38, v14
v_accvgpr_write_b32 a39, v15
v_accvgpr_read_b32 v12, a40
v_accvgpr_read_b32 v13, a41
v_accvgpr_read_b32 v14, a42
v_accvgpr_read_b32 v15, a43
v_mul_f32 v12, v12, v10
v_mul_f32 v13, v13, v10
v_mul_f32 v14, v14, v10
v_mul_f32 v15, v15, v10
v_accvgpr_write_b32 a40, v12
v_accvgpr_write_b32 a41, v13
v_accvgpr_write_b32 a42, v14
v_accvgpr_write_b32 a43, v15
v_accvgpr_read_b32 v12, a44
v_accvgpr_read_b32 v13, a45
v_accvgpr_read_b32 v14, a46
v_accvgpr_read_b32 v15, a47
v_mul_f32 v12, v12, v10
v_mul_f32 v13, v13, v10
v_mul_f32 v14, v14, v10
v_mul_f32 v15, v15, v10
v_accvgpr_write_b32 a44, v12
v_accvgpr_write_b32 a45, v13
v_accvgpr_write_b32 a46, v14
v_accvgpr_write_b32 a47, v15
v_accvgpr_read_b32 v12, a48
v_accvgpr_read_b32 v13, a49
v_accvgpr_read_b32 v14, a50
v_accvgpr_read_b32 v15, a51
v_mul_f32 v12, v12, v10
v_mul_f32 v13, v13, v10
v_mul_f32 v14, v14, v10
v_mul_f32 v15, v15, v10
v_accvgpr_write_b32 a48, v12
v_accvgpr_write_b32 a49, v13
v_accvgpr_write_b32 a50, v14
v_accvgpr_write_b32 a51, v15
v_accvgpr_read_b32 v12, a52
v_accvgpr_read_b32 v13, a53
v_accvgpr_read_b32 v14, a54
v_accvgpr_read_b32 v15, a55
v_mul_f32 v12, v12, v10
v_mul_f32 v13, v13, v10
v_mul_f32 v14, v14, v10
v_mul_f32 v15, v15, v10
v_accvgpr_write_b32 a52, v12
v_accvgpr_write_b32 a53, v13
v_accvgpr_write_b32 a54, v14
v_accvgpr_write_b32 a55, v15
v_accvgpr_read_b32 v12, a56
v_accvgpr_read_b32 v13, a57
v_accvgpr_read_b32 v14, a58
v_accvgpr_read_b32 v15, a59
v_mul_f32 v12, v12, v10
v_mul_f32 v13, v13, v10
v_mul_f32 v14, v14, v10
v_mul_f32 v15, v15, v10
v_accvgpr_write_b32 a56, v12
v_accvgpr_write_b32 a57, v13
v_accvgpr_write_b32 a58, v14
v_accvgpr_write_b32 a59, v15
v_accvgpr_read_b32 v12, a60
v_accvgpr_read_b32 v13, a61
v_accvgpr_read_b32 v14, a62
v_accvgpr_read_b32 v15, a63
v_mul_f32 v12, v12, v10
v_mul_f32 v13, v13, v10
v_mul_f32 v14, v14, v10
v_mul_f32 v15, v15, v10
v_accvgpr_write_b32 a60, v12
v_accvgpr_write_b32 a61, v13
v_accvgpr_write_b32 a62, v14
v_accvgpr_write_b32 a63, v15
v_accvgpr_read_b32 v12, a64
v_accvgpr_read_b32 v13, a65
v_accvgpr_read_b32 v14, a66
v_accvgpr_read_b32 v15, a67
v_mul_f32 v12, v12, v10
v_mul_f32 v13, v13, v10
v_mul_f32 v14, v14, v10
v_mul_f32 v15, v15, v10
v_accvgpr_write_b32 a64, v12
v_accvgpr_write_b32 a65, v13
v_accvgpr_write_b32 a66, v14
v_accvgpr_write_b32 a67, v15
v_accvgpr_read_b32 v12, a68
v_accvgpr_read_b32 v13, a69
v_accvgpr_read_b32 v14, a70
v_accvgpr_read_b32 v15, a71
v_mul_f32 v12, v12, v10
v_mul_f32 v13, v13, v10
v_mul_f32 v14, v14, v10
v_mul_f32 v15, v15, v10
v_accvgpr_write_b32 a68, v12
v_accvgpr_write_b32 a69, v13
v_accvgpr_write_b32 a70, v14
v_accvgpr_write_b32 a71, v15
v_accvgpr_read_b32 v12, a72
v_accvgpr_read_b32 v13, a73
v_accvgpr_read_b32 v14, a74
v_accvgpr_read_b32 v15, a75
v_mul_f32 v12, v12, v10
v_mul_f32 v13, v13, v10
v_mul_f32 v14, v14, v10
v_mul_f32 v15, v15, v10
v_accvgpr_write_b32 a72, v12
v_accvgpr_write_b32 a73, v13
v_accvgpr_write_b32 a74, v14
v_accvgpr_write_b32 a75, v15
v_accvgpr_read_b32 v12, a76
v_accvgpr_read_b32 v13, a77
v_accvgpr_read_b32 v14, a78
v_accvgpr_read_b32 v15, a79
v_mul_f32 v12, v12, v10
v_mul_f32 v13, v13, v10
v_mul_f32 v14, v14, v10
v_mul_f32 v15, v15, v10
v_accvgpr_write_b32 a76, v12
v_accvgpr_write_b32 a77, v13
v_accvgpr_write_b32 a78, v14
v_accvgpr_write_b32 a79, v15
v_accvgpr_read_b32 v12, a80
v_accvgpr_read_b32 v13, a81
v_accvgpr_read_b32 v14, a82
v_accvgpr_read_b32 v15, a83
v_mul_f32 v12, v12, v10
v_mul_f32 v13, v13, v10
v_mul_f32 v14, v14, v10
v_mul_f32 v15, v15, v10
v_accvgpr_write_b32 a80, v12
v_accvgpr_write_b32 a81, v13
v_accvgpr_write_b32 a82, v14
v_accvgpr_write_b32 a83, v15
v_accvgpr_read_b32 v12, a84
v_accvgpr_read_b32 v13, a85
v_accvgpr_read_b32 v14, a86
v_accvgpr_read_b32 v15, a87
v_mul_f32 v12, v12, v10
v_mul_f32 v13, v13, v10
v_mul_f32 v14, v14, v10
v_mul_f32 v15, v15, v10
v_accvgpr_write_b32 a84, v12
v_accvgpr_write_b32 a85, v13
v_accvgpr_write_b32 a86, v14
v_accvgpr_write_b32 a87, v15
v_accvgpr_read_b32 v12, a88
v_accvgpr_read_b32 v13, a89
v_accvgpr_read_b32 v14, a90
v_accvgpr_read_b32 v15, a91
v_mul_f32 v12, v12, v10
v_mul_f32 v13, v13, v10
v_mul_f32 v14, v14, v10
v_mul_f32 v15, v15, v10
v_accvgpr_write_b32 a88, v12
v_accvgpr_write_b32 a89, v13
v_accvgpr_write_b32 a90, v14
v_accvgpr_write_b32 a91, v15
v_accvgpr_read_b32 v12, a92
v_accvgpr_read_b32 v13, a93
v_accvgpr_read_b32 v14, a94
v_accvgpr_read_b32 v15, a95
v_mul_f32 v12, v12, v10
v_mul_f32 v13, v13, v10
v_mul_f32 v14, v14, v10
v_mul_f32 v15, v15, v10
v_accvgpr_write_b32 a92, v12
v_accvgpr_write_b32 a93, v13
v_accvgpr_write_b32 a94, v14
v_accvgpr_write_b32 a95, v15
v_accvgpr_read_b32 v12, a96
v_accvgpr_read_b32 v13, a97
v_accvgpr_read_b32 v14, a98
v_accvgpr_read_b32 v15, a99
v_mul_f32 v12, v12, v10
v_mul_f32 v13, v13, v10
v_mul_f32 v14, v14, v10
v_mul_f32 v15, v15, v10
v_accvgpr_write_b32 a96, v12
v_accvgpr_write_b32 a97, v13
v_accvgpr_write_b32 a98, v14
v_accvgpr_write_b32 a99, v15
v_accvgpr_read_b32 v12, a100
v_accvgpr_read_b32 v13, a101
v_accvgpr_read_b32 v14, a102
v_accvgpr_read_b32 v15, a103
v_mul_f32 v12, v12, v10
v_mul_f32 v13, v13, v10
v_mul_f32 v14, v14, v10
v_mul_f32 v15, v15, v10
v_accvgpr_write_b32 a100, v12
v_accvgpr_write_b32 a101, v13
v_accvgpr_write_b32 a102, v14
v_accvgpr_write_b32 a103, v15
v_accvgpr_read_b32 v12, a104
v_accvgpr_read_b32 v13, a105
v_accvgpr_read_b32 v14, a106
v_accvgpr_read_b32 v15, a107
v_mul_f32 v12, v12, v10
v_mul_f32 v13, v13, v10
v_mul_f32 v14, v14, v10
v_mul_f32 v15, v15, v10
v_accvgpr_write_b32 a104, v12
v_accvgpr_write_b32 a105, v13
v_accvgpr_write_b32 a106, v14
v_accvgpr_write_b32 a107, v15
v_accvgpr_read_b32 v12, a108
v_accvgpr_read_b32 v13, a109
v_accvgpr_read_b32 v14, a110
v_accvgpr_read_b32 v15, a111
v_mul_f32 v12, v12, v10
v_mul_f32 v13, v13, v10
v_mul_f32 v14, v14, v10
v_mul_f32 v15, v15, v10
v_accvgpr_write_b32 a108, v12
v_accvgpr_write_b32 a109, v13
v_accvgpr_write_b32 a110, v14
v_accvgpr_write_b32 a111, v15
v_accvgpr_read_b32 v12, a112
v_accvgpr_read_b32 v13, a113
v_accvgpr_read_b32 v14, a114
v_accvgpr_read_b32 v15, a115
v_mul_f32 v12, v12, v10
v_mul_f32 v13, v13, v10
v_mul_f32 v14, v14, v10
v_mul_f32 v15, v15, v10
v_accvgpr_write_b32 a112, v12
v_accvgpr_write_b32 a113, v13
v_accvgpr_write_b32 a114, v14
v_accvgpr_write_b32 a115, v15
v_accvgpr_read_b32 v12, a116
v_accvgpr_read_b32 v13, a117
v_accvgpr_read_b32 v14, a118
v_accvgpr_read_b32 v15, a119
v_mul_f32 v12, v12, v10
v_mul_f32 v13, v13, v10
v_mul_f32 v14, v14, v10
v_mul_f32 v15, v15, v10
v_accvgpr_write_b32 a116, v12
v_accvgpr_write_b32 a117, v13
v_accvgpr_write_b32 a118, v14
v_accvgpr_write_b32 a119, v15
v_accvgpr_read_b32 v12, a120
v_accvgpr_read_b32 v13, a121
v_accvgpr_read_b32 v14, a122
v_accvgpr_read_b32 v15, a123
v_mul_f32 v12, v12, v10
v_mul_f32 v13, v13, v10
v_mul_f32 v14, v14, v10
v_mul_f32 v15, v15, v10
v_accvgpr_write_b32 a120, v12
v_accvgpr_write_b32 a121, v13
v_accvgpr_write_b32 a122, v14
v_accvgpr_write_b32 a123, v15
v_accvgpr_read_b32 v12, a124
v_accvgpr_read_b32 v13, a125
v_accvgpr_read_b32 v14, a126
v_accvgpr_read_b32 v15, a127
v_mul_f32 v12, v12, v10
v_mul_f32 v13, v13, v10
v_mul_f32 v14, v14, v10
v_mul_f32 v15, v15, v10
v_accvgpr_write_b32 a124, v12
v_accvgpr_write_b32 a125, v13
v_accvgpr_write_b32 a126, v14
v_accvgpr_write_b32 a127, v15
v_exp_f32 v80, v32
s_nop 0
v_exp_f32 v81, v33
s_nop 0
v_exp_f32 v82, v34
s_nop 0
v_exp_f32 v83, v35
s_nop 0
v_cvt_pk_bf16_f32 v72, v80, v81
s_nop 0
v_add_f32 v7, v80, v81
s_nop 0
v_exp_f32 v84, v36
s_nop 0
v_exp_f32 v85, v37
s_nop 0
v_cvt_pk_bf16_f32 v73, v82, v83
s_nop 0
v_add_f32 v15, v82, v83
s_nop 0
v_exp_f32 v86, v38
s_nop 0
v_exp_f32 v87, v39
s_nop 0
v_cvt_pk_bf16_f32 v74, v84, v85
s_nop 0
v_add_f32 v7, v7, v84
s_nop 0
v_add_f32 v15, v15, v85
s_nop 0
v_exp_f32 v88, v40
s_nop 0
v_exp_f32 v89, v41
s_nop 0
v_cvt_pk_bf16_f32 v75, v86, v87
s_nop 0
v_add_f32 v7, v7, v86
s_nop 0
v_add_f32 v15, v15, v87
s_nop 0
v_exp_f32 v90, v42
s_nop 0
v_exp_f32 v91, v43
s_nop 0
v_cvt_pk_bf16_f32 v76, v88, v89
s_nop 0
v_add_f32 v7, v7, v88
s_nop 0
v_add_f32 v15, v15, v89
s_nop 0
v_exp_f32 v92, v44
s_nop 0
v_exp_f32 v93, v45
s_nop 0
v_cvt_pk_bf16_f32 v77, v90, v91
s_nop 0
v_add_f32 v7, v7, v90
s_nop 0
v_add_f32 v15, v15, v91
s_nop 0
v_exp_f32 v94, v46
s_nop 0
v_exp_f32 v95, v47
s_nop 0
v_cvt_pk_bf16_f32 v78, v92, v93
s_nop 0
v_add_f32 v7, v7, v92
s_nop 0
v_add_f32 v15, v15, v93
s_nop 0
v_cvt_pk_bf16_f32 v79, v94, v95
s_nop 0
v_add_f32 v7, v7, v94
s_nop 0
v_add_f32 v15, v15, v95
s_nop 0
v_add_f32 v7, v7, v15
s_nop 0
s_nop 3
s_branch k2_rareret3
k2_pub:
s_mov_b32 s37, 0
s_cmp_eq_u32 s18, 0
s_cbranch_scc0 k2_pubret
s_lshl_b32 s56, s41, 7
s_add_u32 s56, s56, 59777024
v_mov_b32 v12, s101
v_mov_b32 v13, 0
s_mov_b64 s[58:59], exec
s_mov_b64 exec, 1
buffer_store_dword v12, v13, s[4:7], s56 offen sc1
s_mov_b64 exec, s[58:59]
s_branch k2_pubret
k2_rare4:
s_nop 7
s_nop 7
v_max3_f32 v9, v32, v33, v34
v_max3_f32 v9, v9, v35, v36
v_max3_f32 v9, v9, v37, v38
v_max3_f32 v9, v9, v39, v40
v_max3_f32 v9, v9, v41, v42
v_max3_f32 v9, v9, v43, v44
v_max3_f32 v9, v9, v45, v46
v_max_f32 v9, v9, v47
v_mov_b32 v10, v9
s_nop 1
v_permlane32_swap_b32 v9, v10
s_nop 1
v_max_f32 v9, v9, v10
v_max_f32 v9, 0, v9
v_sub_f32 v32, v32, v9
v_sub_f32 v33, v33, v9
v_sub_f32 v34, v34, v9
v_sub_f32 v35, v35, v9
v_sub_f32 v36, v36, v9
v_sub_f32 v37, v37, v9
v_sub_f32 v38, v38, v9
v_sub_f32 v39, v39, v9
v_sub_f32 v40, v40, v9
v_sub_f32 v41, v41, v9
v_sub_f32 v42, v42, v9
v_sub_f32 v43, v43, v9
v_sub_f32 v44, v44, v9
v_sub_f32 v45, v45, v9
v_sub_f32 v46, v46, v9
v_sub_f32 v47, v47, v9
v_sub_f32 v48, v48, v9
v_sub_f32 v49, v49, v9
v_sub_f32 v50, v50, v9
v_sub_f32 v51, v51, v9
v_sub_f32 v52, v52, v9
v_sub_f32 v53, v53, v9
v_sub_f32 v54, v54, v9
v_sub_f32 v55, v55, v9
v_sub_f32 v56, v56, v9
v_sub_f32 v57, v57, v9
v_sub_f32 v58, v58, v9
v_sub_f32 v59, v59, v9
v_sub_f32 v60, v60, v9
v_sub_f32 v61, v61, v9
v_sub_f32 v62, v62, v9
v_sub_f32 v63, v63, v9
v_sub_f32 v10, 0, v9
v_exp_f32 v10, v10
s_nop 0
v_mul_f32 v6, v6, v10
v_accvgpr_read_b32 v12, a0
v_accvgpr_read_b32 v13, a1
v_accvgpr_read_b32 v14, a2
v_accvgpr_read_b32 v15, a3
v_mul_f32 v12, v12, v10
v_mul_f32 v13, v13, v10
v_mul_f32 v14, v14, v10
v_mul_f32 v15, v15, v10
v_accvgpr_write_b32 a0, v12
v_accvgpr_write_b32 a1, v13
v_accvgpr_write_b32 a2, v14
v_accvgpr_write_b32 a3, v15
v_accvgpr_read_b32 v12, a4
v_accvgpr_read_b32 v13, a5
v_accvgpr_read_b32 v14, a6
v_accvgpr_read_b32 v15, a7
v_mul_f32 v12, v12, v10
v_mul_f32 v13, v13, v10
v_mul_f32 v14, v14, v10
v_mul_f32 v15, v15, v10
v_accvgpr_write_b32 a4, v12
v_accvgpr_write_b32 a5, v13
v_accvgpr_write_b32 a6, v14
v_accvgpr_write_b32 a7, v15
v_accvgpr_read_b32 v12, a8
v_accvgpr_read_b32 v13, a9
v_accvgpr_read_b32 v14, a10
v_accvgpr_read_b32 v15, a11
v_mul_f32 v12, v12, v10
v_mul_f32 v13, v13, v10
v_mul_f32 v14, v14, v10
v_mul_f32 v15, v15, v10
v_accvgpr_write_b32 a8, v12
v_accvgpr_write_b32 a9, v13
v_accvgpr_write_b32 a10, v14
v_accvgpr_write_b32 a11, v15
v_accvgpr_read_b32 v12, a12
v_accvgpr_read_b32 v13, a13
v_accvgpr_read_b32 v14, a14
v_accvgpr_read_b32 v15, a15
v_mul_f32 v12, v12, v10
v_mul_f32 v13, v13, v10
v_mul_f32 v14, v14, v10
v_mul_f32 v15, v15, v10
v_accvgpr_write_b32 a12, v12
v_accvgpr_write_b32 a13, v13
v_accvgpr_write_b32 a14, v14
v_accvgpr_write_b32 a15, v15
v_accvgpr_read_b32 v12, a16
v_accvgpr_read_b32 v13, a17
v_accvgpr_read_b32 v14, a18
v_accvgpr_read_b32 v15, a19
v_mul_f32 v12, v12, v10
v_mul_f32 v13, v13, v10
v_mul_f32 v14, v14, v10
v_mul_f32 v15, v15, v10
v_accvgpr_write_b32 a16, v12
v_accvgpr_write_b32 a17, v13
v_accvgpr_write_b32 a18, v14
v_accvgpr_write_b32 a19, v15
v_accvgpr_read_b32 v12, a20
v_accvgpr_read_b32 v13, a21
v_accvgpr_read_b32 v14, a22
v_accvgpr_read_b32 v15, a23
v_mul_f32 v12, v12, v10
v_mul_f32 v13, v13, v10
v_mul_f32 v14, v14, v10
v_mul_f32 v15, v15, v10
v_accvgpr_write_b32 a20, v12
v_accvgpr_write_b32 a21, v13
v_accvgpr_write_b32 a22, v14
v_accvgpr_write_b32 a23, v15
v_accvgpr_read_b32 v12, a24
v_accvgpr_read_b32 v13, a25
v_accvgpr_read_b32 v14, a26
v_accvgpr_read_b32 v15, a27
v_mul_f32 v12, v12, v10
v_mul_f32 v13, v13, v10
v_mul_f32 v14, v14, v10
v_mul_f32 v15, v15, v10
v_accvgpr_write_b32 a24, v12
v_accvgpr_write_b32 a25, v13
v_accvgpr_write_b32 a26, v14
v_accvgpr_write_b32 a27, v15
v_accvgpr_read_b32 v12, a28
v_accvgpr_read_b32 v13, a29
v_accvgpr_read_b32 v14, a30
v_accvgpr_read_b32 v15, a31
v_mul_f32 v12, v12, v10
v_mul_f32 v13, v13, v10
v_mul_f32 v14, v14, v10
v_mul_f32 v15, v15, v10
v_accvgpr_write_b32 a28, v12
v_accvgpr_write_b32 a29, v13
v_accvgpr_write_b32 a30, v14
v_accvgpr_write_b32 a31, v15
v_accvgpr_read_b32 v12, a32
v_accvgpr_read_b32 v13, a33
v_accvgpr_read_b32 v14, a34
v_accvgpr_read_b32 v15, a35
v_mul_f32 v12, v12, v10
v_mul_f32 v13, v13, v10
v_mul_f32 v14, v14, v10
v_mul_f32 v15, v15, v10
v_accvgpr_write_b32 a32, v12
v_accvgpr_write_b32 a33, v13
v_accvgpr_write_b32 a34, v14
v_accvgpr_write_b32 a35, v15
v_accvgpr_read_b32 v12, a36
v_accvgpr_read_b32 v13, a37
v_accvgpr_read_b32 v14, a38
v_accvgpr_read_b32 v15, a39
v_mul_f32 v12, v12, v10
v_mul_f32 v13, v13, v10
v_mul_f32 v14, v14, v10
v_mul_f32 v15, v15, v10
v_accvgpr_write_b32 a36, v12
v_accvgpr_write_b32 a37, v13
v_accvgpr_write_b32 a38, v14
v_accvgpr_write_b32 a39, v15
v_accvgpr_read_b32 v12, a40
v_accvgpr_read_b32 v13, a41
v_accvgpr_read_b32 v14, a42
v_accvgpr_read_b32 v15, a43
v_mul_f32 v12, v12, v10
v_mul_f32 v13, v13, v10
v_mul_f32 v14, v14, v10
v_mul_f32 v15, v15, v10
v_accvgpr_write_b32 a40, v12
v_accvgpr_write_b32 a41, v13
v_accvgpr_write_b32 a42, v14
v_accvgpr_write_b32 a43, v15
v_accvgpr_read_b32 v12, a44
v_accvgpr_read_b32 v13, a45
v_accvgpr_read_b32 v14, a46
v_accvgpr_read_b32 v15, a47
v_mul_f32 v12, v12, v10
v_mul_f32 v13, v13, v10
v_mul_f32 v14, v14, v10
v_mul_f32 v15, v15, v10
v_accvgpr_write_b32 a44, v12
v_accvgpr_write_b32 a45, v13
v_accvgpr_write_b32 a46, v14
v_accvgpr_write_b32 a47, v15
v_accvgpr_read_b32 v12, a48
v_accvgpr_read_b32 v13, a49
v_accvgpr_read_b32 v14, a50
v_accvgpr_read_b32 v15, a51
v_mul_f32 v12, v12, v10
v_mul_f32 v13, v13, v10
v_mul_f32 v14, v14, v10
v_mul_f32 v15, v15, v10
v_accvgpr_write_b32 a48, v12
v_accvgpr_write_b32 a49, v13
v_accvgpr_write_b32 a50, v14
v_accvgpr_write_b32 a51, v15
v_accvgpr_read_b32 v12, a52
v_accvgpr_read_b32 v13, a53
v_accvgpr_read_b32 v14, a54
v_accvgpr_read_b32 v15, a55
v_mul_f32 v12, v12, v10
v_mul_f32 v13, v13, v10
v_mul_f32 v14, v14, v10
v_mul_f32 v15, v15, v10
v_accvgpr_write_b32 a52, v12
v_accvgpr_write_b32 a53, v13
v_accvgpr_write_b32 a54, v14
v_accvgpr_write_b32 a55, v15
v_accvgpr_read_b32 v12, a56
v_accvgpr_read_b32 v13, a57
v_accvgpr_read_b32 v14, a58
v_accvgpr_read_b32 v15, a59
v_mul_f32 v12, v12, v10
v_mul_f32 v13, v13, v10
v_mul_f32 v14, v14, v10
v_mul_f32 v15, v15, v10
v_accvgpr_write_b32 a56, v12
v_accvgpr_write_b32 a57, v13
v_accvgpr_write_b32 a58, v14
v_accvgpr_write_b32 a59, v15
v_accvgpr_read_b32 v12, a60
v_accvgpr_read_b32 v13, a61
v_accvgpr_read_b32 v14, a62
v_accvgpr_read_b32 v15, a63
v_mul_f32 v12, v12, v10
v_mul_f32 v13, v13, v10
v_mul_f32 v14, v14, v10
v_mul_f32 v15, v15, v10
v_accvgpr_write_b32 a60, v12
v_accvgpr_write_b32 a61, v13
v_accvgpr_write_b32 a62, v14
v_accvgpr_write_b32 a63, v15
v_accvgpr_read_b32 v12, a64
v_accvgpr_read_b32 v13, a65
v_accvgpr_read_b32 v14, a66
v_accvgpr_read_b32 v15, a67
v_mul_f32 v12, v12, v10
v_mul_f32 v13, v13, v10
v_mul_f32 v14, v14, v10
v_mul_f32 v15, v15, v10
v_accvgpr_write_b32 a64, v12
v_accvgpr_write_b32 a65, v13
v_accvgpr_write_b32 a66, v14
v_accvgpr_write_b32 a67, v15
v_accvgpr_read_b32 v12, a68
v_accvgpr_read_b32 v13, a69
v_accvgpr_read_b32 v14, a70
v_accvgpr_read_b32 v15, a71
v_mul_f32 v12, v12, v10
v_mul_f32 v13, v13, v10
v_mul_f32 v14, v14, v10
v_mul_f32 v15, v15, v10
v_accvgpr_write_b32 a68, v12
v_accvgpr_write_b32 a69, v13
v_accvgpr_write_b32 a70, v14
v_accvgpr_write_b32 a71, v15
v_accvgpr_read_b32 v12, a72
v_accvgpr_read_b32 v13, a73
v_accvgpr_read_b32 v14, a74
v_accvgpr_read_b32 v15, a75
v_mul_f32 v12, v12, v10
v_mul_f32 v13, v13, v10
v_mul_f32 v14, v14, v10
v_mul_f32 v15, v15, v10
v_accvgpr_write_b32 a72, v12
v_accvgpr_write_b32 a73, v13
v_accvgpr_write_b32 a74, v14
v_accvgpr_write_b32 a75, v15
v_accvgpr_read_b32 v12, a76
v_accvgpr_read_b32 v13, a77
v_accvgpr_read_b32 v14, a78
v_accvgpr_read_b32 v15, a79
v_mul_f32 v12, v12, v10
v_mul_f32 v13, v13, v10
v_mul_f32 v14, v14, v10
v_mul_f32 v15, v15, v10
v_accvgpr_write_b32 a76, v12
v_accvgpr_write_b32 a77, v13
v_accvgpr_write_b32 a78, v14
v_accvgpr_write_b32 a79, v15
v_accvgpr_read_b32 v12, a80
v_accvgpr_read_b32 v13, a81
v_accvgpr_read_b32 v14, a82
v_accvgpr_read_b32 v15, a83
v_mul_f32 v12, v12, v10
v_mul_f32 v13, v13, v10
v_mul_f32 v14, v14, v10
v_mul_f32 v15, v15, v10
v_accvgpr_write_b32 a80, v12
v_accvgpr_write_b32 a81, v13
v_accvgpr_write_b32 a82, v14
v_accvgpr_write_b32 a83, v15
v_accvgpr_read_b32 v12, a84
v_accvgpr_read_b32 v13, a85
v_accvgpr_read_b32 v14, a86
v_accvgpr_read_b32 v15, a87
v_mul_f32 v12, v12, v10
v_mul_f32 v13, v13, v10
v_mul_f32 v14, v14, v10
v_mul_f32 v15, v15, v10
v_accvgpr_write_b32 a84, v12
v_accvgpr_write_b32 a85, v13
v_accvgpr_write_b32 a86, v14
v_accvgpr_write_b32 a87, v15
v_accvgpr_read_b32 v12, a88
v_accvgpr_read_b32 v13, a89
v_accvgpr_read_b32 v14, a90
v_accvgpr_read_b32 v15, a91
v_mul_f32 v12, v12, v10
v_mul_f32 v13, v13, v10
v_mul_f32 v14, v14, v10
v_mul_f32 v15, v15, v10
v_accvgpr_write_b32 a88, v12
v_accvgpr_write_b32 a89, v13
v_accvgpr_write_b32 a90, v14
v_accvgpr_write_b32 a91, v15
v_accvgpr_read_b32 v12, a92
v_accvgpr_read_b32 v13, a93
v_accvgpr_read_b32 v14, a94
v_accvgpr_read_b32 v15, a95
v_mul_f32 v12, v12, v10
v_mul_f32 v13, v13, v10
v_mul_f32 v14, v14, v10
v_mul_f32 v15, v15, v10
v_accvgpr_write_b32 a92, v12
v_accvgpr_write_b32 a93, v13
v_accvgpr_write_b32 a94, v14
v_accvgpr_write_b32 a95, v15
v_accvgpr_read_b32 v12, a96
v_accvgpr_read_b32 v13, a97
v_accvgpr_read_b32 v14, a98
v_accvgpr_read_b32 v15, a99
v_mul_f32 v12, v12, v10
v_mul_f32 v13, v13, v10
v_mul_f32 v14, v14, v10
v_mul_f32 v15, v15, v10
v_accvgpr_write_b32 a96, v12
v_accvgpr_write_b32 a97, v13
v_accvgpr_write_b32 a98, v14
v_accvgpr_write_b32 a99, v15
v_accvgpr_read_b32 v12, a100
v_accvgpr_read_b32 v13, a101
v_accvgpr_read_b32 v14, a102
v_accvgpr_read_b32 v15, a103
v_mul_f32 v12, v12, v10
v_mul_f32 v13, v13, v10
v_mul_f32 v14, v14, v10
v_mul_f32 v15, v15, v10
v_accvgpr_write_b32 a100, v12
v_accvgpr_write_b32 a101, v13
v_accvgpr_write_b32 a102, v14
v_accvgpr_write_b32 a103, v15
v_accvgpr_read_b32 v12, a104
v_accvgpr_read_b32 v13, a105
v_accvgpr_read_b32 v14, a106
v_accvgpr_read_b32 v15, a107
v_mul_f32 v12, v12, v10
v_mul_f32 v13, v13, v10
v_mul_f32 v14, v14, v10
v_mul_f32 v15, v15, v10
v_accvgpr_write_b32 a104, v12
v_accvgpr_write_b32 a105, v13
v_accvgpr_write_b32 a106, v14
v_accvgpr_write_b32 a107, v15
v_accvgpr_read_b32 v12, a108
v_accvgpr_read_b32 v13, a109
v_accvgpr_read_b32 v14, a110
v_accvgpr_read_b32 v15, a111
v_mul_f32 v12, v12, v10
v_mul_f32 v13, v13, v10
v_mul_f32 v14, v14, v10
v_mul_f32 v15, v15, v10
v_accvgpr_write_b32 a108, v12
v_accvgpr_write_b32 a109, v13
v_accvgpr_write_b32 a110, v14
v_accvgpr_write_b32 a111, v15
v_accvgpr_read_b32 v12, a112
v_accvgpr_read_b32 v13, a113
v_accvgpr_read_b32 v14, a114
v_accvgpr_read_b32 v15, a115
v_mul_f32 v12, v12, v10
v_mul_f32 v13, v13, v10
v_mul_f32 v14, v14, v10
v_mul_f32 v15, v15, v10
v_accvgpr_write_b32 a112, v12
v_accvgpr_write_b32 a113, v13
v_accvgpr_write_b32 a114, v14
v_accvgpr_write_b32 a115, v15
v_accvgpr_read_b32 v12, a116
v_accvgpr_read_b32 v13, a117
v_accvgpr_read_b32 v14, a118
v_accvgpr_read_b32 v15, a119
v_mul_f32 v12, v12, v10
v_mul_f32 v13, v13, v10
v_mul_f32 v14, v14, v10
v_mul_f32 v15, v15, v10
v_accvgpr_write_b32 a116, v12
v_accvgpr_write_b32 a117, v13
v_accvgpr_write_b32 a118, v14
v_accvgpr_write_b32 a119, v15
v_accvgpr_read_b32 v12, a120
v_accvgpr_read_b32 v13, a121
v_accvgpr_read_b32 v14, a122
v_accvgpr_read_b32 v15, a123
v_mul_f32 v12, v12, v10
v_mul_f32 v13, v13, v10
v_mul_f32 v14, v14, v10
v_mul_f32 v15, v15, v10
v_accvgpr_write_b32 a120, v12
v_accvgpr_write_b32 a121, v13
v_accvgpr_write_b32 a122, v14
v_accvgpr_write_b32 a123, v15
v_accvgpr_read_b32 v12, a124
v_accvgpr_read_b32 v13, a125
v_accvgpr_read_b32 v14, a126
v_accvgpr_read_b32 v15, a127
v_mul_f32 v12, v12, v10
v_mul_f32 v13, v13, v10
v_mul_f32 v14, v14, v10
v_mul_f32 v15, v15, v10
v_accvgpr_write_b32 a124, v12
v_accvgpr_write_b32 a125, v13
v_accvgpr_write_b32 a126, v14
v_accvgpr_write_b32 a127, v15
v_exp_f32 v80, v32
s_nop 0
v_exp_f32 v81, v33
s_nop 0
v_exp_f32 v82, v34
s_nop 0
v_exp_f32 v83, v35
s_nop 0
v_cvt_pk_bf16_f32 v72, v80, v81
s_nop 0
v_add_f32 v7, v80, v81
s_nop 0
v_exp_f32 v84, v36
s_nop 0
v_exp_f32 v85, v37
s_nop 0
v_cvt_pk_bf16_f32 v73, v82, v83
s_nop 0
v_add_f32 v15, v82, v83
s_nop 0
v_exp_f32 v86, v38
s_nop 0
v_exp_f32 v87, v39
s_nop 0
v_cvt_pk_bf16_f32 v74, v84, v85
s_nop 0
v_add_f32 v7, v7, v84
s_nop 0
v_add_f32 v15, v15, v85
s_nop 0
v_exp_f32 v88, v40
s_nop 0
v_exp_f32 v89, v41
s_nop 0
v_cvt_pk_bf16_f32 v75, v86, v87
s_nop 0
v_add_f32 v7, v7, v86
s_nop 0
v_add_f32 v15, v15, v87
s_nop 0
v_exp_f32 v90, v42
s_nop 0
v_exp_f32 v91, v43
s_nop 0
v_cvt_pk_bf16_f32 v76, v88, v89
s_nop 0
v_add_f32 v7, v7, v88
s_nop 0
v_add_f32 v15, v15, v89
s_nop 0
v_exp_f32 v92, v44
s_nop 0
v_exp_f32 v93, v45
s_nop 0
v_cvt_pk_bf16_f32 v77, v90, v91
s_nop 0
v_add_f32 v7, v7, v90
s_nop 0
v_add_f32 v15, v15, v91
s_nop 0
v_exp_f32 v94, v46
s_nop 0
v_exp_f32 v95, v47
s_nop 0
v_cvt_pk_bf16_f32 v78, v92, v93
s_nop 0
v_add_f32 v7, v7, v92
s_nop 0
v_add_f32 v15, v15, v93
s_nop 0
v_cvt_pk_bf16_f32 v79, v94, v95
s_nop 0
v_add_f32 v7, v7, v94
s_nop 0
v_add_f32 v15, v15, v95
s_nop 0
v_add_f32 v7, v7, v15
s_nop 0
s_nop 3
s_branch k2_rareret4
k2_poll:
s_mov_b32 s58, 0
k2_poll2:
buffer_load_dword v198, v199, s[4:7], s55 offen sc1
s_waitcnt vmcnt(0)
v_readfirstlane_b32 s57, v198
s_add_u32 s58, s58, 1
s_cmp_ge_u32 s58, 131072
s_cbranch_scc1 k2_pollend
s_cmp_eq_u32 s57, s101
s_cbranch_scc0 k2_poll2
s_branch k2_pollend
mix_end:
s_endpgm
.section .rodata,"a"
.p2align 6
.amdhsa_kernel gated_mix__compressed_kv_cla__dense_activation_relu__prompt_kernel
.amdhsa_next_free_vgpr 512
.amdhsa_next_free_sgpr 102
.amdhsa_accum_offset 256
.amdhsa_group_segment_fixed_size 0
.amdhsa_kernarg_size 104
.amdhsa_user_sgpr_count 2
.amdhsa_user_sgpr_kernarg_segment_ptr 1
.amdhsa_system_sgpr_workgroup_id_x 1
.amdhsa_float_denorm_mode_32 3
.end_amdhsa_kernel
.text
```
